```python
import torch

def _softmax(x, axis=-1):
    return torch.softmax(x, dim=axis)

def _gelu(x):
    return torch.nn.functional.gelu(x, approximate='tanh')

def _silu(x):
    return torch.nn.functional.silu(x)

def _sigmoid(x):
    return torch.sigmoid(x)

def _layernorm(x, axis=-1, eps=1e-05):
    m = x.mean(dim=axis, keepdim=True)
    v = x.var(dim=axis, keepdim=True, unbiased=False)
    return (x - m) / torch.sqrt(v + eps)

def _scatter_add(tgt, idx, src, axis=0):
    return tgt.clone().index_add_(axis, idx, src)

def _segment_sum(src, seg, n):
    out = torch.zeros((n,) + src.shape[1:], dtype=src.dtype)
    return out.index_add_(0, seg, src)

def _pad(x, pw):
    flat = tuple((v for pair in reversed(pw) for v in pair))
    return torch.nn.functional.pad(x, flat)
kernel_name = 'adaLN_cond__ssm_conv_s4d__mixer_s_mlp__prompt'

def setup_inputs():

    _w = lambda a: (lambda t: t.to(torch.bfloat16) if t.is_floating_point() else t)(torch.as_tensor(a))

    def _A_setup():
        Bsz, L, D, N = (1, 2048, 576, 128)
        return {'u': _w((lambda *s: torch.randn(*s, dtype=torch.bfloat16) * 0.05)(Bsz, L, D)), 'log_A_real': _w((lambda *s: torch.randn(*s, dtype=torch.bfloat16) * 3.2)(D, N) * 0.5), 'A_imag': _w((lambda *s: torch.randn(*s, dtype=torch.bfloat16) * 0.1)(D, N) * 3.14), 'C_real': _w((lambda *s: torch.randn(*s, dtype=torch.bfloat16) * 0.4)(D, N) / N ** 0.5), 'C_imag': _w((lambda *s: torch.randn(*s, dtype=torch.bfloat16) * 0.4)(D, N) / N ** 0.5), 'log_dt': _w((lambda *s: torch.randn(*s, dtype=torch.bfloat16) * 0.1)(D) * 0.5 - 4.0), 'D_skip': _w((lambda *s: torch.randn(*s, dtype=torch.bfloat16) * 0.1)(D))}
    _A_in = _A_setup()

    def _B_setup():
        B, S, D, F = (1, 2048, 576, 4608)
        return {'x': _w((lambda *s: torch.randn(*s, dtype=torch.bfloat16) * 0.05)(B, S, D)), 'w1': _w((lambda *s: torch.randn(*s, dtype=torch.bfloat16) * 3.2)(D, D) * D ** (-0.5)), 'w2': _w((lambda *s: torch.randn(*s, dtype=torch.bfloat16) * 3.2)(D, D) * D ** (-0.5)), 'w3': _w((lambda *s: torch.randn(*s, dtype=torch.bfloat16) * 3.2)(D, F) * D ** (-0.5)), 'w4': _w((lambda *s: torch.randn(*s, dtype=torch.bfloat16) * 3.2)(F, D) * F ** (-0.5))}
    _B_in = _B_setup()
    return {'A_u': _A_in['u'], 'A_log_A_real': _A_in['log_A_real'], 'A_A_imag': _A_in['A_imag'], 'A_C_real': _A_in['C_real'], 'A_C_imag': _A_in['C_imag'], 'A_log_dt': _A_in['log_dt'], 'A_D_skip': _A_in['D_skip'], 'B_x': _B_in['x'], 'B_w1': _B_in['w1'], 'B_w2': _B_in['w2'], 'B_w3': _B_in['w3'], 'B_w4': _B_in['w4'], 'c': _w((lambda *s: torch.randn(*s, dtype=torch.bfloat16) * 0.2)(1, 576) * 8.0), 'w_mod': _w((lambda *s: torch.randn(*s, dtype=torch.bfloat16) * 0.2)(576, 6 * 576) * 576 ** (-0.5) * 8.0)}

def reference(A_u, A_log_A_real, A_A_imag, A_C_real, A_C_imag, A_log_dt, A_D_skip, B_x, B_w1, B_w2, B_w3, B_w4, c, w_mod):

    def _A_ref(u, log_A_real, A_imag, C_real, C_imag, log_dt, D_skip):
        L = u.shape[1]
        dt = torch.exp(log_dt)
        A = -torch.exp(log_A_real) + 1j * A_imag
        C = (C_real + 1j * C_imag) * dt[:, None]
        pos = (lambda x, dt: x.to(dt))(torch.arange(L), log_dt.dtype)
        P = torch.exp((A * dt[:, None])[:, :, None] * pos[None, None, :])
        K = 2.0 * torch.einsum('dn,dnl->dl', C, P).real
        L2 = 2 * L
        u_t = (lambda x, *d: x.permute(*d))(u, 0, 2, 1)
        Kf = (lambda x, *a, **k: torch.fft.rfft(x.float(), *a, **k))(K, L2)
        Uf = (lambda x, *a, **k: torch.fft.rfft(x.float(), *a, **k))(u_t, L2)
        y = (lambda x, *a, **k: torch.fft.irfft(x, *a, **k).to(torch.bfloat16))(Uf * Kf[None, :, :], L2)[:, :, :L]
        y = (lambda x, *d: x.permute(*d))(y, 0, 2, 1)
        return y + u * D_skip[None, None, :]

    def _B_ref(x, w1, w2, w3, w4):
        B, S, D = x.shape
        h = _gelu(_layernorm(x, axis=-1) @ w1)
        c = D // 4
        g0 = _pad(h[:, :, 0 * c:1 * c], ((0, 0), (1, 0), (0, 0)))[:, :S, :]
        g1 = _pad(h[:, :, 1 * c:2 * c], ((0, 0), (0, 1), (0, 0)))[:, 1:, :]
        g2 = _pad(h[:, :, 2 * c:3 * c], ((0, 0), (2, 0), (0, 0)))[:, :S, :]
        g3 = _pad(h[:, :, 3 * c:], ((0, 0), (0, 2), (0, 0)))[:, 2:, :]
        hs = torch.concatenate([g0, g1, g2, g3], axis=-1) @ w2
        x1 = x + hs
        h2 = _gelu(_layernorm(x1, axis=-1) @ w3) @ w4
        return x1 + h2
    x = A_u
    mod = (_silu(c) @ w_mod).reshape(c.shape[0], 6, 1, -1)
    sa, ca, ga, sb, cb, gb = (mod[:, 0].clone(), mod[:, 1].clone(), mod[:, 2].clone(), mod[:, 3].clone(), mod[:, 4].clone(), mod[:, 5].clone())
    h = _layernorm(x, axis=-1) * (1 + ca) + sa
    x = x + ga * _A_ref(h, A_log_A_real, A_A_imag, A_C_real, A_C_imag, A_log_dt, A_D_skip)
    h = _layernorm(x, axis=-1) * (1 + cb) + sb
    x = x + gb * _B_ref(h, B_w1, B_w2, B_w3, B_w4)
    return x
```

```asm
; @launch grid=(256,1,1) block=(256,1,1) lds=163840
.amdgcn_target "amdgcn-amd-amdhsa--gfx950"
.text
.globl adaLN_cond__ssm_conv_s4d__mixer_s_mlp__prompt_kernel
.p2align 8
.type adaLN_cond__ssm_conv_s4d__mixer_s_mlp__prompt_kernel,@function
adaLN_cond__ssm_conv_s4d__mixer_s_mlp__prompt_kernel:
    s_cmp_ge_u32 s2, 256
    s_cbranch_scc1 exit
k1_top:
    s_load_dwordx16 s[4:19], s[0:1], 0
    s_load_dwordx16 s[20:35], s[0:1], 64
    s_load_dwordx2 s[36:37], s[0:1], 128
    s_getpc_b64 s[38:39]
pc_here:
    s_cmp_ge_u32 s2, 112
    s_cselect_b32 vcc_lo, 0, k1_service-pc_here
    s_add_u32 s38, s38, vcc_lo
    s_addc_u32 s39, s39, 0
    v_lshlrev_b32 v2, 7, v0
    v_min_u32 v2, code_end-k1_service-4, v2
    global_load_dword v3, v2, s[38:39]
    v_lshrrev_b32 v1, 6, v0
    s_nop 0
    v_readfirstlane_b32 s3, v1
    v_and_b32 v1, 63, v0
    s_waitcnt lgkmcnt(0)
    s_cmp_lt_u32 s2, 112
    s_cbranch_scc1 k1_service
k1_conv:
    s_and_b32 s40, s2, 7
    s_mul_i32 s40, s40, 18
    s_lshr_b32 s42, s2, 3
    s_add_u32 s40, s40, s42
    s_sub_u32 s40, s40, 14
    s_lshl_b32 s41, s40, 2
    s_add_u32 s41, s41, s3
    s_lshl_b32 s42, s40, 3
    s_load_dwordx2 s[46:47], s[14:15], s42
    s_load_dwordx2 s[48:49], s[16:17], s42
    v_lshlrev_b32 v8, 2, v1
    s_lshl_b32 s43, s41, 8
    s_mov_b32 s52, s6
    s_mov_b32 s53, s7
    s_mov_b32 s54, 147456
    s_mov_b32 s55, 0x20000
    buffer_load_dword v4, v8, s[52:55], s43 offen
    s_mov_b32 s52, s8
    s_mov_b32 s53, s9
    s_mov_b32 s54, 147456
    s_mov_b32 s55, 0x20000
    buffer_load_dword v5, v8, s[52:55], s43 offen
    s_mov_b32 s52, s10
    s_mov_b32 s53, s11
    s_mov_b32 s54, 147456
    s_mov_b32 s55, 0x20000
    buffer_load_dword v6, v8, s[52:55], s43 offen
    s_mov_b32 s52, s12
    s_mov_b32 s53, s13
    s_mov_b32 s54, 147456
    s_mov_b32 s55, 0x20000
    buffer_load_dword v7, v8, s[52:55], s43 offen
    s_mov_b32 s56, s36
    s_mov_b32 s57, s37
    s_mov_b32 s58, 67108864
    s_mov_b32 s59, 0x20000
    s_mov_b32 s60, s34
    s_mov_b32 s61, s35
    s_mov_b32 s62, 256
    s_mov_b32 s63, 0x20000
    s_mul_i32 s50, s3, 19072
    v_lshrrev_b32 v32, 4, v1
    v_and_b32 v33, 15, v1
    s_add_u32 s43, s50, -16638
    v_mov_b32 v37, s43
    v_lshlrev_b32 v10, 3, v1
    v_cvt_f32_u32 v10, v10
    v_add_f32 v12, 0x00000000, v10
    v_add_f32 v13, 0x3f800000, v10
    v_cvt_pk_bf16_f32 v12, v12, v13
    v_mad_u32_u16 v40, v12, 2, v37
    v_mad_u32_u16 v41, v12, 2, v37 op_sel:[1,0,0,0]
    v_add_f32 v12, 0x40000000, v10
    v_add_f32 v13, 0x40400000, v10
    v_cvt_pk_bf16_f32 v12, v12, v13
    v_mad_u32_u16 v42, v12, 2, v37
    v_mad_u32_u16 v43, v12, 2, v37 op_sel:[1,0,0,0]
    v_add_f32 v12, 0x40800000, v10
    v_add_f32 v13, 0x40a00000, v10
    v_cvt_pk_bf16_f32 v12, v12, v13
    v_mad_u32_u16 v44, v12, 2, v37
    v_mad_u32_u16 v45, v12, 2, v37 op_sel:[1,0,0,0]
    v_add_f32 v12, 0x40c00000, v10
    v_add_f32 v13, 0x40e00000, v10
    v_cvt_pk_bf16_f32 v12, v12, v13
    v_mad_u32_u16 v46, v12, 2, v37
    v_mad_u32_u16 v47, v12, 2, v37 op_sel:[1,0,0,0]
    v_add_f32 v12, 0x44000000, v10
    v_add_f32 v13, 0x44004000, v10
    v_cvt_pk_bf16_f32 v12, v12, v13
    v_mad_u32_u16 v48, v12, 2, v37
    v_mad_u32_u16 v49, v12, 2, v37 op_sel:[1,0,0,0]
    v_add_f32 v12, 0x44008000, v10
    v_add_f32 v13, 0x4400c000, v10
    v_cvt_pk_bf16_f32 v12, v12, v13
    v_mad_u32_u16 v50, v12, 2, v37
    v_mad_u32_u16 v51, v12, 2, v37 op_sel:[1,0,0,0]
    v_add_f32 v12, 0x44010000, v10
    v_add_f32 v13, 0x44014000, v10
    v_cvt_pk_bf16_f32 v12, v12, v13
    v_mad_u32_u16 v52, v12, 2, v37
    v_mad_u32_u16 v53, v12, 2, v37 op_sel:[1,0,0,0]
    v_add_f32 v12, 0x44018000, v10
    v_add_f32 v13, 0x4401c000, v10
    v_cvt_pk_bf16_f32 v12, v12, v13
    v_mad_u32_u16 v54, v12, 2, v37
    v_mad_u32_u16 v55, v12, 2, v37 op_sel:[1,0,0,0]
    s_add_u32 s43, s50, 17410
    v_lshl_add_u32 v12, v1, 4, s43
    v_cmp_gt_u32 vcc, 16, v1
    v_add_u32 v13, 0, v12
    s_nop 0
    v_cndmask_b32 v40, v40, v13, vcc
    v_add_u32 v13, 2, v12
    v_cndmask_b32 v41, v41, v13, vcc
    v_add_u32 v13, 4, v12
    v_cndmask_b32 v42, v42, v13, vcc
    v_add_u32 v13, 6, v12
    v_cndmask_b32 v43, v43, v13, vcc
    v_add_u32 v13, 8, v12
    v_cndmask_b32 v44, v44, v13, vcc
    v_add_u32 v13, 10, v12
    v_cndmask_b32 v45, v45, v13, vcc
    v_add_u32 v13, 12, v12
    v_cndmask_b32 v46, v46, v13, vcc
    v_add_u32 v13, 14, v12
    v_cndmask_b32 v47, v47, v13, vcc
    v_lshlrev_b32 v10, 2, v33
    s_mov_b32 s44, 1985229328
    s_mov_b32 s45, 4275878552
    v_lshrrev_b64 v[12:13], v10, s[44:45]
    v_and_b32 v12, 15, v12
    v_lshl_add_u32 v12, v32, 6, v12
    s_add_u32 s43, s50, 17410
    v_lshl_add_u32 v72, v12, 1, s43
    s_mov_b32 s44, 3013775744
    s_mov_b32 s45, 4159100356
    v_lshrrev_b64 v[12:13], v10, s[44:45]
    v_and_b32 v12, 15, v12
    v_lshl_add_u32 v12, v32, 6, v12
    s_add_u32 s43, s50, 17922
    v_lshl_add_u32 v73, v12, 1, s43
    s_mov_b32 s44, 3125909568
    s_mov_b32 s45, 4269005922
    v_lshrrev_b64 v[12:13], v10, s[44:45]
    v_and_b32 v12, 15, v12
    v_lshl_add_u32 v12, v32, 6, v12
    s_add_u32 s43, s50, 18178
    v_lshl_add_u32 v74, v12, 1, s43
    s_mov_b32 s44, 3047785504
    s_mov_b32 s45, 4159555121
    v_lshrrev_b64 v[12:13], v10, s[44:45]
    v_and_b32 v12, 15, v12
    v_lshl_add_u32 v12, v32, 6, v12
    s_add_u32 s43, s50, 18434
    v_lshl_add_u32 v75, v12, 1, s43
    v_lshl_add_u32 v37, v1, 3, s50
    v_mul_u32_u24 v76, 544, v33
    v_lshl_add_u32 v76, v32, 4, v76
    v_add_u32 v76, s50, v76
    v_mov_b32 v78, 0
    v_mov_b32 v79, 0
    v_mov_b32 v80, 0
    v_mov_b32 v81, 0
    v_lshrrev_b32 v12, 5, v0
    v_mul_u32_u24 v12, 4608, v12
    v_and_b32 v13, 31, v0
    v_lshl_add_u32 v12, v13, 4, v12
    v_add_u32 v12, 76288, v12
    v_cmp_gt_u32 vcc, 128, v0
    s_nop 0
    s_and_saveexec_b64 s[44:45], vcc
    ds_write_b128 v12, v[78:81]
    s_mov_b64 exec, s[44:45]
    s_waitcnt lgkmcnt(0)
    s_lshl_b32 s43, s3, 4
    s_lshr_b64 s[46:47], s[46:47], s43
    s_lshl_b32 s46, s46, 16
    v_mov_b32 v77, 0x3fb8aa3b
    v_mul_f32 v77, s46, v77
    v_exp_f32 v77, v77
    s_nop 0
    v_cvt_pk_bf16_f32 v77, v77, v77
    v_and_b32 v77, 0xffff0000, v77
    s_waitcnt vmcnt(0)
    v_lshlrev_b32 v96, 16, v4
    v_lshlrev_b32 v98, 16, v5
    v_lshlrev_b32 v92, 16, v6
    v_lshlrev_b32 v94, 16, v7
    v_and_b32 v97, 0xffff0000, v4
    v_and_b32 v99, 0xffff0000, v5
    v_and_b32 v93, 0xffff0000, v6
    v_and_b32 v95, 0xffff0000, v7
    v_mul_f32 v96, 0x3fb8aa3b, v96
    v_mul_f32 v97, 0x3fb8aa3b, v97
    v_exp_f32 v96, v96
    v_exp_f32 v97, v97
    v_max3_f32 v8, |v92|, |v93|, |v94|
    v_max_f32 v8, |v95|, v8
    v_cvt_pk_bf16_f32 v9, v96, v97
    s_nop 0
    v_max_f32_dpp v8, v8, v8 quad_perm:[1,0,3,2] row_mask:0xf bank_mask:0xf
    s_nop 1
    v_max_f32_dpp v8, v8, v8 quad_perm:[2,3,0,1] row_mask:0xf bank_mask:0xf
    s_nop 1
    v_max_f32_dpp v8, v8, v8 row_half_mirror row_mask:0xf bank_mask:0xf
    s_nop 1
    v_max_f32_dpp v8, v8, v8 row_mirror row_mask:0xf bank_mask:0xf
    v_lshlrev_b32 v96, 16, v9
    v_mul_f32 v96, v96, v77
    v_mul_f32 v98, v98, v77
    v_mul_f32 v96, 0xbfb8aa3b, v96
    v_mul_f32 v98, 0.15915494, v98
    v_and_b32 v97, 0xffff0000, v9
    v_mul_f32 v97, v97, v77
    v_mul_f32 v99, v99, v77
    v_mul_f32 v97, 0xbfb8aa3b, v97
    v_mul_f32 v99, 0.15915494, v99
    v_readlane_b32 s43, v8, 0
    v_readlane_b32 s44, v8, 16
    v_readlane_b32 s45, v8, 32
    v_readlane_b32 s42, v8, 48
    s_max_u32 s43, s43, s44
    s_max_u32 s42, s42, s45
    s_max_u32 s43, s43, s42
    v_fract_f32 v12, v98
    v_exp_f32 v10, v96
    v_cos_f32 v84, v12
    v_sin_f32 v86, v12
    v_fract_f32 v13, v99
    v_exp_f32 v11, v97
    v_cos_f32 v85, v13
    v_sin_f32 v87, v13
    v_pk_mul_f32 v[84:85], v[84:85], v[10:11]
    v_pk_mul_f32 v[86:87], v[86:87], v[10:11]
    v_mul_f32 v10, 0x41800000, v96
    v_mul_f32 v12, 0x41800000, v98
    v_fract_f32 v12, v12
    v_exp_f32 v10, v10
    v_cos_f32 v88, v12
    v_sin_f32 v90, v12
    v_mul_f32 v11, 0x41800000, v97
    v_mul_f32 v13, 0x41800000, v99
    v_fract_f32 v13, v13
    v_exp_f32 v11, v11
    v_cos_f32 v89, v13
    v_sin_f32 v91, v13
    v_pk_mul_f32 v[88:89], v[88:89], v[10:11]
    v_pk_mul_f32 v[90:91], v[90:91], v[10:11]
    v_frexp_exp_i32_f32 v8, s43
    v_sub_u32 v9, 8, v8
    v_add_u32 v8, -7, v8
    v_ldexp_f32 v82, v77, v8
    v_ldexp_f32 v92, v92, v9
    v_ldexp_f32 v94, v94, v9
    v_ldexp_f32 v93, v93, v9
    v_ldexp_f32 v95, v95, v9
    v_pk_mul_f32 v[96:97], v[90:91], v[90:91]
    v_pk_mul_f32 v[98:99], v[88:89], v[90:91]
    v_pk_fma_f32 v[104:105], v[88:89], v[88:89], v[96:97] neg_lo:[0,0,1] neg_hi:[0,0,1]
    v_pk_fma_f32 v[106:107], v[90:91], v[88:89], v[98:99]
    v_pk_mul_f32 v[96:97], v[106:107], v[106:107]
    v_pk_mul_f32 v[98:99], v[104:105], v[106:107]
    v_pk_fma_f32 v[108:109], v[104:105], v[104:105], v[96:97] neg_lo:[0,0,1] neg_hi:[0,0,1]
    v_pk_fma_f32 v[110:111], v[106:107], v[104:105], v[98:99]
    v_pk_mul_f32 v[96:97], v[110:111], v[110:111]
    v_pk_mul_f32 v[98:99], v[108:109], v[110:111]
    v_pk_fma_f32 v[112:113], v[108:109], v[108:109], v[96:97] neg_lo:[0,0,1] neg_hi:[0,0,1]
    v_pk_fma_f32 v[114:115], v[110:111], v[108:109], v[98:99]
    v_mov_b32 v132, 0x3c00
    v_cvt_pk_f16_f32 v136, v92, -v94
    v_mov_b32 v133, 0x3c00
    v_cvt_pk_f16_f32 v137, v93, -v95
    ds_write_b64 v37, v[132:133] offset:0
    ds_write_b64 v37, v[136:137] offset:8704
    v_cvt_pk_f16_f32 v134, v84, v86
    v_pk_mul_f32 v[100:101], v[94:95], v[90:91]
    v_cvt_pk_f16_f32 v135, v85, v87
    v_pk_mul_f32 v[102:103], v[92:93], v[90:91]
    ds_write_b64 v37, v[134:135] offset:544
    v_pk_fma_f32 v[92:93], v[92:93], v[88:89], v[100:101] neg_lo:[0,0,1] neg_hi:[0,0,1]
    v_pk_mul_f32 v[96:97], v[86:87], v[86:87]
    v_pk_fma_f32 v[94:95], v[94:95], v[88:89], v[102:103]
    v_pk_mul_f32 v[98:99], v[84:85], v[86:87]
    v_cvt_pk_f16_f32 v138, v92, -v94
    v_pk_fma_f32 v[116:117], v[84:85], v[84:85], v[96:97] neg_lo:[0,0,1] neg_hi:[0,0,1]
    v_cvt_pk_f16_f32 v139, v93, -v95
    v_pk_fma_f32 v[118:119], v[86:87], v[84:85], v[98:99]
    ds_write_b64 v37, v[138:139] offset:9248
    v_cvt_pk_f16_f32 v132, v116, v118
    v_pk_mul_f32 v[100:101], v[94:95], v[90:91]
    v_cvt_pk_f16_f32 v133, v117, v119
    v_pk_mul_f32 v[102:103], v[92:93], v[90:91]
    ds_write_b64 v37, v[132:133] offset:1088
    v_pk_fma_f32 v[92:93], v[92:93], v[88:89], v[100:101] neg_lo:[0,0,1] neg_hi:[0,0,1]
    v_pk_mul_f32 v[96:97], v[118:119], v[86:87]
    v_pk_fma_f32 v[94:95], v[94:95], v[88:89], v[102:103]
    v_pk_mul_f32 v[98:99], v[116:117], v[86:87]
    v_cvt_pk_f16_f32 v136, v92, -v94
    v_pk_fma_f32 v[128:129], v[116:117], v[84:85], v[96:97] neg_lo:[0,0,1] neg_hi:[0,0,1]
    v_cvt_pk_f16_f32 v137, v93, -v95
    v_pk_fma_f32 v[130:131], v[118:119], v[84:85], v[98:99]
    ds_write_b64 v37, v[136:137] offset:9792
    v_cvt_pk_f16_f32 v134, v128, v130
    v_pk_mul_f32 v[100:101], v[94:95], v[90:91]
    v_cvt_pk_f16_f32 v135, v129, v131
    v_pk_mul_f32 v[102:103], v[92:93], v[90:91]
    ds_write_b64 v37, v[134:135] offset:1632
    v_pk_fma_f32 v[92:93], v[92:93], v[88:89], v[100:101] neg_lo:[0,0,1] neg_hi:[0,0,1]
    v_pk_mul_f32 v[96:97], v[130:131], v[86:87]
    v_pk_fma_f32 v[94:95], v[94:95], v[88:89], v[102:103]
    v_pk_mul_f32 v[98:99], v[128:129], v[86:87]
    v_cvt_pk_f16_f32 v138, v92, -v94
    v_pk_fma_f32 v[120:121], v[128:129], v[84:85], v[96:97] neg_lo:[0,0,1] neg_hi:[0,0,1]
    v_cvt_pk_f16_f32 v139, v93, -v95
    v_pk_fma_f32 v[122:123], v[130:131], v[84:85], v[98:99]
    ds_write_b64 v37, v[138:139] offset:10336
    v_cvt_pk_f16_f32 v132, v120, v122
    v_pk_mul_f32 v[100:101], v[94:95], v[90:91]
    v_cvt_pk_f16_f32 v133, v121, v123
    v_pk_mul_f32 v[102:103], v[92:93], v[90:91]
    ds_write_b64 v37, v[132:133] offset:2176
    v_pk_fma_f32 v[92:93], v[92:93], v[88:89], v[100:101] neg_lo:[0,0,1] neg_hi:[0,0,1]
    v_pk_mul_f32 v[96:97], v[122:123], v[86:87]
    v_pk_fma_f32 v[94:95], v[94:95], v[88:89], v[102:103]
    v_pk_mul_f32 v[98:99], v[120:121], v[86:87]
    v_cvt_pk_f16_f32 v136, v92, -v94
    v_pk_fma_f32 v[128:129], v[120:121], v[84:85], v[96:97] neg_lo:[0,0,1] neg_hi:[0,0,1]
    v_cvt_pk_f16_f32 v137, v93, -v95
    v_pk_fma_f32 v[130:131], v[122:123], v[84:85], v[98:99]
    ds_write_b64 v37, v[136:137] offset:10880
    v_cvt_pk_f16_f32 v134, v128, v130
    v_pk_mul_f32 v[100:101], v[94:95], v[90:91]
    v_cvt_pk_f16_f32 v135, v129, v131
    v_pk_mul_f32 v[102:103], v[92:93], v[90:91]
    ds_write_b64 v37, v[134:135] offset:2720
    v_pk_fma_f32 v[92:93], v[92:93], v[88:89], v[100:101] neg_lo:[0,0,1] neg_hi:[0,0,1]
    v_pk_mul_f32 v[96:97], v[130:131], v[86:87]
    v_pk_fma_f32 v[94:95], v[94:95], v[88:89], v[102:103]
    v_pk_mul_f32 v[98:99], v[128:129], v[86:87]
    v_cvt_pk_f16_f32 v138, v92, -v94
    v_pk_fma_f32 v[128:129], v[128:129], v[84:85], v[96:97] neg_lo:[0,0,1] neg_hi:[0,0,1]
    v_cvt_pk_f16_f32 v139, v93, -v95
    v_pk_fma_f32 v[130:131], v[130:131], v[84:85], v[98:99]
    ds_write_b64 v37, v[138:139] offset:11424
    v_cvt_pk_f16_f32 v132, v128, v130
    v_pk_mul_f32 v[100:101], v[94:95], v[90:91]
    v_cvt_pk_f16_f32 v133, v129, v131
    v_pk_mul_f32 v[102:103], v[92:93], v[90:91]
    ds_write_b64 v37, v[132:133] offset:3264
    v_pk_fma_f32 v[92:93], v[92:93], v[88:89], v[100:101] neg_lo:[0,0,1] neg_hi:[0,0,1]
    v_pk_mul_f32 v[96:97], v[130:131], v[86:87]
    v_pk_fma_f32 v[94:95], v[94:95], v[88:89], v[102:103]
    v_pk_mul_f32 v[98:99], v[128:129], v[86:87]
    v_cvt_pk_f16_f32 v136, v92, -v94
    v_pk_fma_f32 v[128:129], v[128:129], v[84:85], v[96:97] neg_lo:[0,0,1] neg_hi:[0,0,1]
    v_cvt_pk_f16_f32 v137, v93, -v95
    v_pk_fma_f32 v[130:131], v[130:131], v[84:85], v[98:99]
    ds_write_b64 v37, v[136:137] offset:11968
    v_cvt_pk_f16_f32 v134, v128, v130
    v_pk_mul_f32 v[100:101], v[94:95], v[90:91]
    v_cvt_pk_f16_f32 v135, v129, v131
    v_pk_mul_f32 v[102:103], v[92:93], v[90:91]
    ds_write_b64 v37, v[134:135] offset:3808
    v_pk_fma_f32 v[92:93], v[92:93], v[88:89], v[100:101] neg_lo:[0,0,1] neg_hi:[0,0,1]
    v_pk_mul_f32 v[96:97], v[130:131], v[86:87]
    v_pk_fma_f32 v[94:95], v[94:95], v[88:89], v[102:103]
    v_pk_mul_f32 v[98:99], v[128:129], v[86:87]
    v_cvt_pk_f16_f32 v138, v92, -v94
    v_pk_fma_f32 v[124:125], v[128:129], v[84:85], v[96:97] neg_lo:[0,0,1] neg_hi:[0,0,1]
    v_cvt_pk_f16_f32 v139, v93, -v95
    v_pk_fma_f32 v[126:127], v[130:131], v[84:85], v[98:99]
    ds_write_b64 v37, v[138:139] offset:12512
    v_cvt_pk_f16_f32 v132, v124, v126
    v_pk_mul_f32 v[100:101], v[94:95], v[90:91]
    v_cvt_pk_f16_f32 v133, v125, v127
    v_pk_mul_f32 v[102:103], v[92:93], v[90:91]
    ds_write_b64 v37, v[132:133] offset:4352
    v_pk_fma_f32 v[92:93], v[92:93], v[88:89], v[100:101] neg_lo:[0,0,1] neg_hi:[0,0,1]
    v_pk_mul_f32 v[96:97], v[126:127], v[86:87]
    v_pk_fma_f32 v[94:95], v[94:95], v[88:89], v[102:103]
    v_pk_mul_f32 v[98:99], v[124:125], v[86:87]
    v_cvt_pk_f16_f32 v136, v92, -v94
    v_pk_fma_f32 v[128:129], v[124:125], v[84:85], v[96:97] neg_lo:[0,0,1] neg_hi:[0,0,1]
    v_cvt_pk_f16_f32 v137, v93, -v95
    v_pk_fma_f32 v[130:131], v[126:127], v[84:85], v[98:99]
    ds_write_b64 v37, v[136:137] offset:13056
    v_cvt_pk_f16_f32 v134, v128, v130
    v_pk_mul_f32 v[100:101], v[94:95], v[90:91]
    v_cvt_pk_f16_f32 v135, v129, v131
    v_pk_mul_f32 v[102:103], v[92:93], v[90:91]
    ds_write_b64 v37, v[134:135] offset:4896
    v_pk_fma_f32 v[92:93], v[92:93], v[88:89], v[100:101] neg_lo:[0,0,1] neg_hi:[0,0,1]
    v_pk_mul_f32 v[96:97], v[130:131], v[86:87]
    v_pk_fma_f32 v[94:95], v[94:95], v[88:89], v[102:103]
    v_pk_mul_f32 v[98:99], v[128:129], v[86:87]
    v_cvt_pk_f16_f32 v138, v92, -v94
    v_pk_fma_f32 v[128:129], v[128:129], v[84:85], v[96:97] neg_lo:[0,0,1] neg_hi:[0,0,1]
    v_cvt_pk_f16_f32 v139, v93, -v95
    v_pk_fma_f32 v[130:131], v[130:131], v[84:85], v[98:99]
    ds_write_b64 v37, v[138:139] offset:13600
    v_cvt_pk_f16_f32 v132, v128, v130
    v_pk_mul_f32 v[100:101], v[94:95], v[90:91]
    v_cvt_pk_f16_f32 v133, v129, v131
    v_pk_mul_f32 v[102:103], v[92:93], v[90:91]
    ds_write_b64 v37, v[132:133] offset:5440
    v_pk_fma_f32 v[92:93], v[92:93], v[88:89], v[100:101] neg_lo:[0,0,1] neg_hi:[0,0,1]
    v_pk_mul_f32 v[96:97], v[130:131], v[86:87]
    v_pk_fma_f32 v[94:95], v[94:95], v[88:89], v[102:103]
    v_pk_mul_f32 v[98:99], v[128:129], v[86:87]
    v_cvt_pk_f16_f32 v136, v92, -v94
    v_pk_fma_f32 v[128:129], v[128:129], v[84:85], v[96:97] neg_lo:[0,0,1] neg_hi:[0,0,1]
    v_cvt_pk_f16_f32 v137, v93, -v95
    v_pk_fma_f32 v[130:131], v[130:131], v[84:85], v[98:99]
    ds_write_b64 v37, v[136:137] offset:14144
    v_cvt_pk_f16_f32 v134, v128, v130
    v_pk_mul_f32 v[100:101], v[94:95], v[90:91]
    v_cvt_pk_f16_f32 v135, v129, v131
    v_pk_mul_f32 v[102:103], v[92:93], v[90:91]
    ds_write_b64 v37, v[134:135] offset:5984
    v_pk_fma_f32 v[92:93], v[92:93], v[88:89], v[100:101] neg_lo:[0,0,1] neg_hi:[0,0,1]
    v_pk_mul_f32 v[96:97], v[130:131], v[86:87]
    v_pk_fma_f32 v[94:95], v[94:95], v[88:89], v[102:103]
    v_pk_mul_f32 v[98:99], v[128:129], v[86:87]
    v_cvt_pk_f16_f32 v138, v92, -v94
    v_pk_fma_f32 v[128:129], v[128:129], v[84:85], v[96:97] neg_lo:[0,0,1] neg_hi:[0,0,1]
    v_cvt_pk_f16_f32 v139, v93, -v95
    v_pk_fma_f32 v[130:131], v[130:131], v[84:85], v[98:99]
    ds_write_b64 v37, v[138:139] offset:14688
    v_cvt_pk_f16_f32 v132, v128, v130
    v_pk_mul_f32 v[100:101], v[94:95], v[90:91]
    v_cvt_pk_f16_f32 v133, v129, v131
    v_pk_mul_f32 v[102:103], v[92:93], v[90:91]
    ds_write_b64 v37, v[132:133] offset:6528
    v_pk_fma_f32 v[92:93], v[92:93], v[88:89], v[100:101] neg_lo:[0,0,1] neg_hi:[0,0,1]
    v_pk_mul_f32 v[96:97], v[130:131], v[86:87]
    v_pk_fma_f32 v[94:95], v[94:95], v[88:89], v[102:103]
    v_pk_mul_f32 v[98:99], v[128:129], v[86:87]
    v_cvt_pk_f16_f32 v136, v92, -v94
    v_pk_fma_f32 v[128:129], v[128:129], v[84:85], v[96:97] neg_lo:[0,0,1] neg_hi:[0,0,1]
    v_cvt_pk_f16_f32 v137, v93, -v95
    v_pk_fma_f32 v[130:131], v[130:131], v[84:85], v[98:99]
    ds_write_b64 v37, v[136:137] offset:15232
    v_cvt_pk_f16_f32 v134, v128, v130
    v_pk_mul_f32 v[100:101], v[94:95], v[90:91]
    v_cvt_pk_f16_f32 v135, v129, v131
    v_pk_mul_f32 v[102:103], v[92:93], v[90:91]
    ds_write_b64 v37, v[134:135] offset:7072
    v_pk_fma_f32 v[92:93], v[92:93], v[88:89], v[100:101] neg_lo:[0,0,1] neg_hi:[0,0,1]
    v_pk_mul_f32 v[96:97], v[130:131], v[86:87]
    v_pk_fma_f32 v[94:95], v[94:95], v[88:89], v[102:103]
    v_pk_mul_f32 v[98:99], v[128:129], v[86:87]
    v_cvt_pk_f16_f32 v138, v92, -v94
    v_pk_fma_f32 v[128:129], v[128:129], v[84:85], v[96:97] neg_lo:[0,0,1] neg_hi:[0,0,1]
    v_cvt_pk_f16_f32 v139, v93, -v95
    v_pk_fma_f32 v[130:131], v[130:131], v[84:85], v[98:99]
    ds_write_b64 v37, v[138:139] offset:15776
    v_cvt_pk_f16_f32 v132, v128, v130
    v_pk_mul_f32 v[100:101], v[94:95], v[90:91]
    v_cvt_pk_f16_f32 v133, v129, v131
    v_pk_mul_f32 v[102:103], v[92:93], v[90:91]
    ds_write_b64 v37, v[132:133] offset:7616
    v_pk_fma_f32 v[92:93], v[92:93], v[88:89], v[100:101] neg_lo:[0,0,1] neg_hi:[0,0,1]
    v_pk_mul_f32 v[96:97], v[130:131], v[86:87]
    v_pk_fma_f32 v[94:95], v[94:95], v[88:89], v[102:103]
    v_pk_mul_f32 v[98:99], v[128:129], v[86:87]
    v_cvt_pk_f16_f32 v136, v92, -v94
    v_pk_fma_f32 v[128:129], v[128:129], v[84:85], v[96:97] neg_lo:[0,0,1] neg_hi:[0,0,1]
    v_cvt_pk_f16_f32 v137, v93, -v95
    v_pk_fma_f32 v[130:131], v[130:131], v[84:85], v[98:99]
    ds_write_b64 v37, v[136:137] offset:16320
    v_cvt_pk_f16_f32 v134, v128, v130
    v_pk_mul_f32 v[100:101], v[94:95], v[90:91]
    v_cvt_pk_f16_f32 v135, v129, v131
    v_pk_mul_f32 v[102:103], v[92:93], v[90:91]
    ds_write_b64 v37, v[134:135] offset:8160
    v_pk_fma_f32 v[92:93], v[92:93], v[88:89], v[100:101] neg_lo:[0,0,1] neg_hi:[0,0,1]
    v_pk_fma_f32 v[94:95], v[94:95], v[88:89], v[102:103]
    v_cvt_pk_f16_f32 v138, v92, -v94
    v_cvt_pk_f16_f32 v139, v93, -v95
    ds_write_b64 v37, v[138:139] offset:16864
    ds_read_b128 v[140:143], v76 offset:8704
    ds_read_b128 v[172:175], v76 offset:0
    ds_read_b128 v[144:147], v76 offset:8768
    ds_read_b128 v[176:179], v76 offset:64
    ds_read_b128 v[148:151], v76 offset:8832
    ds_read_b128 v[180:183], v76 offset:128
    ds_read_b128 v[152:155], v76 offset:8896
    ds_read_b128 v[184:187], v76 offset:192
    ds_read_b128 v[156:159], v76 offset:8960
    ds_read_b128 v[188:191], v76 offset:256
    ds_read_b128 v[160:163], v76 offset:9024
    ds_read_b128 v[192:195], v76 offset:320
    ds_read_b128 v[164:167], v76 offset:9088
    ds_read_b128 v[196:199], v76 offset:384
    ds_read_b128 v[168:171], v76 offset:9152
    ds_read_b128 v[200:203], v76 offset:448
    v_pk_mul_f32 v[96:97], v[130:131], v[86:87]
    v_pk_mul_f32 v[100:101], v[94:95], v[90:91]
    v_pk_mul_f32 v[98:99], v[128:129], v[86:87]
    v_pk_mul_f32 v[102:103], v[92:93], v[90:91]
    v_pk_fma_f32 v[128:129], v[128:129], v[84:85], v[96:97] neg_lo:[0,0,1] neg_hi:[0,0,1]
    v_pk_fma_f32 v[92:93], v[92:93], v[88:89], v[100:101] neg_lo:[0,0,1] neg_hi:[0,0,1]
    v_pk_fma_f32 v[130:131], v[130:131], v[84:85], v[98:99]
    v_pk_fma_f32 v[94:95], v[94:95], v[88:89], v[102:103]
    v_cvt_pk_f16_f32 v132, v128, v130
    v_cvt_pk_f16_f32 v136, v92, -v94
    v_cvt_pk_f16_f32 v133, v129, v131
    v_cvt_pk_f16_f32 v137, v93, -v95
    ds_write_b64 v37, v[132:133] offset:544
    ds_write_b64 v37, v[136:137] offset:8704
    v_pk_mul_f32 v[96:97], v[130:131], v[118:119]
    v_pk_mul_f32 v[100:101], v[94:95], v[106:107]
    v_pk_mul_f32 v[98:99], v[128:129], v[118:119]
    v_pk_mul_f32 v[102:103], v[92:93], v[106:107]
    v_pk_fma_f32 v[128:129], v[128:129], v[116:117], v[96:97] neg_lo:[0,0,1] neg_hi:[0,0,1]
    v_pk_fma_f32 v[92:93], v[92:93], v[104:105], v[100:101] neg_lo:[0,0,1] neg_hi:[0,0,1]
    v_pk_fma_f32 v[130:131], v[130:131], v[116:117], v[98:99]
    v_pk_fma_f32 v[94:95], v[94:95], v[104:105], v[102:103]
    v_cvt_pk_f16_f32 v134, v128, v130
    v_cvt_pk_f16_f32 v138, v92, -v94
    v_cvt_pk_f16_f32 v135, v129, v131
    v_cvt_pk_f16_f32 v139, v93, -v95
    ds_write_b64 v37, v[134:135] offset:1632
    ds_write_b64 v37, v[138:139] offset:9248
    s_waitcnt lgkmcnt(15)
    v_mfma_f32_16x16x32_f16 v[204:207], v[140:143], v[172:175], 0
    v_mfma_f32_16x16x32_f16 v[204:207], v[144:147], v[176:179], v[204:207]
    s_waitcnt lgkmcnt(14)
    v_mfma_f32_16x16x32_f16 v[204:207], v[148:151], v[180:183], v[204:207]
    s_waitcnt lgkmcnt(12)
    v_mfma_f32_16x16x32_f16 v[204:207], v[152:155], v[184:187], v[204:207]
    s_waitcnt lgkmcnt(10)
    v_mfma_f32_16x16x32_f16 v[204:207], v[156:159], v[188:191], v[204:207]
    s_waitcnt lgkmcnt(8)
    v_mfma_f32_16x16x32_f16 v[204:207], v[160:163], v[192:195], v[204:207]
    s_waitcnt lgkmcnt(6)
    v_mfma_f32_16x16x32_f16 v[204:207], v[164:167], v[196:199], v[204:207]
    s_waitcnt lgkmcnt(4)
    v_mfma_f32_16x16x32_f16 v[204:207], v[168:171], v[200:203], v[204:207]
    v_pk_mul_f32 v[96:97], v[130:131], v[118:119]
    v_pk_mul_f32 v[100:101], v[94:95], v[106:107]
    v_pk_mul_f32 v[98:99], v[128:129], v[118:119]
    v_pk_mul_f32 v[102:103], v[92:93], v[106:107]
    v_pk_fma_f32 v[128:129], v[128:129], v[116:117], v[96:97] neg_lo:[0,0,1] neg_hi:[0,0,1]
    v_pk_fma_f32 v[92:93], v[92:93], v[104:105], v[100:101] neg_lo:[0,0,1] neg_hi:[0,0,1]
    v_pk_fma_f32 v[130:131], v[130:131], v[116:117], v[98:99]
    v_pk_fma_f32 v[94:95], v[94:95], v[104:105], v[102:103]
    v_cvt_pk_f16_f32 v132, v128, v130
    v_cvt_pk_f16_f32 v136, v92, -v94
    v_cvt_pk_f16_f32 v133, v129, v131
    v_cvt_pk_f16_f32 v137, v93, -v95
    ds_write_b64 v37, v[132:133] offset:2720
    ds_write_b64 v37, v[136:137] offset:9792
    v_pk_mul_f32 v[96:97], v[130:131], v[118:119]
    v_pk_mul_f32 v[100:101], v[94:95], v[106:107]
    v_pk_mul_f32 v[98:99], v[128:129], v[118:119]
    v_pk_mul_f32 v[102:103], v[92:93], v[106:107]
    v_pk_fma_f32 v[128:129], v[128:129], v[116:117], v[96:97] neg_lo:[0,0,1] neg_hi:[0,0,1]
    v_pk_fma_f32 v[92:93], v[92:93], v[104:105], v[100:101] neg_lo:[0,0,1] neg_hi:[0,0,1]
    v_pk_fma_f32 v[130:131], v[130:131], v[116:117], v[98:99]
    v_pk_fma_f32 v[94:95], v[94:95], v[104:105], v[102:103]
    v_cvt_pk_f16_f32 v134, v128, v130
    v_cvt_pk_f16_f32 v138, v92, -v94
    v_cvt_pk_f16_f32 v135, v129, v131
    v_cvt_pk_f16_f32 v139, v93, -v95
    ds_write_b64 v37, v[134:135] offset:3808
    ds_write_b64 v37, v[138:139] offset:10336
    v_pk_mul_f32 v[96:97], v[130:131], v[118:119]
    v_pk_mul_f32 v[100:101], v[94:95], v[106:107]
    v_pk_mul_f32 v[98:99], v[128:129], v[118:119]
    v_pk_mul_f32 v[102:103], v[92:93], v[106:107]
    v_pk_fma_f32 v[128:129], v[128:129], v[116:117], v[96:97] neg_lo:[0,0,1] neg_hi:[0,0,1]
    v_pk_fma_f32 v[92:93], v[92:93], v[104:105], v[100:101] neg_lo:[0,0,1] neg_hi:[0,0,1]
    v_pk_fma_f32 v[130:131], v[130:131], v[116:117], v[98:99]
    v_pk_fma_f32 v[94:95], v[94:95], v[104:105], v[102:103]
    v_cvt_pk_f16_f32 v132, v128, v130
    v_cvt_pk_f16_f32 v136, v92, -v94
    v_cvt_pk_f16_f32 v133, v129, v131
    v_cvt_pk_f16_f32 v137, v93, -v95
    ds_write_b64 v37, v[132:133] offset:4896
    ds_write_b64 v37, v[136:137] offset:10880
    v_pk_mul_f32 v[96:97], v[130:131], v[118:119]
    v_pk_mul_f32 v[100:101], v[94:95], v[106:107]
    v_pk_mul_f32 v[98:99], v[128:129], v[118:119]
    v_pk_mul_f32 v[102:103], v[92:93], v[106:107]
    v_pk_fma_f32 v[128:129], v[128:129], v[116:117], v[96:97] neg_lo:[0,0,1] neg_hi:[0,0,1]
    v_pk_fma_f32 v[92:93], v[92:93], v[104:105], v[100:101] neg_lo:[0,0,1] neg_hi:[0,0,1]
    v_pk_fma_f32 v[130:131], v[130:131], v[116:117], v[98:99]
    v_pk_fma_f32 v[94:95], v[94:95], v[104:105], v[102:103]
    v_cvt_pk_f16_f32 v134, v128, v130
    v_cvt_pk_f16_f32 v138, v92, -v94
    v_cvt_pk_f16_f32 v135, v129, v131
    v_cvt_pk_f16_f32 v139, v93, -v95
    ds_write_b64 v37, v[134:135] offset:5984
    ds_write_b64 v37, v[138:139] offset:11424
    v_pk_mul_f32 v[96:97], v[130:131], v[118:119]
    v_pk_mul_f32 v[100:101], v[94:95], v[106:107]
    v_pk_mul_f32 v[98:99], v[128:129], v[118:119]
    v_pk_mul_f32 v[102:103], v[92:93], v[106:107]
    v_pk_fma_f32 v[128:129], v[128:129], v[116:117], v[96:97] neg_lo:[0,0,1] neg_hi:[0,0,1]
    v_pk_fma_f32 v[92:93], v[92:93], v[104:105], v[100:101] neg_lo:[0,0,1] neg_hi:[0,0,1]
    v_pk_fma_f32 v[130:131], v[130:131], v[116:117], v[98:99]
    v_pk_fma_f32 v[94:95], v[94:95], v[104:105], v[102:103]
    v_cvt_pk_f16_f32 v132, v128, v130
    v_cvt_pk_f16_f32 v136, v92, -v94
    v_cvt_pk_f16_f32 v133, v129, v131
    v_cvt_pk_f16_f32 v137, v93, -v95
    ds_write_b64 v37, v[132:133] offset:7072
    ds_write_b64 v37, v[136:137] offset:11968
    v_pk_mul_f32 v[96:97], v[130:131], v[118:119]
    v_pk_mul_f32 v[100:101], v[94:95], v[106:107]
    v_pk_mul_f32 v[98:99], v[128:129], v[118:119]
    v_pk_mul_f32 v[102:103], v[92:93], v[106:107]
    v_pk_fma_f32 v[128:129], v[128:129], v[116:117], v[96:97] neg_lo:[0,0,1] neg_hi:[0,0,1]
    v_pk_fma_f32 v[92:93], v[92:93], v[104:105], v[100:101] neg_lo:[0,0,1] neg_hi:[0,0,1]
    v_pk_fma_f32 v[130:131], v[130:131], v[116:117], v[98:99]
    v_pk_fma_f32 v[94:95], v[94:95], v[104:105], v[102:103]
    v_cvt_pk_f16_f32 v134, v128, v130
    v_cvt_pk_f16_f32 v138, v92, -v94
    v_cvt_pk_f16_f32 v135, v129, v131
    v_cvt_pk_f16_f32 v139, v93, -v95
    ds_write_b64 v37, v[134:135] offset:8160
    ds_write_b64 v37, v[138:139] offset:12512
    ds_read_b128 v[140:143], v76 offset:8704
    ds_read_b128 v[172:175], v76 offset:0
    ds_read_b128 v[144:147], v76 offset:8768
    ds_read_b128 v[176:179], v76 offset:64
    ds_read_b128 v[148:151], v76 offset:8832
    ds_read_b128 v[180:183], v76 offset:128
    ds_read_b128 v[152:155], v76 offset:8896
    ds_read_b128 v[184:187], v76 offset:192
    ds_read_b128 v[156:159], v76 offset:8960
    ds_read_b128 v[188:191], v76 offset:256
    ds_read_b128 v[160:163], v76 offset:9024
    ds_read_b128 v[192:195], v76 offset:320
    ds_read_b128 v[164:167], v76 offset:9088
    ds_read_b128 v[196:199], v76 offset:384
    ds_read_b128 v[168:171], v76 offset:9152
    ds_read_b128 v[200:203], v76 offset:448
    v_pk_mul_f32 v[96:97], v[130:131], v[118:119]
    v_pk_mul_f32 v[100:101], v[94:95], v[106:107]
    v_pk_mul_f32 v[98:99], v[128:129], v[118:119]
    v_pk_mul_f32 v[102:103], v[92:93], v[106:107]
    v_pk_fma_f32 v[128:129], v[128:129], v[116:117], v[96:97] neg_lo:[0,0,1] neg_hi:[0,0,1]
    v_pk_fma_f32 v[92:93], v[92:93], v[104:105], v[100:101] neg_lo:[0,0,1] neg_hi:[0,0,1]
    v_pk_fma_f32 v[130:131], v[130:131], v[116:117], v[98:99]
    v_pk_fma_f32 v[94:95], v[94:95], v[104:105], v[102:103]
    v_cvt_pk_f16_f32 v132, v128, v130
    v_cvt_pk_f16_f32 v136, v92, -v94
    v_cvt_pk_f16_f32 v133, v129, v131
    v_cvt_pk_f16_f32 v137, v93, -v95
    ds_write_b64 v37, v[132:133] offset:1088
    ds_write_b64 v37, v[136:137] offset:8704
    v_pk_mul_f32 v[96:97], v[130:131], v[122:123]
    v_pk_mul_f32 v[100:101], v[94:95], v[110:111]
    v_pk_mul_f32 v[98:99], v[128:129], v[122:123]
    v_pk_mul_f32 v[102:103], v[92:93], v[110:111]
    v_pk_fma_f32 v[128:129], v[128:129], v[120:121], v[96:97] neg_lo:[0,0,1] neg_hi:[0,0,1]
    v_pk_fma_f32 v[92:93], v[92:93], v[108:109], v[100:101] neg_lo:[0,0,1] neg_hi:[0,0,1]
    v_pk_fma_f32 v[130:131], v[130:131], v[120:121], v[98:99]
    v_pk_fma_f32 v[94:95], v[94:95], v[108:109], v[102:103]
    v_cvt_pk_f16_f32 v134, v128, v130
    v_cvt_pk_f16_f32 v138, v92, -v94
    v_cvt_pk_f16_f32 v135, v129, v131
    v_cvt_pk_f16_f32 v139, v93, -v95
    ds_write_b64 v37, v[134:135] offset:1632
    ds_write_b64 v37, v[138:139] offset:9248
    s_waitcnt lgkmcnt(15)
    v_mfma_f32_16x16x32_f16 v[208:211], v[140:143], v[172:175], 0
    v_mfma_f32_16x16x32_f16 v[208:211], v[144:147], v[176:179], v[208:211]
    s_waitcnt lgkmcnt(14)
    v_mfma_f32_16x16x32_f16 v[208:211], v[148:151], v[180:183], v[208:211]
    s_waitcnt lgkmcnt(12)
    v_mfma_f32_16x16x32_f16 v[208:211], v[152:155], v[184:187], v[208:211]
    s_waitcnt lgkmcnt(10)
    v_mfma_f32_16x16x32_f16 v[208:211], v[156:159], v[188:191], v[208:211]
    s_waitcnt lgkmcnt(8)
    v_mfma_f32_16x16x32_f16 v[208:211], v[160:163], v[192:195], v[208:211]
    s_waitcnt lgkmcnt(6)
    v_mfma_f32_16x16x32_f16 v[208:211], v[164:167], v[196:199], v[208:211]
    s_waitcnt lgkmcnt(4)
    v_mfma_f32_16x16x32_f16 v[208:211], v[168:171], v[200:203], v[208:211]
    v_pk_mul_f32 v[96:97], v[130:131], v[122:123]
    v_pk_mul_f32 v[100:101], v[94:95], v[110:111]
    v_pk_mul_f32 v[98:99], v[128:129], v[122:123]
    v_pk_mul_f32 v[102:103], v[92:93], v[110:111]
    v_pk_fma_f32 v[128:129], v[128:129], v[120:121], v[96:97] neg_lo:[0,0,1] neg_hi:[0,0,1]
    v_pk_fma_f32 v[92:93], v[92:93], v[108:109], v[100:101] neg_lo:[0,0,1] neg_hi:[0,0,1]
    v_pk_fma_f32 v[130:131], v[130:131], v[120:121], v[98:99]
    v_pk_fma_f32 v[94:95], v[94:95], v[108:109], v[102:103]
    v_cvt_pk_f16_f32 v132, v128, v130
    v_cvt_pk_f16_f32 v136, v92, -v94
    v_cvt_pk_f16_f32 v133, v129, v131
    v_cvt_pk_f16_f32 v137, v93, -v95
    ds_write_b64 v37, v[132:133] offset:3264
    ds_write_b64 v37, v[136:137] offset:9792
    v_pk_mul_f32 v[96:97], v[130:131], v[122:123]
    v_pk_mul_f32 v[100:101], v[94:95], v[110:111]
    v_pk_mul_f32 v[98:99], v[128:129], v[122:123]
    v_pk_mul_f32 v[102:103], v[92:93], v[110:111]
    v_pk_fma_f32 v[128:129], v[128:129], v[120:121], v[96:97] neg_lo:[0,0,1] neg_hi:[0,0,1]
    v_pk_fma_f32 v[92:93], v[92:93], v[108:109], v[100:101] neg_lo:[0,0,1] neg_hi:[0,0,1]
    v_pk_fma_f32 v[130:131], v[130:131], v[120:121], v[98:99]
    v_pk_fma_f32 v[94:95], v[94:95], v[108:109], v[102:103]
    v_cvt_pk_f16_f32 v134, v128, v130
    v_cvt_pk_f16_f32 v138, v92, -v94
    v_cvt_pk_f16_f32 v135, v129, v131
    v_cvt_pk_f16_f32 v139, v93, -v95
    ds_write_b64 v37, v[134:135] offset:3808
    ds_write_b64 v37, v[138:139] offset:10336
    v_pk_mul_f32 v[96:97], v[130:131], v[122:123]
    v_pk_mul_f32 v[100:101], v[94:95], v[110:111]
    v_pk_mul_f32 v[98:99], v[128:129], v[122:123]
    v_pk_mul_f32 v[102:103], v[92:93], v[110:111]
    v_pk_fma_f32 v[128:129], v[128:129], v[120:121], v[96:97] neg_lo:[0,0,1] neg_hi:[0,0,1]
    v_pk_fma_f32 v[92:93], v[92:93], v[108:109], v[100:101] neg_lo:[0,0,1] neg_hi:[0,0,1]
    v_pk_fma_f32 v[130:131], v[130:131], v[120:121], v[98:99]
    v_pk_fma_f32 v[94:95], v[94:95], v[108:109], v[102:103]
    v_cvt_pk_f16_f32 v132, v128, v130
    v_cvt_pk_f16_f32 v136, v92, -v94
    v_cvt_pk_f16_f32 v133, v129, v131
    v_cvt_pk_f16_f32 v137, v93, -v95
    ds_write_b64 v37, v[132:133] offset:5440
    ds_write_b64 v37, v[136:137] offset:10880
    v_pk_mul_f32 v[96:97], v[130:131], v[122:123]
    v_pk_mul_f32 v[100:101], v[94:95], v[110:111]
    v_pk_mul_f32 v[98:99], v[128:129], v[122:123]
    v_pk_mul_f32 v[102:103], v[92:93], v[110:111]
    v_pk_fma_f32 v[128:129], v[128:129], v[120:121], v[96:97] neg_lo:[0,0,1] neg_hi:[0,0,1]
    v_pk_fma_f32 v[92:93], v[92:93], v[108:109], v[100:101] neg_lo:[0,0,1] neg_hi:[0,0,1]
    v_pk_fma_f32 v[130:131], v[130:131], v[120:121], v[98:99]
    v_pk_fma_f32 v[94:95], v[94:95], v[108:109], v[102:103]
    v_cvt_pk_f16_f32 v134, v128, v130
    v_cvt_pk_f16_f32 v138, v92, -v94
    v_cvt_pk_f16_f32 v135, v129, v131
    v_cvt_pk_f16_f32 v139, v93, -v95
    ds_write_b64 v37, v[134:135] offset:5984
    ds_write_b64 v37, v[138:139] offset:11424
    v_pk_mul_f32 v[96:97], v[130:131], v[122:123]
    v_pk_mul_f32 v[100:101], v[94:95], v[110:111]
    v_pk_mul_f32 v[98:99], v[128:129], v[122:123]
    v_pk_mul_f32 v[102:103], v[92:93], v[110:111]
    v_pk_fma_f32 v[128:129], v[128:129], v[120:121], v[96:97] neg_lo:[0,0,1] neg_hi:[0,0,1]
    v_pk_fma_f32 v[92:93], v[92:93], v[108:109], v[100:101] neg_lo:[0,0,1] neg_hi:[0,0,1]
    v_pk_fma_f32 v[130:131], v[130:131], v[120:121], v[98:99]
    v_pk_fma_f32 v[94:95], v[94:95], v[108:109], v[102:103]
    v_cvt_pk_f16_f32 v132, v128, v130
    v_cvt_pk_f16_f32 v136, v92, -v94
    v_cvt_pk_f16_f32 v133, v129, v131
    v_cvt_pk_f16_f32 v137, v93, -v95
    ds_write_b64 v37, v[132:133] offset:7616
    ds_write_b64 v37, v[136:137] offset:11968
    v_pk_mul_f32 v[96:97], v[130:131], v[122:123]
    v_pk_mul_f32 v[100:101], v[94:95], v[110:111]
    v_pk_mul_f32 v[98:99], v[128:129], v[122:123]
    v_pk_mul_f32 v[102:103], v[92:93], v[110:111]
    v_pk_fma_f32 v[128:129], v[128:129], v[120:121], v[96:97] neg_lo:[0,0,1] neg_hi:[0,0,1]
    v_pk_fma_f32 v[92:93], v[92:93], v[108:109], v[100:101] neg_lo:[0,0,1] neg_hi:[0,0,1]
    v_pk_fma_f32 v[130:131], v[130:131], v[120:121], v[98:99]
    v_pk_fma_f32 v[94:95], v[94:95], v[108:109], v[102:103]
    v_cvt_pk_f16_f32 v134, v128, v130
    v_cvt_pk_f16_f32 v138, v92, -v94
    v_cvt_pk_f16_f32 v135, v129, v131
    v_cvt_pk_f16_f32 v139, v93, -v95
    ds_write_b64 v37, v[134:135] offset:8160
    ds_write_b64 v37, v[138:139] offset:12512
    ds_read_b128 v[140:143], v76 offset:8704
    ds_read_b128 v[172:175], v76 offset:0
    ds_read_b128 v[144:147], v76 offset:8768
    ds_read_b128 v[176:179], v76 offset:64
    ds_read_b128 v[148:151], v76 offset:8832
    ds_read_b128 v[180:183], v76 offset:128
    ds_read_b128 v[152:155], v76 offset:8896
    ds_read_b128 v[184:187], v76 offset:192
    ds_read_b128 v[156:159], v76 offset:8960
    ds_read_b128 v[188:191], v76 offset:256
    ds_read_b128 v[160:163], v76 offset:9024
    ds_read_b128 v[192:195], v76 offset:320
    ds_read_b128 v[164:167], v76 offset:9088
    ds_read_b128 v[196:199], v76 offset:384
    ds_read_b128 v[168:171], v76 offset:9152
    ds_read_b128 v[200:203], v76 offset:448
    v_pk_mul_f32 v[96:97], v[130:131], v[122:123]
    v_pk_mul_f32 v[100:101], v[94:95], v[110:111]
    v_pk_mul_f32 v[98:99], v[128:129], v[122:123]
    v_pk_mul_f32 v[102:103], v[92:93], v[110:111]
    v_pk_fma_f32 v[128:129], v[128:129], v[120:121], v[96:97] neg_lo:[0,0,1] neg_hi:[0,0,1]
    v_pk_fma_f32 v[92:93], v[92:93], v[108:109], v[100:101] neg_lo:[0,0,1] neg_hi:[0,0,1]
    v_pk_fma_f32 v[130:131], v[130:131], v[120:121], v[98:99]
    v_pk_fma_f32 v[94:95], v[94:95], v[108:109], v[102:103]
    v_cvt_pk_f16_f32 v132, v128, v130
    v_cvt_pk_f16_f32 v136, v92, -v94
    v_cvt_pk_f16_f32 v133, v129, v131
    v_cvt_pk_f16_f32 v137, v93, -v95
    ds_write_b64 v37, v[132:133] offset:1632
    ds_write_b64 v37, v[136:137] offset:8704
    v_pk_mul_f32 v[96:97], v[130:131], v[126:127]
    v_pk_mul_f32 v[100:101], v[94:95], v[114:115]
    v_pk_mul_f32 v[98:99], v[128:129], v[126:127]
    v_pk_mul_f32 v[102:103], v[92:93], v[114:115]
    v_pk_fma_f32 v[128:129], v[128:129], v[124:125], v[96:97] neg_lo:[0,0,1] neg_hi:[0,0,1]
    v_pk_fma_f32 v[92:93], v[92:93], v[112:113], v[100:101] neg_lo:[0,0,1] neg_hi:[0,0,1]
    v_pk_fma_f32 v[130:131], v[130:131], v[124:125], v[98:99]
    v_pk_fma_f32 v[94:95], v[94:95], v[112:113], v[102:103]
    v_cvt_pk_f16_f32 v134, v128, v130
    v_cvt_pk_f16_f32 v138, v92, -v94
    v_cvt_pk_f16_f32 v135, v129, v131
    v_cvt_pk_f16_f32 v139, v93, -v95
    ds_write_b64 v37, v[134:135] offset:2176
    ds_write_b64 v37, v[138:139] offset:9248
    s_waitcnt lgkmcnt(15)
    v_mfma_f32_16x16x32_f16 v[212:215], v[140:143], v[172:175], 0
    v_mfma_f32_16x16x32_f16 v[212:215], v[144:147], v[176:179], v[212:215]
    s_waitcnt lgkmcnt(14)
    v_mfma_f32_16x16x32_f16 v[212:215], v[148:151], v[180:183], v[212:215]
    s_waitcnt lgkmcnt(12)
    v_mfma_f32_16x16x32_f16 v[212:215], v[152:155], v[184:187], v[212:215]
    s_waitcnt lgkmcnt(10)
    v_mfma_f32_16x16x32_f16 v[212:215], v[156:159], v[188:191], v[212:215]
    s_waitcnt lgkmcnt(8)
    v_mfma_f32_16x16x32_f16 v[212:215], v[160:163], v[192:195], v[212:215]
    s_waitcnt lgkmcnt(6)
    v_mfma_f32_16x16x32_f16 v[212:215], v[164:167], v[196:199], v[212:215]
    s_waitcnt lgkmcnt(4)
    v_mfma_f32_16x16x32_f16 v[212:215], v[168:171], v[200:203], v[212:215]
    v_pk_mul_f32 v[96:97], v[130:131], v[126:127]
    v_pk_mul_f32 v[100:101], v[94:95], v[114:115]
    v_pk_mul_f32 v[98:99], v[128:129], v[126:127]
    v_pk_mul_f32 v[102:103], v[92:93], v[114:115]
    v_pk_fma_f32 v[128:129], v[128:129], v[124:125], v[96:97] neg_lo:[0,0,1] neg_hi:[0,0,1]
    v_pk_fma_f32 v[92:93], v[92:93], v[112:113], v[100:101] neg_lo:[0,0,1] neg_hi:[0,0,1]
    v_pk_fma_f32 v[130:131], v[130:131], v[124:125], v[98:99]
    v_pk_fma_f32 v[94:95], v[94:95], v[112:113], v[102:103]
    v_cvt_pk_f16_f32 v132, v128, v130
    v_cvt_pk_f16_f32 v136, v92, -v94
    v_cvt_pk_f16_f32 v133, v129, v131
    v_cvt_pk_f16_f32 v137, v93, -v95
    ds_write_b64 v37, v[132:133] offset:2720
    buffer_load_dwordx2 v[38:39], v78, s[60:63], 0 offen offset:192 sc1
    ds_write_b64 v37, v[136:137] offset:9792
    v_pk_mul_f32 v[96:97], v[130:131], v[126:127]
    v_pk_mul_f32 v[100:101], v[94:95], v[114:115]
    v_pk_mul_f32 v[98:99], v[128:129], v[126:127]
    v_pk_mul_f32 v[102:103], v[92:93], v[114:115]
    v_pk_fma_f32 v[128:129], v[128:129], v[124:125], v[96:97] neg_lo:[0,0,1] neg_hi:[0,0,1]
    v_pk_fma_f32 v[92:93], v[92:93], v[112:113], v[100:101] neg_lo:[0,0,1] neg_hi:[0,0,1]
    v_pk_fma_f32 v[130:131], v[130:131], v[124:125], v[98:99]
    v_pk_fma_f32 v[94:95], v[94:95], v[112:113], v[102:103]
    v_cvt_pk_f16_f32 v134, v128, v130
    v_cvt_pk_f16_f32 v138, v92, -v94
    v_cvt_pk_f16_f32 v135, v129, v131
    v_cvt_pk_f16_f32 v139, v93, -v95
    ds_write_b64 v37, v[134:135] offset:3808
    ds_write_b64 v37, v[138:139] offset:10336
    v_pk_mul_f32 v[96:97], v[130:131], v[126:127]
    v_pk_mul_f32 v[100:101], v[94:95], v[114:115]
    v_pk_mul_f32 v[98:99], v[128:129], v[126:127]
    v_pk_mul_f32 v[102:103], v[92:93], v[114:115]
    v_pk_fma_f32 v[128:129], v[128:129], v[124:125], v[96:97] neg_lo:[0,0,1] neg_hi:[0,0,1]
    v_pk_fma_f32 v[92:93], v[92:93], v[112:113], v[100:101] neg_lo:[0,0,1] neg_hi:[0,0,1]
    v_pk_fma_f32 v[130:131], v[130:131], v[124:125], v[98:99]
    v_pk_fma_f32 v[94:95], v[94:95], v[112:113], v[102:103]
    v_cvt_pk_f16_f32 v132, v128, v130
    v_cvt_pk_f16_f32 v136, v92, -v94
    v_cvt_pk_f16_f32 v133, v129, v131
    v_cvt_pk_f16_f32 v137, v93, -v95
    ds_write_b64 v37, v[132:133] offset:5984
    ds_write_b64 v37, v[136:137] offset:10880
    v_pk_mul_f32 v[96:97], v[130:131], v[126:127]
    v_pk_mul_f32 v[100:101], v[94:95], v[114:115]
    v_pk_mul_f32 v[98:99], v[128:129], v[126:127]
    v_pk_mul_f32 v[102:103], v[92:93], v[114:115]
    v_pk_fma_f32 v[128:129], v[128:129], v[124:125], v[96:97] neg_lo:[0,0,1] neg_hi:[0,0,1]
    v_pk_fma_f32 v[92:93], v[92:93], v[112:113], v[100:101] neg_lo:[0,0,1] neg_hi:[0,0,1]
    v_pk_fma_f32 v[130:131], v[130:131], v[124:125], v[98:99]
    v_pk_fma_f32 v[94:95], v[94:95], v[112:113], v[102:103]
    v_cvt_pk_f16_f32 v134, v128, v130
    v_cvt_pk_f16_f32 v138, v92, -v94
    v_cvt_pk_f16_f32 v135, v129, v131
    v_cvt_pk_f16_f32 v139, v93, -v95
    ds_write_b64 v37, v[134:135] offset:6528
    ds_write_b64 v37, v[138:139] offset:11424
    v_pk_mul_f32 v[96:97], v[130:131], v[126:127]
    v_pk_mul_f32 v[100:101], v[94:95], v[114:115]
    v_pk_mul_f32 v[98:99], v[128:129], v[126:127]
    v_pk_mul_f32 v[102:103], v[92:93], v[114:115]
    v_pk_fma_f32 v[128:129], v[128:129], v[124:125], v[96:97] neg_lo:[0,0,1] neg_hi:[0,0,1]
    v_pk_fma_f32 v[92:93], v[92:93], v[112:113], v[100:101] neg_lo:[0,0,1] neg_hi:[0,0,1]
    v_pk_fma_f32 v[130:131], v[130:131], v[124:125], v[98:99]
    v_pk_fma_f32 v[94:95], v[94:95], v[112:113], v[102:103]
    v_cvt_pk_f16_f32 v132, v128, v130
    v_cvt_pk_f16_f32 v136, v92, -v94
    v_cvt_pk_f16_f32 v133, v129, v131
    v_cvt_pk_f16_f32 v137, v93, -v95
    ds_write_b64 v37, v[132:133] offset:7072
    ds_write_b64 v37, v[136:137] offset:11968
    v_pk_mul_f32 v[96:97], v[130:131], v[126:127]
    v_pk_mul_f32 v[100:101], v[94:95], v[114:115]
    v_pk_mul_f32 v[98:99], v[128:129], v[126:127]
    v_pk_mul_f32 v[102:103], v[92:93], v[114:115]
    v_pk_fma_f32 v[128:129], v[128:129], v[124:125], v[96:97] neg_lo:[0,0,1] neg_hi:[0,0,1]
    v_pk_fma_f32 v[92:93], v[92:93], v[112:113], v[100:101] neg_lo:[0,0,1] neg_hi:[0,0,1]
    v_pk_fma_f32 v[130:131], v[130:131], v[124:125], v[98:99]
    v_pk_fma_f32 v[94:95], v[94:95], v[112:113], v[102:103]
    v_cvt_pk_f16_f32 v134, v128, v130
    v_cvt_pk_f16_f32 v138, v92, -v94
    v_cvt_pk_f16_f32 v135, v129, v131
    v_cvt_pk_f16_f32 v139, v93, -v95
    ds_write_b64 v37, v[134:135] offset:8160
    ds_write_b64 v37, v[138:139] offset:12512
    v_pk_mul_f32 v[100:101], v[94:95], v[114:115]
    v_pk_mul_f32 v[102:103], v[92:93], v[114:115]
    v_pk_fma_f32 v[92:93], v[92:93], v[112:113], v[100:101] neg_lo:[0,0,1] neg_hi:[0,0,1]
    v_pk_fma_f32 v[94:95], v[94:95], v[112:113], v[102:103]
    v_cvt_pk_f16_f32 v136, v92, -v94
    v_cvt_pk_f16_f32 v137, v93, -v95
    ds_write_b64 v37, v[136:137] offset:13056
    ds_read_b128 v[140:143], v76 offset:8704
    ds_read_b128 v[172:175], v76 offset:0
    ds_read_b128 v[144:147], v76 offset:8768
    ds_read_b128 v[176:179], v76 offset:64
    ds_read_b128 v[148:151], v76 offset:8832
    ds_read_b128 v[180:183], v76 offset:128
    ds_read_b128 v[152:155], v76 offset:8896
    ds_read_b128 v[184:187], v76 offset:192
    ds_read_b128 v[156:159], v76 offset:8960
    ds_read_b128 v[188:191], v76 offset:256
    ds_read_b128 v[160:163], v76 offset:9024
    ds_read_b128 v[192:195], v76 offset:320
    ds_read_b128 v[164:167], v76 offset:9088
    ds_read_b128 v[196:199], v76 offset:384
    ds_read_b128 v[168:171], v76 offset:9152
    ds_read_b128 v[200:203], v76 offset:448
    v_lshrrev_b32 v6, 2, v33
    v_min_u32 v6, 2, v6
    v_mul_u32_u24 v6, 4608, v6
    v_and_b32 v4, 3, v33
    v_lshl_add_u32 v6, v4, 3, v6
    v_mul_f32 v204, v82, v204
    v_mul_f32 v205, v82, v205
    v_mul_f32 v206, v82, v206
    v_mul_f32 v207, v82, v207
    v_cvt_pk_bf16_f32 v204, v204, v205
    v_cvt_pk_bf16_f32 v206, v206, v207
    ds_write_b16 v72, v204 offset:0
    ds_write_b16_d16_hi v72, v204 offset:32
    ds_write_b16 v72, v206 offset:64
    ds_write_b16_d16_hi v72, v206 offset:96
    v_mul_f32 v208, v82, v208
    v_mul_f32 v209, v82, v209
    v_mul_f32 v210, v82, v210
    v_mul_f32 v211, v82, v211
    v_cvt_pk_bf16_f32 v208, v208, v209
    v_cvt_pk_bf16_f32 v210, v210, v211
    ds_write_b16 v73, v208 offset:0
    ds_write_b16_d16_hi v73, v208 offset:32
    ds_write_b16 v73, v210 offset:64
    ds_write_b16_d16_hi v73, v210 offset:96
    v_mul_f32 v212, v82, v212
    v_mul_f32 v213, v82, v213
    v_mul_f32 v214, v82, v214
    v_mul_f32 v215, v82, v215
    v_cvt_pk_bf16_f32 v212, v212, v213
    v_cvt_pk_bf16_f32 v214, v214, v215
    ds_write_b16 v74, v212 offset:0
    ds_write_b16_d16_hi v74, v212 offset:32
    ds_write_b16 v74, v214 offset:64
    ds_write_b16_d16_hi v74, v214 offset:96
    v_lshlrev_b32 v34, 4, v0
    v_lshlrev_b32 v36, 2, v0
    s_mov_b32 s51, 0
    s_waitcnt vmcnt(0)
poll_adaLN_cond__ssm_conv_s4d__mixer_s_mlp__prompt_27:
    v_readfirstlane_b32 s42, v38
    s_nop 0
    s_cmp_ge_u32 s42, 1
    s_cbranch_scc0 slow_adaLN_cond__ssm_conv_s4d__mixer_s_mlp__prompt_28
    s_mov_b32 s42, 262144
    s_nop 0
    buffer_load_dwordx4 v[84:87], v34, s[56:59], s42 offen sc1
    s_mov_b32 s42, 266240
    buffer_load_dwordx4 v[88:91], v34, s[56:59], s42 offen sc1
    s_mov_b32 s42, 270336
    buffer_load_dwordx4 v[92:95], v34, s[56:59], s42 offen sc1
    s_mov_b32 s42, 274432
    buffer_load_dwordx4 v[96:99], v34, s[56:59], s42 offen sc1
    s_lshl_b32 s42, s40, 5
    s_add_u32 s42, s42, 303104
    buffer_load_dwordx2 v[4:5], v6, s[56:59], s42 offen sc1
    s_waitcnt lgkmcnt(15)
    v_mfma_f32_16x16x32_f16 v[216:219], v[140:143], v[172:175], 0
    v_mfma_f32_16x16x32_f16 v[216:219], v[144:147], v[176:179], v[216:219]
    v_mfma_f32_16x16x32_f16 v[216:219], v[148:151], v[180:183], v[216:219]
    v_mfma_f32_16x16x32_f16 v[216:219], v[152:155], v[184:187], v[216:219]
    v_mfma_f32_16x16x32_f16 v[216:219], v[156:159], v[188:191], v[216:219]
    v_mfma_f32_16x16x32_f16 v[216:219], v[160:163], v[192:195], v[216:219]
    s_waitcnt lgkmcnt(14)
    v_mfma_f32_16x16x32_f16 v[216:219], v[164:167], v[196:199], v[216:219]
    s_waitcnt lgkmcnt(12)
    v_mfma_f32_16x16x32_f16 v[216:219], v[168:171], v[200:203], v[216:219]
    s_nop 7
    v_mul_f32 v216, v82, v216
    v_mul_f32 v217, v82, v217
    v_mul_f32 v218, v82, v218
    v_mul_f32 v219, v82, v219
    v_cvt_pk_bf16_f32 v216, v216, v217
    v_cvt_pk_bf16_f32 v218, v218, v219
    ds_write_b16 v75, v216 offset:0
    ds_write_b16_d16_hi v75, v216 offset:32
    ds_write_b16 v75, v218 offset:64
    ds_write_b16_d16_hi v75, v218 offset:96
    ds_read_u16 v40, v40
    ds_read_u16 v41, v41
    ds_read_u16 v42, v42
    ds_read_u16 v43, v43
    ds_read_u16 v44, v44
    ds_read_u16 v45, v45
    ds_read_u16 v46, v46
    ds_read_u16 v47, v47
    ds_read_u16 v48, v48
    ds_read_u16 v49, v49
    ds_read_u16 v50, v50
    ds_read_u16 v51, v51
    ds_read_u16 v52, v52
    ds_read_u16 v53, v53
    ds_read_u16 v54, v54
    ds_read_u16 v55, v55
    s_add_u32 s42, s50, 18434
    v_mov_b32 v56, s42
    ds_read_u16 v56, v56
    v_lshl_add_u32 v72, v1, 4, s50
    v_lshrrev_b32 v73, 1, v1
    v_mul_u32_u24 v73, 4160, v73
    v_and_b32 v9, 1, v1
    v_lshl_add_u32 v73, v9, 4, v73
    v_add_u32 v73, s50, v73
    v_cmp_eq_u32 vcc, 0, v1
    s_mov_b64 exec, 0xff
    ds_write_b128 v73, v[78:81]
    s_mov_b64 exec, -1
    s_waitcnt lgkmcnt(10)
    v_lshl_or_b32 v140, v41, 16, v40
    v_lshl_or_b32 v141, v43, 16, v42
    v_lshl_or_b32 v142, v45, 16, v44
    v_lshl_or_b32 v143, v47, 16, v46
    ds_write_b128 v72, v[140:143] offset:32
    s_waitcnt lgkmcnt(3)
    v_lshl_or_b32 v144, v49, 16, v48
    v_lshl_or_b32 v145, v51, 16, v50
    v_lshl_or_b32 v146, v53, 16, v52
    v_lshl_or_b32 v147, v55, 16, v54
    ds_write_b128 v72, v[144:147] offset:1056
    s_waitcnt lgkmcnt(3)
    v_cndmask_b32 v150, 0, v56, vcc
    v_mov_b32 v151, 0
    v_lshl_or_b32 v148, v150, 16, v150
    v_mov_b32 v149, v148
    ds_write_b128 v72, v[148:151] offset:2080
    ds_read_b64 v[156:157], v72 offset:24
    ds_read_b64 v[158:159], v72 offset:1048
    ds_read_b64 v[160:161], v72 offset:2072
    s_waitcnt vmcnt(0)
    v_and_b32 v35, v85, v87
    v_bitop3_b32 v35, v35, v89, v91 bitop3:0x80
    v_bitop3_b32 v35, v35, v93, v95 bitop3:0x80
    v_bitop3_b32 v35, v35, v97, v99 bitop3:0x80
    v_cmp_ne_u32 vcc, 1, v35
    s_nop 0
    s_cmp_eq_u64 vcc, 0
    s_cselect_b32 s64, 1, 0
    s_cbranch_scc0 late_adaLN_cond__ssm_conv_s4d__mixer_s_mlp__prompt_29
    s_lshl_b32 s42, s40, 14
    s_add_u32 s42, s42, 1048576
    buffer_load_dwordx4 v[16:19], v34, s[56:59], s42 offen sc1
    s_add_u32 s42, s42, 4096
    buffer_load_dwordx4 v[20:23], v34, s[56:59], s42 offen sc1
    s_add_u32 s42, s42, 4096
    buffer_load_dwordx4 v[24:27], v34, s[56:59], s42 offen sc1
    s_add_u32 s42, s42, 4096
    buffer_load_dwordx4 v[28:31], v34, s[56:59], s42 offen sc1
late_adaLN_cond__ssm_conv_s4d__mixer_s_mlp__prompt_29:
    s_waitcnt lgkmcnt(2)
    v_alignbit_b32 v172, v157, v156, 16
    v_alignbit_b32 v173, v140, v157, 16
    v_alignbit_b32 v174, v141, v140, 16
    v_alignbit_b32 v175, v142, v141, 16
    v_mov_b32 v176, v173
    v_mov_b32 v177, v174
    v_mov_b32 v178, v175
    v_alignbit_b32 v179, v143, v142, 16
    v_mov_b32 v180, v157
    v_mov_b32 v181, v140
    v_mov_b32 v182, v141
    v_mov_b32 v183, v142
    ds_write_b128 v72, v[176:179] offset:4192
    ds_write_b128 v72, v[180:183] offset:8352
    ds_write_b128 v72, v[172:175] offset:12512
    s_waitcnt lgkmcnt(4)
    v_alignbit_b32 v184, v159, v158, 16
    v_alignbit_b32 v185, v144, v159, 16
    v_alignbit_b32 v186, v145, v144, 16
    v_alignbit_b32 v187, v146, v145, 16
    v_mov_b32 v188, v185
    v_mov_b32 v189, v186
    v_mov_b32 v190, v187
    v_alignbit_b32 v191, v147, v146, 16
    v_mov_b32 v192, v159
    v_mov_b32 v193, v144
    v_mov_b32 v194, v145
    v_mov_b32 v195, v146
    ds_write_b128 v72, v[188:191] offset:5216
    ds_write_b128 v72, v[192:195] offset:9376
    ds_write_b128 v72, v[184:187] offset:13536
    s_waitcnt lgkmcnt(6)
    v_alignbit_b32 v172, v161, v160, 16
    v_alignbit_b32 v173, v148, v161, 16
    v_alignbit_b32 v174, v149, v148, 16
    v_alignbit_b32 v175, v150, v149, 16
    v_mov_b32 v176, v173
    v_mov_b32 v177, v174
    v_mov_b32 v178, v175
    v_alignbit_b32 v179, v151, v150, 16
    v_mov_b32 v180, v161
    v_mov_b32 v181, v148
    v_mov_b32 v182, v149
    v_mov_b32 v183, v150
    ds_write_b128 v72, v[176:179] offset:6240
    ds_write_b128 v72, v[180:183] offset:10400
    ds_write_b128 v72, v[172:175] offset:14560
    s_cmp_eq_u32 s64, 0
    s_cbranch_scc1 again_adaLN_cond__ssm_conv_s4d__mixer_s_mlp__prompt_31
have_adaLN_cond__ssm_conv_s4d__mixer_s_mlp__prompt_30:
    v_and_b32 v236, 0xffff0000, v84
    v_lshlrev_b32 v237, 16, v84
    v_and_b32 v238, 0xffff0000, v86
    v_lshlrev_b32 v239, 16, v86
    v_and_b32 v240, 0xffff0000, v88
    v_lshlrev_b32 v241, 16, v88
    v_and_b32 v242, 0xffff0000, v90
    v_lshlrev_b32 v243, 16, v90
    v_and_b32 v244, 0xffff0000, v92
    v_lshlrev_b32 v245, 16, v92
    v_and_b32 v246, 0xffff0000, v94
    v_lshlrev_b32 v247, 16, v94
    v_and_b32 v248, 0xffff0000, v96
    v_lshlrev_b32 v249, 16, v96
    v_and_b32 v250, 0xffff0000, v98
    v_lshlrev_b32 v251, 16, v98
    v_rcp_f32 v236, v236
    v_rcp_f32 v238, v238
    v_rcp_f32 v240, v240
    v_rcp_f32 v242, v242
    v_rcp_f32 v244, v244
    v_rcp_f32 v246, v246
    v_rcp_f32 v248, v248
    v_rcp_f32 v250, v250
    v_mul_f32 v237, -v237, v236
    v_mul_f32 v239, -v239, v238
    v_mul_f32 v241, -v241, v240
    v_mul_f32 v243, -v243, v242
    v_mul_f32 v245, -v245, v244
    v_mul_f32 v247, -v247, v246
    v_mul_f32 v249, -v249, v248
    v_mul_f32 v251, -v251, v250
    s_waitcnt vmcnt(0)
    v_lshlrev_b32 v100, 16, v16
    v_and_b32 v101, 0xffff0000, v16
    v_lshlrev_b32 v102, 16, v17
    v_and_b32 v103, 0xffff0000, v17
    v_lshlrev_b32 v104, 16, v18
    v_and_b32 v105, 0xffff0000, v18
    v_lshlrev_b32 v106, 16, v19
    v_and_b32 v107, 0xffff0000, v19
    v_lshlrev_b32 v108, 16, v20
    v_and_b32 v109, 0xffff0000, v20
    v_lshlrev_b32 v110, 16, v21
    v_and_b32 v111, 0xffff0000, v21
    v_lshlrev_b32 v112, 16, v22
    v_and_b32 v113, 0xffff0000, v22
    v_lshlrev_b32 v114, 16, v23
    v_and_b32 v115, 0xffff0000, v23
    v_lshlrev_b32 v116, 16, v24
    v_and_b32 v117, 0xffff0000, v24
    v_lshlrev_b32 v118, 16, v25
    v_and_b32 v119, 0xffff0000, v25
    v_lshlrev_b32 v120, 16, v26
    v_and_b32 v121, 0xffff0000, v26
    v_lshlrev_b32 v122, 16, v27
    v_and_b32 v123, 0xffff0000, v27
    v_lshlrev_b32 v124, 16, v28
    v_and_b32 v125, 0xffff0000, v28
    v_lshlrev_b32 v126, 16, v29
    v_and_b32 v127, 0xffff0000, v29
    v_lshlrev_b32 v128, 16, v30
    v_and_b32 v129, 0xffff0000, v30
    v_lshlrev_b32 v130, 16, v31
    v_and_b32 v131, 0xffff0000, v31
    v_add_u32 v35, 76800, v36
    v_pk_fma_f32 v[204:205], v[100:101], v[236:237], v[236:237] op_sel:[0,0,1] op_sel_hi:[1,0,1]
    v_pk_fma_f32 v[206:207], v[102:103], v[236:237], v[236:237] op_sel:[0,0,1] op_sel_hi:[1,0,1]
    v_pk_fma_f32 v[208:209], v[104:105], v[238:239], v[238:239] op_sel:[0,0,1] op_sel_hi:[1,0,1]
    v_pk_fma_f32 v[210:211], v[106:107], v[238:239], v[238:239] op_sel:[0,0,1] op_sel_hi:[1,0,1]
    v_pk_fma_f32 v[212:213], v[108:109], v[240:241], v[240:241] op_sel:[0,0,1] op_sel_hi:[1,0,1]
    v_pk_fma_f32 v[214:215], v[110:111], v[240:241], v[240:241] op_sel:[0,0,1] op_sel_hi:[1,0,1]
    v_pk_fma_f32 v[216:217], v[112:113], v[242:243], v[242:243] op_sel:[0,0,1] op_sel_hi:[1,0,1]
    v_pk_fma_f32 v[218:219], v[114:115], v[242:243], v[242:243] op_sel:[0,0,1] op_sel_hi:[1,0,1]
    v_pk_fma_f32 v[220:221], v[116:117], v[244:245], v[244:245] op_sel:[0,0,1] op_sel_hi:[1,0,1]
    v_pk_fma_f32 v[222:223], v[118:119], v[244:245], v[244:245] op_sel:[0,0,1] op_sel_hi:[1,0,1]
    v_pk_fma_f32 v[224:225], v[120:121], v[246:247], v[246:247] op_sel:[0,0,1] op_sel_hi:[1,0,1]
    v_pk_fma_f32 v[226:227], v[122:123], v[246:247], v[246:247] op_sel:[0,0,1] op_sel_hi:[1,0,1]
    v_pk_fma_f32 v[228:229], v[124:125], v[248:249], v[248:249] op_sel:[0,0,1] op_sel_hi:[1,0,1]
    v_pk_fma_f32 v[230:231], v[126:127], v[248:249], v[248:249] op_sel:[0,0,1] op_sel_hi:[1,0,1]
    v_pk_fma_f32 v[232:233], v[128:129], v[250:251], v[250:251] op_sel:[0,0,1] op_sel_hi:[1,0,1]
    v_pk_fma_f32 v[234:235], v[130:131], v[250:251], v[250:251] op_sel:[0,0,1] op_sel_hi:[1,0,1]
gran_adaLN_cond__ssm_conv_s4d__mixer_s_mlp__prompt_33:
    v_cmp_ne_u32 vcc, 1, v5
    s_nop 0
    s_cmp_eq_u64 vcc, 0
    s_cbranch_scc0 slow_adaLN_cond__ssm_conv_s4d__mixer_s_mlp__prompt_35
    v_mov_b32_dpp v84, v4 row_newbcast:0 row_mask:0xf bank_mask:0xf
    v_mov_b32_dpp v85, v4 row_newbcast:1 row_mask:0xf bank_mask:0xf
    v_mov_b32_dpp v86, v4 row_newbcast:2 row_mask:0xf bank_mask:0xf
    v_mov_b32_dpp v87, v4 row_newbcast:3 row_mask:0xf bank_mask:0xf
    v_mov_b32_dpp v88, v4 row_newbcast:4 row_mask:0xf bank_mask:0xf
    v_mov_b32_dpp v89, v4 row_newbcast:5 row_mask:0xf bank_mask:0xf
    v_mov_b32_dpp v90, v4 row_newbcast:6 row_mask:0xf bank_mask:0xf
    v_mov_b32_dpp v91, v4 row_newbcast:7 row_mask:0xf bank_mask:0xf
    v_mov_b32_dpp v92, v4 row_newbcast:8 row_mask:0xf bank_mask:0xf
    v_mov_b32_dpp v93, v4 row_newbcast:9 row_mask:0xf bank_mask:0xf
    v_mov_b32_dpp v94, v4 row_newbcast:10 row_mask:0xf bank_mask:0xf
    v_mov_b32_dpp v95, v4 row_newbcast:11 row_mask:0xf bank_mask:0xf
    v_pk_fma_f32 v[204:205], v[204:205], v[88:89], v[84:85]
    v_pk_fma_f32 v[206:207], v[206:207], v[90:91], v[86:87]
    v_pk_fma_f32 v[208:209], v[208:209], v[88:89], v[84:85]
    v_pk_fma_f32 v[210:211], v[210:211], v[90:91], v[86:87]
    v_cvt_pk_bf16_f32 v16, v204, v208
    v_cvt_pk_bf16_f32 v17, v205, v209
    v_cvt_pk_bf16_f32 v18, v206, v210
    v_cvt_pk_bf16_f32 v19, v207, v211
    ds_write_b32 v35, v16 offset:0
    ds_write_b32 v35, v17 offset:4608
    ds_write_b32 v35, v18 offset:9216
    ds_write_b32 v35, v19 offset:13824
    v_pk_fma_f32 v[212:213], v[212:213], v[88:89], v[84:85]
    v_pk_fma_f32 v[214:215], v[214:215], v[90:91], v[86:87]
    v_pk_fma_f32 v[216:217], v[216:217], v[88:89], v[84:85]
    v_pk_fma_f32 v[218:219], v[218:219], v[90:91], v[86:87]
    v_cvt_pk_bf16_f32 v20, v212, v216
    v_cvt_pk_bf16_f32 v21, v213, v217
    v_cvt_pk_bf16_f32 v22, v214, v218
    v_cvt_pk_bf16_f32 v23, v215, v219
    ds_write_b32 v35, v20 offset:1024
    ds_write_b32 v35, v21 offset:5632
    ds_write_b32 v35, v22 offset:10240
    ds_write_b32 v35, v23 offset:14848
    v_pk_fma_f32 v[220:221], v[220:221], v[88:89], v[84:85]
    v_pk_fma_f32 v[222:223], v[222:223], v[90:91], v[86:87]
    v_pk_fma_f32 v[224:225], v[224:225], v[88:89], v[84:85]
    v_pk_fma_f32 v[226:227], v[226:227], v[90:91], v[86:87]
    v_cvt_pk_bf16_f32 v24, v220, v224
    v_cvt_pk_bf16_f32 v25, v221, v225
    v_cvt_pk_bf16_f32 v26, v222, v226
    v_cvt_pk_bf16_f32 v27, v223, v227
    ds_write_b32 v35, v24 offset:2048
    ds_write_b32 v35, v25 offset:6656
    ds_write_b32 v35, v26 offset:11264
    ds_write_b32 v35, v27 offset:15872
    v_pk_fma_f32 v[228:229], v[228:229], v[88:89], v[84:85]
    v_pk_fma_f32 v[230:231], v[230:231], v[90:91], v[86:87]
    v_pk_fma_f32 v[232:233], v[232:233], v[88:89], v[84:85]
    v_pk_fma_f32 v[234:235], v[234:235], v[90:91], v[86:87]
    v_cvt_pk_bf16_f32 v28, v228, v232
    v_cvt_pk_bf16_f32 v29, v229, v233
    v_cvt_pk_bf16_f32 v30, v230, v234
    v_cvt_pk_bf16_f32 v31, v231, v235
    ds_write_b32 v35, v28 offset:3072
    ds_write_b32 v35, v29 offset:7680
    ds_write_b32 v35, v30 offset:12288
    ds_write_b32 v35, v31 offset:16896
    v_bfe_u32 v8, v1, 2, 2
    v_mul_u32_u24 v74, 4160, v8
    v_and_b32 v8, 3, v1
    v_lshl_add_u32 v74, v8, 3, v74
    v_lshlrev_b32 v8, 4, v32
    v_sub_u32 v74, v74, v8
    s_add_u32 s42, s50, 56
    v_add_u32 v74, s42, v74
    s_mul_i32 s42, s3, 4608
    s_add_u32 s42, s42, 76768
    v_lshl_add_u32 v75, v33, 5, v8
    v_add_u32 v75, s42, v75
    s_waitcnt lgkmcnt(0)
    s_barrier
    v_add_u32 v75, -448, v75
    s_lshr_b32 s65, s2, 5
    s_sub_u32 s65, s65, 2
    v_lshlrev_b32 v37, 4, v1
    s_mul_i32 s66, s65, 110592
    s_mul_i32 s69, s3, 3072
    s_add_u32 s66, s66, s69
    s_add_u32 s66, s66, 15728640
    s_lshr_b32 s67, s3, 1
    s_mul_i32 s68, s3, 3072
    v_lshlrev_b32 v8, 3, v32
    v_lshl_add_u32 v8, v33, 5, v8
    v_add_u32 v8, s50, v8
    s_lshl_b32 s42, s48, 16
    s_and_b32 s43, s48, 0xffff0000
    v_mov_b32 v12, s42
    v_mov_b32 v13, s43
    s_lshl_b32 s42, s49, 16
    s_and_b32 s43, s49, 0xffff0000
    v_mov_b32 v14, s42
    v_mov_b32 v15, s43
    ds_read_b128 v[172:175], v75 offset:448
    ds_read_b64_tr_b16 v[140:141], v74 offset:8
    ds_read_b64_tr_b16 v[142:143], v74 offset:0
    ds_read_b128 v[176:179], v75 offset:960
    ds_read_b64_tr_b16 v[144:145], v74 offset:520
    ds_read_b64_tr_b16 v[146:147], v74 offset:512
    ds_read_b128 v[180:183], v75 offset:1472
    ds_read_b64_tr_b16 v[148:149], v74 offset:1032
    ds_read_b64_tr_b16 v[150:151], v74 offset:1024
    ds_read_b128 v[184:187], v75 offset:1984
    ds_read_b64_tr_b16 v[152:153], v74 offset:1544
    ds_read_b64_tr_b16 v[154:155], v74 offset:1536
    ds_read_b128 v[188:191], v75 offset:2496
    ds_read_b64_tr_b16 v[156:157], v74 offset:2056
    ds_read_b64_tr_b16 v[158:159], v74 offset:2048
    ds_read_b128 v[192:195], v75 offset:3008
    ds_read_b128 v[196:199], v75 offset:3520
    ds_read_b128 v[200:203], v75 offset:4032
    s_waitcnt lgkmcnt(15)
    v_mfma_f32_16x16x32_bf16 v[40:43], v[140:143], v[172:175], 0
    ds_read_b128 a[32:35], v75 offset:384
    s_waitcnt lgkmcnt(15)
    v_mfma_f32_16x16x32_bf16 v[44:47], v[140:143], v[176:179], 0
    ds_read_b64_tr_b16 a[0:1], v74 offset:72
    s_waitcnt lgkmcnt(14)
    v_mfma_f32_16x16x32_bf16 v[44:47], v[144:147], v[172:175], v[44:47]
    ds_read_b64_tr_b16 a[2:3], v74 offset:64
    v_mfma_f32_16x16x32_bf16 v[48:51], v[144:147], v[176:179], 0
    ds_read_b128 a[36:39], v75 offset:896
    s_waitcnt lgkmcnt(15)
    v_mfma_f32_16x16x32_bf16 v[48:51], v[140:143], v[180:183], v[48:51]
    ds_read_b64_tr_b16 a[4:5], v74 offset:584
    v_mfma_f32_16x16x32_bf16 v[52:55], v[144:147], v[180:183], 0
    ds_read_b64_tr_b16 a[6:7], v74 offset:576
    s_waitcnt lgkmcnt(15)
    v_mfma_f32_16x16x32_bf16 v[48:51], v[148:151], v[172:175], v[48:51]
    ds_read_b128 a[40:43], v75 offset:1408
    v_mfma_f32_16x16x32_bf16 v[52:55], v[148:151], v[176:179], v[52:55]
    ds_read_b64_tr_b16 a[8:9], v74 offset:1096
    v_mfma_f32_16x16x32_bf16 v[56:59], v[148:151], v[180:183], 0
    ds_read_b64_tr_b16 a[10:11], v74 offset:1088
    s_waitcnt lgkmcnt(15)
    v_mfma_f32_16x16x32_bf16 v[52:55], v[140:143], v[184:187], v[52:55]
    ds_read_b128 a[44:47], v75 offset:1920
    v_mfma_f32_16x16x32_bf16 v[56:59], v[144:147], v[184:187], v[56:59]
    ds_read_b64_tr_b16 a[12:13], v74 offset:1608
    v_mfma_f32_16x16x32_bf16 v[60:63], v[148:151], v[184:187], 0
    ds_read_b64_tr_b16 a[14:15], v74 offset:1600
    v_mfma_f32_16x16x32_bf16 v[52:55], v[152:155], v[172:175], v[52:55]
    ds_read_b128 a[48:51], v75 offset:2432
    v_mfma_f32_16x16x32_bf16 v[56:59], v[152:155], v[176:179], v[56:59]
    ds_read_b128 a[52:55], v75 offset:2944
    v_mfma_f32_16x16x32_bf16 v[60:63], v[152:155], v[180:183], v[60:63]
    ds_read_b128 a[56:59], v75 offset:3456
    v_mfma_f32_16x16x32_bf16 v[64:67], v[152:155], v[184:187], 0
    ds_read_b128 a[60:63], v75 offset:3968
    s_waitcnt lgkmcnt(15)
    v_mfma_f32_16x16x32_bf16 v[56:59], v[140:143], v[188:191], v[56:59]
    v_mfma_f32_16x16x32_bf16 v[60:63], v[144:147], v[188:191], v[60:63]
    v_mfma_f32_16x16x32_bf16 v[64:67], v[148:151], v[188:191], v[64:67]
    v_mfma_f32_16x16x32_bf16 v[68:71], v[152:155], v[188:191], 0
    v_mfma_f32_16x16x32_bf16 v[56:59], v[156:159], v[172:175], v[56:59]
    v_mfma_f32_16x16x32_bf16 v[60:63], v[156:159], v[176:179], v[60:63]
    v_mfma_f32_16x16x32_bf16 v[64:67], v[156:159], v[180:183], v[64:67]
    v_mfma_f32_16x16x32_bf16 v[68:71], v[156:159], v[184:187], v[68:71]
    v_mfma_f32_16x16x32_bf16 v[60:63], v[140:143], v[192:195], v[60:63]
    v_mfma_f32_16x16x32_bf16 v[64:67], v[144:147], v[192:195], v[64:67]
    v_mfma_f32_16x16x32_bf16 v[68:71], v[148:151], v[192:195], v[68:71]
    v_mfma_f32_16x16x32_bf16 v[64:67], v[140:143], v[196:199], v[64:67]
    v_mfma_f32_16x16x32_bf16 v[68:71], v[144:147], v[196:199], v[68:71]
    v_mfma_f32_16x16x32_bf16 v[68:71], v[140:143], v[200:203], v[68:71]
    s_waitcnt lgkmcnt(13)
    v_mfma_f32_16x16x32_bf16 v[40:43], a[0:3], a[32:35], v[40:43]
    ds_read_b128 v[172:175], v75 offset:320
    v_lshlrev_b32 v16, 3, v32
    s_waitcnt lgkmcnt(13)
    v_mfma_f32_16x16x32_bf16 v[44:47], a[0:3], a[36:39], v[44:47]
    ds_read_b64_tr_b16 v[140:141], v74 offset:136
    v_sub_u32 v16, v16, v33
    s_waitcnt lgkmcnt(11)
    v_mfma_f32_16x16x32_bf16 v[48:51], a[0:3], a[40:43], v[48:51]
    ds_read_b64_tr_b16 v[142:143], v74 offset:128
    v_add_u32 v17, -4, v16
    s_waitcnt lgkmcnt(9)
    v_mfma_f32_16x16x32_bf16 v[52:55], a[0:3], a[44:47], v[52:55]
    ds_read_b128 v[176:179], v75 offset:832
    v_add_u32 v18, -3, v16
    s_waitcnt lgkmcnt(7)
    v_mfma_f32_16x16x32_bf16 v[56:59], a[0:3], a[48:51], v[56:59]
    ds_read_b64_tr_b16 v[144:145], v74 offset:648
    v_cmp_gt_u32 s[44:45], 9, v17
    s_waitcnt lgkmcnt(7)
    v_mfma_f32_16x16x32_bf16 v[60:63], a[0:3], a[52:55], v[60:63]
    ds_read_b64_tr_b16 v[146:147], v74 offset:640
    v_cmp_gt_u32 vcc, 9, v18
    s_waitcnt lgkmcnt(7)
    v_mfma_f32_16x16x32_bf16 v[64:67], a[0:3], a[56:59], v[64:67]
    ds_read_b128 v[180:183], v75 offset:1344
    v_mov_b32 v17, 0x3f80
    s_waitcnt lgkmcnt(7)
    v_mfma_f32_16x16x32_bf16 v[68:71], a[0:3], a[60:63], v[68:71]
    ds_read_b64_tr_b16 v[148:149], v74 offset:1160
    v_mov_b32 v18, 1.0
    v_mfma_f32_16x16x32_bf16 v[44:47], a[4:7], a[32:35], v[44:47]
    ds_read_b64_tr_b16 v[150:151], v74 offset:1152
    v_cndmask_b32 v17, 0, v17, s[44:45]
    v_mfma_f32_16x16x32_bf16 v[48:51], a[4:7], a[36:39], v[48:51]
    ds_read_b128 v[184:187], v75 offset:1856
    v_cndmask_b32 v18, 0, v18, vcc
    v_mfma_f32_16x16x32_bf16 v[52:55], a[4:7], a[40:43], v[52:55]
    ds_read_b64_tr_b16 v[152:153], v74 offset:1672
    v_or_b32 v164, v17, v18
    v_mfma_f32_16x16x32_bf16 v[56:59], a[4:7], a[44:47], v[56:59]
    ds_read_b64_tr_b16 v[154:155], v74 offset:1664
    v_add_u32 v17, -2, v16
    v_mfma_f32_16x16x32_bf16 v[60:63], a[4:7], a[48:51], v[60:63]
    ds_read_b128 v[188:191], v75 offset:2368
    v_add_u32 v18, -1, v16
    v_mfma_f32_16x16x32_bf16 v[64:67], a[4:7], a[52:55], v[64:67]
    ds_read_b128 v[192:195], v75 offset:2880
    v_cmp_gt_u32 s[44:45], 9, v17
    v_mfma_f32_16x16x32_bf16 v[68:71], a[4:7], a[56:59], v[68:71]
    ds_read_b128 v[196:199], v75 offset:3392
    v_cmp_gt_u32 vcc, 9, v18
    v_mfma_f32_16x16x32_bf16 v[48:51], a[8:11], a[32:35], v[48:51]
    ds_read_b128 v[200:203], v75 offset:3904
    v_mov_b32 v17, 0x3f80
    v_mfma_f32_16x16x32_bf16 v[52:55], a[8:11], a[36:39], v[52:55]
    v_mov_b32 v18, 1.0
    v_cndmask_b32 v17, 0, v17, s[44:45]
    v_mfma_f32_16x16x32_bf16 v[56:59], a[8:11], a[40:43], v[56:59]
    v_cndmask_b32 v18, 0, v18, vcc
    v_or_b32 v165, v17, v18
    v_mfma_f32_16x16x32_bf16 v[60:63], a[8:11], a[44:47], v[60:63]
    v_add_u32 v17, 0, v16
    v_add_u32 v18, 1, v16
    v_mfma_f32_16x16x32_bf16 v[64:67], a[8:11], a[48:51], v[64:67]
    v_cmp_gt_u32 s[44:45], 9, v17
    v_cmp_gt_u32 vcc, 9, v18
    v_mfma_f32_16x16x32_bf16 v[68:71], a[8:11], a[52:55], v[68:71]
    v_mov_b32 v17, 0x3f80
    v_mov_b32 v18, 1.0
    v_mfma_f32_16x16x32_bf16 v[52:55], a[12:15], a[32:35], v[52:55]
    v_cndmask_b32 v17, 0, v17, s[44:45]
    v_cndmask_b32 v18, 0, v18, vcc
    v_mfma_f32_16x16x32_bf16 v[56:59], a[12:15], a[36:39], v[56:59]
    v_or_b32 v166, v17, v18
    v_add_u32 v17, 2, v16
    v_mfma_f32_16x16x32_bf16 v[60:63], a[12:15], a[40:43], v[60:63]
    v_add_u32 v18, 3, v16
    v_cmp_gt_u32 s[44:45], 9, v17
    v_mfma_f32_16x16x32_bf16 v[64:67], a[12:15], a[44:47], v[64:67]
    v_cmp_gt_u32 vcc, 9, v18
    v_mov_b32 v17, 0x3f80
    v_mfma_f32_16x16x32_bf16 v[68:71], a[12:15], a[48:51], v[68:71]
    v_mov_b32 v18, 1.0
    v_cndmask_b32 v17, 0, v17, s[44:45]
    v_cndmask_b32 v18, 0, v18, vcc
    v_or_b32 v167, v17, v18
    buffer_load_dwordx2 v[38:39], v78, s[60:63], 0 offen offset:200 sc1
    s_waitcnt lgkmcnt(13)
    v_mfma_f32_16x16x32_bf16 v[40:43], v[140:143], v[172:175], v[40:43]
    ds_read_b128 a[32:35], v75 offset:256
    v_add_u32 v17, -5, v16
    s_waitcnt lgkmcnt(13)
    v_mfma_f32_16x16x32_bf16 v[44:47], v[140:143], v[176:179], v[44:47]
    ds_read_b64_tr_b16 a[0:1], v74 offset:200
    v_add_u32 v18, -4, v16
    s_waitcnt lgkmcnt(11)
    v_mfma_f32_16x16x32_bf16 v[48:51], v[140:143], v[180:183], v[48:51]
    ds_read_b64_tr_b16 a[2:3], v74 offset:192
    v_cmp_gt_u32 s[44:45], 7, v17
    s_waitcnt lgkmcnt(9)
    v_mfma_f32_16x16x32_bf16 v[52:55], v[140:143], v[184:187], v[52:55]
    ds_read_b128 a[36:39], v75 offset:768
    v_cmp_gt_u32 vcc, 7, v18
    s_waitcnt lgkmcnt(7)
    v_mfma_f32_16x16x32_bf16 v[56:59], v[140:143], v[188:191], v[56:59]
    ds_read_b64_tr_b16 a[4:5], v74 offset:712
    v_mov_b32 v17, 0x3f80
    s_waitcnt lgkmcnt(7)
    v_mfma_f32_16x16x32_bf16 v[60:63], v[140:143], v[192:195], v[60:63]
    ds_read_b64_tr_b16 a[6:7], v74 offset:704
    v_mov_b32 v18, 1.0
    s_waitcnt lgkmcnt(7)
    v_mfma_f32_16x16x32_bf16 v[64:67], v[140:143], v[196:199], v[64:67]
    ds_read_b128 a[40:43], v75 offset:1280
    v_cndmask_b32 v17, 0, v17, s[44:45]
    s_waitcnt lgkmcnt(7)
    v_mfma_f32_16x16x32_bf16 v[68:71], v[140:143], v[200:203], v[68:71]
    ds_read_b64_tr_b16 a[8:9], v74 offset:1224
    v_cndmask_b32 v18, 0, v18, vcc
    v_mfma_f32_16x16x32_bf16 v[44:47], v[144:147], v[172:175], v[44:47]
    ds_read_b64_tr_b16 a[10:11], v74 offset:1216
    v_or_b32 v168, v17, v18
    v_mfma_f32_16x16x32_bf16 v[48:51], v[144:147], v[176:179], v[48:51]
    ds_read_b128 a[44:47], v75 offset:1792
    v_add_u32 v17, -3, v16
    v_mfma_f32_16x16x32_bf16 v[52:55], v[144:147], v[180:183], v[52:55]
    ds_read_b64_tr_b16 a[12:13], v74 offset:1736
    v_add_u32 v18, -2, v16
    v_mfma_f32_16x16x32_bf16 v[56:59], v[144:147], v[184:187], v[56:59]
    ds_read_b64_tr_b16 a[14:15], v74 offset:1728
    v_cmp_gt_u32 s[44:45], 7, v17
    v_mfma_f32_16x16x32_bf16 v[60:63], v[144:147], v[188:191], v[60:63]
    ds_read_b128 a[48:51], v75 offset:2304
    v_cmp_gt_u32 vcc, 7, v18
    v_mfma_f32_16x16x32_bf16 v[64:67], v[144:147], v[192:195], v[64:67]
    ds_read_b128 a[52:55], v75 offset:2816
    v_mov_b32 v17, 0x3f80
    v_mfma_f32_16x16x32_bf16 v[68:71], v[144:147], v[196:199], v[68:71]
    ds_read_b128 a[56:59], v75 offset:3328
    v_mov_b32 v18, 1.0
    v_mfma_f32_16x16x32_bf16 v[48:51], v[148:151], v[172:175], v[48:51]
    ds_read_b128 a[60:63], v75 offset:3840
    v_cndmask_b32 v17, 0, v17, s[44:45]
    v_mfma_f32_16x16x32_bf16 v[52:55], v[148:151], v[176:179], v[52:55]
    v_cndmask_b32 v18, 0, v18, vcc
    v_or_b32 v169, v17, v18
    v_mfma_f32_16x16x32_bf16 v[56:59], v[148:151], v[180:183], v[56:59]
    v_add_u32 v17, -1, v16
    v_add_u32 v18, 0, v16
    v_mfma_f32_16x16x32_bf16 v[60:63], v[148:151], v[184:187], v[60:63]
    v_cmp_gt_u32 s[44:45], 7, v17
    v_cmp_gt_u32 vcc, 7, v18
    v_mfma_f32_16x16x32_bf16 v[64:67], v[148:151], v[188:191], v[64:67]
    v_mov_b32 v17, 0x3f80
    v_mov_b32 v18, 1.0
    v_mfma_f32_16x16x32_bf16 v[68:71], v[148:151], v[192:195], v[68:71]
    v_cndmask_b32 v17, 0, v17, s[44:45]
    v_cndmask_b32 v18, 0, v18, vcc
    v_mfma_f32_16x16x32_bf16 v[52:55], v[152:155], v[172:175], v[52:55]
    v_or_b32 v170, v17, v18
    v_add_u32 v17, 1, v16
    v_mfma_f32_16x16x32_bf16 v[56:59], v[152:155], v[176:179], v[56:59]
    v_add_u32 v18, 2, v16
    v_cmp_gt_u32 s[44:45], 7, v17
    v_mfma_f32_16x16x32_bf16 v[60:63], v[152:155], v[180:183], v[60:63]
    v_cmp_gt_u32 vcc, 7, v18
    v_mov_b32 v17, 0x3f80
    v_mfma_f32_16x16x32_bf16 v[64:67], v[152:155], v[184:187], v[64:67]
    v_mov_b32 v18, 1.0
    v_cndmask_b32 v17, 0, v17, s[44:45]
    v_mfma_f32_16x16x32_bf16 v[68:71], v[152:155], v[188:191], v[68:71]
    v_cndmask_b32 v18, 0, v18, vcc
    v_or_b32 v171, v17, v18
    v_lshlrev_b32 v16, 2, v32
    v_sub_u32 v16, v33, v16
    s_add_u32 s42, s50, 18424
    v_lshl_add_u32 v19, v16, 2, s42
    s_waitcnt lgkmcnt(13)
    v_mfma_f32_16x16x32_bf16 v[40:43], a[0:3], a[32:35], v[40:43]
    ds_read_b128 v[172:175], v75 offset:192
    s_waitcnt lgkmcnt(13)
    v_mfma_f32_16x16x32_bf16 v[44:47], a[0:3], a[36:39], v[44:47]
    ds_read_b64_tr_b16 v[140:141], v74 offset:264
    s_waitcnt lgkmcnt(11)
    v_mfma_f32_16x16x32_bf16 v[48:51], a[0:3], a[40:43], v[48:51]
    ds_read_b64_tr_b16 v[142:143], v74 offset:256
    s_waitcnt lgkmcnt(9)
    v_mfma_f32_16x16x32_bf16 v[52:55], a[0:3], a[44:47], v[52:55]
    ds_read_b128 v[176:179], v75 offset:704
    s_waitcnt lgkmcnt(7)
    v_mfma_f32_16x16x32_bf16 v[56:59], a[0:3], a[48:51], v[56:59]
    ds_read_b64_tr_b16 v[144:145], v74 offset:776
    s_waitcnt lgkmcnt(7)
    v_mfma_f32_16x16x32_bf16 v[60:63], a[0:3], a[52:55], v[60:63]
    ds_read_b64_tr_b16 v[146:147], v74 offset:768
    s_waitcnt lgkmcnt(7)
    v_mfma_f32_16x16x32_bf16 v[64:67], a[0:3], a[56:59], v[64:67]
    ds_read_b128 v[180:183], v75 offset:1216
    s_waitcnt lgkmcnt(7)
    v_mfma_f32_16x16x32_bf16 v[68:71], a[0:3], a[60:63], v[68:71]
    ds_read_b64_tr_b16 v[148:149], v74 offset:1288
    v_mfma_f32_16x16x32_bf16 v[44:47], a[4:7], a[32:35], v[44:47]
    ds_read_b64_tr_b16 v[150:151], v74 offset:1280
    v_mfma_f32_16x16x32_bf16 v[48:51], a[4:7], a[36:39], v[48:51]
    ds_read_b128 v[184:187], v75 offset:1728
    v_mfma_f32_16x16x32_bf16 v[52:55], a[4:7], a[40:43], v[52:55]
    ds_read_b64_tr_b16 v[152:153], v74 offset:1800
    v_mfma_f32_16x16x32_bf16 v[56:59], a[4:7], a[44:47], v[56:59]
    ds_read_b64_tr_b16 v[154:155], v74 offset:1792
    v_mfma_f32_16x16x32_bf16 v[60:63], a[4:7], a[48:51], v[60:63]
    ds_read_b128 v[188:191], v75 offset:2240
    v_mfma_f32_16x16x32_bf16 v[64:67], a[4:7], a[52:55], v[64:67]
    ds_read_b128 v[192:195], v75 offset:2752
    v_mfma_f32_16x16x32_bf16 v[68:71], a[4:7], a[56:59], v[68:71]
    ds_read_b128 v[196:199], v75 offset:3264
    v_mfma_f32_16x16x32_bf16 v[48:51], a[8:11], a[32:35], v[48:51]
    ds_read_b128 v[200:203], v75 offset:3776
    ds_read2_b32 v[160:161], v19 offset0:0 offset1:1
    v_mfma_f32_16x16x32_bf16 v[52:55], a[8:11], a[36:39], v[52:55]
    ds_read2_b32 v[162:163], v19 offset0:2 offset1:3
    ds_read2_b32 a[16:17], v19 offset0:16 offset1:17
    v_mfma_f32_16x16x32_bf16 v[56:59], a[8:11], a[40:43], v[56:59]
    ds_read2_b32 a[18:19], v19 offset0:18 offset1:19
    ds_read2_b32 a[20:21], v19 offset0:32 offset1:33
    v_mfma_f32_16x16x32_bf16 v[60:63], a[8:11], a[44:47], v[60:63]
    ds_read2_b32 a[22:23], v19 offset0:34 offset1:35
    ds_read2_b32 a[24:25], v19 offset0:48 offset1:49
    v_mfma_f32_16x16x32_bf16 v[64:67], a[8:11], a[48:51], v[64:67]
    ds_read2_b32 a[26:27], v19 offset0:50 offset1:51
    ds_read_b128 a[64:67], v75 offset:432
    v_mfma_f32_16x16x32_bf16 v[68:71], a[8:11], a[52:55], v[68:71]
    ds_read_b128 a[68:71], v75 offset:448
    ds_read_b128 a[72:75], v75 offset:944
    v_mfma_f32_16x16x32_bf16 v[52:55], a[12:15], a[32:35], v[52:55]
    ds_read_b128 a[76:79], v75 offset:960
    ds_read_b128 a[80:83], v75 offset:1456
    v_mfma_f32_16x16x32_bf16 v[56:59], a[12:15], a[36:39], v[56:59]
    ds_read_b128 a[84:87], v75 offset:1472
    ds_read_b128 a[88:91], v75 offset:1968
    v_mfma_f32_16x16x32_bf16 v[60:63], a[12:15], a[40:43], v[60:63]
    ds_read_b128 a[92:95], v75 offset:1984
    v_mfma_f32_16x16x32_bf16 v[64:67], a[12:15], a[44:47], v[64:67]
    v_mfma_f32_16x16x32_bf16 v[68:71], a[12:15], a[48:51], v[68:71]
    s_waitcnt vmcnt(0)
poll_adaLN_cond__ssm_conv_s4d__mixer_s_mlp__prompt_36:
    v_readfirstlane_b32 s42, v38
    s_nop 0
    s_cmp_ge_u32 s42, 1
    s_cbranch_scc0 slow_adaLN_cond__ssm_conv_s4d__mixer_s_mlp__prompt_37
    s_waitcnt lgkmcnt(15)
    v_mfma_f32_16x16x32_bf16 v[40:43], v[140:143], v[172:175], v[40:43]
    ds_read_b128 a[32:35], v75 offset:128
    s_waitcnt lgkmcnt(1)
    v_mfma_f32_16x16x32_bf16 v[44:47], v[140:143], v[176:179], v[44:47]
    ds_read_b64_tr_b16 a[0:1], v74 offset:328
    v_cmp_le_i32 vcc, 3, v16
    v_mfma_f32_16x16x32_bf16 v[48:51], v[140:143], v[180:183], v[48:51]
    ds_read_b64_tr_b16 a[2:3], v74 offset:320
    s_nop 0
    v_mfma_f32_16x16x32_bf16 v[52:55], v[140:143], v[184:187], v[52:55]
    ds_read_b128 a[36:39], v75 offset:640
    v_cndmask_b32 v160, 0, v160, vcc
    v_mfma_f32_16x16x32_bf16 v[56:59], v[140:143], v[188:191], v[56:59]
    ds_read_b64_tr_b16 a[4:5], v74 offset:840
    v_cmp_le_i32 vcc, 2, v16
    s_add_u32 m0, s68, 94720
    s_nop 0
    buffer_load_dwordx4 v37, s[56:59], s66 offen offset:0 sc1 lds
    v_mfma_f32_16x16x32_bf16 v[60:63], v[140:143], v[192:195], v[60:63]
    ds_read_b64_tr_b16 a[6:7], v74 offset:832
    s_nop 0
    v_mfma_f32_16x16x32_bf16 v[64:67], v[140:143], v[196:199], v[64:67]
    ds_read_b128 a[40:43], v75 offset:1152
    v_cndmask_b32 v161, 0, v161, vcc
    v_mfma_f32_16x16x32_bf16 v[68:71], v[140:143], v[200:203], v[68:71]
    ds_read_b64_tr_b16 a[8:9], v74 offset:1352
    v_cmp_le_i32 vcc, 1, v16
    v_mfma_f32_16x16x32_bf16 v[44:47], v[144:147], v[172:175], v[44:47]
    ds_read_b64_tr_b16 a[10:11], v74 offset:1344
    s_nop 0
    v_mfma_f32_16x16x32_bf16 v[48:51], v[144:147], v[176:179], v[48:51]
    ds_read_b128 a[44:47], v75 offset:1664
    v_cndmask_b32 v162, 0, v162, vcc
    v_mfma_f32_16x16x32_bf16 v[52:55], v[144:147], v[180:183], v[52:55]
    ds_read_b64_tr_b16 a[12:13], v74 offset:1864
    v_cmp_le_i32 vcc, 0, v16
    buffer_load_dwordx4 v37, s[56:59], s66 offen offset:1024 sc1 lds
    v_mfma_f32_16x16x32_bf16 v[56:59], v[144:147], v[184:187], v[56:59]
    ds_read_b64_tr_b16 a[14:15], v74 offset:1856
    s_nop 0
    v_mfma_f32_16x16x32_bf16 v[60:63], v[144:147], v[188:191], v[60:63]
    ds_read_b128 a[48:51], v75 offset:2176
    v_cndmask_b32 v163, 0, v163, vcc
    v_mfma_f32_16x16x32_bf16 v[16:19], a[64:67], v[164:167], 0
    v_mfma_f32_16x16x32_bf16 v[20:23], a[68:71], v[168:171], 0
    v_mfma_f32_16x16x32_bf16 v[64:67], v[144:147], v[192:195], v[64:67]
    ds_read_b128 a[52:55], v75 offset:2688
    v_mfma_f32_16x16x32_bf16 v[68:71], v[144:147], v[196:199], v[68:71]
    ds_read_b128 a[56:59], v75 offset:3200
    v_mfma_f32_16x16x32_bf16 v[48:51], v[148:151], v[172:175], v[48:51]
    ds_read_b128 a[60:63], v75 offset:3712
    v_mfma_f32_16x16x32_bf16 v[52:55], v[148:151], v[176:179], v[52:55]
    buffer_load_dwordx4 v37, s[56:59], s66 offen offset:2048 sc1 lds
    s_add_u32 s66, s66, 12288
    v_mfma_f32_16x16x32_bf16 v[56:59], v[148:151], v[180:183], v[56:59]
    v_cvt_pk_bf16_f32 v24, v23, v19
    v_cvt_pk_bf16_f32 v25, v22, v18
    v_cvt_pk_bf16_f32 v26, v21, v17
    v_cvt_pk_bf16_f32 v27, v20, v16
    v_mfma_f32_16x16x32_bf16 v[60:63], v[148:151], v[184:187], v[60:63]
    v_mfma_f32_16x16x32_bf16 v[64:67], v[148:151], v[188:191], v[64:67]
    v_mfma_f32_16x16x32_bf16 v[68:71], v[148:151], v[192:195], v[68:71]
    v_mfma_f32_16x16x32_bf16 v[16:19], a[72:75], v[164:167], 0
    v_mfma_f32_16x16x32_bf16 v[20:23], a[76:79], v[168:171], 0
    v_mfma_f32_16x16x32_bf16 v[56:59], v[24:27], v[160:163], v[56:59]
    v_mfma_f32_16x16x32_bf16 v[60:63], v[24:27], a[16:19], v[60:63]
    v_mfma_f32_16x16x32_bf16 v[64:67], v[24:27], a[20:23], v[64:67]
    v_mfma_f32_16x16x32_bf16 v[68:71], v[24:27], a[24:27], v[68:71]
    v_mfma_f32_16x16x32_bf16 v[52:55], v[152:155], v[172:175], v[52:55]
    v_mfma_f32_16x16x32_bf16 v[56:59], v[152:155], v[176:179], v[56:59]
    s_add_u32 m0, s68, 107008
    s_nop 0
    buffer_load_dwordx4 v37, s[56:59], s66 offen offset:0 sc1 lds
    v_mfma_f32_16x16x32_bf16 v[60:63], v[152:155], v[180:183], v[60:63]
    v_mfma_f32_16x16x32_bf16 v[64:67], v[152:155], v[184:187], v[64:67]
    v_mfma_f32_16x16x32_bf16 v[68:71], v[152:155], v[188:191], v[68:71]
    v_cvt_pk_bf16_f32 v28, v23, v19
    v_cvt_pk_bf16_f32 v29, v22, v18
    v_cvt_pk_bf16_f32 v30, v21, v17
    v_cvt_pk_bf16_f32 v31, v20, v16
    s_waitcnt lgkmcnt(13)
    v_mfma_f32_16x16x32_bf16 v[40:43], a[0:3], a[32:35], v[40:43]
    ds_read_b128 v[172:175], v75 offset:64
    s_waitcnt lgkmcnt(13)
    v_mfma_f32_16x16x32_bf16 v[44:47], a[0:3], a[36:39], v[44:47]
    ds_read_b64_tr_b16 v[140:141], v74 offset:392
    s_waitcnt lgkmcnt(11)
    v_mfma_f32_16x16x32_bf16 v[48:51], a[0:3], a[40:43], v[48:51]
    ds_read_b64_tr_b16 v[142:143], v74 offset:384
    v_mfma_f32_16x16x32_bf16 v[16:19], a[80:83], v[164:167], 0
    v_mfma_f32_16x16x32_bf16 v[20:23], a[84:87], v[168:171], 0
    v_mfma_f32_16x16x32_bf16 v[60:63], v[28:31], v[160:163], v[60:63]
    v_mfma_f32_16x16x32_bf16 v[64:67], v[28:31], a[16:19], v[64:67]
    v_mfma_f32_16x16x32_bf16 v[68:71], v[28:31], a[20:23], v[68:71]
    s_waitcnt lgkmcnt(9)
    v_mfma_f32_16x16x32_bf16 v[52:55], a[0:3], a[44:47], v[52:55]
    ds_read_b128 v[176:179], v75 offset:576
    s_waitcnt lgkmcnt(7)
    v_mfma_f32_16x16x32_bf16 v[56:59], a[0:3], a[48:51], v[56:59]
    ds_read_b64_tr_b16 v[144:145], v74 offset:904
    buffer_load_dwordx4 v37, s[56:59], s66 offen offset:1024 sc1 lds
    s_waitcnt lgkmcnt(7)
    v_mfma_f32_16x16x32_bf16 v[60:63], a[0:3], a[52:55], v[60:63]
    ds_read_b64_tr_b16 v[146:147], v74 offset:896
    s_waitcnt lgkmcnt(7)
    v_mfma_f32_16x16x32_bf16 v[64:67], a[0:3], a[56:59], v[64:67]
    ds_read_b128 v[180:183], v75 offset:1088
    s_waitcnt lgkmcnt(7)
    v_mfma_f32_16x16x32_bf16 v[68:71], a[0:3], a[60:63], v[68:71]
    ds_read_b64_tr_b16 v[148:149], v74 offset:1416
    v_cvt_pk_bf16_f32 v24, v23, v19
    v_cvt_pk_bf16_f32 v25, v22, v18
    v_cvt_pk_bf16_f32 v26, v21, v17
    v_cvt_pk_bf16_f32 v27, v20, v16
    v_mfma_f32_16x16x32_bf16 v[44:47], a[4:7], a[32:35], v[44:47]
    ds_read_b64_tr_b16 v[150:151], v74 offset:1408
    v_mfma_f32_16x16x32_bf16 v[48:51], a[4:7], a[36:39], v[48:51]
    ds_read_b128 v[184:187], v75 offset:1600
    v_mfma_f32_16x16x32_bf16 v[52:55], a[4:7], a[40:43], v[52:55]
    ds_read_b64_tr_b16 v[152:153], v74 offset:1928
    v_mfma_f32_16x16x32_bf16 v[16:19], a[88:91], v[164:167], 0
    v_mfma_f32_16x16x32_bf16 v[20:23], a[92:95], v[168:171], 0
    v_mfma_f32_16x16x32_bf16 v[64:67], v[24:27], v[160:163], v[64:67]
    v_mfma_f32_16x16x32_bf16 v[68:71], v[24:27], a[16:19], v[68:71]
    buffer_load_dwordx4 v37, s[56:59], s66 offen offset:2048 sc1 lds
    s_add_u32 s66, s66, 12288
    v_mfma_f32_16x16x32_bf16 v[56:59], a[4:7], a[44:47], v[56:59]
    ds_read_b64_tr_b16 v[154:155], v74 offset:1920
    v_mfma_f32_16x16x32_bf16 v[60:63], a[4:7], a[48:51], v[60:63]
    ds_read_b128 v[188:191], v75 offset:2112
    v_mfma_f32_16x16x32_bf16 v[64:67], a[4:7], a[52:55], v[64:67]
    ds_read_b128 v[192:195], v75 offset:2624
    v_mfma_f32_16x16x32_bf16 v[68:71], a[4:7], a[56:59], v[68:71]
    ds_read_b128 v[196:199], v75 offset:3136
    v_mfma_f32_16x16x32_bf16 v[48:51], a[8:11], a[32:35], v[48:51]
    ds_read_b128 v[200:203], v75 offset:3648
    v_cvt_pk_bf16_f32 v28, v23, v19
    v_cvt_pk_bf16_f32 v29, v22, v18
    v_cvt_pk_bf16_f32 v30, v21, v17
    v_cvt_pk_bf16_f32 v31, v20, v16
    v_mfma_f32_16x16x32_bf16 v[52:55], a[8:11], a[36:39], v[52:55]
    s_add_u32 m0, s68, 119296
    s_nop 0
    buffer_load_dwordx4 v37, s[56:59], s66 offen offset:0 sc1 lds
    v_mfma_f32_16x16x32_bf16 v[56:59], a[8:11], a[40:43], v[56:59]
    v_mfma_f32_16x16x32_bf16 v[60:63], a[8:11], a[44:47], v[60:63]
    v_mfma_f32_16x16x32_bf16 v[68:71], v[28:31], v[160:163], v[68:71]
    v_mfma_f32_16x16x32_bf16 v[64:67], a[8:11], a[48:51], v[64:67]
    v_mfma_f32_16x16x32_bf16 v[68:71], a[8:11], a[52:55], v[68:71]
    v_mfma_f32_16x16x32_bf16 v[52:55], a[12:15], a[32:35], v[52:55]
    v_mfma_f32_16x16x32_bf16 v[56:59], a[12:15], a[36:39], v[56:59]
    buffer_load_dwordx4 v37, s[56:59], s66 offen offset:1024 sc1 lds
    v_mfma_f32_16x16x32_bf16 v[60:63], a[12:15], a[40:43], v[60:63]
    v_mfma_f32_16x16x32_bf16 v[64:67], a[12:15], a[44:47], v[64:67]
    v_mfma_f32_16x16x32_bf16 v[68:71], a[12:15], a[48:51], v[68:71]
    s_waitcnt lgkmcnt(13)
    v_mfma_f32_16x16x32_bf16 v[40:43], v[140:143], v[172:175], v[40:43]
    ds_read_b128 a[32:35], v75 offset:0
    s_waitcnt lgkmcnt(13)
    v_mfma_f32_16x16x32_bf16 v[44:47], v[140:143], v[176:179], v[44:47]
    ds_read_b64_tr_b16 a[0:1], v74 offset:456
    s_waitcnt lgkmcnt(11)
    v_mfma_f32_16x16x32_bf16 v[48:51], v[140:143], v[180:183], v[48:51]
    ds_read_b64_tr_b16 a[2:3], v74 offset:448
    s_waitcnt lgkmcnt(9)
    v_mfma_f32_16x16x32_bf16 v[52:55], v[140:143], v[184:187], v[52:55]
    ds_read_b128 a[36:39], v75 offset:512
    s_waitcnt lgkmcnt(7)
    v_mfma_f32_16x16x32_bf16 v[56:59], v[140:143], v[188:191], v[56:59]
    ds_read_b64_tr_b16 a[4:5], v74 offset:968
    buffer_load_dwordx4 v37, s[56:59], s66 offen offset:2048 sc1 lds
    s_add_u32 s66, s66, 12288
    s_waitcnt lgkmcnt(7)
    v_mfma_f32_16x16x32_bf16 v[60:63], v[140:143], v[192:195], v[60:63]
    ds_read_b64_tr_b16 a[6:7], v74 offset:960
    s_waitcnt lgkmcnt(7)
    v_mfma_f32_16x16x32_bf16 v[64:67], v[140:143], v[196:199], v[64:67]
    ds_read_b128 a[40:43], v75 offset:1024
    s_waitcnt lgkmcnt(7)
    v_mfma_f32_16x16x32_bf16 v[68:71], v[140:143], v[200:203], v[68:71]
    ds_read_b64_tr_b16 a[8:9], v74 offset:1480
    v_mfma_f32_16x16x32_bf16 v[44:47], v[144:147], v[172:175], v[44:47]
    ds_read_b64_tr_b16 a[10:11], v74 offset:1472
    v_mfma_f32_16x16x32_bf16 v[48:51], v[144:147], v[176:179], v[48:51]
    ds_read_b128 a[44:47], v75 offset:1536
    v_mfma_f32_16x16x32_bf16 v[52:55], v[144:147], v[180:183], v[52:55]
    ds_read_b64_tr_b16 a[12:13], v74 offset:1992
    s_add_u32 m0, s68, 131584
    s_nop 0
    buffer_load_dwordx4 v37, s[56:59], s66 offen offset:0 sc1 lds
    v_mfma_f32_16x16x32_bf16 v[56:59], v[144:147], v[184:187], v[56:59]
    ds_read_b64_tr_b16 a[14:15], v74 offset:1984
    v_mfma_f32_16x16x32_bf16 v[60:63], v[144:147], v[188:191], v[60:63]
    ds_read_b128 a[48:51], v75 offset:2048
    v_mfma_f32_16x16x32_bf16 v[64:67], v[144:147], v[192:195], v[64:67]
    ds_read_b128 a[52:55], v75 offset:2560
    v_mfma_f32_16x16x32_bf16 v[68:71], v[144:147], v[196:199], v[68:71]
    ds_read_b128 a[56:59], v75 offset:3072
    v_mfma_f32_16x16x32_bf16 v[48:51], v[148:151], v[172:175], v[48:51]
    ds_read_b128 a[60:63], v75 offset:3584
    v_mfma_f32_16x16x32_bf16 v[52:55], v[148:151], v[176:179], v[52:55]
    buffer_load_dwordx4 v37, s[56:59], s66 offen offset:1024 sc1 lds
    v_mfma_f32_16x16x32_bf16 v[56:59], v[148:151], v[180:183], v[56:59]
    v_mfma_f32_16x16x32_bf16 v[60:63], v[148:151], v[184:187], v[60:63]
    v_mfma_f32_16x16x32_bf16 v[64:67], v[148:151], v[188:191], v[64:67]
    v_mfma_f32_16x16x32_bf16 v[68:71], v[148:151], v[192:195], v[68:71]
    v_mfma_f32_16x16x32_bf16 v[52:55], v[152:155], v[172:175], v[52:55]
    v_mfma_f32_16x16x32_bf16 v[56:59], v[152:155], v[176:179], v[56:59]
    buffer_load_dwordx4 v37, s[56:59], s66 offen offset:2048 sc1 lds
    s_add_u32 s66, s66, 12288
    v_mfma_f32_16x16x32_bf16 v[60:63], v[152:155], v[180:183], v[60:63]
    v_mfma_f32_16x16x32_bf16 v[64:67], v[152:155], v[184:187], v[64:67]
    v_mfma_f32_16x16x32_bf16 v[68:71], v[152:155], v[188:191], v[68:71]
    s_waitcnt lgkmcnt(13)
    v_mfma_f32_16x16x32_bf16 v[40:43], a[0:3], a[32:35], v[40:43]
    s_waitcnt lgkmcnt(12)
    v_mfma_f32_16x16x32_bf16 v[44:47], a[0:3], a[36:39], v[44:47]
    s_waitcnt lgkmcnt(10)
    v_mfma_f32_16x16x32_bf16 v[44:47], a[4:7], a[32:35], v[44:47]
    s_nop 3
    v_cvt_pk_bf16_f32 v16, v40, v41
    v_cvt_pk_bf16_f32 v17, v42, v43
    s_waitcnt lgkmcnt(9)
    v_mfma_f32_16x16x32_bf16 v[48:51], a[0:3], a[40:43], v[48:51]
    ds_write_b64 v8, v[16:17] offset:0
    v_mfma_f32_16x16x32_bf16 v[48:51], a[4:7], a[36:39], v[48:51]
    s_add_u32 m0, s68, 143872
    s_nop 0
    buffer_load_dwordx4 v37, s[56:59], s66 offen offset:0 sc1 lds
    s_waitcnt lgkmcnt(8)
    v_mfma_f32_16x16x32_bf16 v[48:51], a[8:11], a[32:35], v[48:51]
    v_cvt_pk_bf16_f32 v18, v44, v45
    v_cvt_pk_bf16_f32 v19, v46, v47
    s_waitcnt lgkmcnt(7)
    v_mfma_f32_16x16x32_bf16 v[52:55], a[0:3], a[44:47], v[52:55]
    ds_write_b64 v8, v[18:19] offset:512
    v_mfma_f32_16x16x32_bf16 v[52:55], a[4:7], a[40:43], v[52:55]
    v_mfma_f32_16x16x32_bf16 v[52:55], a[8:11], a[36:39], v[52:55]
    s_waitcnt lgkmcnt(6)
    v_mfma_f32_16x16x32_bf16 v[52:55], a[12:15], a[32:35], v[52:55]
    v_cvt_pk_bf16_f32 v20, v48, v49
    v_cvt_pk_bf16_f32 v21, v50, v51
    s_waitcnt lgkmcnt(5)
    v_mfma_f32_16x16x32_bf16 v[56:59], a[0:3], a[48:51], v[56:59]
    ds_write_b64 v8, v[20:21] offset:1024
    buffer_load_dwordx4 v37, s[56:59], s66 offen offset:1024 sc1 lds
    v_mfma_f32_16x16x32_bf16 v[56:59], a[4:7], a[44:47], v[56:59]
    v_mfma_f32_16x16x32_bf16 v[56:59], a[8:11], a[40:43], v[56:59]
    v_mfma_f32_16x16x32_bf16 v[56:59], a[12:15], a[36:39], v[56:59]
    v_cvt_pk_bf16_f32 v22, v52, v53
    v_cvt_pk_bf16_f32 v23, v54, v55
    s_waitcnt lgkmcnt(5)
    v_mfma_f32_16x16x32_bf16 v[60:63], a[0:3], a[52:55], v[60:63]
    ds_write_b64 v8, v[22:23] offset:1536
    v_mfma_f32_16x16x32_bf16 v[60:63], a[4:7], a[48:51], v[60:63]
    v_mfma_f32_16x16x32_bf16 v[60:63], a[8:11], a[44:47], v[60:63]
    buffer_load_dwordx4 v37, s[56:59], s66 offen offset:2048 sc1 lds
    s_add_u32 s66, s66, 12288
    v_mfma_f32_16x16x32_bf16 v[60:63], a[12:15], a[40:43], v[60:63]
    v_cvt_pk_bf16_f32 v24, v56, v57
    v_cvt_pk_bf16_f32 v25, v58, v59
    s_waitcnt lgkmcnt(5)
    v_mfma_f32_16x16x32_bf16 v[64:67], a[0:3], a[56:59], v[64:67]
    ds_write_b64 v8, v[24:25] offset:2048
    v_mfma_f32_16x16x32_bf16 v[64:67], a[4:7], a[52:55], v[64:67]
    v_mfma_f32_16x16x32_bf16 v[64:67], a[8:11], a[48:51], v[64:67]
    v_mfma_f32_16x16x32_bf16 v[64:67], a[12:15], a[44:47], v[64:67]
    v_cvt_pk_bf16_f32 v26, v60, v61
    v_cvt_pk_bf16_f32 v27, v62, v63
    s_waitcnt lgkmcnt(5)
    v_mfma_f32_16x16x32_bf16 v[68:71], a[0:3], a[60:63], v[68:71]
    ds_write_b64 v8, v[26:27] offset:2560
    v_mfma_f32_16x16x32_bf16 v[68:71], a[4:7], a[56:59], v[68:71]
    v_mfma_f32_16x16x32_bf16 v[68:71], a[8:11], a[52:55], v[68:71]
    v_mfma_f32_16x16x32_bf16 v[68:71], a[12:15], a[48:51], v[68:71]
    v_cvt_pk_bf16_f32 v28, v64, v65
    v_cvt_pk_bf16_f32 v29, v66, v67
    ds_write_b64 v8, v[28:29] offset:3072
    s_nop 4
    v_cvt_pk_bf16_f32 v30, v68, v69
    v_cvt_pk_bf16_f32 v31, v70, v71
    ds_write_b64 v8, v[30:31] offset:3584
    s_waitcnt lgkmcnt(0)
    s_barrier
    ds_read_b32 v172, v36 offset:0
    ds_read_b32 v173, v36 offset:19072
    ds_read_b32 v174, v36 offset:38144
    ds_read_b32 v175, v36 offset:57216
    ds_read_b32 v176, v36 offset:1024
    ds_read_b32 v177, v36 offset:20096
    ds_read_b32 v178, v36 offset:39168
    ds_read_b32 v179, v36 offset:58240
    ds_read_b32 v180, v36 offset:2048
    ds_read_b32 v181, v36 offset:21120
    ds_read_b32 v182, v36 offset:40192
    ds_read_b32 v183, v36 offset:59264
    ds_read_b32 v184, v36 offset:3072
    ds_read_b32 v185, v36 offset:22144
    ds_read_b32 v186, v36 offset:41216
    ds_read_b32 v187, v36 offset:60288
    s_lshl_b32 s42, s40, 14
    s_add_u32 s42, s42, 52428800
    s_waitcnt lgkmcnt(12)
    v_lshlrev_b32 v40, 16, v172
    v_and_b32 v44, 0xffff0000, v172
    v_lshlrev_b32 v41, 16, v173
    v_and_b32 v45, 0xffff0000, v173
    v_lshlrev_b32 v42, 16, v174
    v_and_b32 v46, 0xffff0000, v174
    v_lshlrev_b32 v43, 16, v175
    v_and_b32 v47, 0xffff0000, v175
    v_pk_fma_f32 v[40:41], v[204:205], v[12:13], v[40:41]
    v_pk_fma_f32 v[42:43], v[206:207], v[14:15], v[42:43]
    v_pk_fma_f32 v[44:45], v[208:209], v[12:13], v[44:45]
    v_pk_fma_f32 v[46:47], v[210:211], v[14:15], v[46:47]
    v_pk_fma_f32 v[40:41], v[40:41], v[92:93], v[100:101]
    v_pk_fma_f32 v[42:43], v[42:43], v[94:95], v[102:103]
    v_pk_fma_f32 v[44:45], v[44:45], v[92:93], v[104:105]
    v_pk_fma_f32 v[46:47], v[46:47], v[94:95], v[106:107]
    v_cvt_pk_bf16_f32 v140, v40, v41
    v_cvt_pk_bf16_f32 v141, v42, v43
    v_cvt_pk_bf16_f32 v142, v44, v45
    v_cvt_pk_bf16_f32 v143, v46, v47
    buffer_store_dwordx4 v[140:143], v34, s[56:59], s42 offen sc1
    s_add_u32 s42, s42, 4096
    s_waitcnt lgkmcnt(8)
    v_lshlrev_b32 v48, 16, v176
    v_and_b32 v52, 0xffff0000, v176
    v_lshlrev_b32 v49, 16, v177
    v_and_b32 v53, 0xffff0000, v177
    v_lshlrev_b32 v50, 16, v178
    v_and_b32 v54, 0xffff0000, v178
    v_lshlrev_b32 v51, 16, v179
    v_and_b32 v55, 0xffff0000, v179
    v_pk_fma_f32 v[48:49], v[212:213], v[12:13], v[48:49]
    v_pk_fma_f32 v[50:51], v[214:215], v[14:15], v[50:51]
    v_pk_fma_f32 v[52:53], v[216:217], v[12:13], v[52:53]
    v_pk_fma_f32 v[54:55], v[218:219], v[14:15], v[54:55]
    v_pk_fma_f32 v[48:49], v[48:49], v[92:93], v[108:109]
    v_pk_fma_f32 v[50:51], v[50:51], v[94:95], v[110:111]
    v_pk_fma_f32 v[52:53], v[52:53], v[92:93], v[112:113]
    v_pk_fma_f32 v[54:55], v[54:55], v[94:95], v[114:115]
    v_cvt_pk_bf16_f32 v144, v48, v49
    v_cvt_pk_bf16_f32 v145, v50, v51
    v_cvt_pk_bf16_f32 v146, v52, v53
    v_cvt_pk_bf16_f32 v147, v54, v55
    buffer_store_dwordx4 v[144:147], v34, s[56:59], s42 offen sc1
    s_add_u32 s42, s42, 4096
    s_waitcnt lgkmcnt(4)
    v_lshlrev_b32 v56, 16, v180
    v_and_b32 v60, 0xffff0000, v180
    v_lshlrev_b32 v57, 16, v181
    v_and_b32 v61, 0xffff0000, v181
    v_lshlrev_b32 v58, 16, v182
    v_and_b32 v62, 0xffff0000, v182
    v_lshlrev_b32 v59, 16, v183
    v_and_b32 v63, 0xffff0000, v183
    v_pk_fma_f32 v[56:57], v[220:221], v[12:13], v[56:57]
    v_pk_fma_f32 v[58:59], v[222:223], v[14:15], v[58:59]
    v_pk_fma_f32 v[60:61], v[224:225], v[12:13], v[60:61]
    v_pk_fma_f32 v[62:63], v[226:227], v[14:15], v[62:63]
    v_pk_fma_f32 v[56:57], v[56:57], v[92:93], v[116:117]
    v_pk_fma_f32 v[58:59], v[58:59], v[94:95], v[118:119]
    v_pk_fma_f32 v[60:61], v[60:61], v[92:93], v[120:121]
    v_pk_fma_f32 v[62:63], v[62:63], v[94:95], v[122:123]
    v_cvt_pk_bf16_f32 v148, v56, v57
    v_cvt_pk_bf16_f32 v149, v58, v59
    v_cvt_pk_bf16_f32 v150, v60, v61
    v_cvt_pk_bf16_f32 v151, v62, v63
    buffer_store_dwordx4 v[148:151], v34, s[56:59], s42 offen sc1
    s_add_u32 s42, s42, 4096
    s_waitcnt lgkmcnt(0)
    v_lshlrev_b32 v64, 16, v184
    v_and_b32 v68, 0xffff0000, v184
    v_lshlrev_b32 v65, 16, v185
    v_and_b32 v69, 0xffff0000, v185
    v_lshlrev_b32 v66, 16, v186
    v_and_b32 v70, 0xffff0000, v186
    v_lshlrev_b32 v67, 16, v187
    v_and_b32 v71, 0xffff0000, v187
    v_pk_fma_f32 v[64:65], v[228:229], v[12:13], v[64:65]
    v_pk_fma_f32 v[66:67], v[230:231], v[14:15], v[66:67]
    v_pk_fma_f32 v[68:69], v[232:233], v[12:13], v[68:69]
    v_pk_fma_f32 v[70:71], v[234:235], v[14:15], v[70:71]
    v_pk_fma_f32 v[64:65], v[64:65], v[92:93], v[124:125]
    v_pk_fma_f32 v[66:67], v[66:67], v[94:95], v[126:127]
    v_pk_fma_f32 v[68:69], v[68:69], v[92:93], v[128:129]
    v_pk_fma_f32 v[70:71], v[70:71], v[94:95], v[130:131]
    v_cvt_pk_bf16_f32 v152, v64, v65
    v_cvt_pk_bf16_f32 v153, v66, v67
    v_cvt_pk_bf16_f32 v154, v68, v69
    v_cvt_pk_bf16_f32 v155, v70, v71
    buffer_store_dwordx4 v[152:155], v34, s[56:59], s42 offen sc1
phase2:
    s_mov_b32 s8, s34
    s_mov_b32 s9, s35
    s_mov_b32 s10, 256
    s_mov_b32 s11, 0x20000
    s_sub_u32 vcc_lo, s2, 103
    s_sub_u32 vcc_hi, s2, 7
    s_cmp_lt_u32 vcc_hi, 9
    s_cselect_b32 vcc_hi, 96, 0
    s_cmp_lt_u32 vcc_lo, 9
    s_cselect_b32 vcc_hi, -96, vcc_hi
    s_add_u32 s2, s2, vcc_hi
    v_mov_b32 v5, 1
    v_mov_b32 v6, 0
    buffer_load_dwordx4 v[8:11], v6, s[8:11], 0 offen offset:192 sc1
    v_lshrrev_b32 v2, 4, v1
    v_and_b32 v3, 15, v1
    v_lshlrev_b32 v4, 4, v1
    s_and_b32 s20, s2, 1
    s_lshl_b32 s18, s20, 4
    s_bfe_u32 s20, s2, 0x20001
    s_lshl_b32 s19, s20, 1
    s_lshl_b32 s16, s20, 2
    s_add_u32 s16, s16, s18
    s_bfe_u32 s20, s2, 0x20003
    s_add_u32 s16, s16, s20
    s_lshr_b32 s17, s2, 5
    s_sub_u32 s17, s17, 2
    s_bfe_u32 s20, s2, 0x40003
    s_add_u32 s18, s18, s20
    s_lshr_b32 s20, s2, 7
    s_add_u32 s19, s19, s20
    s_lshl_b32 s25, s16, 2
    s_add_u32 s25, s25, s3
    s_mov_b32 s24, 0
    s_mov_b32 s4, s36
    s_mov_b32 s5, s37
    s_mov_b32 s6, 67108864
    s_mov_b32 s7, 0x20000
    s_mov_b32 s12, s36
    s_mov_b32 s13, s37
    s_mov_b32 s14, 67108864
    s_mov_b32 s15, 0x20000
    v_add_u32 v7, 4096, v4
    v_add_u32 v16, 8192, v4
    v_add_u32 v17, 12288, v4
    v_add_u32 v18, 16384, v4
    s_lshl_b32 s28, s19, 2
    s_add_u32 s28, s28, s3
    s_mul_i32 s28, s28, 165888
    s_add_u32 s29, s28, 24117248
    s_add_u32 s28, s28, 17825792
    s_lshl_b32 s30, s3, 10
    s_mul_i32 s38, s17, 110592
    s_mul_i32 s41, s3, 3072
    s_add_u32 s38, s38, s41
    s_add_u32 s38, s38, 15728640
    s_lshr_b32 s39, s3, 1
    s_mul_i32 s40, s3, 3072
    s_lshl_b32 s20, s3, 6
    v_add_u32 v192, s20, v1
    s_mul_i32 s20, s17, 12
    v_cmp_le_u32 vcc, 72, v192
    v_subrev_u32 v44, 72, v192
    s_nop 0
    v_cndmask_b32 v44, v192, v44, vcc
    v_add_u32 v44, s20, v44
    v_mov_b32 v46, 300160
    v_mov_b32 v47, 299008
    v_cndmask_b32 v46, v46, v47, vcc
    v_cmp_le_u32 vcc, 72, v44
    v_subrev_u32 v45, 72, v44
    s_nop 0
    v_cndmask_b32 v44, v44, v45, vcc
    v_lshl_add_u32 v193, v44, 4, v46
    s_mul_i32 s20, s17, 24
    s_sub_u32 s20, s20, 144
    v_add_u32 v44, s20, v192
    v_cmp_le_u32 vcc, 144, v44
    v_subrev_u32 v45, 144, v44
    s_nop 0
    v_cndmask_b32 v44, v44, v45, vcc
    v_lshlrev_b32 v44, 4, v44
    v_add_u32 v44, 287744, v44
    v_cmp_le_u32 vcc, 144, v192
    s_nop 1
    v_cndmask_b32 v193, v193, v44, vcc
    v_add_u32 v195, 256, v1
    s_mul_i32 s20, s17, 12
    v_cmp_le_u32 vcc, 72, v195
    v_subrev_u32 v44, 72, v195
    s_nop 0
    v_cndmask_b32 v44, v195, v44, vcc
    v_add_u32 v44, s20, v44
    v_mov_b32 v46, 300160
    v_mov_b32 v47, 299008
    v_cndmask_b32 v46, v46, v47, vcc
    v_cmp_le_u32 vcc, 72, v44
    v_subrev_u32 v45, 72, v44
    s_nop 0
    v_cndmask_b32 v44, v44, v45, vcc
    v_lshl_add_u32 v194, v44, 4, v46
    s_mul_i32 s20, s17, 24
    s_sub_u32 s20, s20, 144
    v_add_u32 v44, s20, v195
    v_cmp_le_u32 vcc, 144, v44
    v_subrev_u32 v45, 144, v44
    s_nop 0
    v_cndmask_b32 v44, v44, v45, vcc
    v_lshlrev_b32 v44, 4, v44
    v_add_u32 v44, 287744, v44
    v_cmp_le_u32 vcc, 144, v195
    s_nop 1
    v_cndmask_b32 v194, v194, v44, vcc
    v_mul_u32_u24 v195, 43691, v192
    v_lshrrev_b32 v195, 20, v195
    v_mul_u32_u24 v196, 120, v195
    v_add_u32 v196, v196, v192
    v_lshlrev_b32 v196, 4, v196
    s_mul_i32 s42, s17, 110592
    s_mul_i32 s45, s3, 3072
    s_add_u32 s42, s42, s45
    s_add_u32 s42, s42, 16777216
    s_lshr_b32 s43, s3, 1
    s_mul_i32 s44, s3, 3072
    s_lshl_b32 s20, s25, 4
    v_add_u32 v19, s20, v3
    v_lshlrev_b32 v190, 15, v2
    v_lshl_add_u32 v190, v19, 3, v190
    v_add_u32 v191, 0x4000, v190
    v_mov_b32 v200, 0x3f803f80
    v_mov_b32 v201, 0x3f803f80
    v_mov_b32 v202, 0x3f803f80
    v_mov_b32 v203, 0x3f803f80
    v_and_b32 v192, 3, v3
    v_cmp_eq_u32 s[46:47], 1, v192
    v_cmp_eq_u32 s[48:49], 2, v192
    v_cmp_eq_u32 s[50:51], 3, v192
    v_min_u32 v192, 2, v192
    v_mul_u32_u24 v199, 1152, v192
    v_lshl_add_u32 v199, v2, 4, v199
    v_add_u32 v199, 57216, v199
    v_lshlrev_b32 v197, 5, v2
    v_add_u32 v197, 60672, v197
    v_lshrrev_b32 v192, 2, v3
    v_lshl_add_u32 v192, v192, 4, v3
    v_lshlrev_b32 v198, 2, v192
    v_add_u32 v244, 0xf000, v4
    v_add_u32 v245, 0x1e000, v4
    v_lshlrev_b32 v192, 4, v0
    v_add_u32 v192, 57216, v192
spin_adaLN_cond__ssm_conv_s4d__mixer_s_mlp__prompt_38:
    s_waitcnt vmcnt(0)
    v_cmp_eq_u32 vcc, 0, v8
    s_nop 0
    s_cmp_eq_u64 vcc, 0
    s_cbranch_scc0 slow_adaLN_cond__ssm_conv_s4d__mixer_s_mlp__prompt_40
    s_waitcnt lgkmcnt(0)
    s_barrier
    s_sub_u32 s20, s2, 7
    s_cmp_lt_u32 s20, 9
    s_cbranch_scc1 noarr_adaLN_cond__ssm_conv_s4d__mixer_s_mlp__prompt_41
    s_cmp_lg_u32 s3, 0
    s_cbranch_scc1 noarr_adaLN_cond__ssm_conv_s4d__mixer_s_mlp__prompt_41
    s_lshr_b32 s21, s2, 3
    s_and_b32 s21, s21, 3
    s_lshl_b32 s20, s21, 7
    s_add_u32 s20, s20, 37888
    s_mov_b64 exec, 1
    v_mov_b32 v12, 1
    buffer_atomic_add v12, v6, s[4:7], s20 offen sc0 sc1
    s_cmp_eq_u32 s21, 0
    s_cselect_b32 s31, 62, 63
    s_cmp_eq_u32 s21, 1
    s_cselect_b32 s31, 55, s31
    s_add_u32 s21, s20, 1024
    s_waitcnt vmcnt(0)
    v_readfirstlane_b32 s20, v12
    s_nop 0
    s_cmp_lg_u32 s20, s31
    s_cbranch_scc1 notlast_adaLN_cond__ssm_conv_s4d__mixer_s_mlp__prompt_42
    buffer_store_dword v5, v6, s[4:7], s21 offen sc1
notlast_adaLN_cond__ssm_conv_s4d__mixer_s_mlp__prompt_42:
    s_mov_b64 exec, -1
noarr_adaLN_cond__ssm_conv_s4d__mixer_s_mlp__prompt_41:
    v_and_b32 v13, 3, v1
    v_lshlrev_b32 v13, 7, v13
    v_add_u32 v13, 38912, v13
    s_cmp_lt_u32 s2, 64
    s_cbranch_scc1 k2_idle
spin_adaLN_cond__ssm_conv_s4d__mixer_s_mlp__prompt_46:
    s_waitcnt vmcnt(0)
    v_and_b32 v15, v10, v11
    v_cmp_eq_u32 vcc, 0, v15
    s_nop 0
    s_cmp_eq_u64 vcc, 0
    s_cbranch_scc0 slow_adaLN_cond__ssm_conv_s4d__mixer_s_mlp__prompt_48
    s_add_u32 m0, s30, 58368
    s_nop 0
    buffer_load_dwordx4 v193, s[4:7], 0 offen sc1 lds
    s_mov_b32 m0, 62464
    s_mov_b32 exec_hi, 0
    buffer_load_dwordx4 v194, s[4:7], 0 offen sc1 lds
    s_mov_b64 exec, -1
    s_cmp_lt_u32 s2, 112
    s_cbranch_scc1 havew1_adaLN_cond__ssm_conv_s4d__mixer_s_mlp__prompt_43_x
havew1_adaLN_cond__ssm_conv_s4d__mixer_s_mlp__prompt_43:
    s_barrier
    s_cmp_eq_u32 s3, 0
    s_cbranch_scc1 rest_adaLN_cond__ssm_conv_s4d__mixer_s_mlp__prompt_44
    s_lshl_b32 s41, s3, 11
    s_sub_u32 s41, s41, 2048
    s_mul_i32 s38, s17, 110592
    s_add_u32 s38, s38, s41
    s_add_u32 s38, s38, 15790080
    s_add_u32 m0, s41, 156160
    s_nop 0
    buffer_load_dwordx4 v4, s[4:7], s38 offen sc1 lds
    buffer_load_dwordx4 v4, s[4:7], s38 offen offset:1024 sc1 lds
    s_add_u32 s38, s38, 6144
    s_add_u32 m0, s41, 76288
    s_nop 0
    buffer_load_dwordx4 v4, s[4:7], s38 offen sc1 lds
    buffer_load_dwordx4 v4, s[4:7], s38 offen offset:1024 sc1 lds
    s_add_u32 s38, s38, 6144
    s_add_u32 m0, s41, 82432
    s_nop 0
    buffer_load_dwordx4 v4, s[4:7], s38 offen sc1 lds
    buffer_load_dwordx4 v4, s[4:7], s38 offen offset:1024 sc1 lds
    s_add_u32 s38, s38, 6144
    s_add_u32 m0, s41, 88576
    s_nop 0
    buffer_load_dwordx4 v4, s[4:7], s38 offen sc1 lds
    buffer_load_dwordx4 v4, s[4:7], s38 offen offset:1024 sc1 lds
    s_add_u32 s38, s38, 6144
    s_add_u32 m0, s41, 12288
    s_nop 0
    buffer_load_dwordx4 v4, s[4:7], s38 offen sc1 lds
    buffer_load_dwordx4 v4, s[4:7], s38 offen offset:1024 sc1 lds
    s_add_u32 s38, s38, 6144
    s_add_u32 m0, s41, 31360
    s_nop 0
    buffer_load_dwordx4 v4, s[4:7], s38 offen sc1 lds
    buffer_load_dwordx4 v4, s[4:7], s38 offen offset:1024 sc1 lds
    s_add_u32 s38, s38, 6144
    s_add_u32 m0, s41, 50432
    s_nop 0
    buffer_load_dwordx4 v4, s[4:7], s38 offen sc1 lds
    buffer_load_dwordx4 v4, s[4:7], s38 offen offset:1024 sc1 lds
    s_add_u32 s38, s38, 6144
    s_add_u32 m0, s41, 69504
    s_nop 0
    buffer_load_dwordx4 v4, s[4:7], s38 offen sc1 lds
    buffer_load_dwordx4 v4, s[4:7], s38 offen offset:1024 sc1 lds
rest_adaLN_cond__ssm_conv_s4d__mixer_s_mlp__prompt_44:
    v_cmp_gt_u32 vcc, 72, v0
    s_nop 0
    s_and_saveexec_b64 s[22:23], vcc
    ds_write_b128 v192, v[200:203]
    s_mov_b64 exec, s[22:23]
    s_cmp_lg_u32 s3, 0
    s_cbranch_scc1 joined_adaLN_cond__ssm_conv_s4d__mixer_s_mlp__prompt_45
    buffer_load_dword v8, v13, s[4:7], 0 offen sc1
spin_adaLN_cond__ssm_conv_s4d__mixer_s_mlp__prompt_49:
    s_waitcnt vmcnt(0)
    v_cmp_eq_u32 vcc, 0, v8
    s_nop 0
    s_cmp_eq_u64 vcc, 0
    s_cbranch_scc1 slow_adaLN_cond__ssm_conv_s4d__mixer_s_mlp__prompt_51
    s_sleep 2
    buffer_load_dword v8, v13, s[4:7], 0 offen sc1
    s_add_u32 s24, s24, 1
    s_cmp_lt_u32 s24, 40000
    s_cbranch_scc1 spin_adaLN_cond__ssm_conv_s4d__mixer_s_mlp__prompt_49
    s_branch all_done
slow_adaLN_cond__ssm_conv_s4d__mixer_s_mlp__prompt_51:
joined_adaLN_cond__ssm_conv_s4d__mixer_s_mlp__prompt_45:
    s_mul_i32 s21, s17, 393216
    s_add_u32 s21, s21, 52428800
    s_mul_i32 s31, s17, 384
    s_add_u32 s31, s31, 285440
    s_waitcnt vmcnt(16) lgkmcnt(0)
    s_barrier
    buffer_load_dwordx2 v[44:45], v190, s[4:7], s21 offen sc1
    buffer_load_dwordx2 v[46:47], v191, s[4:7], s21 offen sc1
    s_add_u32 s21, s21, 131072
    buffer_load_dwordx2 v[48:49], v190, s[4:7], s21 offen sc1
    buffer_load_dwordx2 v[50:51], v191, s[4:7], s21 offen sc1
    s_add_u32 s21, s21, 131072
    buffer_load_dwordx2 v[52:53], v190, s[4:7], s21 offen sc1
    buffer_load_dwordx2 v[54:55], v191, s[4:7], s21 offen sc1
    s_add_u32 s21, s21, 131072
    s_cmp_eq_u32 s21, 54788096
    s_cselect_b32 s21, 52428800, s21
    buffer_load_dwordx2 v[56:57], v190, s[4:7], s21 offen sc1
    buffer_load_dwordx2 v[58:59], v191, s[4:7], s21 offen sc1
    s_add_u32 s21, s21, 131072
    buffer_load_dwordx2 v[60:61], v190, s[4:7], s21 offen sc1
    buffer_load_dwordx2 v[62:63], v191, s[4:7], s21 offen sc1
    s_add_u32 s21, s21, 131072
    s_mov_b32 s20, 39424
    buffer_load_dword v8, v6, s[4:7], s20 offen sc1
    ds_read_b128 a[72:75], v199 offset:0
    ds_read_b128 a[76:79], v199 offset:64
    ds_read_b128 a[80:83], v199 offset:128
    ds_read_b128 a[84:87], v199 offset:192
    ds_read_b128 a[88:91], v199 offset:256
    ds_read_b128 a[92:95], v199 offset:320
    ds_read_b128 a[96:99], v199 offset:384
    ds_read_b128 a[100:103], v199 offset:448
    ds_read_b128 a[104:107], v199 offset:512
    ds_read_b128 a[108:111], v199 offset:576
    ds_read_b128 a[112:115], v199 offset:640
    ds_read_b128 a[116:119], v199 offset:704
    ds_read_b128 a[120:123], v199 offset:768
    ds_read_b128 a[124:127], v199 offset:832
    ds_read_b128 a[128:131], v199 offset:896
    ds_read_b128 a[132:135], v199 offset:960
    ds_read_b128 a[136:139], v199 offset:1024
    ds_read_b128 a[140:143], v199 offset:1088
    ds_read_b128 a[144:147], v244 offset:33280
    ds_read_b128 a[148:151], v244 offset:34304
    ds_read_b128 a[152:155], v244 offset:35328
    ds_read_b128 a[156:159], v244 offset:36352
    ds_read_b128 a[160:163], v244 offset:37376
    ds_read_b128 a[164:167], v244 offset:38400
    s_waitcnt lgkmcnt(15)
    v_mfma_f32_16x16x32_bf16 v[224:227], a[72:75], a[72:75], 0
    v_mfma_f32_16x16x32_bf16 v[224:227], a[76:79], a[76:79], v[224:227]
    v_mfma_f32_16x16x32_bf16 v[224:227], a[80:83], a[80:83], v[224:227]
    v_mfma_f32_16x16x32_bf16 v[224:227], a[84:87], a[84:87], v[224:227]
    v_mfma_f32_16x16x32_bf16 v[224:227], a[88:91], a[88:91], v[224:227]
    v_mfma_f32_16x16x32_bf16 v[224:227], a[92:95], a[92:95], v[224:227]
    v_mfma_f32_16x16x32_bf16 v[224:227], a[96:99], a[96:99], v[224:227]
    v_mfma_f32_16x16x32_bf16 v[224:227], a[100:103], a[100:103], v[224:227]
    v_mfma_f32_16x16x32_bf16 v[224:227], a[104:107], a[104:107], v[224:227]
    s_waitcnt lgkmcnt(14)
    v_mfma_f32_16x16x32_bf16 v[224:227], a[108:111], a[108:111], v[224:227]
    s_waitcnt lgkmcnt(13)
    v_mfma_f32_16x16x32_bf16 v[224:227], a[112:115], a[112:115], v[224:227]
    s_waitcnt lgkmcnt(12)
    v_mfma_f32_16x16x32_bf16 v[224:227], a[116:119], a[116:119], v[224:227]
    s_waitcnt lgkmcnt(11)
    v_mfma_f32_16x16x32_bf16 v[224:227], a[120:123], a[120:123], v[224:227]
    s_waitcnt lgkmcnt(10)
    v_mfma_f32_16x16x32_bf16 v[224:227], a[124:127], a[124:127], v[224:227]
    s_waitcnt lgkmcnt(9)
    v_mfma_f32_16x16x32_bf16 v[224:227], a[128:131], a[128:131], v[224:227]
    s_waitcnt lgkmcnt(8)
    v_mfma_f32_16x16x32_bf16 v[224:227], a[132:135], a[132:135], v[224:227]
    s_waitcnt lgkmcnt(7)
    v_mfma_f32_16x16x32_bf16 v[224:227], a[136:139], a[136:139], v[224:227]
    s_waitcnt lgkmcnt(6)
    v_mfma_f32_16x16x32_bf16 v[224:227], a[140:143], a[140:143], v[224:227]
    s_nop 7
    v_readlane_b32 s52, v224, 1
    v_readlane_b32 s53, v224, 2
    v_readlane_b32 s54, v225, 1
    v_readlane_b32 s55, v225, 2
    v_readlane_b32 s56, v226, 2
    ds_read_b128 v[124:127], v197 offset:0
    ds_read_b128 v[128:131], v197 offset:16
    ds_read_b128 v[132:135], v197 offset:128
    ds_read_b128 v[136:139], v197 offset:144
    s_waitcnt vmcnt(9)
    s_waitcnt lgkmcnt(2)
    v_lshlrev_b32 v140, 16, v44
    v_and_b32 v141, 0xffff0000, v44
    v_lshlrev_b32 v142, 16, v45
    v_and_b32 v143, 0xffff0000, v45
    v_lshlrev_b32 v144, 16, v46
    v_and_b32 v145, 0xffff0000, v46
    v_lshlrev_b32 v146, 16, v47
    v_and_b32 v147, 0xffff0000, v47
    v_mul_f32 v140, v140, v124
    v_mul_f32 v141, v141, v125
    v_mul_f32 v142, v142, v126
    v_mul_f32 v143, v143, v127
    v_mul_f32 v144, v144, v128
    v_mul_f32 v145, v145, v129
    v_mul_f32 v146, v146, v130
    v_mul_f32 v147, v147, v131
    v_cvt_pk_bf16_f32 v116, v140, v141
    v_cvt_pk_bf16_f32 v117, v142, v143
    v_cvt_pk_bf16_f32 v118, v144, v145
    v_cvt_pk_bf16_f32 v119, v146, v147
    v_mfma_f32_16x16x32_bf16 v[204:207], v[200:203], v[44:47], 0
    ds_read_b128 a[168:171], v244 offset:39424
    s_waitcnt vmcnt(7)
    v_lshlrev_b32 v140, 16, v48
    v_and_b32 v141, 0xffff0000, v48
    v_mfma_f32_16x16x32_bf16 v[208:211], v[44:47], v[44:47], 0
    ds_read_b128 a[172:175], v244 offset:40448
    v_lshlrev_b32 v142, 16, v49
    v_and_b32 v143, 0xffff0000, v49
    v_mfma_f32_16x16x32_bf16 v[212:215], a[72:75], v[116:119], 0
    ds_read_b128 a[176:179], v244 offset:41472
    v_lshlrev_b32 v144, 16, v50
    v_and_b32 v145, 0xffff0000, v50
    v_mfma_f32_16x16x32_bf16 v[216:219], v[116:119], v[116:119], 0
    ds_read_b128 a[180:183], v244 offset:42496
    v_lshlrev_b32 v146, 16, v51
    v_and_b32 v147, 0xffff0000, v51
    v_mfma_f32_16x16x32_bf16 v[220:223], a[144:147], v[116:119], 0
    ds_read_b128 a[184:187], v244 offset:43520
    s_waitcnt lgkmcnt(5)
    v_mul_f32 v140, v140, v132
    v_mul_f32 v141, v141, v133
    v_mfma_f32_16x16x32_bf16 v[224:227], a[148:151], v[116:119], 0
    ds_read_b128 a[188:191], v244 offset:44544
    v_mul_f32 v142, v142, v134
    v_mul_f32 v143, v143, v135
    v_mfma_f32_16x16x32_bf16 v[228:231], a[152:155], v[116:119], 0
    v_mul_f32 v144, v144, v136
    v_mul_f32 v145, v145, v137
    v_mfma_f32_16x16x32_bf16 v[232:235], a[156:159], v[116:119], 0
    v_mul_f32 v146, v146, v138
    v_mul_f32 v147, v147, v139
    v_mfma_f32_16x16x32_bf16 v[236:239], a[160:163], v[116:119], 0
    ds_read_b128 v[124:127], v197 offset:256
    v_cvt_pk_bf16_f32 v120, v140, v141
    v_cvt_pk_bf16_f32 v121, v142, v143
    v_mfma_f32_16x16x32_bf16 v[240:243], a[164:167], v[116:119], 0
    ds_read_b128 v[128:131], v197 offset:272
    v_cvt_pk_bf16_f32 v122, v144, v145
    v_cvt_pk_bf16_f32 v123, v146, v147
    buffer_load_dwordx2 v[64:65], v190, s[4:7], s21 offen sc1
    buffer_load_dwordx2 v[66:67], v191, s[4:7], s21 offen sc1
    s_add_u32 s21, s21, 131072
    s_cmp_eq_u32 s21, 54788096
    s_cselect_b32 s21, 52428800, s21
    buffer_load_dwordx2 v[68:69], v190, s[4:7], s21 offen sc1
    buffer_load_dwordx2 v[70:71], v191, s[4:7], s21 offen sc1
    s_add_u32 s21, s21, 131072
    v_mfma_f32_16x16x32_bf16 v[204:207], v[200:203], v[48:51], v[204:207]
    ds_read_b128 a[144:147], v244 offset:45568
    s_waitcnt vmcnt(9)
    v_lshlrev_b32 v140, 16, v52
    v_and_b32 v141, 0xffff0000, v52
    v_mfma_f32_16x16x32_bf16 v[208:211], v[48:51], v[48:51], v[208:211]
    ds_read_b128 a[148:151], v244 offset:46592
    v_lshlrev_b32 v142, 16, v53
    v_and_b32 v143, 0xffff0000, v53
    v_mfma_f32_16x16x32_bf16 v[212:215], a[76:79], v[120:123], v[212:215]
    ds_read_b128 a[152:155], v244 offset:47616
    v_lshlrev_b32 v144, 16, v54
    v_and_b32 v145, 0xffff0000, v54
    v_mfma_f32_16x16x32_bf16 v[216:219], v[120:123], v[120:123], v[216:219]
    ds_read_b128 a[156:159], v244 offset:48640
    v_lshlrev_b32 v146, 16, v55
    v_and_b32 v147, 0xffff0000, v55
    s_waitcnt lgkmcnt(11)
    v_mfma_f32_16x16x32_bf16 v[220:223], a[168:171], v[120:123], v[220:223]
    ds_read_b128 a[160:163], v244 offset:49664
    s_waitcnt lgkmcnt(5)
    v_mul_f32 v140, v140, v124
    v_mul_f32 v141, v141, v125
    v_mfma_f32_16x16x32_bf16 v[224:227], a[172:175], v[120:123], v[224:227]
    ds_read_b128 a[164:167], v244 offset:50688
    v_mul_f32 v142, v142, v126
    v_mul_f32 v143, v143, v127
    v_mfma_f32_16x16x32_bf16 v[228:231], a[176:179], v[120:123], v[228:231]
    v_mul_f32 v144, v144, v128
    v_mul_f32 v145, v145, v129
    v_mfma_f32_16x16x32_bf16 v[232:235], a[180:183], v[120:123], v[232:235]
    v_mul_f32 v146, v146, v130
    v_mul_f32 v147, v147, v131
    v_mfma_f32_16x16x32_bf16 v[236:239], a[184:187], v[120:123], v[236:239]
    ds_read_b128 v[132:135], v197 offset:384
    v_cvt_pk_bf16_f32 v116, v140, v141
    v_cvt_pk_bf16_f32 v117, v142, v143
    v_mfma_f32_16x16x32_bf16 v[240:243], a[188:191], v[120:123], v[240:243]
    ds_read_b128 v[136:139], v197 offset:400
    v_cvt_pk_bf16_f32 v118, v144, v145
    v_cvt_pk_bf16_f32 v119, v146, v147
    buffer_load_dwordx2 v[72:73], v190, s[4:7], s21 offen sc1
    buffer_load_dwordx2 v[74:75], v191, s[4:7], s21 offen sc1
    s_add_u32 s21, s21, 131072
    buffer_load_dwordx2 v[76:77], v190, s[4:7], s21 offen sc1
    buffer_load_dwordx2 v[78:79], v191, s[4:7], s21 offen sc1
    s_add_u32 s21, s21, 131072
    s_cmp_eq_u32 s21, 54788096
    s_cselect_b32 s21, 52428800, s21
    v_mfma_f32_16x16x32_bf16 v[204:207], v[200:203], v[52:55], v[204:207]
    ds_read_b128 a[168:171], v244 offset:51712
    s_waitcnt vmcnt(11)
    v_lshlrev_b32 v140, 16, v56
    v_and_b32 v141, 0xffff0000, v56
    v_mfma_f32_16x16x32_bf16 v[208:211], v[52:55], v[52:55], v[208:211]
    ds_read_b128 a[172:175], v244 offset:52736
    v_lshlrev_b32 v142, 16, v57
    v_and_b32 v143, 0xffff0000, v57
    v_mfma_f32_16x16x32_bf16 v[212:215], a[80:83], v[116:119], v[212:215]
    ds_read_b128 a[176:179], v244 offset:53760
    v_lshlrev_b32 v144, 16, v58
    v_and_b32 v145, 0xffff0000, v58
    v_mfma_f32_16x16x32_bf16 v[216:219], v[116:119], v[116:119], v[216:219]
    ds_read_b128 a[180:183], v244 offset:54784
    v_lshlrev_b32 v146, 16, v59
    v_and_b32 v147, 0xffff0000, v59
    s_waitcnt lgkmcnt(11)
    v_mfma_f32_16x16x32_bf16 v[220:223], a[144:147], v[116:119], v[220:223]
    ds_read_b128 a[184:187], v244 offset:55808
    s_waitcnt lgkmcnt(5)
    v_mul_f32 v140, v140, v132
    v_mul_f32 v141, v141, v133
    v_mfma_f32_16x16x32_bf16 v[224:227], a[148:151], v[116:119], v[224:227]
    ds_read_b128 a[188:191], v244 offset:56832
    v_mul_f32 v142, v142, v134
    v_mul_f32 v143, v143, v135
    v_mfma_f32_16x16x32_bf16 v[228:231], a[152:155], v[116:119], v[228:231]
    v_mul_f32 v144, v144, v136
    v_mul_f32 v145, v145, v137
    v_mfma_f32_16x16x32_bf16 v[232:235], a[156:159], v[116:119], v[232:235]
    v_mul_f32 v146, v146, v138
    v_mul_f32 v147, v147, v139
    v_mfma_f32_16x16x32_bf16 v[236:239], a[160:163], v[116:119], v[236:239]
    ds_read_b128 v[124:127], v197 offset:512
    v_cvt_pk_bf16_f32 v120, v140, v141
    v_cvt_pk_bf16_f32 v121, v142, v143
    v_mfma_f32_16x16x32_bf16 v[240:243], a[164:167], v[116:119], v[240:243]
    ds_read_b128 v[128:131], v197 offset:528
    v_cvt_pk_bf16_f32 v122, v144, v145
    v_cvt_pk_bf16_f32 v123, v146, v147
    buffer_load_dwordx2 v[80:81], v190, s[4:7], s21 offen sc1
    buffer_load_dwordx2 v[82:83], v191, s[4:7], s21 offen sc1
    s_add_u32 s21, s21, 131072
    buffer_load_dwordx2 v[84:85], v190, s[4:7], s21 offen sc1
    buffer_load_dwordx2 v[86:87], v191, s[4:7], s21 offen sc1
    s_add_u32 s21, s21, 131072
    v_mfma_f32_16x16x32_bf16 v[204:207], v[200:203], v[56:59], v[204:207]
    ds_read_b128 a[144:147], v244 offset:57856
    s_waitcnt vmcnt(13)
    v_lshlrev_b32 v140, 16, v60
    v_and_b32 v141, 0xffff0000, v60
    v_mfma_f32_16x16x32_bf16 v[208:211], v[56:59], v[56:59], v[208:211]
    ds_read_b128 a[148:151], v244 offset:58880
    v_lshlrev_b32 v142, 16, v61
    v_and_b32 v143, 0xffff0000, v61
    v_mfma_f32_16x16x32_bf16 v[212:215], a[84:87], v[120:123], v[212:215]
    ds_read_b128 a[152:155], v244 offset:59904
    v_lshlrev_b32 v144, 16, v62
    v_and_b32 v145, 0xffff0000, v62
    v_mfma_f32_16x16x32_bf16 v[216:219], v[120:123], v[120:123], v[216:219]
    ds_read_b128 a[156:159], v244 offset:60928
    v_lshlrev_b32 v146, 16, v63
    v_and_b32 v147, 0xffff0000, v63
    s_waitcnt lgkmcnt(11)
    v_mfma_f32_16x16x32_bf16 v[220:223], a[168:171], v[120:123], v[220:223]
    ds_read_b128 a[160:163], v245 offset:512
    s_waitcnt lgkmcnt(5)
    v_mul_f32 v140, v140, v124
    v_mul_f32 v141, v141, v125
    v_mfma_f32_16x16x32_bf16 v[224:227], a[172:175], v[120:123], v[224:227]
    ds_read_b128 a[164:167], v245 offset:1536
    v_mul_f32 v142, v142, v126
    v_mul_f32 v143, v143, v127
    v_mfma_f32_16x16x32_bf16 v[228:231], a[176:179], v[120:123], v[228:231]
    v_mul_f32 v144, v144, v128
    v_mul_f32 v145, v145, v129
    v_mfma_f32_16x16x32_bf16 v[232:235], a[180:183], v[120:123], v[232:235]
    v_mul_f32 v146, v146, v130
    v_mul_f32 v147, v147, v131
    v_mfma_f32_16x16x32_bf16 v[236:239], a[184:187], v[120:123], v[236:239]
    ds_read_b128 v[132:135], v197 offset:640
    v_cvt_pk_bf16_f32 v116, v140, v141
    v_cvt_pk_bf16_f32 v117, v142, v143
    v_mfma_f32_16x16x32_bf16 v[240:243], a[188:191], v[120:123], v[240:243]
    ds_read_b128 v[136:139], v197 offset:656
    v_cvt_pk_bf16_f32 v118, v144, v145
    v_cvt_pk_bf16_f32 v119, v146, v147
    buffer_load_dwordx2 v[88:89], v190, s[4:7], s21 offen sc1
    buffer_load_dwordx2 v[90:91], v191, s[4:7], s21 offen sc1
    s_add_u32 s21, s21, 131072
    s_cmp_eq_u32 s21, 54788096
    s_cselect_b32 s21, 52428800, s21
    buffer_load_dwordx2 v[92:93], v190, s[4:7], s21 offen sc1
    buffer_load_dwordx2 v[94:95], v191, s[4:7], s21 offen sc1
    s_add_u32 s21, s21, 131072
    v_mfma_f32_16x16x32_bf16 v[204:207], v[200:203], v[60:63], v[204:207]
    ds_read_b128 a[168:171], v245 offset:2560
    s_waitcnt vmcnt(14)
    v_lshlrev_b32 v140, 16, v64
    v_and_b32 v141, 0xffff0000, v64
    v_mfma_f32_16x16x32_bf16 v[208:211], v[60:63], v[60:63], v[208:211]
    ds_read_b128 a[172:175], v245 offset:3584
    v_lshlrev_b32 v142, 16, v65
    v_and_b32 v143, 0xffff0000, v65
    v_mfma_f32_16x16x32_bf16 v[212:215], a[88:91], v[116:119], v[212:215]
    ds_read_b128 a[176:179], v245 offset:4608
    v_lshlrev_b32 v144, 16, v66
    v_and_b32 v145, 0xffff0000, v66
    v_mfma_f32_16x16x32_bf16 v[216:219], v[116:119], v[116:119], v[216:219]
    ds_read_b128 a[180:183], v245 offset:5632
    v_lshlrev_b32 v146, 16, v67
    v_and_b32 v147, 0xffff0000, v67
    s_waitcnt lgkmcnt(11)
    v_mfma_f32_16x16x32_bf16 v[220:223], a[144:147], v[116:119], v[220:223]
    ds_read_b128 a[184:187], v245 offset:6656
    s_waitcnt lgkmcnt(5)
    v_mul_f32 v140, v140, v132
    v_mul_f32 v141, v141, v133
    v_mfma_f32_16x16x32_bf16 v[224:227], a[148:151], v[116:119], v[224:227]
    ds_read_b128 a[188:191], v245 offset:7680
    v_mul_f32 v142, v142, v134
    v_mul_f32 v143, v143, v135
    v_mfma_f32_16x16x32_bf16 v[228:231], a[152:155], v[116:119], v[228:231]
    v_mul_f32 v144, v144, v136
    v_mul_f32 v145, v145, v137
    v_mfma_f32_16x16x32_bf16 v[232:235], a[156:159], v[116:119], v[232:235]
    v_mul_f32 v146, v146, v138
    v_mul_f32 v147, v147, v139
    v_mfma_f32_16x16x32_bf16 v[236:239], a[160:163], v[116:119], v[236:239]
    ds_read_b128 v[124:127], v197 offset:768
    v_cvt_pk_bf16_f32 v120, v140, v141
    v_cvt_pk_bf16_f32 v121, v142, v143
    v_mfma_f32_16x16x32_bf16 v[240:243], a[164:167], v[116:119], v[240:243]
    ds_read_b128 v[128:131], v197 offset:784
    v_cvt_pk_bf16_f32 v122, v144, v145
    v_cvt_pk_bf16_f32 v123, v146, v147
    buffer_load_dwordx2 v[96:97], v190, s[4:7], s21 offen sc1
    buffer_load_dwordx2 v[98:99], v191, s[4:7], s21 offen sc1
    s_add_u32 s21, s21, 131072
    v_mfma_f32_16x16x32_bf16 v[204:207], v[200:203], v[64:67], v[204:207]
    ds_read_b128 a[144:147], v245 offset:8704
    s_waitcnt vmcnt(14)
    v_lshlrev_b32 v140, 16, v68
    v_and_b32 v141, 0xffff0000, v68
    v_mfma_f32_16x16x32_bf16 v[208:211], v[64:67], v[64:67], v[208:211]
    ds_read_b128 a[148:151], v245 offset:9728
    v_lshlrev_b32 v142, 16, v69
    v_and_b32 v143, 0xffff0000, v69
    v_mfma_f32_16x16x32_bf16 v[212:215], a[92:95], v[120:123], v[212:215]
    ds_read_b128 a[152:155], v245 offset:10752
    v_lshlrev_b32 v144, 16, v70
    v_and_b32 v145, 0xffff0000, v70
    v_mfma_f32_16x16x32_bf16 v[216:219], v[120:123], v[120:123], v[216:219]
    ds_read_b128 a[156:159], v245 offset:11776
    v_lshlrev_b32 v146, 16, v71
    v_and_b32 v147, 0xffff0000, v71
    s_waitcnt lgkmcnt(11)
    v_mfma_f32_16x16x32_bf16 v[220:223], a[168:171], v[120:123], v[220:223]
    ds_read_b128 a[160:163], v245 offset:12800
    s_waitcnt lgkmcnt(5)
    v_mul_f32 v140, v140, v124
    v_mul_f32 v141, v141, v125
    v_mfma_f32_16x16x32_bf16 v[224:227], a[172:175], v[120:123], v[224:227]
    ds_read_b128 a[164:167], v245 offset:13824
    v_mul_f32 v142, v142, v126
    v_mul_f32 v143, v143, v127
    v_mfma_f32_16x16x32_bf16 v[228:231], a[176:179], v[120:123], v[228:231]
    v_mul_f32 v144, v144, v128
    v_mul_f32 v145, v145, v129
    v_mfma_f32_16x16x32_bf16 v[232:235], a[180:183], v[120:123], v[232:235]
    v_mul_f32 v146, v146, v130
    v_mul_f32 v147, v147, v131
    v_mfma_f32_16x16x32_bf16 v[236:239], a[184:187], v[120:123], v[236:239]
    ds_read_b128 v[132:135], v197 offset:896
    v_cvt_pk_bf16_f32 v116, v140, v141
    v_cvt_pk_bf16_f32 v117, v142, v143
    v_mfma_f32_16x16x32_bf16 v[240:243], a[188:191], v[120:123], v[240:243]
    ds_read_b128 v[136:139], v197 offset:912
    v_cvt_pk_bf16_f32 v118, v144, v145
    v_cvt_pk_bf16_f32 v119, v146, v147
upoll_adaLN_cond__ssm_conv_s4d__mixer_s_mlp__prompt_53:
    v_cmp_gt_u32 vcc, 9, v8
    s_nop 0
    s_cmp_eq_u64 vcc, 0
    s_cbranch_scc0 slow_adaLN_cond__ssm_conv_s4d__mixer_s_mlp__prompt_54
    s_add_u32 m0, s30, 63360
    s_nop 0
    buffer_load_dwordx4 v196, s[4:7], s31 offen sc1 lds
    buffer_load_dwordx2 v[100:101], v190, s[4:7], s21 offen sc1
    buffer_load_dwordx2 v[102:103], v191, s[4:7], s21 offen sc1
    s_add_u32 s21, s21, 131072
    s_cmp_eq_u32 s21, 54788096
    s_cselect_b32 s21, 52428800, s21
    v_mfma_f32_16x16x32_bf16 v[204:207], v[200:203], v[68:71], v[204:207]
    ds_read_b128 a[168:171], v245 offset:14848
    s_waitcnt vmcnt(15)
    v_lshlrev_b32 v140, 16, v72
    v_and_b32 v141, 0xffff0000, v72
    v_mfma_f32_16x16x32_bf16 v[208:211], v[68:71], v[68:71], v[208:211]
    ds_read_b128 a[172:175], v245 offset:15872
    v_lshlrev_b32 v142, 16, v73
    v_and_b32 v143, 0xffff0000, v73
    v_mfma_f32_16x16x32_bf16 v[212:215], a[96:99], v[116:119], v[212:215]
    ds_read_b128 a[176:179], v245 offset:16896
    v_lshlrev_b32 v144, 16, v74
    v_and_b32 v145, 0xffff0000, v74
    v_mfma_f32_16x16x32_bf16 v[216:219], v[116:119], v[116:119], v[216:219]
    ds_read_b128 a[180:183], v245 offset:17920
    v_lshlrev_b32 v146, 16, v75
    v_and_b32 v147, 0xffff0000, v75
    s_waitcnt lgkmcnt(11)
    v_mfma_f32_16x16x32_bf16 v[220:223], a[144:147], v[116:119], v[220:223]
    ds_read_b128 a[184:187], v245 offset:18944
    s_waitcnt lgkmcnt(5)
    v_mul_f32 v140, v140, v132
    v_mul_f32 v141, v141, v133
    v_mfma_f32_16x16x32_bf16 v[224:227], a[148:151], v[116:119], v[224:227]
    ds_read_b128 a[188:191], v245 offset:19968
    v_mul_f32 v142, v142, v134
    v_mul_f32 v143, v143, v135
    v_mfma_f32_16x16x32_bf16 v[228:231], a[152:155], v[116:119], v[228:231]
    v_mul_f32 v144, v144, v136
    v_mul_f32 v145, v145, v137
    v_mfma_f32_16x16x32_bf16 v[232:235], a[156:159], v[116:119], v[232:235]
    v_mul_f32 v146, v146, v138
    v_mul_f32 v147, v147, v139
    v_mfma_f32_16x16x32_bf16 v[236:239], a[160:163], v[116:119], v[236:239]
    ds_read_b128 v[124:127], v197 offset:1024
    v_cvt_pk_bf16_f32 v120, v140, v141
    v_cvt_pk_bf16_f32 v121, v142, v143
    v_mfma_f32_16x16x32_bf16 v[240:243], a[164:167], v[116:119], v[240:243]
    ds_read_b128 v[128:131], v197 offset:1040
    v_cvt_pk_bf16_f32 v122, v144, v145
    v_cvt_pk_bf16_f32 v123, v146, v147
    buffer_load_dwordx2 v[104:105], v190, s[4:7], s21 offen sc1
    buffer_load_dwordx2 v[106:107], v191, s[4:7], s21 offen sc1
    s_add_u32 s21, s21, 131072
    v_mfma_f32_16x16x32_bf16 v[204:207], v[200:203], v[72:75], v[204:207]
    ds_read_b128 a[144:147], v245 offset:20992
    s_waitcnt vmcnt(15)
    v_lshlrev_b32 v140, 16, v76
    v_and_b32 v141, 0xffff0000, v76
    v_mfma_f32_16x16x32_bf16 v[208:211], v[72:75], v[72:75], v[208:211]
    ds_read_b128 a[148:151], v245 offset:22016
    v_lshlrev_b32 v142, 16, v77
    v_and_b32 v143, 0xffff0000, v77
    v_mfma_f32_16x16x32_bf16 v[212:215], a[100:103], v[120:123], v[212:215]
    ds_read_b128 a[152:155], v245 offset:23040
    v_lshlrev_b32 v144, 16, v78
    v_and_b32 v145, 0xffff0000, v78
    v_mfma_f32_16x16x32_bf16 v[216:219], v[120:123], v[120:123], v[216:219]
    ds_read_b128 a[156:159], v245 offset:24064
    v_lshlrev_b32 v146, 16, v79
    v_and_b32 v147, 0xffff0000, v79
    s_waitcnt lgkmcnt(11)
    v_mfma_f32_16x16x32_bf16 v[220:223], a[168:171], v[120:123], v[220:223]
    ds_read_b128 a[160:163], v245 offset:25088
    s_waitcnt lgkmcnt(5)
    v_mul_f32 v140, v140, v124
    v_mul_f32 v141, v141, v125
    v_mfma_f32_16x16x32_bf16 v[224:227], a[172:175], v[120:123], v[224:227]
    ds_read_b128 a[164:167], v245 offset:26112
    v_mul_f32 v142, v142, v126
    v_mul_f32 v143, v143, v127
    v_mfma_f32_16x16x32_bf16 v[228:231], a[176:179], v[120:123], v[228:231]
    v_mul_f32 v144, v144, v128
    v_mul_f32 v145, v145, v129
    v_mfma_f32_16x16x32_bf16 v[232:235], a[180:183], v[120:123], v[232:235]
    v_mul_f32 v146, v146, v130
    v_mul_f32 v147, v147, v131
    v_mfma_f32_16x16x32_bf16 v[236:239], a[184:187], v[120:123], v[236:239]
    ds_read_b128 v[132:135], v197 offset:1152
    v_cvt_pk_bf16_f32 v116, v140, v141
    v_cvt_pk_bf16_f32 v117, v142, v143
    v_mfma_f32_16x16x32_bf16 v[240:243], a[188:191], v[120:123], v[240:243]
    ds_read_b128 v[136:139], v197 offset:1168
    v_cvt_pk_bf16_f32 v118, v144, v145
    v_cvt_pk_bf16_f32 v119, v146, v147
    buffer_load_dwordx2 v[108:109], v190, s[4:7], s21 offen sc1
    buffer_load_dwordx2 v[110:111], v191, s[4:7], s21 offen sc1
    s_add_u32 s21, s21, 131072
    v_mfma_f32_16x16x32_bf16 v[204:207], v[200:203], v[76:79], v[204:207]
    ds_read_b128 a[168:171], v245 offset:27136
    s_waitcnt vmcnt(15)
    v_lshlrev_b32 v140, 16, v80
    v_and_b32 v141, 0xffff0000, v80
    v_mfma_f32_16x16x32_bf16 v[208:211], v[76:79], v[76:79], v[208:211]
    ds_read_b128 a[172:175], v245 offset:28160
    v_lshlrev_b32 v142, 16, v81
    v_and_b32 v143, 0xffff0000, v81
    v_mfma_f32_16x16x32_bf16 v[212:215], a[104:107], v[116:119], v[212:215]
    ds_read_b128 a[176:179], v245 offset:29184
    v_lshlrev_b32 v144, 16, v82
    v_and_b32 v145, 0xffff0000, v82
    v_mfma_f32_16x16x32_bf16 v[216:219], v[116:119], v[116:119], v[216:219]
    ds_read_b128 a[180:183], v245 offset:30208
    v_lshlrev_b32 v146, 16, v83
    v_and_b32 v147, 0xffff0000, v83
    s_waitcnt lgkmcnt(11)
    v_mfma_f32_16x16x32_bf16 v[220:223], a[144:147], v[116:119], v[220:223]
    ds_read_b128 a[184:187], v245 offset:31232
    s_waitcnt lgkmcnt(5)
    v_mul_f32 v140, v140, v132
    v_mul_f32 v141, v141, v133
    v_mfma_f32_16x16x32_bf16 v[224:227], a[148:151], v[116:119], v[224:227]
    ds_read_b128 a[188:191], v245 offset:32256
    v_mul_f32 v142, v142, v134
    v_mul_f32 v143, v143, v135
    v_mfma_f32_16x16x32_bf16 v[228:231], a[152:155], v[116:119], v[228:231]
    v_mul_f32 v144, v144, v136
    v_mul_f32 v145, v145, v137
    v_mfma_f32_16x16x32_bf16 v[232:235], a[156:159], v[116:119], v[232:235]
    v_mul_f32 v146, v146, v138
    v_mul_f32 v147, v147, v139
    v_mfma_f32_16x16x32_bf16 v[236:239], a[160:163], v[116:119], v[236:239]
    ds_read_b128 v[124:127], v197 offset:1280
    v_cvt_pk_bf16_f32 v120, v140, v141
    v_cvt_pk_bf16_f32 v121, v142, v143
    v_mfma_f32_16x16x32_bf16 v[240:243], a[164:167], v[116:119], v[240:243]
    ds_read_b128 v[128:131], v197 offset:1296
    v_cvt_pk_bf16_f32 v122, v144, v145
    v_cvt_pk_bf16_f32 v123, v146, v147
    buffer_load_dwordx2 v[112:113], v190, s[4:7], s21 offen sc1
    buffer_load_dwordx2 v[114:115], v191, s[4:7], s21 offen sc1
    s_waitcnt vmcnt(8)
    s_barrier
    v_mfma_f32_16x16x32_bf16 v[204:207], v[200:203], v[80:83], v[204:207]
    ds_read_b128 a[144:147], v245 offset:33280
    v_lshlrev_b32 v140, 16, v84
    v_and_b32 v141, 0xffff0000, v84
    v_mfma_f32_16x16x32_bf16 v[208:211], v[80:83], v[80:83], v[208:211]
    ds_read_b128 a[148:151], v245 offset:34304
    v_lshlrev_b32 v142, 16, v85
    v_and_b32 v143, 0xffff0000, v85
    v_mfma_f32_16x16x32_bf16 v[212:215], a[108:111], v[120:123], v[212:215]
    ds_read_b128 a[152:155], v245 offset:35328
    v_lshlrev_b32 v144, 16, v86
    v_and_b32 v145, 0xffff0000, v86
    v_mfma_f32_16x16x32_bf16 v[216:219], v[120:123], v[120:123], v[216:219]
    ds_read_b128 a[156:159], v245 offset:36352
    v_lshlrev_b32 v146, 16, v87
    v_and_b32 v147, 0xffff0000, v87
    s_waitcnt lgkmcnt(11)
    v_mfma_f32_16x16x32_bf16 v[220:223], a[168:171], v[120:123], v[220:223]
    ds_read_b128 a[160:163], v245 offset:37376
    s_waitcnt lgkmcnt(5)
    v_mul_f32 v140, v140, v124
    v_mul_f32 v141, v141, v125
    v_mfma_f32_16x16x32_bf16 v[224:227], a[172:175], v[120:123], v[224:227]
    ds_read_b128 a[164:167], v245 offset:38400
    v_mul_f32 v142, v142, v126
    v_mul_f32 v143, v143, v127
    v_mfma_f32_16x16x32_bf16 v[228:231], a[176:179], v[120:123], v[228:231]
    v_mul_f32 v144, v144, v128
    v_mul_f32 v145, v145, v129
    v_mfma_f32_16x16x32_bf16 v[232:235], a[180:183], v[120:123], v[232:235]
    v_mul_f32 v146, v146, v130
    v_mul_f32 v147, v147, v131
    v_mfma_f32_16x16x32_bf16 v[236:239], a[184:187], v[120:123], v[236:239]
    ds_read_b128 v[132:135], v197 offset:1408
    v_cvt_pk_bf16_f32 v116, v140, v141
    v_cvt_pk_bf16_f32 v117, v142, v143
    v_mfma_f32_16x16x32_bf16 v[240:243], a[188:191], v[120:123], v[240:243]
    ds_read_b128 v[136:139], v197 offset:1424
    v_cvt_pk_bf16_f32 v118, v144, v145
    v_cvt_pk_bf16_f32 v119, v146, v147
    s_add_u32 m0, s44, 0
    s_nop 0
    buffer_load_dwordx4 v4, s[4:7], s42 offen offset:0 sc1 lds
    buffer_load_dwordx4 v4, s[4:7], s42 offen offset:1024 sc1 lds
    buffer_load_dwordx4 v4, s[4:7], s42 offen offset:2048 sc1 lds
    s_add_u32 s42, s42, 12288
    v_mfma_f32_16x16x32_bf16 v[204:207], v[200:203], v[84:87], v[204:207]
    ds_read_b128 a[168:171], v244 offset:14848
    v_lshlrev_b32 v140, 16, v88
    v_and_b32 v141, 0xffff0000, v88
    v_mfma_f32_16x16x32_bf16 v[208:211], v[84:87], v[84:87], v[208:211]
    ds_read_b128 a[172:175], v244 offset:15872
    v_lshlrev_b32 v142, 16, v89
    v_and_b32 v143, 0xffff0000, v89
    v_mfma_f32_16x16x32_bf16 v[212:215], a[112:115], v[116:119], v[212:215]
    ds_read_b128 a[176:179], v244 offset:16896
    v_lshlrev_b32 v144, 16, v90
    v_and_b32 v145, 0xffff0000, v90
    v_mfma_f32_16x16x32_bf16 v[216:219], v[116:119], v[116:119], v[216:219]
    ds_read_b128 a[180:183], v244 offset:17920
    v_lshlrev_b32 v146, 16, v91
    v_and_b32 v147, 0xffff0000, v91
    s_waitcnt lgkmcnt(11)
    v_mfma_f32_16x16x32_bf16 v[220:223], a[144:147], v[116:119], v[220:223]
    ds_read_b128 a[184:187], v244 offset:18944
    s_waitcnt lgkmcnt(5)
    v_mul_f32 v140, v140, v132
    v_mul_f32 v141, v141, v133
    v_mfma_f32_16x16x32_bf16 v[224:227], a[148:151], v[116:119], v[224:227]
    ds_read_b128 a[188:191], v244 offset:19968
    v_mul_f32 v142, v142, v134
    v_mul_f32 v143, v143, v135
    v_mfma_f32_16x16x32_bf16 v[228:231], a[152:155], v[116:119], v[228:231]
    v_mul_f32 v144, v144, v136
    v_mul_f32 v145, v145, v137
    v_mfma_f32_16x16x32_bf16 v[232:235], a[156:159], v[116:119], v[232:235]
    v_mul_f32 v146, v146, v138
    v_mul_f32 v147, v147, v139
    v_mfma_f32_16x16x32_bf16 v[236:239], a[160:163], v[116:119], v[236:239]
    ds_read_b128 v[124:127], v197 offset:1536
    v_cvt_pk_bf16_f32 v120, v140, v141
    v_cvt_pk_bf16_f32 v121, v142, v143
    v_mfma_f32_16x16x32_bf16 v[240:243], a[164:167], v[116:119], v[240:243]
    ds_read_b128 v[128:131], v197 offset:1552
    v_cvt_pk_bf16_f32 v122, v144, v145
    v_cvt_pk_bf16_f32 v123, v146, v147
    s_add_u32 m0, s44, 19072
    s_nop 0
    buffer_load_dwordx4 v4, s[4:7], s42 offen offset:0 sc1 lds
    buffer_load_dwordx4 v4, s[4:7], s42 offen offset:1024 sc1 lds
    buffer_load_dwordx4 v4, s[4:7], s42 offen offset:2048 sc1 lds
    s_add_u32 s42, s42, 12288
    v_mfma_f32_16x16x32_bf16 v[204:207], v[200:203], v[88:91], v[204:207]
    ds_read_b128 a[144:147], v244 offset:20992
    v_lshlrev_b32 v140, 16, v92
    v_and_b32 v141, 0xffff0000, v92
    v_mfma_f32_16x16x32_bf16 v[208:211], v[88:91], v[88:91], v[208:211]
    ds_read_b128 a[148:151], v244 offset:22016
    v_lshlrev_b32 v142, 16, v93
    v_and_b32 v143, 0xffff0000, v93
    v_mfma_f32_16x16x32_bf16 v[212:215], a[116:119], v[120:123], v[212:215]
    ds_read_b128 a[152:155], v244 offset:23040
    v_lshlrev_b32 v144, 16, v94
    v_and_b32 v145, 0xffff0000, v94
    v_mfma_f32_16x16x32_bf16 v[216:219], v[120:123], v[120:123], v[216:219]
    ds_read_b128 a[156:159], v244 offset:24064
    v_lshlrev_b32 v146, 16, v95
    v_and_b32 v147, 0xffff0000, v95
    s_waitcnt lgkmcnt(11)
    v_mfma_f32_16x16x32_bf16 v[220:223], a[168:171], v[120:123], v[220:223]
    ds_read_b128 a[160:163], v244 offset:25088
    s_waitcnt lgkmcnt(5)
    v_mul_f32 v140, v140, v124
    v_mul_f32 v141, v141, v125
    v_mfma_f32_16x16x32_bf16 v[224:227], a[172:175], v[120:123], v[224:227]
    ds_read_b128 a[164:167], v244 offset:26112
    v_mul_f32 v142, v142, v126
    v_mul_f32 v143, v143, v127
    v_mfma_f32_16x16x32_bf16 v[228:231], a[176:179], v[120:123], v[228:231]
    v_mul_f32 v144, v144, v128
    v_mul_f32 v145, v145, v129
    v_mfma_f32_16x16x32_bf16 v[232:235], a[180:183], v[120:123], v[232:235]
    v_mul_f32 v146, v146, v130
    v_mul_f32 v147, v147, v131
    v_mfma_f32_16x16x32_bf16 v[236:239], a[184:187], v[120:123], v[236:239]
    ds_read_b128 v[132:135], v197 offset:1664
    v_cvt_pk_bf16_f32 v116, v140, v141
    v_cvt_pk_bf16_f32 v117, v142, v143
    v_mfma_f32_16x16x32_bf16 v[240:243], a[188:191], v[120:123], v[240:243]
    ds_read_b128 v[136:139], v197 offset:1680
    v_cvt_pk_bf16_f32 v118, v144, v145
    v_cvt_pk_bf16_f32 v119, v146, v147
    s_add_u32 m0, s44, 38144
    s_nop 0
    buffer_load_dwordx4 v4, s[4:7], s42 offen offset:0 sc1 lds
    buffer_load_dwordx4 v4, s[4:7], s42 offen offset:1024 sc1 lds
    buffer_load_dwordx4 v4, s[4:7], s42 offen offset:2048 sc1 lds
    s_add_u32 s42, s42, 12288
    v_mfma_f32_16x16x32_bf16 v[204:207], v[200:203], v[92:95], v[204:207]
    ds_read_b128 a[168:171], v244 offset:27136
    v_lshlrev_b32 v140, 16, v96
    v_and_b32 v141, 0xffff0000, v96
    v_mfma_f32_16x16x32_bf16 v[208:211], v[92:95], v[92:95], v[208:211]
    ds_read_b128 a[172:175], v244 offset:28160
    v_lshlrev_b32 v142, 16, v97
    v_and_b32 v143, 0xffff0000, v97
    v_mfma_f32_16x16x32_bf16 v[212:215], a[120:123], v[116:119], v[212:215]
    ds_read_b128 a[176:179], v244 offset:29184
    v_lshlrev_b32 v144, 16, v98
    v_and_b32 v145, 0xffff0000, v98
    v_mfma_f32_16x16x32_bf16 v[216:219], v[116:119], v[116:119], v[216:219]
    ds_read_b128 a[180:183], v244 offset:30208
    v_lshlrev_b32 v146, 16, v99
    v_and_b32 v147, 0xffff0000, v99
    s_waitcnt lgkmcnt(11)
    v_mfma_f32_16x16x32_bf16 v[220:223], a[144:147], v[116:119], v[220:223]
    ds_read_b128 a[184:187], v244 offset:31232
    s_waitcnt lgkmcnt(5)
    v_mul_f32 v140, v140, v132
    v_mul_f32 v141, v141, v133
    v_mfma_f32_16x16x32_bf16 v[224:227], a[148:151], v[116:119], v[224:227]
    ds_read_b128 a[188:191], v244 offset:32256
    v_mul_f32 v142, v142, v134
    v_mul_f32 v143, v143, v135
    v_mfma_f32_16x16x32_bf16 v[228:231], a[152:155], v[116:119], v[228:231]
    v_mul_f32 v144, v144, v136
    v_mul_f32 v145, v145, v137
    v_mfma_f32_16x16x32_bf16 v[232:235], a[156:159], v[116:119], v[232:235]
    v_mul_f32 v146, v146, v138
    v_mul_f32 v147, v147, v139
    v_mfma_f32_16x16x32_bf16 v[236:239], a[160:163], v[116:119], v[236:239]
    ds_read_b128 v[124:127], v197 offset:1792
    v_cvt_pk_bf16_f32 v120, v140, v141
    v_cvt_pk_bf16_f32 v121, v142, v143
    v_mfma_f32_16x16x32_bf16 v[240:243], a[164:167], v[116:119], v[240:243]
    ds_read_b128 v[128:131], v197 offset:1808
    v_cvt_pk_bf16_f32 v122, v144, v145
    v_cvt_pk_bf16_f32 v123, v146, v147
    s_add_u32 m0, s44, 94720
    s_nop 0
    buffer_load_dwordx4 v4, s[4:7], s42 offen offset:0 sc1 lds
    buffer_load_dwordx4 v4, s[4:7], s42 offen offset:1024 sc1 lds
    buffer_load_dwordx4 v4, s[4:7], s42 offen offset:2048 sc1 lds
    s_add_u32 s42, s42, 12288
    s_barrier
    v_mfma_f32_16x16x32_bf16 v[204:207], v[200:203], v[96:99], v[204:207]
    ds_read_b128 a[144:147], v4 offset:12288
    s_waitcnt vmcnt(18)
    v_lshlrev_b32 v140, 16, v100
    v_and_b32 v141, 0xffff0000, v100
    v_mfma_f32_16x16x32_bf16 v[208:211], v[96:99], v[96:99], v[208:211]
    ds_read_b128 a[148:151], v4 offset:13312
    v_lshlrev_b32 v142, 16, v101
    v_and_b32 v143, 0xffff0000, v101
    v_mfma_f32_16x16x32_bf16 v[212:215], a[124:127], v[120:123], v[212:215]
    ds_read_b128 a[152:155], v4 offset:14336
    v_lshlrev_b32 v144, 16, v102
    v_and_b32 v145, 0xffff0000, v102
    v_mfma_f32_16x16x32_bf16 v[216:219], v[120:123], v[120:123], v[216:219]
    ds_read_b128 a[156:159], v4 offset:15360
    v_lshlrev_b32 v146, 16, v103
    v_and_b32 v147, 0xffff0000, v103
    s_waitcnt lgkmcnt(11)
    v_mfma_f32_16x16x32_bf16 v[220:223], a[168:171], v[120:123], v[220:223]
    ds_read_b128 a[160:163], v4 offset:16384
    s_waitcnt lgkmcnt(5)
    v_mul_f32 v140, v140, v124
    v_mul_f32 v141, v141, v125
    v_mfma_f32_16x16x32_bf16 v[224:227], a[172:175], v[120:123], v[224:227]
    ds_read_b128 a[164:167], v4 offset:17408
    v_mul_f32 v142, v142, v126
    v_mul_f32 v143, v143, v127
    v_mfma_f32_16x16x32_bf16 v[228:231], a[176:179], v[120:123], v[228:231]
    v_mul_f32 v144, v144, v128
    v_mul_f32 v145, v145, v129
    v_mfma_f32_16x16x32_bf16 v[232:235], a[180:183], v[120:123], v[232:235]
    v_mul_f32 v146, v146, v130
    v_mul_f32 v147, v147, v131
    v_mfma_f32_16x16x32_bf16 v[236:239], a[184:187], v[120:123], v[236:239]
    ds_read_b128 v[132:135], v197 offset:1920
    v_cvt_pk_bf16_f32 v116, v140, v141
    v_cvt_pk_bf16_f32 v117, v142, v143
    v_mfma_f32_16x16x32_bf16 v[240:243], a[188:191], v[120:123], v[240:243]
    ds_read_b128 v[136:139], v197 offset:1936
    v_cvt_pk_bf16_f32 v118, v144, v145
    v_cvt_pk_bf16_f32 v119, v146, v147
    s_add_u32 m0, s44, 107008
    s_nop 0
    buffer_load_dwordx4 v4, s[4:7], s42 offen offset:0 sc1 lds
    buffer_load_dwordx4 v4, s[4:7], s42 offen offset:1024 sc1 lds
    buffer_load_dwordx4 v4, s[4:7], s42 offen offset:2048 sc1 lds
    s_add_u32 s42, s42, 12288
    v_mfma_f32_16x16x32_bf16 v[204:207], v[200:203], v[100:103], v[204:207]
    ds_read_b128 a[168:171], v4 offset:31360
    s_waitcnt vmcnt(19)
    v_lshlrev_b32 v140, 16, v104
    v_and_b32 v141, 0xffff0000, v104
    v_mfma_f32_16x16x32_bf16 v[208:211], v[100:103], v[100:103], v[208:211]
    ds_read_b128 a[172:175], v4 offset:32384
    v_lshlrev_b32 v142, 16, v105
    v_and_b32 v143, 0xffff0000, v105
    v_mfma_f32_16x16x32_bf16 v[212:215], a[128:131], v[116:119], v[212:215]
    ds_read_b128 a[176:179], v4 offset:33408
    v_lshlrev_b32 v144, 16, v106
    v_and_b32 v145, 0xffff0000, v106
    v_mfma_f32_16x16x32_bf16 v[216:219], v[116:119], v[116:119], v[216:219]
    ds_read_b128 a[180:183], v4 offset:34432
    v_lshlrev_b32 v146, 16, v107
    v_and_b32 v147, 0xffff0000, v107
    s_waitcnt lgkmcnt(11)
    v_mfma_f32_16x16x32_bf16 v[220:223], a[144:147], v[116:119], v[220:223]
    ds_read_b128 a[184:187], v4 offset:35456
    s_waitcnt lgkmcnt(5)
    v_mul_f32 v140, v140, v132
    v_mul_f32 v141, v141, v133
    v_mfma_f32_16x16x32_bf16 v[224:227], a[148:151], v[116:119], v[224:227]
    ds_read_b128 a[188:191], v4 offset:36480
    v_mul_f32 v142, v142, v134
    v_mul_f32 v143, v143, v135
    v_mfma_f32_16x16x32_bf16 v[228:231], a[152:155], v[116:119], v[228:231]
    v_mul_f32 v144, v144, v136
    v_mul_f32 v145, v145, v137
    v_mfma_f32_16x16x32_bf16 v[232:235], a[156:159], v[116:119], v[232:235]
    v_mul_f32 v146, v146, v138
    v_mul_f32 v147, v147, v139
    v_mfma_f32_16x16x32_bf16 v[236:239], a[160:163], v[116:119], v[236:239]
    ds_read_b128 v[124:127], v197 offset:2048
    v_cvt_pk_bf16_f32 v120, v140, v141
    v_cvt_pk_bf16_f32 v121, v142, v143
    v_mfma_f32_16x16x32_bf16 v[240:243], a[164:167], v[116:119], v[240:243]
    ds_read_b128 v[128:131], v197 offset:2064
    v_cvt_pk_bf16_f32 v122, v144, v145
    v_cvt_pk_bf16_f32 v123, v146, v147
    s_add_u32 m0, s44, 119296
    s_nop 0
    buffer_load_dwordx4 v4, s[4:7], s42 offen offset:0 sc1 lds
    buffer_load_dwordx4 v4, s[4:7], s42 offen offset:1024 sc1 lds
    buffer_load_dwordx4 v4, s[4:7], s42 offen offset:2048 sc1 lds
    s_add_u32 s42, s42, 12288
    v_mfma_f32_16x16x32_bf16 v[204:207], v[200:203], v[104:107], v[204:207]
    ds_read_b128 a[144:147], v4 offset:50432
    s_waitcnt vmcnt(20)
    v_lshlrev_b32 v140, 16, v108
    v_and_b32 v141, 0xffff0000, v108
    v_mfma_f32_16x16x32_bf16 v[208:211], v[104:107], v[104:107], v[208:211]
    ds_read_b128 a[148:151], v4 offset:51456
    v_lshlrev_b32 v142, 16, v109
    v_and_b32 v143, 0xffff0000, v109
    v_mfma_f32_16x16x32_bf16 v[212:215], a[132:135], v[120:123], v[212:215]
    ds_read_b128 a[152:155], v4 offset:52480
    v_lshlrev_b32 v144, 16, v110
    v_and_b32 v145, 0xffff0000, v110
    v_mfma_f32_16x16x32_bf16 v[216:219], v[120:123], v[120:123], v[216:219]
    ds_read_b128 a[156:159], v4 offset:53504
    v_lshlrev_b32 v146, 16, v111
    v_and_b32 v147, 0xffff0000, v111
    s_waitcnt lgkmcnt(11)
    v_mfma_f32_16x16x32_bf16 v[220:223], a[168:171], v[120:123], v[220:223]
    ds_read_b128 a[160:163], v4 offset:54528
    s_waitcnt lgkmcnt(5)
    v_mul_f32 v140, v140, v124
    v_mul_f32 v141, v141, v125
    v_mfma_f32_16x16x32_bf16 v[224:227], a[172:175], v[120:123], v[224:227]
    ds_read_b128 a[164:167], v4 offset:55552
    v_mul_f32 v142, v142, v126
    v_mul_f32 v143, v143, v127
    v_mfma_f32_16x16x32_bf16 v[228:231], a[176:179], v[120:123], v[228:231]
    v_mul_f32 v144, v144, v128
    v_mul_f32 v145, v145, v129
    v_mfma_f32_16x16x32_bf16 v[232:235], a[180:183], v[120:123], v[232:235]
    v_mul_f32 v146, v146, v130
    v_mul_f32 v147, v147, v131
    v_mfma_f32_16x16x32_bf16 v[236:239], a[184:187], v[120:123], v[236:239]
    ds_read_b128 v[132:135], v197 offset:2176
    v_cvt_pk_bf16_f32 v116, v140, v141
    v_cvt_pk_bf16_f32 v117, v142, v143
    v_mfma_f32_16x16x32_bf16 v[240:243], a[188:191], v[120:123], v[240:243]
    ds_read_b128 v[136:139], v197 offset:2192
    v_cvt_pk_bf16_f32 v118, v144, v145
    v_cvt_pk_bf16_f32 v119, v146, v147
    s_add_u32 m0, s44, 131584
    s_nop 0
    buffer_load_dwordx4 v4, s[4:7], s42 offen offset:0 sc1 lds
    buffer_load_dwordx4 v4, s[4:7], s42 offen offset:1024 sc1 lds
    buffer_load_dwordx4 v4, s[4:7], s42 offen offset:2048 sc1 lds
    s_add_u32 s42, s42, 12288
    v_mfma_f32_16x16x32_bf16 v[204:207], v[200:203], v[108:111], v[204:207]
    ds_read_b128 a[168:171], v244 offset:8064
    s_waitcnt vmcnt(21)
    v_lshlrev_b32 v140, 16, v112
    v_and_b32 v141, 0xffff0000, v112
    v_mfma_f32_16x16x32_bf16 v[208:211], v[108:111], v[108:111], v[208:211]
    ds_read_b128 a[172:175], v244 offset:9088
    v_lshlrev_b32 v142, 16, v113
    v_and_b32 v143, 0xffff0000, v113
    v_mfma_f32_16x16x32_bf16 v[212:215], a[136:139], v[116:119], v[212:215]
    ds_read_b128 a[176:179], v244 offset:10112
    v_lshlrev_b32 v144, 16, v114
    v_and_b32 v145, 0xffff0000, v114
    v_mfma_f32_16x16x32_bf16 v[216:219], v[116:119], v[116:119], v[216:219]
    ds_read_b128 a[180:183], v244 offset:11136
    v_lshlrev_b32 v146, 16, v115
    v_and_b32 v147, 0xffff0000, v115
    s_waitcnt lgkmcnt(11)
    v_mfma_f32_16x16x32_bf16 v[220:223], a[144:147], v[116:119], v[220:223]
    ds_read_b128 a[184:187], v244 offset:12160
    s_waitcnt lgkmcnt(5)
    v_mul_f32 v140, v140, v132
    v_mul_f32 v141, v141, v133
    v_mfma_f32_16x16x32_bf16 v[224:227], a[148:151], v[116:119], v[224:227]
    ds_read_b128 a[188:191], v244 offset:13184
    v_mul_f32 v142, v142, v134
    v_mul_f32 v143, v143, v135
    v_mfma_f32_16x16x32_bf16 v[228:231], a[152:155], v[116:119], v[228:231]
    v_mul_f32 v144, v144, v136
    v_mul_f32 v145, v145, v137
    v_mfma_f32_16x16x32_bf16 v[232:235], a[156:159], v[116:119], v[232:235]
    v_mul_f32 v146, v146, v138
    v_mul_f32 v147, v147, v139
    v_mfma_f32_16x16x32_bf16 v[236:239], a[160:163], v[116:119], v[236:239]
    v_cvt_pk_bf16_f32 v120, v140, v141
    v_cvt_pk_bf16_f32 v121, v142, v143
    v_mfma_f32_16x16x32_bf16 v[240:243], a[164:167], v[116:119], v[240:243]
    v_cvt_pk_bf16_f32 v122, v144, v145
    v_cvt_pk_bf16_f32 v123, v146, v147
    s_add_u32 m0, s44, 143872
    s_nop 0
    buffer_load_dwordx4 v4, s[4:7], s42 offen offset:0 sc1 lds
    buffer_load_dwordx4 v4, s[4:7], s42 offen offset:1024 sc1 lds
    buffer_load_dwordx4 v4, s[4:7], s42 offen offset:2048 sc1 lds
    s_add_u32 s42, s42, 12288
    v_mfma_f32_16x16x32_bf16 v[204:207], v[200:203], v[112:115], v[204:207]
    v_mfma_f32_16x16x32_bf16 v[208:211], v[112:115], v[112:115], v[208:211]
    v_mfma_f32_16x16x32_bf16 v[212:215], a[140:143], v[120:123], v[212:215]
    v_mfma_f32_16x16x32_bf16 v[216:219], v[120:123], v[120:123], v[216:219]
    s_waitcnt lgkmcnt(5)
    v_mfma_f32_16x16x32_bf16 v[220:223], a[168:171], v[120:123], v[220:223]
    s_waitcnt lgkmcnt(4)
    v_mfma_f32_16x16x32_bf16 v[224:227], a[172:175], v[120:123], v[224:227]
    s_waitcnt lgkmcnt(3)
    v_mfma_f32_16x16x32_bf16 v[228:231], a[176:179], v[120:123], v[228:231]
    s_waitcnt lgkmcnt(2)
    v_mfma_f32_16x16x32_bf16 v[232:235], a[180:183], v[120:123], v[232:235]
    s_waitcnt lgkmcnt(1)
    v_mfma_f32_16x16x32_bf16 v[236:239], a[184:187], v[120:123], v[236:239]
    s_waitcnt lgkmcnt(0)
    v_mfma_f32_16x16x32_bf16 v[240:243], a[188:191], v[120:123], v[240:243]
    s_mul_i32 s45, s43, -86016
    s_add_u32 s45, s45, s44
    s_add_u32 m0, s45, 156160
    s_nop 0
    buffer_load_dwordx4 v4, s[4:7], s42 offen offset:0 sc1 lds
    buffer_load_dwordx4 v4, s[4:7], s42 offen offset:1024 sc1 lds
    buffer_load_dwordx4 v4, s[4:7], s42 offen offset:2048 sc1 lds
    s_add_u32 s42, s42, 12288
    v_lshlrev_b32 v199, 5, v2
    v_add_u32 v199, 63360, v199
    v_cndmask_b32 v192, v216, v217, s[46:47]
    v_cndmask_b32 v192, v192, v218, s[48:49]
    v_cndmask_b32 v192, v192, v219, s[50:51]
    ds_bpermute_b32 v192, v198, v192
    v_cndmask_b32 v191, v208, v209, s[46:47]
    v_cndmask_b32 v191, v191, v210, s[48:49]
    v_cndmask_b32 v191, v191, v211, s[50:51]
    ds_bpermute_b32 v191, v198, v191
    ds_read_b128 v[100:103], v199 offset:1152
    ds_read_b128 v[124:127], v199 offset:1536
    ds_read_b128 v[104:107], v199 offset:1168
    ds_read_b128 v[128:131], v199 offset:1552
    ds_read_b128 v[108:111], v199 offset:1280
    ds_read_b128 v[132:135], v199 offset:1664
    ds_read_b128 v[112:115], v199 offset:1296
    ds_read_b128 v[136:139], v199 offset:1680
    ds_read_b128 v[116:119], v199 offset:1408
    ds_read_b128 v[140:143], v199 offset:1792
    ds_read_b128 v[120:123], v199 offset:1424
    ds_read_b128 v[144:147], v199 offset:1808
    v_mov_b32 v190, v204
    buffer_load_dwordx4 a[0:3], v4, s[12:15], s28 offen offset:0 sc1
    s_waitcnt lgkmcnt(12)
    v_mul_f32 v190, 0x3ae38e39, v190
    v_mul_f32 v191, 0x3ae38e39, v191
    v_fma_f32 v191, -v190, v190, v191
    v_max_f32 v191, 0, v191
    v_cvt_pk_bf16_f32 v191, v191, v191
    v_and_b32 v191, 0xffff0000, v191
    v_add_f32 v191, 0x3727c5ac, v191
    v_cvt_pk_bf16_f32 v191, v191, v191
    v_and_b32 v191, 0xffff0000, v191
    buffer_load_dwordx4 a[4:7], v4, s[12:15], s28 offen offset:1024 sc1
    v_sqrt_f32 v191, v191
    s_nop 0
    v_cvt_pk_bf16_f32 v190, v190, v191
    v_and_b32 v184, 0xffff0000, v190
    v_lshlrev_b32 v185, 16, v190
    v_rcp_f32 v184, v184
    v_mov_b32 v193, s53
    v_mov_b32 v194, s55
    v_mul_f32 v185, -v185, v184
    v_fma_f32 v193, v185, s52, v193
    buffer_load_dwordx4 a[8:11], v4, s[12:15], s28 offen offset:2048 sc1
    v_fma_f32 v190, v184, v212, v193
    v_fma_f32 v193, v185, v213, v214
    v_add_f32 v193, v193, v193
    v_fma_f32 v193, v184, v192, v193
    v_add_f32 v194, v194, v194
    v_fma_f32 v194, v185, s54, v194
    v_mov_b32 v195, s56
    v_fma_f32 v194, v185, v194, v195
    v_fma_f32 v191, v184, v193, v194
    buffer_load_dwordx4 a[20:23], v7, s[12:15], s28 offen offset:1024 sc1
    v_mul_f32 v190, 0x3ae38e39, v190
    v_mul_f32 v191, 0x3ae38e39, v191
    v_fma_f32 v191, -v190, v190, v191
    v_max_f32 v191, 0, v191
    v_cvt_pk_bf16_f32 v191, v191, v191
    v_and_b32 v191, 0xffff0000, v191
    v_add_f32 v191, 0x3727c5ac, v191
    v_cvt_pk_bf16_f32 v191, v191, v191
    v_and_b32 v191, 0xffff0000, v191
    buffer_load_dwordx4 a[24:27], v7, s[12:15], s28 offen offset:2048 sc1
    v_sqrt_f32 v191, v191
    s_nop 0
    v_cvt_pk_bf16_f32 v191, v191, v191
    v_and_b32 v191, 0xffff0000, v191
    v_mov_b32 v182, v191
    v_rcp_f32 v180, v191
    s_nop 0
    v_mul_f32 v181, v180, v180
    v_mul_f32 v181, v181, v180
    v_mul_f32 v180, 0xc0135761, v180
    v_mul_f32 v181, 0xbdd2d3e8, v181
    buffer_load_dwordx4 a[28:31], v7, s[12:15], s28 offen offset:3072 sc1
    s_mul_i32 s20, s17, 399360
    s_lshl_b32 s31, s25, 10
    s_add_u32 s20, s20, s31
    s_add_u32 s20, s20, 4195328
    s_waitcnt lgkmcnt(0)
    v_pk_fma_f32 v[100:101], v[100:101], v[184:185], v[124:125] op_sel:[0,1,0] op_sel_hi:[1,1,1]
    v_pk_fma_f32 v[102:103], v[102:103], v[184:185], v[126:127] op_sel:[0,1,0] op_sel_hi:[1,1,1]
    v_pk_fma_f32 v[104:105], v[104:105], v[184:185], v[128:129] op_sel:[0,1,0] op_sel_hi:[1,1,1]
    v_pk_fma_f32 v[106:107], v[106:107], v[184:185], v[130:131] op_sel:[0,1,0] op_sel_hi:[1,1,1]
    v_pk_fma_f32 v[108:109], v[108:109], v[184:185], v[132:133] op_sel:[0,1,0] op_sel_hi:[1,1,1]
    v_pk_fma_f32 v[110:111], v[110:111], v[184:185], v[134:135] op_sel:[0,1,0] op_sel_hi:[1,1,1]
    v_pk_fma_f32 v[112:113], v[112:113], v[184:185], v[136:137] op_sel:[0,1,0] op_sel_hi:[1,1,1]
    v_pk_fma_f32 v[114:115], v[114:115], v[184:185], v[138:139] op_sel:[0,1,0] op_sel_hi:[1,1,1]
    v_pk_fma_f32 v[116:117], v[116:117], v[184:185], v[140:141] op_sel:[0,1,0] op_sel_hi:[1,1,1]
    buffer_load_dwordx4 a[36:39], v16, s[12:15], s28 offen offset:1024 sc1
    v_pk_fma_f32 v[118:119], v[118:119], v[184:185], v[142:143] op_sel:[0,1,0] op_sel_hi:[1,1,1]
    v_pk_fma_f32 v[120:121], v[120:121], v[184:185], v[144:145] op_sel:[0,1,0] op_sel_hi:[1,1,1]
    v_pk_fma_f32 v[122:123], v[122:123], v[184:185], v[146:147] op_sel:[0,1,0] op_sel_hi:[1,1,1]
    v_pk_fma_f32 v[220:221], v[220:221], v[184:185], v[100:101] op_sel_hi:[1,0,1]
    v_pk_fma_f32 v[222:223], v[222:223], v[184:185], v[102:103] op_sel_hi:[1,0,1]
    v_pk_fma_f32 v[224:225], v[224:225], v[184:185], v[104:105] op_sel_hi:[1,0,1]
    v_pk_fma_f32 v[226:227], v[226:227], v[184:185], v[106:107] op_sel_hi:[1,0,1]
    v_pk_fma_f32 v[228:229], v[228:229], v[184:185], v[108:109] op_sel_hi:[1,0,1]
    v_pk_fma_f32 v[230:231], v[230:231], v[184:185], v[110:111] op_sel_hi:[1,0,1]
    buffer_load_dwordx4 a[40:43], v16, s[12:15], s28 offen offset:2048 sc1
    v_pk_fma_f32 v[232:233], v[232:233], v[184:185], v[112:113] op_sel_hi:[1,0,1]
    v_pk_fma_f32 v[234:235], v[234:235], v[184:185], v[114:115] op_sel_hi:[1,0,1]
    v_pk_fma_f32 v[236:237], v[236:237], v[184:185], v[116:117] op_sel_hi:[1,0,1]
    v_pk_fma_f32 v[238:239], v[238:239], v[184:185], v[118:119] op_sel_hi:[1,0,1]
    v_pk_fma_f32 v[240:241], v[240:241], v[184:185], v[120:121] op_sel_hi:[1,0,1]
    v_pk_fma_f32 v[242:243], v[242:243], v[184:185], v[122:123] op_sel_hi:[1,0,1]
    v_pk_mul_f32 v[68:69], v[220:221], v[220:221]
    v_pk_mul_f32 v[70:71], v[222:223], v[222:223]
    v_pk_mul_f32 v[72:73], v[224:225], v[224:225]
    buffer_load_dwordx4 a[44:47], v16, s[12:15], s28 offen offset:3072 sc1
    v_pk_mul_f32 v[74:75], v[226:227], v[226:227]
    v_pk_fma_f32 v[68:69], v[68:69], v[180:181], v[180:181] op_sel:[0,1,0] op_sel_hi:[1,1,0]
    v_pk_fma_f32 v[70:71], v[70:71], v[180:181], v[180:181] op_sel:[0,1,0] op_sel_hi:[1,1,0]
    v_pk_fma_f32 v[72:73], v[72:73], v[180:181], v[180:181] op_sel:[0,1,0] op_sel_hi:[1,1,0]
    v_pk_fma_f32 v[74:75], v[74:75], v[180:181], v[180:181] op_sel:[0,1,0] op_sel_hi:[1,1,0]
    v_pk_mul_f32 v[68:69], v[68:69], v[220:221]
    v_pk_mul_f32 v[70:71], v[70:71], v[222:223]
    v_pk_mul_f32 v[72:73], v[72:73], v[224:225]
    v_pk_mul_f32 v[74:75], v[74:75], v[226:227]
    buffer_load_dwordx4 a[56:59], v17, s[12:15], s28 offen offset:2048 sc1
    v_exp_f32 v68, v68
    v_exp_f32 v69, v69
    v_exp_f32 v70, v70
    v_exp_f32 v71, v71
    v_exp_f32 v72, v72
    v_exp_f32 v73, v73
    v_exp_f32 v74, v74
    v_exp_f32 v75, v75
    v_pk_fma_f32 v[68:69], v[68:69], v[182:183], v[182:183] op_sel_hi:[1,0,0]
    buffer_load_dwordx4 a[60:63], v17, s[12:15], s28 offen offset:3072 sc1
    v_pk_fma_f32 v[70:71], v[70:71], v[182:183], v[182:183] op_sel_hi:[1,0,0]
    v_pk_fma_f32 v[72:73], v[72:73], v[182:183], v[182:183] op_sel_hi:[1,0,0]
    v_pk_fma_f32 v[74:75], v[74:75], v[182:183], v[182:183] op_sel_hi:[1,0,0]
    v_rcp_f32 v68, v68
    v_rcp_f32 v69, v69
    v_rcp_f32 v70, v70
    v_rcp_f32 v71, v71
    v_rcp_f32 v72, v72
    v_rcp_f32 v73, v73
    buffer_load_dwordx4 a[64:67], v18, s[12:15], s28 offen offset:0 sc1
    v_rcp_f32 v74, v74
    v_rcp_f32 v75, v75
    v_pk_mul_f32 v[68:69], v[68:69], v[220:221]
    v_pk_mul_f32 v[70:71], v[70:71], v[222:223]
    v_pk_mul_f32 v[72:73], v[72:73], v[224:225]
    v_pk_mul_f32 v[74:75], v[74:75], v[226:227]
    v_cvt_pk_bf16_f32 v84, v68, v69
    v_cvt_pk_bf16_f32 v85, v70, v71
    v_cvt_pk_bf16_f32 v86, v72, v73
    buffer_load_dwordx4 a[12:15], v4, s[12:15], s28 offen offset:3072 sc1
    v_cvt_pk_bf16_f32 v87, v74, v75
    buffer_store_dwordx4 v[84:87], v4, s[4:7], s20 offen sc1
    s_add_u32 s20, s20, 133120
    v_pk_mul_f32 v[68:69], v[228:229], v[228:229]
    v_pk_mul_f32 v[70:71], v[230:231], v[230:231]
    v_pk_mul_f32 v[72:73], v[232:233], v[232:233]
    v_pk_mul_f32 v[74:75], v[234:235], v[234:235]
    v_pk_fma_f32 v[68:69], v[68:69], v[180:181], v[180:181] op_sel:[0,1,0] op_sel_hi:[1,1,0]
    v_pk_fma_f32 v[70:71], v[70:71], v[180:181], v[180:181] op_sel:[0,1,0] op_sel_hi:[1,1,0]
    v_pk_fma_f32 v[72:73], v[72:73], v[180:181], v[180:181] op_sel:[0,1,0] op_sel_hi:[1,1,0]
    v_pk_fma_f32 v[74:75], v[74:75], v[180:181], v[180:181] op_sel:[0,1,0] op_sel_hi:[1,1,0]
    buffer_load_dwordx4 a[48:51], v17, s[12:15], s28 offen offset:0 sc1
    v_pk_mul_f32 v[68:69], v[68:69], v[228:229]
    v_pk_mul_f32 v[70:71], v[70:71], v[230:231]
    v_pk_mul_f32 v[72:73], v[72:73], v[232:233]
    v_pk_mul_f32 v[74:75], v[74:75], v[234:235]
    v_exp_f32 v68, v68
    v_exp_f32 v69, v69
    v_exp_f32 v70, v70
    v_exp_f32 v71, v71
    v_exp_f32 v72, v72
    buffer_load_dwordx4 a[16:19], v7, s[12:15], s28 offen offset:0 sc1
    v_exp_f32 v73, v73
    v_exp_f32 v74, v74
    v_exp_f32 v75, v75
    v_pk_fma_f32 v[68:69], v[68:69], v[182:183], v[182:183] op_sel_hi:[1,0,0]
    v_pk_fma_f32 v[70:71], v[70:71], v[182:183], v[182:183] op_sel_hi:[1,0,0]
    v_pk_fma_f32 v[72:73], v[72:73], v[182:183], v[182:183] op_sel_hi:[1,0,0]
    v_pk_fma_f32 v[74:75], v[74:75], v[182:183], v[182:183] op_sel_hi:[1,0,0]
    v_rcp_f32 v68, v68
    v_rcp_f32 v69, v69
    buffer_load_dwordx4 a[32:35], v16, s[12:15], s28 offen offset:0 sc1
    v_rcp_f32 v70, v70
    v_rcp_f32 v71, v71
    v_rcp_f32 v72, v72
    v_rcp_f32 v73, v73
    v_rcp_f32 v74, v74
    v_rcp_f32 v75, v75
    v_pk_mul_f32 v[68:69], v[68:69], v[228:229]
    v_pk_mul_f32 v[70:71], v[70:71], v[230:231]
    v_pk_mul_f32 v[72:73], v[72:73], v[232:233]
    buffer_load_dwordx4 a[52:55], v17, s[12:15], s28 offen offset:1024 sc1
    v_pk_mul_f32 v[74:75], v[74:75], v[234:235]
    v_cvt_pk_bf16_f32 v88, v68, v69
    v_cvt_pk_bf16_f32 v89, v70, v71
    v_cvt_pk_bf16_f32 v90, v72, v73
    v_cvt_pk_bf16_f32 v91, v74, v75
    buffer_store_dwordx4 v[88:91], v4, s[4:7], s20 offen sc1
    s_add_u32 s20, s20, 133120
    v_pk_mul_f32 v[68:69], v[236:237], v[236:237]
    v_pk_mul_f32 v[70:71], v[238:239], v[238:239]
    v_pk_mul_f32 v[72:73], v[240:241], v[240:241]
    v_pk_mul_f32 v[74:75], v[242:243], v[242:243]
    buffer_load_dwordx4 a[68:71], v18, s[12:15], s28 offen offset:1024 sc1
    v_pk_fma_f32 v[68:69], v[68:69], v[180:181], v[180:181] op_sel:[0,1,0] op_sel_hi:[1,1,0]
    v_pk_fma_f32 v[70:71], v[70:71], v[180:181], v[180:181] op_sel:[0,1,0] op_sel_hi:[1,1,0]
    v_pk_fma_f32 v[72:73], v[72:73], v[180:181], v[180:181] op_sel:[0,1,0] op_sel_hi:[1,1,0]
    v_pk_fma_f32 v[74:75], v[74:75], v[180:181], v[180:181] op_sel:[0,1,0] op_sel_hi:[1,1,0]
    v_pk_mul_f32 v[68:69], v[68:69], v[236:237]
    v_pk_mul_f32 v[70:71], v[70:71], v[238:239]
    v_pk_mul_f32 v[72:73], v[72:73], v[240:241]
    v_pk_mul_f32 v[74:75], v[74:75], v[242:243]
    v_exp_f32 v68, v68
    v_exp_f32 v69, v69
    v_exp_f32 v70, v70
    v_exp_f32 v71, v71
    v_exp_f32 v72, v72
    v_exp_f32 v73, v73
    v_exp_f32 v74, v74
    v_exp_f32 v75, v75
    v_pk_fma_f32 v[68:69], v[68:69], v[182:183], v[182:183] op_sel_hi:[1,0,0]
    v_pk_fma_f32 v[70:71], v[70:71], v[182:183], v[182:183] op_sel_hi:[1,0,0]
    v_pk_fma_f32 v[72:73], v[72:73], v[182:183], v[182:183] op_sel_hi:[1,0,0]
    v_pk_fma_f32 v[74:75], v[74:75], v[182:183], v[182:183] op_sel_hi:[1,0,0]
    v_rcp_f32 v68, v68
    v_rcp_f32 v69, v69
    v_rcp_f32 v70, v70
    v_rcp_f32 v71, v71
    v_rcp_f32 v72, v72
    v_rcp_f32 v73, v73
    v_rcp_f32 v74, v74
    v_rcp_f32 v75, v75
    v_pk_mul_f32 v[68:69], v[68:69], v[236:237]
    v_pk_mul_f32 v[70:71], v[70:71], v[238:239]
    v_pk_mul_f32 v[72:73], v[72:73], v[240:241]
    v_pk_mul_f32 v[74:75], v[74:75], v[242:243]
    v_cvt_pk_bf16_f32 v92, v68, v69
    v_cvt_pk_bf16_f32 v93, v70, v71
    v_cvt_pk_bf16_f32 v94, v72, v73
    v_cvt_pk_bf16_f32 v95, v74, v75
    buffer_store_dwordx4 v[92:95], v4, s[4:7], s20 offen sc1
    ds_read_b128 v[20:23], v199 offset:384
    ds_read_b128 v[24:27], v199 offset:400
    ds_read_b128 v[28:31], v199 offset:512
    ds_read_b128 v[32:35], v199 offset:528
    ds_read_b128 v[36:39], v199 offset:640
    ds_read_b128 v[40:43], v199 offset:656
    ds_read_b128 v[124:127], v199 offset:0
    ds_read_b128 v[128:131], v199 offset:16
    ds_read_b128 v[132:135], v199 offset:128
    ds_read_b128 v[136:139], v199 offset:144
    ds_read_b128 v[140:143], v199 offset:256
    ds_read_b128 v[144:147], v199 offset:272
    v_lshlrev_b32 v148, 16, v44
    v_and_b32 v149, 0xffff0000, v44
    v_lshlrev_b32 v150, 16, v45
    v_and_b32 v151, 0xffff0000, v45
    v_lshlrev_b32 v152, 16, v46
    v_and_b32 v153, 0xffff0000, v46
    v_lshlrev_b32 v154, 16, v47
    v_and_b32 v155, 0xffff0000, v47
    v_lshlrev_b32 v156, 16, v48
    v_and_b32 v157, 0xffff0000, v48
    v_lshlrev_b32 v158, 16, v49
    v_and_b32 v159, 0xffff0000, v49
    v_lshlrev_b32 v160, 16, v50
    v_and_b32 v161, 0xffff0000, v50
    v_lshlrev_b32 v162, 16, v51
    v_and_b32 v163, 0xffff0000, v51
    v_lshlrev_b32 v164, 16, v52
    v_and_b32 v165, 0xffff0000, v52
    v_lshlrev_b32 v166, 16, v53
    v_and_b32 v167, 0xffff0000, v53
    v_lshlrev_b32 v168, 16, v54
    v_and_b32 v169, 0xffff0000, v54
    v_lshlrev_b32 v170, 16, v55
    v_and_b32 v171, 0xffff0000, v55
    v_cmp_gt_u32 vcc, 2, v2
    v_add_u32 v176, 15, v19
    v_lshrrev_b32 v177, 4, v176
    v_and_b32 v176, 15, v176
    v_lshlrev_b32 v176, 4, v176
    v_lshl_add_u32 v176, v177, 10, v176
    v_lshl_add_u32 v172, v2, 8, v176
    v_add_u32 v176, 17, v19
    v_lshrrev_b32 v177, 4, v176
    v_and_b32 v176, 15, v176
    v_lshlrev_b32 v176, 4, v176
    v_lshl_add_u32 v176, v177, 10, v176
    v_lshl_add_u32 v173, v2, 8, v176
    v_add_u32 v176, 14, v19
    v_lshrrev_b32 v177, 4, v176
    v_and_b32 v176, 15, v176
    v_lshlrev_b32 v176, 4, v176
    v_lshl_add_u32 v176, v177, 10, v176
    v_lshl_add_u32 v174, v2, 8, v176
    v_add_u32 v176, 18, v19
    v_lshrrev_b32 v177, 4, v176
    v_and_b32 v176, 15, v176
    v_lshlrev_b32 v176, 4, v176
    v_lshl_add_u32 v176, v177, 10, v176
    v_lshl_add_u32 v175, v2, 8, v176
    v_cndmask_b32 v176, v173, v172, vcc
    v_cndmask_b32 v177, v175, v174, vcc
    v_min_u32 v178, 2, v1
    v_add_u32 v178, s25, v178
    v_add_u32 v178, -1, v178
    v_max_i32 v178, 0, v178
    v_min_u32 v178, 127, v178
    v_lshlrev_b32 v178, 7, v178
    s_waitcnt vmcnt(0)
    s_lshl_b32 s20, s25, 7
    s_add_u32 s20, s20, 0
    s_mov_b64 exec, 1
    buffer_atomic_add v5, v6, s[4:7], s20 offen sc1
    s_mov_b64 exec, -1
    s_add_u32 s28, s28, 18432
    v_pk_fma_f32 v[100:101], v[148:149], v[184:185], v[184:185] op_sel:[0,0,1] op_sel_hi:[1,0,1]
    v_pk_fma_f32 v[102:103], v[150:151], v[184:185], v[184:185] op_sel:[0,0,1] op_sel_hi:[1,0,1]
    v_pk_fma_f32 v[104:105], v[152:153], v[184:185], v[184:185] op_sel:[0,0,1] op_sel_hi:[1,0,1]
    v_pk_fma_f32 v[106:107], v[154:155], v[184:185], v[184:185] op_sel:[0,0,1] op_sel_hi:[1,0,1]
    v_pk_fma_f32 v[108:109], v[156:157], v[184:185], v[184:185] op_sel:[0,0,1] op_sel_hi:[1,0,1]
    v_pk_fma_f32 v[110:111], v[158:159], v[184:185], v[184:185] op_sel:[0,0,1] op_sel_hi:[1,0,1]
    v_pk_fma_f32 v[112:113], v[160:161], v[184:185], v[184:185] op_sel:[0,0,1] op_sel_hi:[1,0,1]
    v_pk_fma_f32 v[114:115], v[162:163], v[184:185], v[184:185] op_sel:[0,0,1] op_sel_hi:[1,0,1]
    v_pk_fma_f32 v[116:117], v[164:165], v[184:185], v[184:185] op_sel:[0,0,1] op_sel_hi:[1,0,1]
    v_pk_fma_f32 v[118:119], v[166:167], v[184:185], v[184:185] op_sel:[0,0,1] op_sel_hi:[1,0,1]
    v_pk_fma_f32 v[120:121], v[168:169], v[184:185], v[184:185] op_sel:[0,0,1] op_sel_hi:[1,0,1]
    v_pk_fma_f32 v[122:123], v[170:171], v[184:185], v[184:185] op_sel:[0,0,1] op_sel_hi:[1,0,1]
    s_waitcnt lgkmcnt(0)
    v_pk_fma_f32 v[100:101], v[100:101], v[20:21], v[124:125]
    v_pk_fma_f32 v[102:103], v[102:103], v[22:23], v[126:127]
    v_pk_fma_f32 v[104:105], v[104:105], v[24:25], v[128:129]
    v_pk_fma_f32 v[106:107], v[106:107], v[26:27], v[130:131]
    v_pk_fma_f32 v[108:109], v[108:109], v[28:29], v[132:133]
    v_pk_fma_f32 v[110:111], v[110:111], v[30:31], v[134:135]
    v_pk_fma_f32 v[112:113], v[112:113], v[32:33], v[136:137]
    v_pk_fma_f32 v[114:115], v[114:115], v[34:35], v[138:139]
    v_pk_fma_f32 v[116:117], v[116:117], v[36:37], v[140:141]
    v_pk_fma_f32 v[118:119], v[118:119], v[38:39], v[142:143]
    v_pk_fma_f32 v[120:121], v[120:121], v[40:41], v[144:145]
    v_pk_fma_f32 v[122:123], v[122:123], v[42:43], v[146:147]
    s_barrier
    ds_read_b128 a[144:147], v4 offset:0
    ds_read_b128 a[148:151], v4 offset:1024
    ds_read_b128 a[152:155], v4 offset:2048
    ds_read_b128 a[156:159], v4 offset:3072
    ds_read_b128 a[160:163], v4 offset:4096
    ds_read_b128 a[164:167], v4 offset:5120
    ds_read_b128 a[168:171], v4 offset:6144
    ds_read_b128 a[172:175], v4 offset:7168
    ds_read_b128 a[176:179], v4 offset:8192
    ds_read_b128 a[180:183], v4 offset:9216
    ds_read_b128 a[184:187], v4 offset:10240
    ds_read_b128 a[188:191], v4 offset:11264
    ds_read_b128 a[192:195], v4 offset:19072
    ds_read_b128 a[196:199], v4 offset:20096
    ds_read_b128 a[200:203], v4 offset:21120
    ds_read_b128 a[204:207], v4 offset:22144
    ds_read_b128 a[208:211], v4 offset:23168
    ds_read_b128 a[212:215], v4 offset:24192
    ds_read_b128 a[216:219], v4 offset:25216
    ds_read_b128 a[220:223], v4 offset:26240
    ds_read_b128 a[224:227], v4 offset:27264
    ds_read_b128 a[228:231], v4 offset:28288
    ds_read_b128 a[232:235], v4 offset:29312
    ds_read_b128 a[236:239], v4 offset:30336
    ds_read_b128 v[44:47], v4 offset:38144
    ds_read_b128 v[48:51], v4 offset:39168
    ds_read_b128 v[52:55], v4 offset:40192
    ds_read_b128 v[56:59], v4 offset:41216
    ds_read_b128 v[60:63], v4 offset:42240
    ds_read_b128 v[64:67], v4 offset:43264
    s_mov_b32 s21, 0
poll_adaLN_cond__ssm_conv_s4d__mixer_s_mlp__prompt_55:
    buffer_load_dword v246, v178, s[4:7], s21 offen sc1
    s_waitcnt vmcnt(0)
    v_cmp_gt_u32 vcc, 6, v246
    s_nop 0
    s_cmp_eq_u64 vcc, 0
    s_cbranch_scc1 slow_adaLN_cond__ssm_conv_s4d__mixer_s_mlp__prompt_57
    s_add_u32 s24, s24, 1
    s_cmp_lt_u32 s24, 40000
    s_cbranch_scc1 poll_adaLN_cond__ssm_conv_s4d__mixer_s_mlp__prompt_55
    s_branch all_done
slow_adaLN_cond__ssm_conv_s4d__mixer_s_mlp__prompt_57:
    s_mov_b32 s20, 4194304
    buffer_load_dwordx4 a[72:75], v172, s[4:7], s20 offen sc1
    s_mov_b32 s20, 4327424
    buffer_load_dwordx4 a[76:79], v172, s[4:7], s20 offen sc1
    s_mov_b32 s20, 4460544
    buffer_load_dwordx4 a[80:83], v172, s[4:7], s20 offen sc1
    s_mov_b32 s20, 4593664
    buffer_load_dwordx4 a[84:87], v172, s[4:7], s20 offen sc1
    s_mov_b32 s20, 4726784
    buffer_load_dwordx4 a[88:91], v176, s[4:7], s20 offen sc1
    s_mov_b32 s20, 4859904
    buffer_load_dwordx4 a[92:95], v173, s[4:7], s20 offen sc1
    s_mov_b32 s20, 4993024
    buffer_load_dwordx4 a[96:99], v173, s[4:7], s20 offen sc1
    s_mov_b32 s20, 5126144
    buffer_load_dwordx4 a[100:103], v173, s[4:7], s20 offen sc1
    s_mov_b32 s20, 5259264
    buffer_load_dwordx4 a[104:107], v173, s[4:7], s20 offen sc1
    s_mov_b32 s20, 5392384
    buffer_load_dwordx4 a[108:111], v174, s[4:7], s20 offen sc1
    s_mov_b32 s20, 5525504
    buffer_load_dwordx4 a[112:115], v174, s[4:7], s20 offen sc1
    s_mov_b32 s20, 5658624
    buffer_load_dwordx4 a[116:119], v174, s[4:7], s20 offen sc1
    s_mov_b32 s20, 5791744
    buffer_load_dwordx4 a[120:123], v174, s[4:7], s20 offen sc1
    s_mov_b32 s20, 5924864
    buffer_load_dwordx4 a[124:127], v177, s[4:7], s20 offen sc1
    s_mov_b32 s20, 6057984
    buffer_load_dwordx4 a[128:131], v175, s[4:7], s20 offen sc1
    s_mov_b32 s20, 6191104
    buffer_load_dwordx4 a[132:135], v175, s[4:7], s20 offen sc1
    s_mov_b32 s20, 6324224
    buffer_load_dwordx4 a[136:139], v175, s[4:7], s20 offen sc1
    s_mov_b32 s20, 6457344
    buffer_load_dwordx4 a[140:143], v175, s[4:7], s20 offen sc1
    s_waitcnt lgkmcnt(0)
    s_waitcnt vmcnt(17)
    v_mfma_f32_16x16x32_bf16 v[220:223], a[144:147], a[72:75], 0
    ds_read_b128 a[144:147], v4 offset:44288
    v_mfma_f32_16x16x32_bf16 v[224:227], a[148:151], a[72:75], 0
    ds_read_b128 a[148:151], v4 offset:45312
    v_mfma_f32_16x16x32_bf16 v[228:231], a[152:155], a[72:75], 0
    ds_read_b128 a[152:155], v4 offset:46336
    v_mfma_f32_16x16x32_bf16 v[232:235], a[156:159], a[72:75], 0
    ds_read_b128 a[156:159], v4 offset:47360
    v_mfma_f32_16x16x32_bf16 v[236:239], a[160:163], a[72:75], 0
    ds_read_b128 a[160:163], v4 offset:48384
    v_mfma_f32_16x16x32_bf16 v[240:243], a[164:167], a[72:75], 0
    ds_read_b128 a[164:167], v4 offset:49408
    buffer_load_dwordx4 a[72:75], v4, s[12:15], s28 offen offset:0 sc1
    s_waitcnt vmcnt(17)
    v_mfma_f32_16x16x32_bf16 v[220:223], a[168:171], a[76:79], v[220:223]
    ds_read_b128 a[168:171], v244 offset:33280
    v_mfma_f32_16x16x32_bf16 v[224:227], a[172:175], a[76:79], v[224:227]
    ds_read_b128 a[172:175], v244 offset:34304
    v_mfma_f32_16x16x32_bf16 v[228:231], a[176:179], a[76:79], v[228:231]
    ds_read_b128 a[176:179], v244 offset:35328
    v_mfma_f32_16x16x32_bf16 v[232:235], a[180:183], a[76:79], v[232:235]
    ds_read_b128 a[180:183], v244 offset:36352
    v_mfma_f32_16x16x32_bf16 v[236:239], a[184:187], a[76:79], v[236:239]
    ds_read_b128 a[184:187], v244 offset:37376
    v_mfma_f32_16x16x32_bf16 v[240:243], a[188:191], a[76:79], v[240:243]
    ds_read_b128 a[188:191], v244 offset:38400
    buffer_load_dwordx4 a[76:79], v4, s[12:15], s28 offen offset:1024 sc1
    s_waitcnt vmcnt(17)
    v_mfma_f32_16x16x32_bf16 v[220:223], a[192:195], a[80:83], v[220:223]
    ds_read_b128 a[192:195], v244 offset:39424
    v_mfma_f32_16x16x32_bf16 v[224:227], a[196:199], a[80:83], v[224:227]
    ds_read_b128 a[196:199], v244 offset:40448
    v_mfma_f32_16x16x32_bf16 v[228:231], a[200:203], a[80:83], v[228:231]
    ds_read_b128 a[200:203], v244 offset:41472
    v_mfma_f32_16x16x32_bf16 v[232:235], a[204:207], a[80:83], v[232:235]
    ds_read_b128 a[204:207], v244 offset:42496
    v_mfma_f32_16x16x32_bf16 v[236:239], a[208:211], a[80:83], v[236:239]
    ds_read_b128 a[208:211], v244 offset:43520
    v_mfma_f32_16x16x32_bf16 v[240:243], a[212:215], a[80:83], v[240:243]
    ds_read_b128 a[212:215], v244 offset:44544
    buffer_load_dwordx4 a[80:83], v4, s[12:15], s28 offen offset:2048 sc1
    s_waitcnt vmcnt(17)
    v_mfma_f32_16x16x32_bf16 v[220:223], a[216:219], a[84:87], v[220:223]
    ds_read_b128 a[216:219], v244 offset:45568
    v_mfma_f32_16x16x32_bf16 v[224:227], a[220:223], a[84:87], v[224:227]
    ds_read_b128 a[220:223], v244 offset:46592
    v_mfma_f32_16x16x32_bf16 v[228:231], a[224:227], a[84:87], v[228:231]
    ds_read_b128 a[224:227], v244 offset:47616
    v_mfma_f32_16x16x32_bf16 v[232:235], a[228:231], a[84:87], v[232:235]
    ds_read_b128 a[228:231], v244 offset:48640
    v_mfma_f32_16x16x32_bf16 v[236:239], a[232:235], a[84:87], v[236:239]
    ds_read_b128 a[232:235], v244 offset:49664
    v_mfma_f32_16x16x32_bf16 v[240:243], a[236:239], a[84:87], v[240:243]
    ds_read_b128 a[236:239], v244 offset:50688
    buffer_load_dwordx4 a[84:87], v4, s[12:15], s28 offen offset:3072 sc1
    s_waitcnt vmcnt(17)
    v_mfma_f32_16x16x32_bf16 v[220:223], v[44:47], a[88:91], v[220:223]
    ds_read_b128 v[44:47], v244 offset:51712
    v_mfma_f32_16x16x32_bf16 v[224:227], v[48:51], a[88:91], v[224:227]
    ds_read_b128 v[48:51], v244 offset:52736
    v_mfma_f32_16x16x32_bf16 v[228:231], v[52:55], a[88:91], v[228:231]
    ds_read_b128 v[52:55], v244 offset:53760
    v_mfma_f32_16x16x32_bf16 v[232:235], v[56:59], a[88:91], v[232:235]
    ds_read_b128 v[56:59], v244 offset:54784
    v_mfma_f32_16x16x32_bf16 v[236:239], v[60:63], a[88:91], v[236:239]
    ds_read_b128 v[60:63], v244 offset:55808
    v_mfma_f32_16x16x32_bf16 v[240:243], v[64:67], a[88:91], v[240:243]
    ds_read_b128 v[64:67], v244 offset:56832
    buffer_load_dwordx4 a[88:91], v7, s[12:15], s28 offen offset:0 sc1
    s_waitcnt vmcnt(17)
    s_waitcnt lgkmcnt(15)
    v_mfma_f32_16x16x32_bf16 v[220:223], a[144:147], a[92:95], v[220:223]
    ds_read_b128 a[144:147], v244 offset:57856
    v_mfma_f32_16x16x32_bf16 v[224:227], a[148:151], a[92:95], v[224:227]
    ds_read_b128 a[148:151], v244 offset:58880
    v_mfma_f32_16x16x32_bf16 v[228:231], a[152:155], a[92:95], v[228:231]
    ds_read_b128 a[152:155], v244 offset:59904
    v_mfma_f32_16x16x32_bf16 v[232:235], a[156:159], a[92:95], v[232:235]
    ds_read_b128 a[156:159], v244 offset:60928
    v_mfma_f32_16x16x32_bf16 v[236:239], a[160:163], a[92:95], v[236:239]
    ds_read_b128 a[160:163], v245 offset:512
    v_mfma_f32_16x16x32_bf16 v[240:243], a[164:167], a[92:95], v[240:243]
    ds_read_b128 a[164:167], v245 offset:1536
    buffer_load_dwordx4 a[92:95], v7, s[12:15], s28 offen offset:1024 sc1
    s_waitcnt vmcnt(17)
    v_mfma_f32_16x16x32_bf16 v[220:223], a[168:171], a[96:99], v[220:223]
    ds_read_b128 a[168:171], v245 offset:2560
    v_mfma_f32_16x16x32_bf16 v[224:227], a[172:175], a[96:99], v[224:227]
    ds_read_b128 a[172:175], v245 offset:3584
    v_mfma_f32_16x16x32_bf16 v[228:231], a[176:179], a[96:99], v[228:231]
    ds_read_b128 a[176:179], v245 offset:4608
    v_mfma_f32_16x16x32_bf16 v[232:235], a[180:183], a[96:99], v[232:235]
    ds_read_b128 a[180:183], v245 offset:5632
    v_mfma_f32_16x16x32_bf16 v[236:239], a[184:187], a[96:99], v[236:239]
    ds_read_b128 a[184:187], v245 offset:6656
    v_mfma_f32_16x16x32_bf16 v[240:243], a[188:191], a[96:99], v[240:243]
    ds_read_b128 a[188:191], v245 offset:7680
    buffer_load_dwordx4 a[96:99], v7, s[12:15], s28 offen offset:2048 sc1
    s_waitcnt vmcnt(17)
    v_mfma_f32_16x16x32_bf16 v[220:223], a[192:195], a[100:103], v[220:223]
    ds_read_b128 a[192:195], v245 offset:8704
    v_mfma_f32_16x16x32_bf16 v[224:227], a[196:199], a[100:103], v[224:227]
    ds_read_b128 a[196:199], v245 offset:9728
    v_mfma_f32_16x16x32_bf16 v[228:231], a[200:203], a[100:103], v[228:231]
    ds_read_b128 a[200:203], v245 offset:10752
    s_waitcnt lgkmcnt(15)
    v_mfma_f32_16x16x32_bf16 v[232:235], a[204:207], a[100:103], v[232:235]
    ds_read_b128 a[204:207], v245 offset:11776
    v_mfma_f32_16x16x32_bf16 v[236:239], a[208:211], a[100:103], v[236:239]
    ds_read_b128 a[208:211], v245 offset:12800
    v_mfma_f32_16x16x32_bf16 v[240:243], a[212:215], a[100:103], v[240:243]
    ds_read_b128 a[212:215], v245 offset:13824
    buffer_load_dwordx4 a[100:103], v7, s[12:15], s28 offen offset:3072 sc1
    s_waitcnt vmcnt(17)
    v_mfma_f32_16x16x32_bf16 v[220:223], a[216:219], a[104:107], v[220:223]
    ds_read_b128 a[216:219], v245 offset:14848
    v_mfma_f32_16x16x32_bf16 v[224:227], a[220:223], a[104:107], v[224:227]
    ds_read_b128 a[220:223], v245 offset:15872
    v_mfma_f32_16x16x32_bf16 v[228:231], a[224:227], a[104:107], v[228:231]
    ds_read_b128 a[224:227], v245 offset:16896
    v_mfma_f32_16x16x32_bf16 v[232:235], a[228:231], a[104:107], v[232:235]
    ds_read_b128 a[228:231], v245 offset:17920
    v_mfma_f32_16x16x32_bf16 v[236:239], a[232:235], a[104:107], v[236:239]
    ds_read_b128 a[232:235], v245 offset:18944
    v_mfma_f32_16x16x32_bf16 v[240:243], a[236:239], a[104:107], v[240:243]
    ds_read_b128 a[236:239], v245 offset:19968
    buffer_load_dwordx4 a[104:107], v16, s[12:15], s28 offen offset:0 sc1
    s_waitcnt vmcnt(17)
    v_mfma_f32_16x16x32_bf16 v[220:223], v[44:47], a[108:111], v[220:223]
    ds_read_b128 v[44:47], v245 offset:20992
    v_mfma_f32_16x16x32_bf16 v[224:227], v[48:51], a[108:111], v[224:227]
    ds_read_b128 v[48:51], v245 offset:22016
    v_mfma_f32_16x16x32_bf16 v[228:231], v[52:55], a[108:111], v[228:231]
    ds_read_b128 v[52:55], v245 offset:23040
    v_mfma_f32_16x16x32_bf16 v[232:235], v[56:59], a[108:111], v[232:235]
    ds_read_b128 v[56:59], v245 offset:24064
    v_mfma_f32_16x16x32_bf16 v[236:239], v[60:63], a[108:111], v[236:239]
    ds_read_b128 v[60:63], v245 offset:25088
    v_mfma_f32_16x16x32_bf16 v[240:243], v[64:67], a[108:111], v[240:243]
    ds_read_b128 v[64:67], v245 offset:26112
    buffer_load_dwordx4 a[108:111], v16, s[12:15], s28 offen offset:1024 sc1
    s_waitcnt vmcnt(17)
    s_waitcnt lgkmcnt(15)
    v_mfma_f32_16x16x32_bf16 v[220:223], a[144:147], a[112:115], v[220:223]
    ds_read_b128 a[144:147], v245 offset:27136
    v_mfma_f32_16x16x32_bf16 v[224:227], a[148:151], a[112:115], v[224:227]
    ds_read_b128 a[148:151], v245 offset:28160
    v_mfma_f32_16x16x32_bf16 v[228:231], a[152:155], a[112:115], v[228:231]
    ds_read_b128 a[152:155], v245 offset:29184
    v_mfma_f32_16x16x32_bf16 v[232:235], a[156:159], a[112:115], v[232:235]
    ds_read_b128 a[156:159], v245 offset:30208
    v_mfma_f32_16x16x32_bf16 v[236:239], a[160:163], a[112:115], v[236:239]
    ds_read_b128 a[160:163], v245 offset:31232
    v_mfma_f32_16x16x32_bf16 v[240:243], a[164:167], a[112:115], v[240:243]
    ds_read_b128 a[164:167], v245 offset:32256
    buffer_load_dwordx4 a[112:115], v16, s[12:15], s28 offen offset:2048 sc1
    s_waitcnt vmcnt(17)
    v_mfma_f32_16x16x32_bf16 v[220:223], a[168:171], a[116:119], v[220:223]
    ds_read_b128 a[168:171], v245 offset:33280
    v_mfma_f32_16x16x32_bf16 v[224:227], a[172:175], a[116:119], v[224:227]
    ds_read_b128 a[172:175], v245 offset:34304
    v_mfma_f32_16x16x32_bf16 v[228:231], a[176:179], a[116:119], v[228:231]
    ds_read_b128 a[176:179], v245 offset:35328
    v_mfma_f32_16x16x32_bf16 v[232:235], a[180:183], a[116:119], v[232:235]
    ds_read_b128 a[180:183], v245 offset:36352
    v_mfma_f32_16x16x32_bf16 v[236:239], a[184:187], a[116:119], v[236:239]
    ds_read_b128 a[184:187], v245 offset:37376
    v_mfma_f32_16x16x32_bf16 v[240:243], a[188:191], a[116:119], v[240:243]
    ds_read_b128 a[188:191], v245 offset:38400
    buffer_load_dwordx4 a[116:119], v16, s[12:15], s28 offen offset:3072 sc1
    s_waitcnt vmcnt(17)
    v_mfma_f32_16x16x32_bf16 v[220:223], a[192:195], a[120:123], v[220:223]
    ds_read_b128 a[192:195], v244 offset:14848
    v_mfma_f32_16x16x32_bf16 v[224:227], a[196:199], a[120:123], v[224:227]
    ds_read_b128 a[196:199], v244 offset:15872
    v_mfma_f32_16x16x32_bf16 v[228:231], a[200:203], a[120:123], v[228:231]
    ds_read_b128 a[200:203], v244 offset:16896
    s_waitcnt lgkmcnt(15)
    v_mfma_f32_16x16x32_bf16 v[232:235], a[204:207], a[120:123], v[232:235]
    ds_read_b128 a[204:207], v244 offset:17920
    v_mfma_f32_16x16x32_bf16 v[236:239], a[208:211], a[120:123], v[236:239]
    ds_read_b128 a[208:211], v244 offset:18944
    v_mfma_f32_16x16x32_bf16 v[240:243], a[212:215], a[120:123], v[240:243]
    ds_read_b128 a[212:215], v244 offset:19968
    buffer_load_dwordx4 a[120:123], v17, s[12:15], s28 offen offset:0 sc1
    s_waitcnt vmcnt(17)
    v_mfma_f32_16x16x32_bf16 v[220:223], a[216:219], a[124:127], v[220:223]
    v_mfma_f32_16x16x32_bf16 v[224:227], a[220:223], a[124:127], v[224:227]
    v_mfma_f32_16x16x32_bf16 v[228:231], a[224:227], a[124:127], v[228:231]
    v_mfma_f32_16x16x32_bf16 v[232:235], a[228:231], a[124:127], v[232:235]
    v_mfma_f32_16x16x32_bf16 v[236:239], a[232:235], a[124:127], v[236:239]
    v_mfma_f32_16x16x32_bf16 v[240:243], a[236:239], a[124:127], v[240:243]
    buffer_load_dwordx4 a[124:127], v17, s[12:15], s28 offen offset:1024 sc1
    s_waitcnt vmcnt(17)
    v_mfma_f32_16x16x32_bf16 v[220:223], v[44:47], a[128:131], v[220:223]
    v_mfma_f32_16x16x32_bf16 v[224:227], v[48:51], a[128:131], v[224:227]
    v_mfma_f32_16x16x32_bf16 v[228:231], v[52:55], a[128:131], v[228:231]
    v_mfma_f32_16x16x32_bf16 v[232:235], v[56:59], a[128:131], v[232:235]
    v_mfma_f32_16x16x32_bf16 v[236:239], v[60:63], a[128:131], v[236:239]
    v_mfma_f32_16x16x32_bf16 v[240:243], v[64:67], a[128:131], v[240:243]
    buffer_load_dwordx4 a[128:131], v17, s[12:15], s28 offen offset:2048 sc1
    s_waitcnt vmcnt(17)
    s_waitcnt lgkmcnt(15)
    v_mfma_f32_16x16x32_bf16 v[220:223], a[144:147], a[132:135], v[220:223]
    v_mfma_f32_16x16x32_bf16 v[224:227], a[148:151], a[132:135], v[224:227]
    v_mfma_f32_16x16x32_bf16 v[228:231], a[152:155], a[132:135], v[228:231]
    s_waitcnt lgkmcnt(14)
    v_mfma_f32_16x16x32_bf16 v[232:235], a[156:159], a[132:135], v[232:235]
    s_waitcnt lgkmcnt(13)
    v_mfma_f32_16x16x32_bf16 v[236:239], a[160:163], a[132:135], v[236:239]
    s_waitcnt lgkmcnt(12)
    v_mfma_f32_16x16x32_bf16 v[240:243], a[164:167], a[132:135], v[240:243]
    buffer_load_dwordx4 a[132:135], v17, s[12:15], s28 offen offset:3072 sc1
    s_waitcnt vmcnt(17)
    s_waitcnt lgkmcnt(11)
    v_mfma_f32_16x16x32_bf16 v[220:223], a[168:171], a[136:139], v[220:223]
    s_waitcnt lgkmcnt(10)
    v_mfma_f32_16x16x32_bf16 v[224:227], a[172:175], a[136:139], v[224:227]
    s_waitcnt lgkmcnt(9)
    v_mfma_f32_16x16x32_bf16 v[228:231], a[176:179], a[136:139], v[228:231]
    s_waitcnt lgkmcnt(8)
    v_mfma_f32_16x16x32_bf16 v[232:235], a[180:183], a[136:139], v[232:235]
    s_waitcnt lgkmcnt(7)
    v_mfma_f32_16x16x32_bf16 v[236:239], a[184:187], a[136:139], v[236:239]
    s_waitcnt lgkmcnt(6)
    v_mfma_f32_16x16x32_bf16 v[240:243], a[188:191], a[136:139], v[240:243]
    buffer_load_dwordx4 a[136:139], v18, s[12:15], s28 offen offset:0 sc1
    s_waitcnt vmcnt(17)
    s_waitcnt lgkmcnt(5)
    v_mfma_f32_16x16x32_bf16 v[220:223], a[192:195], a[140:143], v[220:223]
    s_waitcnt lgkmcnt(4)
    v_mfma_f32_16x16x32_bf16 v[224:227], a[196:199], a[140:143], v[224:227]
    s_waitcnt lgkmcnt(3)
    v_mfma_f32_16x16x32_bf16 v[228:231], a[200:203], a[140:143], v[228:231]
    s_waitcnt lgkmcnt(2)
    v_mfma_f32_16x16x32_bf16 v[232:235], a[204:207], a[140:143], v[232:235]
    s_waitcnt lgkmcnt(1)
    v_mfma_f32_16x16x32_bf16 v[236:239], a[208:211], a[140:143], v[236:239]
    s_waitcnt lgkmcnt(0)
    v_mfma_f32_16x16x32_bf16 v[240:243], a[212:215], a[140:143], v[240:243]
    buffer_load_dwordx4 a[140:143], v18, s[12:15], s28 offen offset:1024 sc1
    v_lshrrev_b32 v190, 1, v2
    v_lshlrev_b32 v173, 6, v190
    v_lshl_add_u32 v173, v3, 2, v173
    s_mul_i32 s20, s16, 18
    s_mul_i32 s31, s17, 3
    s_add_u32 s20, s20, s31
    s_lshl_b32 s20, s20, 2
    s_add_u32 s20, s20, s3
    s_lshl_b32 s20, s20, 10
    s_add_u32 s20, s20, 7340032
    v_pk_add_f32 v[100:101], v[100:101], v[220:221]
    v_pk_add_f32 v[102:103], v[102:103], v[222:223]
    v_pk_add_f32 v[104:105], v[104:105], v[224:225]
    v_pk_add_f32 v[106:107], v[106:107], v[226:227]
    v_pk_add_f32 v[108:109], v[108:109], v[228:229]
    v_pk_add_f32 v[110:111], v[110:111], v[230:231]
    v_pk_add_f32 v[112:113], v[112:113], v[232:233]
    v_pk_add_f32 v[114:115], v[114:115], v[234:235]
    v_pk_add_f32 v[116:117], v[116:117], v[236:237]
    v_pk_add_f32 v[118:119], v[118:119], v[238:239]
    v_pk_add_f32 v[120:121], v[120:121], v[240:241]
    v_pk_add_f32 v[122:123], v[122:123], v[242:243]
    v_cvt_pk_bf16_f32 v84, v100, v101
    v_cvt_pk_bf16_f32 v85, v102, v103
    v_cvt_pk_bf16_f32 v86, v104, v105
    v_cvt_pk_bf16_f32 v87, v106, v107
    buffer_store_dwordx4 v[84:87], v4, s[4:7], s20 offen sc1
    s_add_u32 s20, s20, 4096
    v_cvt_pk_bf16_f32 v88, v108, v109
    v_cvt_pk_bf16_f32 v89, v110, v111
    v_cvt_pk_bf16_f32 v90, v112, v113
    v_cvt_pk_bf16_f32 v91, v114, v115
    buffer_store_dwordx4 v[88:91], v4, s[4:7], s20 offen sc1
    s_add_u32 s20, s20, 4096
    v_cvt_pk_bf16_f32 v92, v116, v117
    v_cvt_pk_bf16_f32 v93, v118, v119
    v_cvt_pk_bf16_f32 v94, v120, v121
    v_cvt_pk_bf16_f32 v95, v122, v123
    buffer_store_dwordx4 v[92:95], v4, s[4:7], s20 offen sc1
    v_pk_add_f32 v[190:191], v[100:101], v[102:103]
    v_pk_mul_f32 v[192:193], v[100:101], v[100:101]
    v_pk_fma_f32 v[192:193], v[102:103], v[102:103], v[192:193]
    v_pk_add_f32 v[190:191], v[190:191], v[104:105]
    v_pk_fma_f32 v[192:193], v[104:105], v[104:105], v[192:193]
    v_pk_add_f32 v[190:191], v[190:191], v[106:107]
    v_pk_fma_f32 v[192:193], v[106:107], v[106:107], v[192:193]
    v_pk_add_f32 v[190:191], v[190:191], v[108:109]
    v_pk_fma_f32 v[192:193], v[108:109], v[108:109], v[192:193]
    v_pk_add_f32 v[190:191], v[190:191], v[110:111]
    v_pk_fma_f32 v[192:193], v[110:111], v[110:111], v[192:193]
    v_pk_add_f32 v[190:191], v[190:191], v[112:113]
    v_pk_fma_f32 v[192:193], v[112:113], v[112:113], v[192:193]
    v_pk_add_f32 v[190:191], v[190:191], v[114:115]
    v_pk_fma_f32 v[192:193], v[114:115], v[114:115], v[192:193]
    v_pk_add_f32 v[190:191], v[190:191], v[116:117]
    v_pk_fma_f32 v[192:193], v[116:117], v[116:117], v[192:193]
    v_pk_add_f32 v[190:191], v[190:191], v[118:119]
    v_pk_fma_f32 v[192:193], v[118:119], v[118:119], v[192:193]
    v_pk_add_f32 v[190:191], v[190:191], v[120:121]
    v_pk_fma_f32 v[192:193], v[120:121], v[120:121], v[192:193]
    v_pk_add_f32 v[190:191], v[190:191], v[122:123]
    v_pk_fma_f32 v[192:193], v[122:123], v[122:123], v[192:193]
    v_add_f32 v190, v190, v191
    v_add_f32 v192, v192, v193
    s_nop 1
    v_permlane32_swap_b32 v190, v192
    v_add_f32 v190, v190, v192
    v_mov_b32 v191, v190
    s_nop 1
    v_permlane16_swap_b32 v190, v191
    v_add_f32 v190, v190, v191
    s_mul_i32 s20, s25, 6
    s_add_u32 s20, s20, s17
    s_lshl_b32 s20, s20, 7
    s_add_u32 s20, s20, 327680
    s_mov_b32 exec_lo, 0xffff
    s_mov_b32 exec_hi, 0xffff
    buffer_store_dword v190, v173, s[4:7], s20 offen sc1
    s_mov_b64 exec, -1
    s_waitcnt vmcnt(0)
    s_lshl_b32 s20, s25, 7
    s_add_u32 s20, s20, 16384
    s_mov_b64 exec, 1
    buffer_atomic_add v5, v6, s[4:7], s20 offen sc1
    s_mov_b64 exec, -1
k2_phase_e:
    s_add_u32 s28, s28, 18432
    s_lshl_b32 s20, s18, 2
    v_add_u32 v8, s20, v1
    s_add_u32 s20, s19, 160
    v_mov_b32 v236, s20
    v_cmp_gt_u32 vcc, 4, v1
    s_nop 1
    v_cndmask_b32 v8, v236, v8, vcc
    v_lshlrev_b32 v8, 7, v8
    s_cmp_eq_u32 s19, 7
    s_cselect_b32 s20, 196, 36
    v_mov_b32 v236, s20
    v_cndmask_b32 v236, v236, 6, vcc
    s_lshl_b32 s30, s3, 10
    s_mul_i32 s31, s18, 73728
    s_add_u32 s31, s31, s30
    s_add_u32 s31, s31, 7340032
    s_getpc_b64 s[22:23]
pc_adaLN_cond__ssm_conv_s4d__mixer_s_mlp__prompt_64:
    v_subrev_u32 v238, 64, v0
    v_lshlrev_b32 v238, 7, v238
    v_min_u32 v238, all_done-pc_adaLN_cond__ssm_conv_s4d__mixer_s_mlp__prompt_64, v238
    s_cmp_eq_u32 s3, 0
    s_cbranch_scc1 nopoll_adaLN_cond__ssm_conv_s4d__mixer_s_mlp__prompt_63_p
    global_load_dword v239, v238, s[22:23]
    v_add_u32 v238, 0x6000, v238
    v_min_u32 v238, all_done-pc_adaLN_cond__ssm_conv_s4d__mixer_s_mlp__prompt_64, v238
    global_load_dword v239, v238, s[22:23]
    s_branch nopoll_adaLN_cond__ssm_conv_s4d__mixer_s_mlp__prompt_63
nopoll_adaLN_cond__ssm_conv_s4d__mixer_s_mlp__prompt_63_p:
    s_mov_b32 s21, 16384
poll_adaLN_cond__ssm_conv_s4d__mixer_s_mlp__prompt_65:
    buffer_load_dword v237, v8, s[4:7], s21 offen sc1
    s_waitcnt vmcnt(0)
    v_cmp_gt_u32 vcc, v236, v237
    s_nop 0
    s_cmp_eq_u64 vcc, 0
    s_cbranch_scc1 slow_adaLN_cond__ssm_conv_s4d__mixer_s_mlp__prompt_67
    s_sleep 1
    s_add_u32 s24, s24, 1
    s_cmp_lt_u32 s24, 40000
    s_cbranch_scc1 poll_adaLN_cond__ssm_conv_s4d__mixer_s_mlp__prompt_65
    s_branch all_done
slow_adaLN_cond__ssm_conv_s4d__mixer_s_mlp__prompt_67:
nopoll_adaLN_cond__ssm_conv_s4d__mixer_s_mlp__prompt_63:
    s_waitcnt vmcnt(0)
    s_barrier
    s_add_u32 m0, s30, 0
    s_add_u32 s20, s31, 0
    buffer_load_dwordx4 v4, s[4:7], s20 offen sc1 lds
    s_add_u32 m0, s30, 4096
    s_add_u32 s20, s31, 4096
    buffer_load_dwordx4 v4, s[4:7], s20 offen sc1 lds
    s_add_u32 m0, s30, 8192
    s_add_u32 s20, s31, 8192
    buffer_load_dwordx4 v4, s[4:7], s20 offen sc1 lds
    s_add_u32 m0, s30, 20480
    s_add_u32 s20, s31, 20480
    buffer_load_dwordx4 v4, s[4:7], s20 offen sc1 lds
    s_add_u32 m0, s30, 24576
    s_add_u32 s20, s31, 24576
    buffer_load_dwordx4 v4, s[4:7], s20 offen sc1 lds
    s_add_u32 m0, s30, 28672
    s_add_u32 s20, s31, 28672
    buffer_load_dwordx4 v4, s[4:7], s20 offen sc1 lds
    s_add_u32 m0, s30, 36864
    s_add_u32 s20, s31, 36864
    buffer_load_dwordx4 v4, s[4:7], s20 offen sc1 lds
    s_mul_i32 s20, s18, 3072
    s_add_u32 s20, s20, s30
    s_add_u32 s20, s20, 327680
    s_add_u32 m0, s30, 156672
    s_nop 0
    buffer_load_dwordx4 v4, s[4:7], s20 offen sc1 lds
    v_mul_u32_u24 v8, 768, v2
    v_lshl_add_u32 v8, v3, 2, v8
    v_add_u32 v8, 156672, v8
    v_add_u32 v9, 0x9000, v4
    v_add_u32 v10, 73728, v4
    v_add_u32 v11, 110592, v4
    s_mul_i32 s20, s3, 9
    s_add_u32 s20, s20, 0
    s_and_b32 s21, s20, 1
    s_lshl_b32 s21, s21, 3
    s_lshr_b32 s20, s20, 1
    s_lshl_b32 s20, s20, 12
    s_add_u32 s20, s20, s21
    v_add_u32 v12, s20, v10
    s_mul_i32 s20, s3, 9
    s_add_u32 s20, s20, 1
    s_and_b32 s21, s20, 1
    s_lshl_b32 s21, s21, 3
    s_lshr_b32 s20, s20, 1
    s_lshl_b32 s20, s20, 12
    s_add_u32 s20, s20, s21
    v_add_u32 v13, s20, v10
    s_waitcnt vmcnt(5)
    s_barrier
    ds_read_b128 a[144:147], v4 offset:0
    ds_read_b128 a[148:151], v4 offset:1024
    ds_read_b128 a[152:155], v4 offset:2048
    ds_read_b128 a[156:159], v4 offset:3072
    ds_read_b128 a[160:163], v4 offset:4096
    ds_read_b128 a[164:167], v4 offset:5120
    ds_read_b128 a[168:171], v4 offset:6144
    ds_read_b128 a[172:175], v4 offset:7168
    ds_read_b128 a[176:179], v4 offset:8192
    ds_read_b128 a[180:183], v4 offset:9216
    ds_read_b128 a[184:187], v4 offset:10240
    ds_read_b128 a[188:191], v4 offset:11264
    s_waitcnt lgkmcnt(8)
    v_mfma_f32_16x16x32_bf16 v[220:223], a[0:3], a[144:147], 0
    v_mfma_f32_16x16x32_bf16 v[224:227], a[0:3], a[148:151], 0
    v_mfma_f32_16x16x32_bf16 v[228:231], a[0:3], a[152:155], 0
    v_mfma_f32_16x16x32_bf16 v[232:235], a[0:3], a[156:159], 0
    s_add_u32 m0, s30, 40960
    s_add_u32 s20, s31, 40960
    buffer_load_dwordx4 v4, s[4:7], s20 offen sc1 lds
    s_add_u32 m0, s30, 45056
    s_add_u32 s20, s31, 45056
    buffer_load_dwordx4 v4, s[4:7], s20 offen sc1 lds
    s_add_u32 m0, s30, 57344
    s_add_u32 s20, s31, 57344
    buffer_load_dwordx4 v4, s[4:7], s20 offen sc1 lds
    s_add_u32 m0, s30, 61440
    s_add_u32 s20, s31, 61440
    buffer_load_dwordx4 v4, s[4:7], s20 offen sc1 lds
    s_waitcnt vmcnt(5)
    s_barrier
    ds_read_b128 a[224:227], v4 offset:20480
    ds_read_b128 a[228:231], v4 offset:21504
    ds_read_b128 a[232:235], v4 offset:22528
    ds_read_b128 a[236:239], v4 offset:23552
    s_waitcnt lgkmcnt(8)
    v_mfma_f32_16x16x32_bf16 v[220:223], a[4:7], a[160:163], v[220:223]
    v_mfma_f32_16x16x32_bf16 v[224:227], a[4:7], a[164:167], v[224:227]
    v_mfma_f32_16x16x32_bf16 v[228:231], a[4:7], a[168:171], v[228:231]
    v_mfma_f32_16x16x32_bf16 v[232:235], a[4:7], a[172:175], v[232:235]
    s_add_u32 m0, s30, 65536
    s_add_u32 s20, s31, 65536
    buffer_load_dwordx4 v4, s[4:7], s20 offen sc1 lds
    s_add_u32 m0, s30, 12288
    s_add_u32 s20, s31, 12288
    buffer_load_dwordx4 v4, s[4:7], s20 offen sc1 lds
    s_add_u32 m0, s30, 49152
    s_add_u32 s20, s31, 49152
    buffer_load_dwordx4 v4, s[4:7], s20 offen sc1 lds
    s_add_u32 m0, s30, 16384
    s_add_u32 s20, s31, 16384
    buffer_load_dwordx4 v4, s[4:7], s20 offen sc1 lds
    ds_read_b128 a[240:243], v4 offset:24576
    ds_read_b128 a[244:247], v4 offset:25600
    ds_read_b128 a[248:251], v4 offset:26624
    ds_read_b128 a[252:255], v4 offset:27648
    s_waitcnt lgkmcnt(8)
    v_mfma_f32_16x16x32_bf16 v[220:223], a[8:11], a[176:179], v[220:223]
    v_mfma_f32_16x16x32_bf16 v[224:227], a[8:11], a[180:183], v[224:227]
    v_mfma_f32_16x16x32_bf16 v[228:231], a[8:11], a[184:187], v[228:231]
    v_mfma_f32_16x16x32_bf16 v[232:235], a[8:11], a[188:191], v[232:235]
    s_add_u32 m0, s30, 32768
    s_add_u32 s20, s31, 32768
    buffer_load_dwordx4 v4, s[4:7], s20 offen sc1 lds
    s_add_u32 m0, s30, 53248
    s_add_u32 s20, s31, 53248
    buffer_load_dwordx4 v4, s[4:7], s20 offen sc1 lds
    s_add_u32 m0, s30, 69632
    s_add_u32 s20, s31, 69632
    buffer_load_dwordx4 v4, s[4:7], s20 offen sc1 lds
    buffer_load_dwordx4 a[0:3], v4, s[12:15], s28 offen offset:0 sc1
    ds_read_b128 v[44:47], v4 offset:28672
    ds_read_b128 v[48:51], v4 offset:29696
    ds_read_b128 v[52:55], v4 offset:30720
    ds_read_b128 v[56:59], v4 offset:31744
    s_waitcnt lgkmcnt(8)
    v_mfma_f32_16x16x32_bf16 v[220:223], a[20:23], a[224:227], v[220:223]
    v_mfma_f32_16x16x32_bf16 v[224:227], a[20:23], a[228:231], v[224:227]
    v_mfma_f32_16x16x32_bf16 v[228:231], a[20:23], a[232:235], v[228:231]
    v_mfma_f32_16x16x32_bf16 v[232:235], a[20:23], a[236:239], v[232:235]
    buffer_load_dwordx4 a[4:7], v4, s[12:15], s28 offen offset:1024 sc1
    buffer_load_dwordx4 a[8:11], v4, s[12:15], s28 offen offset:2048 sc1
    buffer_load_dwordx4 a[20:23], v7, s[12:15], s28 offen offset:1024 sc1
    ds_read_b128 v[76:79], v9 offset:0
    ds_read_b128 v[80:83], v9 offset:1024
    ds_read_b128 v[84:87], v9 offset:2048
    ds_read_b128 v[88:91], v9 offset:3072
    s_waitcnt lgkmcnt(8)
    v_mfma_f32_16x16x32_bf16 v[220:223], a[24:27], a[240:243], v[220:223]
    v_mfma_f32_16x16x32_bf16 v[224:227], a[24:27], a[244:247], v[224:227]
    v_mfma_f32_16x16x32_bf16 v[228:231], a[24:27], a[248:251], v[228:231]
    v_mfma_f32_16x16x32_bf16 v[232:235], a[24:27], a[252:255], v[232:235]
    buffer_load_dwordx4 a[24:27], v7, s[12:15], s28 offen offset:2048 sc1
    s_waitcnt vmcnt(11)
    s_barrier
    ds_read_b128 v[92:95], v9 offset:4096
    ds_read_b128 v[96:99], v9 offset:5120
    ds_read_b128 v[100:103], v9 offset:6144
    ds_read_b128 v[104:107], v9 offset:7168
    s_waitcnt lgkmcnt(8)
    v_mfma_f32_16x16x32_bf16 v[220:223], a[28:31], v[44:47], v[220:223]
    v_mfma_f32_16x16x32_bf16 v[224:227], a[28:31], v[48:51], v[224:227]
    v_mfma_f32_16x16x32_bf16 v[228:231], a[28:31], v[52:55], v[228:231]
    v_mfma_f32_16x16x32_bf16 v[232:235], a[28:31], v[56:59], v[232:235]
    buffer_load_dwordx4 a[28:31], v7, s[12:15], s28 offen offset:3072 sc1
    ds_read_b128 v[108:111], v9 offset:8192
    ds_read_b128 v[112:115], v9 offset:9216
    ds_read_b128 v[116:119], v9 offset:10240
    ds_read_b128 v[120:123], v9 offset:11264
    s_waitcnt lgkmcnt(8)
    v_mfma_f32_16x16x32_bf16 v[220:223], a[36:39], v[76:79], v[220:223]
    v_mfma_f32_16x16x32_bf16 v[224:227], a[36:39], v[80:83], v[224:227]
    v_mfma_f32_16x16x32_bf16 v[228:231], a[36:39], v[84:87], v[228:231]
    v_mfma_f32_16x16x32_bf16 v[232:235], a[36:39], v[88:91], v[232:235]
    buffer_load_dwordx4 a[36:39], v16, s[12:15], s28 offen offset:1024 sc1
    ds_read_b128 v[156:159], v9 offset:20480
    ds_read_b128 v[160:163], v9 offset:21504
    ds_read_b128 v[164:167], v9 offset:22528
    ds_read_b128 v[168:171], v9 offset:23552
    s_waitcnt lgkmcnt(8)
    v_mfma_f32_16x16x32_bf16 v[220:223], a[40:43], v[92:95], v[220:223]
    v_mfma_f32_16x16x32_bf16 v[224:227], a[40:43], v[96:99], v[224:227]
    v_mfma_f32_16x16x32_bf16 v[228:231], a[40:43], v[100:103], v[228:231]
    v_mfma_f32_16x16x32_bf16 v[232:235], a[40:43], v[104:107], v[232:235]
    buffer_load_dwordx4 a[40:43], v16, s[12:15], s28 offen offset:2048 sc1
    ds_read_b128 v[172:175], v9 offset:24576
    ds_read_b128 v[176:179], v9 offset:25600
    ds_read_b128 v[180:183], v9 offset:26624
    ds_read_b128 v[184:187], v9 offset:27648
    s_waitcnt lgkmcnt(8)
    v_mfma_f32_16x16x32_bf16 v[220:223], a[44:47], v[108:111], v[220:223]
    v_mfma_f32_16x16x32_bf16 v[224:227], a[44:47], v[112:115], v[224:227]
    v_mfma_f32_16x16x32_bf16 v[228:231], a[44:47], v[116:119], v[228:231]
    v_mfma_f32_16x16x32_bf16 v[232:235], a[44:47], v[120:123], v[232:235]
    buffer_load_dwordx4 a[44:47], v16, s[12:15], s28 offen offset:3072 sc1
    ds_read_b128 v[188:191], v9 offset:28672
    ds_read_b128 v[192:195], v9 offset:29696
    ds_read_b128 v[196:199], v9 offset:30720
    ds_read_b128 v[200:203], v9 offset:31744
    s_waitcnt lgkmcnt(8)
    v_mfma_f32_16x16x32_bf16 v[220:223], a[56:59], v[156:159], v[220:223]
    v_mfma_f32_16x16x32_bf16 v[224:227], a[56:59], v[160:163], v[224:227]
    v_mfma_f32_16x16x32_bf16 v[228:231], a[56:59], v[164:167], v[228:231]
    v_mfma_f32_16x16x32_bf16 v[232:235], a[56:59], v[168:171], v[232:235]
    buffer_load_dwordx4 a[56:59], v17, s[12:15], s28 offen offset:2048 sc1
    s_waitcnt vmcnt(10)
    s_barrier
    ds_read_b128 a[192:195], v4 offset:12288
    ds_read_b128 a[196:199], v4 offset:13312
    ds_read_b128 a[200:203], v4 offset:14336
    ds_read_b128 a[204:207], v4 offset:15360
    s_waitcnt lgkmcnt(8)
    v_mfma_f32_16x16x32_bf16 v[220:223], a[60:63], v[172:175], v[220:223]
    v_mfma_f32_16x16x32_bf16 v[224:227], a[60:63], v[176:179], v[224:227]
    v_mfma_f32_16x16x32_bf16 v[228:231], a[60:63], v[180:183], v[228:231]
    v_mfma_f32_16x16x32_bf16 v[232:235], a[60:63], v[184:187], v[232:235]
    buffer_load_dwordx4 a[60:63], v17, s[12:15], s28 offen offset:3072 sc1
    ds_read2_b32 v[236:237], v8 offset0:0 offset1:16
    ds_read2_b32 v[238:239], v8 offset0:32 offset1:48
    ds_read2_b32 v[240:241], v8 offset0:64 offset1:80
    ds_read2_b32 v[242:243], v8 offset0:96 offset1:112
    ds_read2_b32 v[244:245], v8 offset0:128 offset1:144
    ds_read2_b32 v[246:247], v8 offset0:160 offset1:176
    ds_read_b128 v[124:127], v9 offset:12288
    ds_read_b128 v[128:131], v9 offset:13312
    ds_read_b128 v[132:135], v9 offset:14336
    ds_read_b128 v[136:139], v9 offset:15360
    s_waitcnt lgkmcnt(14)
    v_mfma_f32_16x16x32_bf16 v[220:223], a[64:67], v[188:191], v[220:223]
    v_mfma_f32_16x16x32_bf16 v[224:227], a[64:67], v[192:195], v[224:227]
    v_mfma_f32_16x16x32_bf16 v[228:231], a[64:67], v[196:199], v[228:231]
    v_mfma_f32_16x16x32_bf16 v[232:235], a[64:67], v[200:203], v[232:235]
    buffer_load_dwordx4 a[64:67], v18, s[12:15], s28 offen offset:0 sc1
    ds_read_b128 a[208:211], v4 offset:16384
    ds_read_b128 a[212:215], v4 offset:17408
    ds_read_b128 a[216:219], v4 offset:18432
    ds_read_b128 a[220:223], v4 offset:19456
    s_waitcnt lgkmcnt(14)
    v_mfma_f32_16x16x32_bf16 v[220:223], a[12:15], a[192:195], v[220:223]
    s_waitcnt lgkmcnt(8)
    v_add_f32 v236, v236, v238
    v_add_f32 v237, v237, v239
    v_mfma_f32_16x16x32_bf16 v[224:227], a[12:15], a[196:199], v[224:227]
    v_add_f32 v240, v240, v242
    v_add_f32 v241, v241, v243
    v_mfma_f32_16x16x32_bf16 v[228:231], a[12:15], a[200:203], v[228:231]
    v_add_f32 v244, v244, v246
    v_add_f32 v245, v245, v247
    v_mfma_f32_16x16x32_bf16 v[232:235], a[12:15], a[204:207], v[232:235]
    buffer_load_dwordx4 a[12:15], v4, s[12:15], s28 offen offset:3072 sc1
    v_add_f32 v236, v236, v240
    v_add_f32 v237, v237, v241
    ds_read_b128 v[60:63], v4 offset:32768
    ds_read_b128 v[64:67], v4 offset:33792
    ds_read_b128 v[68:71], v4 offset:34816
    ds_read_b128 v[72:75], v4 offset:35840
    s_waitcnt lgkmcnt(8)
    v_mfma_f32_16x16x32_bf16 v[220:223], a[48:51], v[124:127], v[220:223]
    v_add_f32 v236, v236, v244
    v_add_f32 v237, v237, v245
    v_mfma_f32_16x16x32_bf16 v[224:227], a[48:51], v[128:131], v[224:227]
    v_mul_f32 v236, 0x3ae38e39, v236
    v_mul_f32 v237, 0x3ae38e39, v237
    v_mfma_f32_16x16x32_bf16 v[228:231], a[48:51], v[132:135], v[228:231]
    v_fma_f32 v237, -v236, v236, v237
    v_max_f32 v237, 0, v237
    v_mfma_f32_16x16x32_bf16 v[232:235], a[48:51], v[136:139], v[232:235]
    buffer_load_dwordx4 a[48:51], v17, s[12:15], s28 offen offset:0 sc1
    v_cvt_pk_bf16_f32 v237, v237, v237
    ds_read_b128 v[140:143], v9 offset:16384
    ds_read_b128 v[144:147], v9 offset:17408
    ds_read_b128 v[148:151], v9 offset:18432
    ds_read_b128 v[152:155], v9 offset:19456
    s_waitcnt lgkmcnt(8)
    v_mfma_f32_16x16x32_bf16 v[220:223], a[16:19], a[208:211], v[220:223]
    v_and_b32 v237, 0xffff0000, v237
    v_add_f32 v237, 0x3727c5ac, v237
    v_cvt_pk_bf16_f32 v237, v237, v237
    v_mfma_f32_16x16x32_bf16 v[224:227], a[16:19], a[212:215], v[224:227]
    v_and_b32 v237, 0xffff0000, v237
    v_sqrt_f32 v237, v237
    v_mfma_f32_16x16x32_bf16 v[228:231], a[16:19], a[216:219], v[228:231]
    v_cvt_pk_bf16_f32 v237, v237, v237
    v_and_b32 v237, 0xffff0000, v237
    v_mfma_f32_16x16x32_bf16 v[232:235], a[16:19], a[220:223], v[232:235]
    buffer_load_dwordx4 a[16:19], v7, s[12:15], s28 offen offset:0 sc1
    v_lshlrev_b32 v238, 2, v3
    ds_bpermute_b32 v240, v238, v237 offset:0
    ds_read_b128 v[204:207], v9 offset:32768
    ds_read_b128 v[208:211], v9 offset:33792
    ds_read_b128 v[212:215], v9 offset:34816
    ds_read_b128 v[216:219], v9 offset:35840
    s_waitcnt lgkmcnt(9)
    v_mfma_f32_16x16x32_bf16 v[220:223], a[32:35], v[60:63], v[220:223]
    ds_bpermute_b32 v241, v238, v237 offset:64
    ds_bpermute_b32 v242, v238, v237 offset:128
    v_mfma_f32_16x16x32_bf16 v[224:227], a[32:35], v[64:67], v[224:227]
    ds_bpermute_b32 v243, v238, v237 offset:192
    v_mfma_f32_16x16x32_bf16 v[228:231], a[32:35], v[68:71], v[228:231]
    v_mfma_f32_16x16x32_bf16 v[232:235], a[32:35], v[72:75], v[232:235]
    buffer_load_dwordx4 a[32:35], v16, s[12:15], s28 offen offset:0 sc1
    s_waitcnt lgkmcnt(8)
    v_mfma_f32_16x16x32_bf16 v[220:223], a[52:55], v[140:143], v[220:223]
    s_waitcnt lgkmcnt(0)
    v_mov_b32 v30, v240
    v_mov_b32 v33, v241
    v_mfma_f32_16x16x32_bf16 v[224:227], a[52:55], v[144:147], v[224:227]
    v_mov_b32 v36, v242
    v_mov_b32 v39, v243
    v_mfma_f32_16x16x32_bf16 v[228:231], a[52:55], v[148:151], v[228:231]
    v_rcp_f32 v28, v240
    v_mfma_f32_16x16x32_bf16 v[232:235], a[52:55], v[152:155], v[232:235]
    buffer_load_dwordx4 a[52:55], v17, s[12:15], s28 offen offset:1024 sc1
    v_rcp_f32 v31, v241
    v_mfma_f32_16x16x32_bf16 v[220:223], a[68:71], v[204:207], v[220:223]
    v_rcp_f32 v34, v242
    v_mfma_f32_16x16x32_bf16 v[224:227], a[68:71], v[208:211], v[224:227]
    v_rcp_f32 v37, v243
    v_mfma_f32_16x16x32_bf16 v[228:231], a[68:71], v[212:215], v[228:231]
    v_mul_f32 v29, v28, v28
    v_mul_f32 v32, v31, v31
    v_mfma_f32_16x16x32_bf16 v[232:235], a[68:71], v[216:219], v[232:235]
    buffer_load_dwordx4 a[68:71], v18, s[12:15], s28 offen offset:1024 sc1
    v_mul_f32 v35, v34, v34
    v_mul_f32 v38, v37, v37
    v_mul_f32 v29, v29, v28
    v_mul_f32 v32, v32, v31
    v_mul_f32 v35, v35, v34
    v_mul_f32 v38, v38, v37
    v_mul_f32 v28, 0xc0135761, v28
    v_mul_f32 v31, 0xc0135761, v31
    v_mul_f32 v34, 0xc0135761, v34
    v_mul_f32 v37, 0xc0135761, v37
    v_mul_f32 v29, 0xbdd2d3e8, v29
    v_mul_f32 v32, 0xbdd2d3e8, v32
    v_mul_f32 v35, 0xbdd2d3e8, v35
    v_mul_f32 v38, 0xbdd2d3e8, v38
    s_add_u32 s28, s28, 18432
    s_add_u32 s38, s29, 73728
    s_mul_i32 s39, s3, 18432
    s_lshr_b32 s31, s19, 1
    s_mul_i32 s31, s31, 9
    s_and_b32 s21, s19, 1
    s_lshl_b32 s21, s21, 11
    s_lshr_b32 s30, s3, 1
    s_lshl_b32 s30, s30, 8
    s_add_u32 s21, s21, s30
    s_and_b32 s30, s3, 1
    s_lshl_b32 s30, s30, 3
    s_add_u32 s21, s21, s30
    v_lshrrev_b32 v254, 1, v2
    v_lshl_add_u32 v252, v254, 10, s21
    v_lshl_add_u32 v252, v3, 4, v252
    v_and_b32 v254, 1, v2
    v_lshl_add_u32 v254, v254, 2, v252
    s_add_u32 s20, s31, 0
    s_and_b32 s30, s20, 1
    s_lshl_b32 s30, s30, 9
    s_lshr_b32 s20, s20, 1
    s_lshl_b32 s20, s20, 12
    s_add_u32 s20, s20, s30
    v_add_u32 v252, s20, v254
    s_add_u32 s20, s31, 1
    s_and_b32 s30, s20, 1
    s_lshl_b32 s30, s30, 9
    s_lshr_b32 s20, s20, 1
    s_lshl_b32 s20, s20, 12
    s_add_u32 s20, s20, s30
    v_add_u32 v253, s20, v254
    s_mul_i32 s20, s3, 2304
    s_add_u32 s20, s20, 147456
    v_lshl_add_u32 v254, v1, 2, s20
    v_mfma_f32_16x16x32_bf16 v[236:239], a[72:75], a[144:147], 0
    v_mfma_f32_16x16x32_bf16 v[240:243], a[72:75], a[148:151], 0
    v_mul_f32 v20, v220, v220
    v_mul_f32 v21, v221, v221
    v_mul_f32 v22, v222, v222
    v_mul_f32 v23, v223, v223
    v_fma_f32 v20, v20, v29, v28
    v_mfma_f32_16x16x32_bf16 v[244:247], a[72:75], a[152:155], 0
    v_fma_f32 v21, v21, v29, v28
    v_fma_f32 v22, v22, v29, v28
    v_fma_f32 v23, v23, v29, v28
    v_mfma_f32_16x16x32_bf16 v[248:251], a[72:75], a[156:159], 0
    v_mul_f32 v20, v20, v220
    v_mul_f32 v21, v21, v221
    v_mul_f32 v22, v22, v222
    v_mfma_f32_16x16x32_bf16 v[236:239], a[76:79], a[160:163], v[236:239]
    buffer_load_dwordx4 a[72:75], v4, s[12:15], s28 offen offset:0 sc1
    v_mul_f32 v23, v23, v223
    v_mfma_f32_16x16x32_bf16 v[240:243], a[76:79], a[164:167], v[240:243]
    v_exp_f32 v20, v20
    v_exp_f32 v21, v21
    v_mfma_f32_16x16x32_bf16 v[244:247], a[76:79], a[168:171], v[244:247]
    v_exp_f32 v22, v22
    v_mfma_f32_16x16x32_bf16 v[248:251], a[76:79], a[172:175], v[248:251]
    v_exp_f32 v23, v23
    v_mfma_f32_16x16x32_bf16 v[236:239], a[80:83], a[176:179], v[236:239]
    buffer_load_dwordx4 a[76:79], v4, s[12:15], s28 offen offset:1024 sc1
    v_fma_f32 v20, v20, v30, v30
    v_fma_f32 v21, v21, v30, v30
    v_fma_f32 v22, v22, v30, v30
    v_mfma_f32_16x16x32_bf16 v[240:243], a[80:83], a[180:183], v[240:243]
    v_fma_f32 v23, v23, v30, v30
    ds_read_b32 v8, v252 offset:0
    v_mfma_f32_16x16x32_bf16 v[244:247], a[80:83], a[184:187], v[244:247]
    v_rcp_f32 v20, v20
    v_rcp_f32 v21, v21
    v_mfma_f32_16x16x32_bf16 v[248:251], a[80:83], a[188:191], v[248:251]
    v_rcp_f32 v22, v22
    v_mfma_f32_16x16x32_bf16 v[236:239], a[92:95], a[224:227], v[236:239]
    buffer_load_dwordx4 a[80:83], v4, s[12:15], s28 offen offset:2048 sc1
    v_rcp_f32 v23, v23
    v_mfma_f32_16x16x32_bf16 v[240:243], a[92:95], a[228:231], v[240:243]
    v_mul_f32 v20, v20, v220
    v_mul_f32 v21, v21, v221
    v_mfma_f32_16x16x32_bf16 v[244:247], a[92:95], a[232:235], v[244:247]
    v_mul_f32 v22, v22, v222
    v_mul_f32 v23, v23, v223
    v_cvt_pk_bf16_f32 v40, v20, v21
    v_mfma_f32_16x16x32_bf16 v[248:251], a[92:95], a[236:239], v[248:251]
    v_cvt_pk_bf16_f32 v41, v22, v23
    v_mfma_f32_16x16x32_bf16 v[236:239], a[96:99], a[240:243], v[236:239]
    buffer_load_dwordx4 a[92:95], v7, s[12:15], s28 offen offset:1024 sc1
    ds_write_b64 v12, v[40:41] offset:0
    v_mul_f32 v24, v224, v224
    v_mul_f32 v25, v225, v225
    v_mfma_f32_16x16x32_bf16 v[240:243], a[96:99], a[244:247], v[240:243]
    v_mul_f32 v26, v226, v226
    v_mul_f32 v27, v227, v227
    v_mfma_f32_16x16x32_bf16 v[244:247], a[96:99], a[248:251], v[244:247]
    v_fma_f32 v24, v24, v32, v31
    v_fma_f32 v25, v25, v32, v31
    v_fma_f32 v26, v26, v32, v31
    v_mfma_f32_16x16x32_bf16 v[248:251], a[96:99], a[252:255], v[248:251]
    v_fma_f32 v27, v27, v32, v31
    s_waitcnt lgkmcnt(1)
    ds_write_b32 v254, v8 offset:0
    v_mfma_f32_16x16x32_bf16 v[236:239], a[100:103], v[44:47], v[236:239]
    buffer_load_dwordx4 a[96:99], v7, s[12:15], s28 offen offset:2048 sc1
    v_mul_f32 v24, v24, v224
    v_mfma_f32_16x16x32_bf16 v[240:243], a[100:103], v[48:51], v[240:243]
    v_mul_f32 v25, v25, v225
    v_mul_f32 v26, v26, v226
    v_mul_f32 v27, v27, v227
    v_mfma_f32_16x16x32_bf16 v[244:247], a[100:103], v[52:55], v[244:247]
    v_exp_f32 v24, v24
    v_mfma_f32_16x16x32_bf16 v[248:251], a[100:103], v[56:59], v[248:251]
    v_exp_f32 v25, v25
    v_mfma_f32_16x16x32_bf16 v[236:239], a[108:111], v[76:79], v[236:239]
    buffer_load_dwordx4 a[100:103], v7, s[12:15], s28 offen offset:3072 sc1
    v_exp_f32 v26, v26
    v_exp_f32 v27, v27
    v_mfma_f32_16x16x32_bf16 v[240:243], a[108:111], v[80:83], v[240:243]
    v_fma_f32 v24, v24, v33, v33
    v_fma_f32 v25, v25, v33, v33
    v_mfma_f32_16x16x32_bf16 v[244:247], a[108:111], v[84:87], v[244:247]
    v_fma_f32 v26, v26, v33, v33
    v_fma_f32 v27, v27, v33, v33
    ds_read_b32 v8, v253 offset:0
    v_mfma_f32_16x16x32_bf16 v[248:251], a[108:111], v[88:91], v[248:251]
    v_rcp_f32 v24, v24
    v_mfma_f32_16x16x32_bf16 v[236:239], a[112:115], v[92:95], v[236:239]
    buffer_load_dwordx4 a[108:111], v16, s[12:15], s28 offen offset:1024 sc1
    v_rcp_f32 v25, v25
    v_mfma_f32_16x16x32_bf16 v[240:243], a[112:115], v[96:99], v[240:243]
    v_rcp_f32 v26, v26
    v_rcp_f32 v27, v27
    v_mfma_f32_16x16x32_bf16 v[244:247], a[112:115], v[100:103], v[244:247]
    v_mul_f32 v24, v24, v224
    v_mul_f32 v25, v25, v225
    v_mfma_f32_16x16x32_bf16 v[248:251], a[112:115], v[104:107], v[248:251]
    v_mul_f32 v26, v26, v226
    v_mul_f32 v27, v27, v227
    v_mfma_f32_16x16x32_bf16 v[236:239], a[116:119], v[108:111], v[236:239]
    buffer_load_dwordx4 a[112:115], v16, s[12:15], s28 offen offset:2048 sc1
    v_cvt_pk_bf16_f32 v42, v24, v25
    v_cvt_pk_bf16_f32 v43, v26, v27
    v_mfma_f32_16x16x32_bf16 v[240:243], a[116:119], v[112:115], v[240:243]
    ds_write_b64 v12, v[42:43] offset:1024
    v_mul_f32 v20, v228, v228
    v_mfma_f32_16x16x32_bf16 v[244:247], a[116:119], v[116:119], v[244:247]
    v_mul_f32 v21, v229, v229
    v_mul_f32 v22, v230, v230
    v_mul_f32 v23, v231, v231
    v_mfma_f32_16x16x32_bf16 v[248:251], a[116:119], v[120:123], v[248:251]
    v_fma_f32 v20, v20, v35, v34
    v_fma_f32 v21, v21, v35, v34
    v_fma_f32 v22, v22, v35, v34
    v_mfma_f32_16x16x32_bf16 v[236:239], a[128:131], v[156:159], v[236:239]
    buffer_load_dwordx4 a[116:119], v16, s[12:15], s28 offen offset:3072 sc1
    v_fma_f32 v23, v23, v35, v34
    v_mfma_f32_16x16x32_bf16 v[240:243], a[128:131], v[160:163], v[240:243]
    s_waitcnt lgkmcnt(1)
    ds_write_b32 v254, v8 offset:256
    v_mul_f32 v20, v20, v228
    v_mfma_f32_16x16x32_bf16 v[244:247], a[128:131], v[164:167], v[244:247]
    v_mul_f32 v21, v21, v229
    v_mul_f32 v22, v22, v230
    v_mul_f32 v23, v23, v231
    v_mfma_f32_16x16x32_bf16 v[248:251], a[128:131], v[168:171], v[248:251]
    v_exp_f32 v20, v20
    v_mfma_f32_16x16x32_bf16 v[236:239], a[132:135], v[172:175], v[236:239]
    buffer_load_dwordx4 a[128:131], v17, s[12:15], s28 offen offset:2048 sc1
    v_exp_f32 v21, v21
    v_mfma_f32_16x16x32_bf16 v[240:243], a[132:135], v[176:179], v[240:243]
    v_exp_f32 v22, v22
    v_mfma_f32_16x16x32_bf16 v[244:247], a[132:135], v[180:183], v[244:247]
    v_exp_f32 v23, v23
    v_fma_f32 v20, v20, v36, v36
    v_fma_f32 v21, v21, v36, v36
    v_mfma_f32_16x16x32_bf16 v[248:251], a[132:135], v[184:187], v[248:251]
    v_fma_f32 v22, v22, v36, v36
    v_fma_f32 v23, v23, v36, v36
    v_mfma_f32_16x16x32_bf16 v[236:239], a[136:139], v[188:191], v[236:239]
    buffer_load_dwordx4 a[132:135], v17, s[12:15], s28 offen offset:3072 sc1
    ds_read_b32 v8, v252 offset:4096
    v_rcp_f32 v20, v20
    v_mfma_f32_16x16x32_bf16 v[240:243], a[136:139], v[192:195], v[240:243]
    v_rcp_f32 v21, v21
    v_mfma_f32_16x16x32_bf16 v[244:247], a[136:139], v[196:199], v[244:247]
    v_rcp_f32 v22, v22
    v_mfma_f32_16x16x32_bf16 v[248:251], a[136:139], v[200:203], v[248:251]
    v_rcp_f32 v23, v23
    v_mfma_f32_16x16x32_bf16 v[236:239], a[84:87], a[192:195], v[236:239]
    buffer_load_dwordx4 a[136:139], v18, s[12:15], s28 offen offset:0 sc1
    v_mul_f32 v20, v20, v228
    v_mul_f32 v21, v21, v229
    v_mul_f32 v22, v22, v230
    v_mfma_f32_16x16x32_bf16 v[240:243], a[84:87], a[196:199], v[240:243]
    v_mul_f32 v23, v23, v231
    v_cvt_pk_bf16_f32 v40, v20, v21
    v_cvt_pk_bf16_f32 v41, v22, v23
    v_mfma_f32_16x16x32_bf16 v[244:247], a[84:87], a[200:203], v[244:247]
    ds_write_b64 v12, v[40:41] offset:2048
    v_mul_f32 v24, v232, v232
    v_mfma_f32_16x16x32_bf16 v[248:251], a[84:87], a[204:207], v[248:251]
    v_mul_f32 v25, v233, v233
    v_mul_f32 v26, v234, v234
    v_mfma_f32_16x16x32_bf16 v[236:239], a[120:123], v[124:127], v[236:239]
    buffer_load_dwordx4 a[84:87], v4, s[12:15], s28 offen offset:3072 sc1
    v_mul_f32 v27, v235, v235
    v_fma_f32 v24, v24, v38, v37
    v_mfma_f32_16x16x32_bf16 v[240:243], a[120:123], v[128:131], v[240:243]
    v_fma_f32 v25, v25, v38, v37
    v_fma_f32 v26, v26, v38, v37
    v_fma_f32 v27, v27, v38, v37
    v_mfma_f32_16x16x32_bf16 v[244:247], a[120:123], v[132:135], v[244:247]
    s_waitcnt lgkmcnt(1)
    ds_write_b32 v254, v8 offset:512
    v_mfma_f32_16x16x32_bf16 v[248:251], a[120:123], v[136:139], v[248:251]
    v_mul_f32 v24, v24, v232
    v_mul_f32 v25, v25, v233
    v_mfma_f32_16x16x32_bf16 v[236:239], a[88:91], a[208:211], v[236:239]
    buffer_load_dwordx4 a[120:123], v17, s[12:15], s28 offen offset:0 sc1
    v_mul_f32 v26, v26, v234
    v_mul_f32 v27, v27, v235
    v_mfma_f32_16x16x32_bf16 v[240:243], a[88:91], a[212:215], v[240:243]
    v_exp_f32 v24, v24
    v_exp_f32 v25, v25
    v_mfma_f32_16x16x32_bf16 v[244:247], a[88:91], a[216:219], v[244:247]
    v_exp_f32 v26, v26
    v_mfma_f32_16x16x32_bf16 v[248:251], a[88:91], a[220:223], v[248:251]
    v_exp_f32 v27, v27
    v_fma_f32 v24, v24, v39, v39
    v_mfma_f32_16x16x32_bf16 v[236:239], a[104:107], v[60:63], v[236:239]
    buffer_load_dwordx4 a[88:91], v7, s[12:15], s28 offen offset:0 sc1
    v_fma_f32 v25, v25, v39, v39
    v_fma_f32 v26, v26, v39, v39
    v_mfma_f32_16x16x32_bf16 v[240:243], a[104:107], v[64:67], v[240:243]
    v_fma_f32 v27, v27, v39, v39
    v_rcp_f32 v24, v24
    v_mfma_f32_16x16x32_bf16 v[244:247], a[104:107], v[68:71], v[244:247]
    v_rcp_f32 v25, v25
    v_mfma_f32_16x16x32_bf16 v[248:251], a[104:107], v[72:75], v[248:251]
    v_rcp_f32 v26, v26
    v_mfma_f32_16x16x32_bf16 v[236:239], a[124:127], v[140:143], v[236:239]
    buffer_load_dwordx4 a[104:107], v16, s[12:15], s28 offen offset:0 sc1
    v_rcp_f32 v27, v27
    v_mul_f32 v24, v24, v232
    v_mfma_f32_16x16x32_bf16 v[240:243], a[124:127], v[144:147], v[240:243]
    v_mul_f32 v25, v25, v233
    v_mul_f32 v26, v26, v234
    v_mul_f32 v27, v27, v235
    v_mfma_f32_16x16x32_bf16 v[244:247], a[124:127], v[148:151], v[244:247]
    v_cvt_pk_bf16_f32 v42, v24, v25
    v_cvt_pk_bf16_f32 v43, v26, v27
    v_mfma_f32_16x16x32_bf16 v[248:251], a[124:127], v[152:155], v[248:251]
    ds_write_b64 v12, v[42:43] offset:3072
    v_add_u32 v12, 4096, v12
    v_mfma_f32_16x16x32_bf16 v[236:239], a[140:143], v[204:207], v[236:239]
    buffer_load_dwordx4 a[124:127], v17, s[12:15], s28 offen offset:1024 sc1
    v_mfma_f32_16x16x32_bf16 v[240:243], a[140:143], v[208:211], v[240:243]
    v_mfma_f32_16x16x32_bf16 v[244:247], a[140:143], v[212:215], v[244:247]
    v_mfma_f32_16x16x32_bf16 v[248:251], a[140:143], v[216:219], v[248:251]
    buffer_load_dwordx4 a[140:143], v18, s[12:15], s28 offen offset:1024 sc1
    s_add_u32 s28, s28, 18432
    s_waitcnt vmcnt(34)
    v_mfma_f32_16x16x32_bf16 v[220:223], a[0:3], a[144:147], 0
    v_mfma_f32_16x16x32_bf16 v[224:227], a[0:3], a[148:151], 0
    v_mul_f32 v20, v236, v236
    v_mul_f32 v21, v237, v237
    v_mul_f32 v22, v238, v238
    v_mul_f32 v23, v239, v239
    v_mfma_f32_16x16x32_bf16 v[228:231], a[0:3], a[152:155], 0
    v_fma_f32 v20, v20, v29, v28
    v_fma_f32 v21, v21, v29, v28
    v_fma_f32 v22, v22, v29, v28
    v_mfma_f32_16x16x32_bf16 v[232:235], a[0:3], a[156:159], 0
    v_fma_f32 v23, v23, v29, v28
    v_mul_f32 v20, v20, v236
    v_mul_f32 v21, v21, v237
    v_mfma_f32_16x16x32_bf16 v[220:223], a[4:7], a[160:163], v[220:223]
    buffer_load_dwordx4 a[0:3], v4, s[12:15], s28 offen offset:0 sc1
    v_mul_f32 v22, v22, v238
    v_mul_f32 v23, v23, v239
    v_mfma_f32_16x16x32_bf16 v[224:227], a[4:7], a[164:167], v[224:227]
    v_exp_f32 v20, v20
    v_mfma_f32_16x16x32_bf16 v[228:231], a[4:7], a[168:171], v[228:231]
    v_exp_f32 v21, v21
    v_exp_f32 v22, v22
    v_mfma_f32_16x16x32_bf16 v[232:235], a[4:7], a[172:175], v[232:235]
    s_waitcnt vmcnt(33)
    v_mfma_f32_16x16x32_bf16 v[220:223], a[8:11], a[176:179], v[220:223]
    buffer_load_dwordx4 a[4:7], v4, s[12:15], s28 offen offset:1024 sc1
    v_exp_f32 v23, v23
    v_fma_f32 v20, v20, v30, v30
    v_mfma_f32_16x16x32_bf16 v[224:227], a[8:11], a[180:183], v[224:227]
    v_fma_f32 v21, v21, v30, v30
    v_fma_f32 v22, v22, v30, v30
    v_mfma_f32_16x16x32_bf16 v[228:231], a[8:11], a[184:187], v[228:231]
    v_fma_f32 v23, v23, v30, v30
    ds_read_b32 v8, v253 offset:4096
    v_rcp_f32 v20, v20
    v_mfma_f32_16x16x32_bf16 v[232:235], a[8:11], a[188:191], v[232:235]
    v_rcp_f32 v21, v21
    v_mfma_f32_16x16x32_bf16 v[220:223], a[20:23], a[224:227], v[220:223]
    buffer_load_dwordx4 a[8:11], v4, s[12:15], s28 offen offset:2048 sc1
    v_rcp_f32 v22, v22
    v_mfma_f32_16x16x32_bf16 v[224:227], a[20:23], a[228:231], v[224:227]
    v_rcp_f32 v23, v23
    v_mfma_f32_16x16x32_bf16 v[228:231], a[20:23], a[232:235], v[228:231]
    v_mul_f32 v20, v20, v236
    v_mul_f32 v21, v21, v237
    v_mul_f32 v22, v22, v238
    v_mfma_f32_16x16x32_bf16 v[232:235], a[20:23], a[236:239], v[232:235]
    v_mul_f32 v23, v23, v239
    v_cvt_pk_bf16_f32 v40, v20, v21
    s_waitcnt vmcnt(33)
    v_mfma_f32_16x16x32_bf16 v[220:223], a[24:27], a[240:243], v[220:223]
    buffer_load_dwordx4 a[20:23], v7, s[12:15], s28 offen offset:1024 sc1
    v_cvt_pk_bf16_f32 v41, v22, v23
    v_mfma_f32_16x16x32_bf16 v[224:227], a[24:27], a[244:247], v[224:227]
    ds_write_b64 v13, v[40:41] offset:0
    v_mul_f32 v24, v240, v240
    v_mfma_f32_16x16x32_bf16 v[228:231], a[24:27], a[248:251], v[228:231]
    v_mul_f32 v25, v241, v241
    v_mul_f32 v26, v242, v242
    v_mul_f32 v27, v243, v243
    v_mfma_f32_16x16x32_bf16 v[232:235], a[24:27], a[252:255], v[232:235]
    v_fma_f32 v24, v24, v32, v31
    v_fma_f32 v25, v25, v32, v31
    v_fma_f32 v26, v26, v32, v31
    v_mfma_f32_16x16x32_bf16 v[220:223], a[28:31], v[44:47], v[220:223]
    buffer_load_dwordx4 a[24:27], v7, s[12:15], s28 offen offset:2048 sc1
    v_fma_f32 v27, v27, v32, v31
    v_mfma_f32_16x16x32_bf16 v[224:227], a[28:31], v[48:51], v[224:227]
    s_waitcnt lgkmcnt(1)
    ds_write_b32 v254, v8 offset:768
    v_mul_f32 v24, v24, v240
    v_mfma_f32_16x16x32_bf16 v[228:231], a[28:31], v[52:55], v[228:231]
    v_mul_f32 v25, v25, v241
    v_mul_f32 v26, v26, v242
    v_mul_f32 v27, v27, v243
    v_mfma_f32_16x16x32_bf16 v[232:235], a[28:31], v[56:59], v[232:235]
    v_exp_f32 v24, v24
    s_waitcnt vmcnt(33)
    v_mfma_f32_16x16x32_bf16 v[220:223], a[36:39], v[76:79], v[220:223]
    buffer_load_dwordx4 a[28:31], v7, s[12:15], s28 offen offset:3072 sc1
    v_exp_f32 v25, v25
    v_mfma_f32_16x16x32_bf16 v[224:227], a[36:39], v[80:83], v[224:227]
    v_exp_f32 v26, v26
    v_mfma_f32_16x16x32_bf16 v[228:231], a[36:39], v[84:87], v[228:231]
    v_exp_f32 v27, v27
    v_fma_f32 v24, v24, v33, v33
    v_mfma_f32_16x16x32_bf16 v[232:235], a[36:39], v[88:91], v[232:235]
    v_fma_f32 v25, v25, v33, v33
    v_fma_f32 v26, v26, v33, v33
    v_fma_f32 v27, v27, v33, v33
    v_mfma_f32_16x16x32_bf16 v[220:223], a[40:43], v[92:95], v[220:223]
    buffer_load_dwordx4 a[36:39], v16, s[12:15], s28 offen offset:1024 sc1
    ds_read_b32 v8, v252 offset:8192
    v_mfma_f32_16x16x32_bf16 v[224:227], a[40:43], v[96:99], v[224:227]
    v_rcp_f32 v24, v24
    v_rcp_f32 v25, v25
    v_mfma_f32_16x16x32_bf16 v[228:231], a[40:43], v[100:103], v[228:231]
    v_rcp_f32 v26, v26
    v_mfma_f32_16x16x32_bf16 v[232:235], a[40:43], v[104:107], v[232:235]
    v_rcp_f32 v27, v27
    s_waitcnt vmcnt(33)
    v_mfma_f32_16x16x32_bf16 v[220:223], a[44:47], v[108:111], v[220:223]
    buffer_load_dwordx4 a[40:43], v16, s[12:15], s28 offen offset:2048 sc1
    v_mul_f32 v24, v24, v240
    v_mfma_f32_16x16x32_bf16 v[224:227], a[44:47], v[112:115], v[224:227]
    v_mul_f32 v25, v25, v241
    v_mul_f32 v26, v26, v242
    v_mul_f32 v27, v27, v243
    v_mfma_f32_16x16x32_bf16 v[228:231], a[44:47], v[116:119], v[228:231]
    v_cvt_pk_bf16_f32 v42, v24, v25
    v_cvt_pk_bf16_f32 v43, v26, v27
    v_mfma_f32_16x16x32_bf16 v[232:235], a[44:47], v[120:123], v[232:235]
    ds_write_b64 v13, v[42:43] offset:1024
    v_mul_f32 v20, v244, v244
    v_mul_f32 v21, v245, v245
    v_mfma_f32_16x16x32_bf16 v[220:223], a[56:59], v[156:159], v[220:223]
    buffer_load_dwordx4 a[44:47], v16, s[12:15], s28 offen offset:3072 sc1
    v_mul_f32 v22, v246, v246
    v_mfma_f32_16x16x32_bf16 v[224:227], a[56:59], v[160:163], v[224:227]
    v_mul_f32 v23, v247, v247
    v_fma_f32 v20, v20, v35, v34
    v_fma_f32 v21, v21, v35, v34
    v_mfma_f32_16x16x32_bf16 v[228:231], a[56:59], v[164:167], v[228:231]
    v_fma_f32 v22, v22, v35, v34
    v_fma_f32 v23, v23, v35, v34
    v_mfma_f32_16x16x32_bf16 v[232:235], a[56:59], v[168:171], v[232:235]
    s_waitcnt lgkmcnt(1)
    ds_write_b32 v254, v8 offset:1024
    s_waitcnt vmcnt(33)
    v_mfma_f32_16x16x32_bf16 v[220:223], a[60:63], v[172:175], v[220:223]
    buffer_load_dwordx4 a[56:59], v17, s[12:15], s28 offen offset:2048 sc1
    v_mul_f32 v20, v20, v244
    v_mul_f32 v21, v21, v245
    v_mfma_f32_16x16x32_bf16 v[224:227], a[60:63], v[176:179], v[224:227]
    v_mul_f32 v22, v22, v246
    v_mul_f32 v23, v23, v247
    v_mfma_f32_16x16x32_bf16 v[228:231], a[60:63], v[180:183], v[228:231]
    v_exp_f32 v20, v20
    v_exp_f32 v21, v21
    v_mfma_f32_16x16x32_bf16 v[232:235], a[60:63], v[184:187], v[232:235]
    v_exp_f32 v22, v22
    v_mfma_f32_16x16x32_bf16 v[220:223], a[64:67], v[188:191], v[220:223]
    buffer_load_dwordx4 a[60:63], v17, s[12:15], s28 offen offset:3072 sc1
    v_exp_f32 v23, v23
    v_mfma_f32_16x16x32_bf16 v[224:227], a[64:67], v[192:195], v[224:227]
    v_fma_f32 v20, v20, v36, v36
    v_fma_f32 v21, v21, v36, v36
    v_fma_f32 v22, v22, v36, v36
    v_mfma_f32_16x16x32_bf16 v[228:231], a[64:67], v[196:199], v[228:231]
    v_fma_f32 v23, v23, v36, v36
    ds_read_b32 v8, v253 offset:8192
    v_mfma_f32_16x16x32_bf16 v[232:235], a[64:67], v[200:203], v[232:235]
    v_rcp_f32 v20, v20
    s_waitcnt vmcnt(33)
    v_mfma_f32_16x16x32_bf16 v[220:223], a[12:15], a[192:195], v[220:223]
    buffer_load_dwordx4 a[64:67], v18, s[12:15], s28 offen offset:0 sc1
    v_rcp_f32 v21, v21
    v_mfma_f32_16x16x32_bf16 v[224:227], a[12:15], a[196:199], v[224:227]
    v_rcp_f32 v22, v22
    v_mfma_f32_16x16x32_bf16 v[228:231], a[12:15], a[200:203], v[228:231]
    v_rcp_f32 v23, v23
    v_mul_f32 v20, v20, v244
    v_mul_f32 v21, v21, v245
    v_mfma_f32_16x16x32_bf16 v[232:235], a[12:15], a[204:207], v[232:235]
    v_mul_f32 v22, v22, v246
    v_mul_f32 v23, v23, v247
    v_mfma_f32_16x16x32_bf16 v[220:223], a[48:51], v[124:127], v[220:223]
    buffer_load_dwordx4 a[12:15], v4, s[12:15], s28 offen offset:3072 sc1
    v_cvt_pk_bf16_f32 v40, v20, v21
    v_cvt_pk_bf16_f32 v41, v22, v23
    v_mfma_f32_16x16x32_bf16 v[224:227], a[48:51], v[128:131], v[224:227]
    ds_write_b64 v13, v[40:41] offset:2048
    v_mul_f32 v24, v248, v248
    v_mfma_f32_16x16x32_bf16 v[228:231], a[48:51], v[132:135], v[228:231]
    v_mul_f32 v25, v249, v249
    v_mul_f32 v26, v250, v250
    v_mfma_f32_16x16x32_bf16 v[232:235], a[48:51], v[136:139], v[232:235]
    v_mul_f32 v27, v251, v251
    v_fma_f32 v24, v24, v38, v37
    s_waitcnt vmcnt(33)
    v_mfma_f32_16x16x32_bf16 v[220:223], a[16:19], a[208:211], v[220:223]
    buffer_load_dwordx4 a[48:51], v17, s[12:15], s28 offen offset:0 sc1
    v_fma_f32 v25, v25, v38, v37
    v_fma_f32 v26, v26, v38, v37
    v_mfma_f32_16x16x32_bf16 v[224:227], a[16:19], a[212:215], v[224:227]
    v_fma_f32 v27, v27, v38, v37
    s_waitcnt lgkmcnt(1)
    ds_write_b32 v254, v8 offset:1280
    v_mfma_f32_16x16x32_bf16 v[228:231], a[16:19], a[216:219], v[228:231]
    v_mul_f32 v24, v24, v248
    v_mul_f32 v25, v25, v249
    v_mfma_f32_16x16x32_bf16 v[232:235], a[16:19], a[220:223], v[232:235]
    v_mul_f32 v26, v26, v250
    v_mul_f32 v27, v27, v251
    v_exp_f32 v24, v24
    v_mfma_f32_16x16x32_bf16 v[220:223], a[32:35], v[60:63], v[220:223]
    buffer_load_dwordx4 a[16:19], v7, s[12:15], s28 offen offset:0 sc1
    v_mfma_f32_16x16x32_bf16 v[224:227], a[32:35], v[64:67], v[224:227]
    v_exp_f32 v25, v25
    v_exp_f32 v26, v26
    v_mfma_f32_16x16x32_bf16 v[228:231], a[32:35], v[68:71], v[228:231]
    v_exp_f32 v27, v27
    v_mfma_f32_16x16x32_bf16 v[232:235], a[32:35], v[72:75], v[232:235]
    v_fma_f32 v24, v24, v39, v39
    v_fma_f32 v25, v25, v39, v39
    s_waitcnt vmcnt(33)
    v_mfma_f32_16x16x32_bf16 v[220:223], a[52:55], v[140:143], v[220:223]
    buffer_load_dwordx4 a[32:35], v16, s[12:15], s28 offen offset:0 sc1
    v_fma_f32 v26, v26, v39, v39
    v_fma_f32 v27, v27, v39, v39
    v_mfma_f32_16x16x32_bf16 v[224:227], a[52:55], v[144:147], v[224:227]
    v_rcp_f32 v24, v24
    v_mfma_f32_16x16x32_bf16 v[228:231], a[52:55], v[148:151], v[228:231]
    v_rcp_f32 v25, v25
    v_rcp_f32 v26, v26
    v_mfma_f32_16x16x32_bf16 v[232:235], a[52:55], v[152:155], v[232:235]
    v_rcp_f32 v27, v27
    v_mfma_f32_16x16x32_bf16 v[220:223], a[68:71], v[204:207], v[220:223]
    buffer_load_dwordx4 a[52:55], v17, s[12:15], s28 offen offset:1024 sc1
    v_mul_f32 v24, v24, v248
    v_mul_f32 v25, v25, v249
    v_mfma_f32_16x16x32_bf16 v[224:227], a[68:71], v[208:211], v[224:227]
    v_mul_f32 v26, v26, v250
    v_mul_f32 v27, v27, v251
    v_cvt_pk_bf16_f32 v42, v24, v25
    v_mfma_f32_16x16x32_bf16 v[228:231], a[68:71], v[212:215], v[228:231]
    v_cvt_pk_bf16_f32 v43, v26, v27
    ds_write_b64 v13, v[42:43] offset:3072
    v_mfma_f32_16x16x32_bf16 v[232:235], a[68:71], v[216:219], v[232:235]
    v_add_u32 v13, 4096, v13
    buffer_load_dwordx4 a[68:71], v18, s[12:15], s28 offen offset:1024 sc1
    s_add_u32 s28, s28, 18432
    s_waitcnt vmcnt(34)
    v_mfma_f32_16x16x32_bf16 v[236:239], a[72:75], a[144:147], 0
    v_mfma_f32_16x16x32_bf16 v[240:243], a[72:75], a[148:151], 0
    v_mul_f32 v20, v220, v220
    v_mul_f32 v21, v221, v221
    v_mul_f32 v22, v222, v222
    v_mul_f32 v23, v223, v223
    v_mfma_f32_16x16x32_bf16 v[244:247], a[72:75], a[152:155], 0
    v_fma_f32 v20, v20, v29, v28
    v_fma_f32 v21, v21, v29, v28
    v_fma_f32 v22, v22, v29, v28
    v_mfma_f32_16x16x32_bf16 v[248:251], a[72:75], a[156:159], 0
    v_fma_f32 v23, v23, v29, v28
    v_mul_f32 v20, v20, v220
    v_mul_f32 v21, v21, v221
    v_mfma_f32_16x16x32_bf16 v[236:239], a[76:79], a[160:163], v[236:239]
    buffer_load_dwordx4 a[72:75], v4, s[12:15], s28 offen offset:0 sc1
    v_mul_f32 v22, v22, v222
    v_mul_f32 v23, v23, v223
    v_mfma_f32_16x16x32_bf16 v[240:243], a[76:79], a[164:167], v[240:243]
    v_exp_f32 v20, v20
    v_mfma_f32_16x16x32_bf16 v[244:247], a[76:79], a[168:171], v[244:247]
    v_exp_f32 v21, v21
    v_exp_f32 v22, v22
    v_mfma_f32_16x16x32_bf16 v[248:251], a[76:79], a[172:175], v[248:251]
    s_waitcnt vmcnt(33)
    v_mfma_f32_16x16x32_bf16 v[236:239], a[80:83], a[176:179], v[236:239]
    buffer_load_dwordx4 a[76:79], v4, s[12:15], s28 offen offset:1024 sc1
    v_exp_f32 v23, v23
    v_fma_f32 v20, v20, v30, v30
    v_mfma_f32_16x16x32_bf16 v[240:243], a[80:83], a[180:183], v[240:243]
    v_fma_f32 v21, v21, v30, v30
    v_fma_f32 v22, v22, v30, v30
    v_mfma_f32_16x16x32_bf16 v[244:247], a[80:83], a[184:187], v[244:247]
    v_fma_f32 v23, v23, v30, v30
    ds_read_b32 v8, v252 offset:12288
    v_rcp_f32 v20, v20
    v_mfma_f32_16x16x32_bf16 v[248:251], a[80:83], a[188:191], v[248:251]
    v_rcp_f32 v21, v21
    v_mfma_f32_16x16x32_bf16 v[236:239], a[92:95], a[224:227], v[236:239]
    buffer_load_dwordx4 a[80:83], v4, s[12:15], s28 offen offset:2048 sc1
    v_rcp_f32 v22, v22
    v_mfma_f32_16x16x32_bf16 v[240:243], a[92:95], a[228:231], v[240:243]
    v_rcp_f32 v23, v23
    v_mfma_f32_16x16x32_bf16 v[244:247], a[92:95], a[232:235], v[244:247]
    v_mul_f32 v20, v20, v220
    v_mul_f32 v21, v21, v221
    v_mul_f32 v22, v22, v222
    v_mfma_f32_16x16x32_bf16 v[248:251], a[92:95], a[236:239], v[248:251]
    v_mul_f32 v23, v23, v223
    v_cvt_pk_bf16_f32 v40, v20, v21
    s_waitcnt vmcnt(33)
    v_mfma_f32_16x16x32_bf16 v[236:239], a[96:99], a[240:243], v[236:239]
    buffer_load_dwordx4 a[92:95], v7, s[12:15], s28 offen offset:1024 sc1
    v_cvt_pk_bf16_f32 v41, v22, v23
    v_mfma_f32_16x16x32_bf16 v[240:243], a[96:99], a[244:247], v[240:243]
    ds_write_b64 v12, v[40:41] offset:0
    v_mul_f32 v24, v224, v224
    v_mfma_f32_16x16x32_bf16 v[244:247], a[96:99], a[248:251], v[244:247]
    v_mul_f32 v25, v225, v225
    v_mul_f32 v26, v226, v226
    v_mul_f32 v27, v227, v227
    v_mfma_f32_16x16x32_bf16 v[248:251], a[96:99], a[252:255], v[248:251]
    v_fma_f32 v24, v24, v32, v31
    v_fma_f32 v25, v25, v32, v31
    v_fma_f32 v26, v26, v32, v31
    v_mfma_f32_16x16x32_bf16 v[236:239], a[100:103], v[44:47], v[236:239]
    buffer_load_dwordx4 a[96:99], v7, s[12:15], s28 offen offset:2048 sc1
    v_fma_f32 v27, v27, v32, v31
    v_mfma_f32_16x16x32_bf16 v[240:243], a[100:103], v[48:51], v[240:243]
    s_waitcnt lgkmcnt(1)
    ds_write_b32 v254, v8 offset:1536
    v_mul_f32 v24, v24, v224
    v_mfma_f32_16x16x32_bf16 v[244:247], a[100:103], v[52:55], v[244:247]
    v_mul_f32 v25, v25, v225
    v_mul_f32 v26, v26, v226
    v_mul_f32 v27, v27, v227
    v_mfma_f32_16x16x32_bf16 v[248:251], a[100:103], v[56:59], v[248:251]
    v_exp_f32 v24, v24
    s_waitcnt vmcnt(33)
    v_mfma_f32_16x16x32_bf16 v[236:239], a[108:111], v[76:79], v[236:239]
    buffer_load_dwordx4 a[100:103], v7, s[12:15], s28 offen offset:3072 sc1
    v_exp_f32 v25, v25
    v_mfma_f32_16x16x32_bf16 v[240:243], a[108:111], v[80:83], v[240:243]
    v_exp_f32 v26, v26
    v_mfma_f32_16x16x32_bf16 v[244:247], a[108:111], v[84:87], v[244:247]
    v_exp_f32 v27, v27
    v_fma_f32 v24, v24, v33, v33
    v_mfma_f32_16x16x32_bf16 v[248:251], a[108:111], v[88:91], v[248:251]
    v_fma_f32 v25, v25, v33, v33
    v_fma_f32 v26, v26, v33, v33
    v_fma_f32 v27, v27, v33, v33
    v_mfma_f32_16x16x32_bf16 v[236:239], a[112:115], v[92:95], v[236:239]
    buffer_load_dwordx4 a[108:111], v16, s[12:15], s28 offen offset:1024 sc1
    ds_read_b32 v8, v253 offset:12288
    v_mfma_f32_16x16x32_bf16 v[240:243], a[112:115], v[96:99], v[240:243]
    v_rcp_f32 v24, v24
    v_rcp_f32 v25, v25
    v_mfma_f32_16x16x32_bf16 v[244:247], a[112:115], v[100:103], v[244:247]
    v_rcp_f32 v26, v26
    v_mfma_f32_16x16x32_bf16 v[248:251], a[112:115], v[104:107], v[248:251]
    v_rcp_f32 v27, v27
    s_waitcnt vmcnt(33)
    v_mfma_f32_16x16x32_bf16 v[236:239], a[116:119], v[108:111], v[236:239]
    buffer_load_dwordx4 a[112:115], v16, s[12:15], s28 offen offset:2048 sc1
    v_mul_f32 v24, v24, v224
    v_mfma_f32_16x16x32_bf16 v[240:243], a[116:119], v[112:115], v[240:243]
    v_mul_f32 v25, v25, v225
    v_mul_f32 v26, v26, v226
    v_mul_f32 v27, v27, v227
    v_mfma_f32_16x16x32_bf16 v[244:247], a[116:119], v[116:119], v[244:247]
    v_cvt_pk_bf16_f32 v42, v24, v25
    v_cvt_pk_bf16_f32 v43, v26, v27
    v_mfma_f32_16x16x32_bf16 v[248:251], a[116:119], v[120:123], v[248:251]
    ds_write_b64 v12, v[42:43] offset:1024
    v_mul_f32 v20, v228, v228
    v_mul_f32 v21, v229, v229
    v_mfma_f32_16x16x32_bf16 v[236:239], a[128:131], v[156:159], v[236:239]
    buffer_load_dwordx4 a[116:119], v16, s[12:15], s28 offen offset:3072 sc1
    v_mul_f32 v22, v230, v230
    v_mfma_f32_16x16x32_bf16 v[240:243], a[128:131], v[160:163], v[240:243]
    v_mul_f32 v23, v231, v231
    v_fma_f32 v20, v20, v35, v34
    v_fma_f32 v21, v21, v35, v34
    v_mfma_f32_16x16x32_bf16 v[244:247], a[128:131], v[164:167], v[244:247]
    v_fma_f32 v22, v22, v35, v34
    v_fma_f32 v23, v23, v35, v34
    v_mfma_f32_16x16x32_bf16 v[248:251], a[128:131], v[168:171], v[248:251]
    s_waitcnt lgkmcnt(1)
    ds_write_b32 v254, v8 offset:1792
    s_waitcnt vmcnt(33)
    v_mfma_f32_16x16x32_bf16 v[236:239], a[132:135], v[172:175], v[236:239]
    buffer_load_dwordx4 a[128:131], v17, s[12:15], s28 offen offset:2048 sc1
    v_mul_f32 v20, v20, v228
    v_mul_f32 v21, v21, v229
    v_mfma_f32_16x16x32_bf16 v[240:243], a[132:135], v[176:179], v[240:243]
    v_mul_f32 v22, v22, v230
    v_mul_f32 v23, v23, v231
    v_mfma_f32_16x16x32_bf16 v[244:247], a[132:135], v[180:183], v[244:247]
    v_exp_f32 v20, v20
    v_exp_f32 v21, v21
    v_mfma_f32_16x16x32_bf16 v[248:251], a[132:135], v[184:187], v[248:251]
    v_exp_f32 v22, v22
    v_mfma_f32_16x16x32_bf16 v[236:239], a[136:139], v[188:191], v[236:239]
    buffer_load_dwordx4 a[132:135], v17, s[12:15], s28 offen offset:3072 sc1
    v_exp_f32 v23, v23
    v_mfma_f32_16x16x32_bf16 v[240:243], a[136:139], v[192:195], v[240:243]
    v_fma_f32 v20, v20, v36, v36
    v_fma_f32 v21, v21, v36, v36
    v_fma_f32 v22, v22, v36, v36
    v_mfma_f32_16x16x32_bf16 v[244:247], a[136:139], v[196:199], v[244:247]
    v_fma_f32 v23, v23, v36, v36
    ds_read_b32 v8, v252 offset:16384
    v_mfma_f32_16x16x32_bf16 v[248:251], a[136:139], v[200:203], v[248:251]
    v_rcp_f32 v20, v20
    s_waitcnt vmcnt(33)
    v_mfma_f32_16x16x32_bf16 v[236:239], a[84:87], a[192:195], v[236:239]
    buffer_load_dwordx4 a[136:139], v18, s[12:15], s28 offen offset:0 sc1
    v_rcp_f32 v21, v21
    v_mfma_f32_16x16x32_bf16 v[240:243], a[84:87], a[196:199], v[240:243]
    v_rcp_f32 v22, v22
    v_mfma_f32_16x16x32_bf16 v[244:247], a[84:87], a[200:203], v[244:247]
    v_rcp_f32 v23, v23
    v_mul_f32 v20, v20, v228
    v_mul_f32 v21, v21, v229
    v_mfma_f32_16x16x32_bf16 v[248:251], a[84:87], a[204:207], v[248:251]
    v_mul_f32 v22, v22, v230
    v_mul_f32 v23, v23, v231
    v_mfma_f32_16x16x32_bf16 v[236:239], a[120:123], v[124:127], v[236:239]
    buffer_load_dwordx4 a[84:87], v4, s[12:15], s28 offen offset:3072 sc1
    v_cvt_pk_bf16_f32 v40, v20, v21
    v_cvt_pk_bf16_f32 v41, v22, v23
    v_mfma_f32_16x16x32_bf16 v[240:243], a[120:123], v[128:131], v[240:243]
    ds_write_b64 v12, v[40:41] offset:2048
    v_mul_f32 v24, v232, v232
    v_mfma_f32_16x16x32_bf16 v[244:247], a[120:123], v[132:135], v[244:247]
    v_mul_f32 v25, v233, v233
    v_mul_f32 v26, v234, v234
    v_mfma_f32_16x16x32_bf16 v[248:251], a[120:123], v[136:139], v[248:251]
    v_mul_f32 v27, v235, v235
    v_fma_f32 v24, v24, v38, v37
    s_waitcnt vmcnt(33)
    v_mfma_f32_16x16x32_bf16 v[236:239], a[88:91], a[208:211], v[236:239]
    buffer_load_dwordx4 a[120:123], v17, s[12:15], s28 offen offset:0 sc1
    v_fma_f32 v25, v25, v38, v37
    v_fma_f32 v26, v26, v38, v37
    v_mfma_f32_16x16x32_bf16 v[240:243], a[88:91], a[212:215], v[240:243]
    v_fma_f32 v27, v27, v38, v37
    s_waitcnt lgkmcnt(1)
    ds_write_b32 v254, v8 offset:2048
    v_mfma_f32_16x16x32_bf16 v[244:247], a[88:91], a[216:219], v[244:247]
    v_mul_f32 v24, v24, v232
    v_mul_f32 v25, v25, v233
    v_mfma_f32_16x16x32_bf16 v[248:251], a[88:91], a[220:223], v[248:251]
    v_mul_f32 v26, v26, v234
    v_mul_f32 v27, v27, v235
    v_exp_f32 v24, v24
    v_mfma_f32_16x16x32_bf16 v[236:239], a[104:107], v[60:63], v[236:239]
    buffer_load_dwordx4 a[88:91], v7, s[12:15], s28 offen offset:0 sc1
    v_mfma_f32_16x16x32_bf16 v[240:243], a[104:107], v[64:67], v[240:243]
    v_exp_f32 v25, v25
    v_exp_f32 v26, v26
    v_mfma_f32_16x16x32_bf16 v[244:247], a[104:107], v[68:71], v[244:247]
    v_exp_f32 v27, v27
    v_mfma_f32_16x16x32_bf16 v[248:251], a[104:107], v[72:75], v[248:251]
    v_fma_f32 v24, v24, v39, v39
    v_fma_f32 v25, v25, v39, v39
    s_waitcnt vmcnt(33)
    v_mfma_f32_16x16x32_bf16 v[236:239], a[124:127], v[140:143], v[236:239]
    buffer_load_dwordx4 a[104:107], v16, s[12:15], s28 offen offset:0 sc1
    v_fma_f32 v26, v26, v39, v39
    v_fma_f32 v27, v27, v39, v39
    v_mfma_f32_16x16x32_bf16 v[240:243], a[124:127], v[144:147], v[240:243]
    v_rcp_f32 v24, v24
    v_mfma_f32_16x16x32_bf16 v[244:247], a[124:127], v[148:151], v[244:247]
    v_rcp_f32 v25, v25
    v_rcp_f32 v26, v26
    v_mfma_f32_16x16x32_bf16 v[248:251], a[124:127], v[152:155], v[248:251]
    v_rcp_f32 v27, v27
    v_mfma_f32_16x16x32_bf16 v[236:239], a[140:143], v[204:207], v[236:239]
    buffer_load_dwordx4 a[124:127], v17, s[12:15], s28 offen offset:1024 sc1
    v_mul_f32 v24, v24, v232
    v_mul_f32 v25, v25, v233
    v_mfma_f32_16x16x32_bf16 v[240:243], a[140:143], v[208:211], v[240:243]
    v_mul_f32 v26, v26, v234
    v_mul_f32 v27, v27, v235
    v_cvt_pk_bf16_f32 v42, v24, v25
    v_mfma_f32_16x16x32_bf16 v[244:247], a[140:143], v[212:215], v[244:247]
    v_cvt_pk_bf16_f32 v43, v26, v27
    ds_write_b64 v12, v[42:43] offset:3072
    v_mfma_f32_16x16x32_bf16 v[248:251], a[140:143], v[216:219], v[248:251]
    v_add_u32 v12, 4096, v12
    buffer_load_dwordx4 a[140:143], v18, s[12:15], s28 offen offset:1024 sc1
    s_add_u32 s28, s28, 18432
    s_waitcnt lgkmcnt(0)
    s_barrier
    s_waitcnt vmcnt(34)
    v_mfma_f32_16x16x32_bf16 v[220:223], a[0:3], a[144:147], 0
    v_mfma_f32_16x16x32_bf16 v[224:227], a[0:3], a[148:151], 0
    v_mul_f32 v20, v236, v236
    v_mul_f32 v21, v237, v237
    v_mul_f32 v22, v238, v238
    v_mul_f32 v23, v239, v239
    v_mfma_f32_16x16x32_bf16 v[228:231], a[0:3], a[152:155], 0
    v_fma_f32 v20, v20, v29, v28
    v_fma_f32 v21, v21, v29, v28
    v_fma_f32 v22, v22, v29, v28
    v_mfma_f32_16x16x32_bf16 v[232:235], a[0:3], a[156:159], 0
    v_fma_f32 v23, v23, v29, v28
    v_mul_f32 v20, v20, v236
    v_mul_f32 v21, v21, v237
    v_mfma_f32_16x16x32_bf16 v[220:223], a[4:7], a[160:163], v[220:223]
    buffer_load_dwordx4 a[0:3], v4, s[12:15], s28 offen offset:0 sc1
    s_add_u32 m0, s39, 0
    s_nop 0
    buffer_load_dwordx4 v4, s[12:15], s38 offen offset:0 sc1 lds
    v_mfma_f32_16x16x32_bf16 v[224:227], a[4:7], a[164:167], v[224:227]
    v_mul_f32 v22, v22, v238
    v_mul_f32 v23, v23, v239
    v_mfma_f32_16x16x32_bf16 v[228:231], a[4:7], a[168:171], v[228:231]
    v_exp_f32 v20, v20
    v_exp_f32 v21, v21
    v_mfma_f32_16x16x32_bf16 v[232:235], a[4:7], a[172:175], v[232:235]
    s_waitcnt vmcnt(34)
    v_mfma_f32_16x16x32_bf16 v[220:223], a[8:11], a[176:179], v[220:223]
    buffer_load_dwordx4 a[4:7], v4, s[12:15], s28 offen offset:1024 sc1
    v_exp_f32 v22, v22
    v_mfma_f32_16x16x32_bf16 v[224:227], a[8:11], a[180:183], v[224:227]
    v_exp_f32 v23, v23
    v_fma_f32 v20, v20, v30, v30
    v_mfma_f32_16x16x32_bf16 v[228:231], a[8:11], a[184:187], v[228:231]
    v_fma_f32 v21, v21, v30, v30
    v_fma_f32 v22, v22, v30, v30
    v_fma_f32 v23, v23, v30, v30
    v_mfma_f32_16x16x32_bf16 v[232:235], a[8:11], a[188:191], v[232:235]
    v_rcp_f32 v20, v20
    v_mfma_f32_16x16x32_bf16 v[220:223], a[20:23], a[224:227], v[220:223]
    buffer_load_dwordx4 a[8:11], v4, s[12:15], s28 offen offset:2048 sc1
    v_rcp_f32 v21, v21
    v_mfma_f32_16x16x32_bf16 v[224:227], a[20:23], a[228:231], v[224:227]
    v_rcp_f32 v22, v22
    v_rcp_f32 v23, v23
    v_mfma_f32_16x16x32_bf16 v[228:231], a[20:23], a[232:235], v[228:231]
    v_mul_f32 v20, v20, v236
    v_mul_f32 v21, v21, v237
    v_mfma_f32_16x16x32_bf16 v[232:235], a[20:23], a[236:239], v[232:235]
    v_mul_f32 v22, v22, v238
    v_mul_f32 v23, v23, v239
    s_waitcnt vmcnt(34)
    v_mfma_f32_16x16x32_bf16 v[220:223], a[24:27], a[240:243], v[220:223]
    buffer_load_dwordx4 a[20:23], v7, s[12:15], s28 offen offset:1024 sc1
    v_cvt_pk_bf16_f32 v40, v20, v21
    v_mfma_f32_16x16x32_bf16 v[224:227], a[24:27], a[244:247], v[224:227]
    v_cvt_pk_bf16_f32 v41, v22, v23
    ds_write_b64 v13, v[40:41] offset:0
    v_mfma_f32_16x16x32_bf16 v[228:231], a[24:27], a[248:251], v[228:231]
    v_mul_f32 v24, v240, v240
    v_mul_f32 v25, v241, v241
    v_mul_f32 v26, v242, v242
    v_mfma_f32_16x16x32_bf16 v[232:235], a[24:27], a[252:255], v[232:235]
    s_add_u32 m0, s39, 0
    s_nop 0
    buffer_load_dwordx4 v4, s[12:15], s38 offen offset:1024 sc1 lds
    v_mfma_f32_16x16x32_bf16 v[220:223], a[28:31], v[44:47], v[220:223]
    buffer_load_dwordx4 a[24:27], v7, s[12:15], s28 offen offset:2048 sc1
    v_mul_f32 v27, v243, v243
    v_fma_f32 v24, v24, v32, v31
    v_mfma_f32_16x16x32_bf16 v[224:227], a[28:31], v[48:51], v[224:227]
    v_fma_f32 v25, v25, v32, v31
    v_fma_f32 v26, v26, v32, v31
    v_fma_f32 v27, v27, v32, v31
    v_mfma_f32_16x16x32_bf16 v[228:231], a[28:31], v[52:55], v[228:231]
    v_mul_f32 v24, v24, v240
    v_mul_f32 v25, v25, v241
    v_mul_f32 v26, v26, v242
    v_mfma_f32_16x16x32_bf16 v[232:235], a[28:31], v[56:59], v[232:235]
    v_mul_f32 v27, v27, v243
    s_waitcnt vmcnt(35)
    v_mfma_f32_16x16x32_bf16 v[220:223], a[36:39], v[76:79], v[220:223]
    buffer_load_dwordx4 a[28:31], v7, s[12:15], s28 offen offset:3072 sc1
    v_exp_f32 v24, v24
    v_mfma_f32_16x16x32_bf16 v[224:227], a[36:39], v[80:83], v[224:227]
    v_exp_f32 v25, v25
    v_mfma_f32_16x16x32_bf16 v[228:231], a[36:39], v[84:87], v[228:231]
    v_exp_f32 v26, v26
    v_exp_f32 v27, v27
    v_mfma_f32_16x16x32_bf16 v[232:235], a[36:39], v[88:91], v[232:235]
    v_fma_f32 v24, v24, v33, v33
    v_fma_f32 v25, v25, v33, v33
    v_mfma_f32_16x16x32_bf16 v[220:223], a[40:43], v[92:95], v[220:223]
    buffer_load_dwordx4 a[36:39], v16, s[12:15], s28 offen offset:1024 sc1
    v_fma_f32 v26, v26, v33, v33
    v_fma_f32 v27, v27, v33, v33
    v_mfma_f32_16x16x32_bf16 v[224:227], a[40:43], v[96:99], v[224:227]
    v_rcp_f32 v24, v24
    v_mfma_f32_16x16x32_bf16 v[228:231], a[40:43], v[100:103], v[228:231]
    v_rcp_f32 v25, v25
    v_rcp_f32 v26, v26
    v_mfma_f32_16x16x32_bf16 v[232:235], a[40:43], v[104:107], v[232:235]
    v_rcp_f32 v27, v27
    s_waitcnt vmcnt(35)
    v_mfma_f32_16x16x32_bf16 v[220:223], a[44:47], v[108:111], v[220:223]
    buffer_load_dwordx4 a[40:43], v16, s[12:15], s28 offen offset:2048 sc1
    v_mul_f32 v24, v24, v240
    v_mfma_f32_16x16x32_bf16 v[224:227], a[44:47], v[112:115], v[224:227]
    v_mul_f32 v25, v25, v241
    v_mul_f32 v26, v26, v242
    s_add_u32 m0, s39, 0
    v_mfma_f32_16x16x32_bf16 v[228:231], a[44:47], v[116:119], v[228:231]
    buffer_load_dwordx4 v4, s[12:15], s38 offen offset:2048 sc1 lds
    v_mul_f32 v27, v27, v243
    v_mfma_f32_16x16x32_bf16 v[232:235], a[44:47], v[120:123], v[232:235]
    v_cvt_pk_bf16_f32 v42, v24, v25
    v_cvt_pk_bf16_f32 v43, v26, v27
    ds_write_b64 v13, v[42:43] offset:1024
    v_mfma_f32_16x16x32_bf16 v[220:223], a[56:59], v[156:159], v[220:223]
    buffer_load_dwordx4 a[44:47], v16, s[12:15], s28 offen offset:3072 sc1
    v_mul_f32 v20, v244, v244
    v_mfma_f32_16x16x32_bf16 v[224:227], a[56:59], v[160:163], v[224:227]
    v_mul_f32 v21, v245, v245
    v_mul_f32 v22, v246, v246
    v_mfma_f32_16x16x32_bf16 v[228:231], a[56:59], v[164:167], v[228:231]
    v_mul_f32 v23, v247, v247
    v_fma_f32 v20, v20, v35, v34
    v_fma_f32 v21, v21, v35, v34
    v_mfma_f32_16x16x32_bf16 v[232:235], a[56:59], v[168:171], v[232:235]
    v_fma_f32 v22, v22, v35, v34
    v_fma_f32 v23, v23, v35, v34
    s_waitcnt vmcnt(36)
    v_mfma_f32_16x16x32_bf16 v[220:223], a[60:63], v[172:175], v[220:223]
    buffer_load_dwordx4 a[56:59], v17, s[12:15], s28 offen offset:2048 sc1
    v_mul_f32 v20, v20, v244
    v_mul_f32 v21, v21, v245
    v_mfma_f32_16x16x32_bf16 v[224:227], a[60:63], v[176:179], v[224:227]
    v_mul_f32 v22, v22, v246
    v_mul_f32 v23, v23, v247
    v_mfma_f32_16x16x32_bf16 v[228:231], a[60:63], v[180:183], v[228:231]
    v_exp_f32 v20, v20
    v_exp_f32 v21, v21
    v_mfma_f32_16x16x32_bf16 v[232:235], a[60:63], v[184:187], v[232:235]
    v_exp_f32 v22, v22
    v_mfma_f32_16x16x32_bf16 v[220:223], a[64:67], v[188:191], v[220:223]
    buffer_load_dwordx4 a[60:63], v17, s[12:15], s28 offen offset:3072 sc1
    v_exp_f32 v23, v23
    v_mfma_f32_16x16x32_bf16 v[224:227], a[64:67], v[192:195], v[224:227]
    v_fma_f32 v20, v20, v36, v36
    v_fma_f32 v21, v21, v36, v36
    v_mfma_f32_16x16x32_bf16 v[228:231], a[64:67], v[196:199], v[228:231]
    v_fma_f32 v22, v22, v36, v36
    v_fma_f32 v23, v23, v36, v36
    s_add_u32 m0, s39, 0
    v_mfma_f32_16x16x32_bf16 v[232:235], a[64:67], v[200:203], v[232:235]
    buffer_load_dwordx4 v4, s[12:15], s38 offen offset:3072 sc1 lds
    s_waitcnt vmcnt(37)
    v_mfma_f32_16x16x32_bf16 v[220:223], a[12:15], a[192:195], v[220:223]
    buffer_load_dwordx4 a[64:67], v18, s[12:15], s28 offen offset:0 sc1
    v_rcp_f32 v20, v20
    v_mfma_f32_16x16x32_bf16 v[224:227], a[12:15], a[196:199], v[224:227]
    v_rcp_f32 v21, v21
    v_rcp_f32 v22, v22
    v_mfma_f32_16x16x32_bf16 v[228:231], a[12:15], a[200:203], v[228:231]
    v_rcp_f32 v23, v23
    v_mfma_f32_16x16x32_bf16 v[232:235], a[12:15], a[204:207], v[232:235]
    v_mul_f32 v20, v20, v244
    v_mul_f32 v21, v21, v245
    v_mul_f32 v22, v22, v246
    v_mfma_f32_16x16x32_bf16 v[220:223], a[48:51], v[124:127], v[220:223]
    buffer_load_dwordx4 a[12:15], v4, s[12:15], s28 offen offset:3072 sc1
    v_mul_f32 v23, v23, v247
    v_mfma_f32_16x16x32_bf16 v[224:227], a[48:51], v[128:131], v[224:227]
    v_cvt_pk_bf16_f32 v40, v20, v21
    v_cvt_pk_bf16_f32 v41, v22, v23
    ds_write_b64 v13, v[40:41] offset:2048
    v_mfma_f32_16x16x32_bf16 v[228:231], a[48:51], v[132:135], v[228:231]
    v_mul_f32 v24, v248, v248
    v_mul_f32 v25, v249, v249
    v_mfma_f32_16x16x32_bf16 v[232:235], a[48:51], v[136:139], v[232:235]
    v_mul_f32 v26, v250, v250
    s_waitcnt vmcnt(37)
    v_mfma_f32_16x16x32_bf16 v[220:223], a[16:19], a[208:211], v[220:223]
    buffer_load_dwordx4 a[48:51], v17, s[12:15], s28 offen offset:0 sc1
    v_mul_f32 v27, v251, v251
    v_fma_f32 v24, v24, v38, v37
    v_mfma_f32_16x16x32_bf16 v[224:227], a[16:19], a[212:215], v[224:227]
    v_fma_f32 v25, v25, v38, v37
    v_fma_f32 v26, v26, v38, v37
    v_fma_f32 v27, v27, v38, v37
    v_mfma_f32_16x16x32_bf16 v[228:231], a[16:19], a[216:219], v[228:231]
    v_mul_f32 v24, v24, v248
    v_mul_f32 v25, v25, v249
    v_mul_f32 v26, v26, v250
    v_mfma_f32_16x16x32_bf16 v[232:235], a[16:19], a[220:223], v[232:235]
    v_mul_f32 v27, v27, v251
    v_exp_f32 v24, v24
    v_mfma_f32_16x16x32_bf16 v[220:223], a[32:35], v[60:63], v[220:223]
    buffer_load_dwordx4 a[16:19], v7, s[12:15], s28 offen offset:0 sc1
    v_exp_f32 v25, v25
    v_mfma_f32_16x16x32_bf16 v[224:227], a[32:35], v[64:67], v[224:227]
    v_exp_f32 v26, v26
    v_mfma_f32_16x16x32_bf16 v[228:231], a[32:35], v[68:71], v[228:231]
    v_exp_f32 v27, v27
    v_fma_f32 v24, v24, v39, v39
    v_mfma_f32_16x16x32_bf16 v[232:235], a[32:35], v[72:75], v[232:235]
    v_fma_f32 v25, v25, v39, v39
    s_waitcnt vmcnt(37)
    v_mfma_f32_16x16x32_bf16 v[220:223], a[52:55], v[140:143], v[220:223]
    buffer_load_dwordx4 a[32:35], v16, s[12:15], s28 offen offset:0 sc1
    v_fma_f32 v26, v26, v39, v39
    v_fma_f32 v27, v27, v39, v39
    v_mfma_f32_16x16x32_bf16 v[224:227], a[52:55], v[144:147], v[224:227]
    v_rcp_f32 v24, v24
    v_mfma_f32_16x16x32_bf16 v[228:231], a[52:55], v[148:151], v[228:231]
    v_rcp_f32 v25, v25
    v_rcp_f32 v26, v26
    v_mfma_f32_16x16x32_bf16 v[232:235], a[52:55], v[152:155], v[232:235]
    v_rcp_f32 v27, v27
    v_mfma_f32_16x16x32_bf16 v[220:223], a[68:71], v[204:207], v[220:223]
    buffer_load_dwordx4 a[52:55], v17, s[12:15], s28 offen offset:1024 sc1
    v_mul_f32 v24, v24, v248
    v_mul_f32 v25, v25, v249
    v_mfma_f32_16x16x32_bf16 v[224:227], a[68:71], v[208:211], v[224:227]
    v_mul_f32 v26, v26, v250
    v_mul_f32 v27, v27, v251
    v_cvt_pk_bf16_f32 v42, v24, v25
    v_mfma_f32_16x16x32_bf16 v[228:231], a[68:71], v[212:215], v[228:231]
    v_cvt_pk_bf16_f32 v43, v26, v27
    ds_write_b64 v13, v[42:43] offset:3072
    v_mfma_f32_16x16x32_bf16 v[232:235], a[68:71], v[216:219], v[232:235]
    v_add_u32 v13, 4096, v13
    buffer_load_dwordx4 a[68:71], v18, s[12:15], s28 offen offset:1024 sc1
    s_add_u32 s28, s28, 18432
    s_waitcnt vmcnt(38)
    v_mfma_f32_16x16x32_bf16 v[236:239], a[72:75], a[144:147], 0
    v_mfma_f32_16x16x32_bf16 v[240:243], a[72:75], a[148:151], 0
    v_mul_f32 v20, v220, v220
    v_mul_f32 v21, v221, v221
    v_mul_f32 v22, v222, v222
    v_mul_f32 v23, v223, v223
    v_fma_f32 v20, v20, v29, v28
    v_mfma_f32_16x16x32_bf16 v[244:247], a[72:75], a[152:155], 0
    v_fma_f32 v21, v21, v29, v28
    v_fma_f32 v22, v22, v29, v28
    v_mfma_f32_16x16x32_bf16 v[248:251], a[72:75], a[156:159], 0
    v_fma_f32 v23, v23, v29, v28
    v_mul_f32 v20, v20, v220
    v_mul_f32 v21, v21, v221
    v_mfma_f32_16x16x32_bf16 v[236:239], a[76:79], a[160:163], v[236:239]
    buffer_load_dwordx4 a[72:75], v4, s[12:15], s28 offen offset:0 sc1
    s_add_u32 m0, s39, 4096
    s_nop 0
    buffer_load_dwordx4 v7, s[12:15], s38 offen offset:0 sc1 lds
    v_mfma_f32_16x16x32_bf16 v[240:243], a[76:79], a[164:167], v[240:243]
    v_mul_f32 v22, v22, v222
    v_mul_f32 v23, v23, v223
    v_mfma_f32_16x16x32_bf16 v[244:247], a[76:79], a[168:171], v[244:247]
    v_exp_f32 v20, v20
    v_exp_f32 v21, v21
    v_mfma_f32_16x16x32_bf16 v[248:251], a[76:79], a[172:175], v[248:251]
    v_exp_f32 v22, v22
    s_waitcnt vmcnt(38)
    v_mfma_f32_16x16x32_bf16 v[236:239], a[80:83], a[176:179], v[236:239]
    buffer_load_dwordx4 a[76:79], v4, s[12:15], s28 offen offset:1024 sc1
    v_mfma_f32_16x16x32_bf16 v[240:243], a[80:83], a[180:183], v[240:243]
    v_exp_f32 v23, v23
    v_fma_f32 v20, v20, v30, v30
    v_fma_f32 v21, v21, v30, v30
    v_mfma_f32_16x16x32_bf16 v[244:247], a[80:83], a[184:187], v[244:247]
    v_fma_f32 v22, v22, v30, v30
    v_fma_f32 v23, v23, v30, v30
    v_mfma_f32_16x16x32_bf16 v[248:251], a[80:83], a[188:191], v[248:251]
    v_rcp_f32 v20, v20
    v_rcp_f32 v21, v21
    v_mfma_f32_16x16x32_bf16 v[236:239], a[92:95], a[224:227], v[236:239]
    buffer_load_dwordx4 a[80:83], v4, s[12:15], s28 offen offset:2048 sc1
    v_mfma_f32_16x16x32_bf16 v[240:243], a[92:95], a[228:231], v[240:243]
    v_rcp_f32 v22, v22
    v_rcp_f32 v23, v23
    v_mfma_f32_16x16x32_bf16 v[244:247], a[92:95], a[232:235], v[244:247]
    v_mul_f32 v20, v20, v220
    v_mul_f32 v21, v21, v221
    v_mfma_f32_16x16x32_bf16 v[248:251], a[92:95], a[236:239], v[248:251]
    v_mul_f32 v22, v22, v222
    v_mul_f32 v23, v23, v223
    s_waitcnt vmcnt(38)
    v_mfma_f32_16x16x32_bf16 v[236:239], a[96:99], a[240:243], v[236:239]
    buffer_load_dwordx4 a[92:95], v7, s[12:15], s28 offen offset:1024 sc1
    v_cvt_pk_bf16_f32 v40, v20, v21
    v_cvt_pk_bf16_f32 v41, v22, v23
    v_mfma_f32_16x16x32_bf16 v[240:243], a[96:99], a[244:247], v[240:243]
    ds_write_b64 v12, v[40:41] offset:0
    v_mul_f32 v24, v224, v224
    v_mfma_f32_16x16x32_bf16 v[244:247], a[96:99], a[248:251], v[244:247]
    v_mul_f32 v25, v225, v225
    v_mul_f32 v26, v226, v226
    v_mfma_f32_16x16x32_bf16 v[248:251], a[96:99], a[252:255], v[248:251]
    s_add_u32 m0, s39, 4096
    s_nop 0
    buffer_load_dwordx4 v7, s[12:15], s38 offen offset:1024 sc1 lds
    v_mul_f32 v27, v227, v227
    v_mfma_f32_16x16x32_bf16 v[236:239], a[100:103], v[44:47], v[236:239]
    buffer_load_dwordx4 a[96:99], v7, s[12:15], s28 offen offset:2048 sc1
    v_fma_f32 v24, v24, v32, v31
    v_fma_f32 v25, v25, v32, v31
    v_mfma_f32_16x16x32_bf16 v[240:243], a[100:103], v[48:51], v[240:243]
    v_fma_f32 v26, v26, v32, v31
    v_fma_f32 v27, v27, v32, v31
    v_mul_f32 v24, v24, v224
    v_mfma_f32_16x16x32_bf16 v[244:247], a[100:103], v[52:55], v[244:247]
    v_mul_f32 v25, v25, v225
    v_mul_f32 v26, v26, v226
    v_mfma_f32_16x16x32_bf16 v[248:251], a[100:103], v[56:59], v[248:251]
    v_mul_f32 v27, v27, v227
    v_exp_f32 v24, v24
    s_waitcnt vmcnt(39)
    v_mfma_f32_16x16x32_bf16 v[236:239], a[108:111], v[76:79], v[236:239]
    buffer_load_dwordx4 a[100:103], v7, s[12:15], s28 offen offset:3072 sc1
    v_mfma_f32_16x16x32_bf16 v[240:243], a[108:111], v[80:83], v[240:243]
    v_exp_f32 v25, v25
    v_exp_f32 v26, v26
    v_mfma_f32_16x16x32_bf16 v[244:247], a[108:111], v[84:87], v[244:247]
    v_exp_f32 v27, v27
    v_mfma_f32_16x16x32_bf16 v[248:251], a[108:111], v[88:91], v[248:251]
    v_fma_f32 v24, v24, v33, v33
    v_fma_f32 v25, v25, v33, v33
    v_fma_f32 v26, v26, v33, v33
    v_mfma_f32_16x16x32_bf16 v[236:239], a[112:115], v[92:95], v[236:239]
    buffer_load_dwordx4 a[108:111], v16, s[12:15], s28 offen offset:1024 sc1
    v_fma_f32 v27, v27, v33, v33
    v_mfma_f32_16x16x32_bf16 v[240:243], a[112:115], v[96:99], v[240:243]
    v_rcp_f32 v24, v24
    v_rcp_f32 v25, v25
    v_mfma_f32_16x16x32_bf16 v[244:247], a[112:115], v[100:103], v[244:247]
    v_rcp_f32 v26, v26
    v_mfma_f32_16x16x32_bf16 v[248:251], a[112:115], v[104:107], v[248:251]
    v_rcp_f32 v27, v27
    s_waitcnt vmcnt(39)
    v_mfma_f32_16x16x32_bf16 v[236:239], a[116:119], v[108:111], v[236:239]
    buffer_load_dwordx4 a[112:115], v16, s[12:15], s28 offen offset:2048 sc1
    v_mul_f32 v24, v24, v224
    v_mul_f32 v25, v25, v225
    v_mfma_f32_16x16x32_bf16 v[240:243], a[116:119], v[112:115], v[240:243]
    v_mul_f32 v26, v26, v226
    s_add_u32 m0, s39, 4096
    s_nop 0
    buffer_load_dwordx4 v7, s[12:15], s38 offen offset:2048 sc1 lds
    v_mfma_f32_16x16x32_bf16 v[244:247], a[116:119], v[116:119], v[244:247]
    v_mul_f32 v27, v27, v227
    v_cvt_pk_bf16_f32 v42, v24, v25
    v_mfma_f32_16x16x32_bf16 v[248:251], a[116:119], v[120:123], v[248:251]
    v_cvt_pk_bf16_f32 v43, v26, v27
    ds_write_b64 v12, v[42:43] offset:1024
    v_mfma_f32_16x16x32_bf16 v[236:239], a[128:131], v[156:159], v[236:239]
    buffer_load_dwordx4 a[116:119], v16, s[12:15], s28 offen offset:3072 sc1
    v_mul_f32 v20, v228, v228
    v_mul_f32 v21, v229, v229
    v_mfma_f32_16x16x32_bf16 v[240:243], a[128:131], v[160:163], v[240:243]
    v_mul_f32 v22, v230, v230
    v_mul_f32 v23, v231, v231
    v_fma_f32 v20, v20, v35, v34
    v_mfma_f32_16x16x32_bf16 v[244:247], a[128:131], v[164:167], v[244:247]
    v_fma_f32 v21, v21, v35, v34
    v_fma_f32 v22, v22, v35, v34
    v_mfma_f32_16x16x32_bf16 v[248:251], a[128:131], v[168:171], v[248:251]
    v_fma_f32 v23, v23, v35, v34
    v_mul_f32 v20, v20, v228
    s_waitcnt vmcnt(40)
    v_mfma_f32_16x16x32_bf16 v[236:239], a[132:135], v[172:175], v[236:239]
    buffer_load_dwordx4 a[128:131], v17, s[12:15], s28 offen offset:2048 sc1
    v_mul_f32 v21, v21, v229
    v_mul_f32 v22, v22, v230
    v_mfma_f32_16x16x32_bf16 v[240:243], a[132:135], v[176:179], v[240:243]
    v_mul_f32 v23, v23, v231
    v_exp_f32 v20, v20
    v_mfma_f32_16x16x32_bf16 v[244:247], a[132:135], v[180:183], v[244:247]
    v_exp_f32 v21, v21
    v_mfma_f32_16x16x32_bf16 v[248:251], a[132:135], v[184:187], v[248:251]
    v_exp_f32 v22, v22
    v_exp_f32 v23, v23
    v_mfma_f32_16x16x32_bf16 v[236:239], a[136:139], v[188:191], v[236:239]
    buffer_load_dwordx4 a[132:135], v17, s[12:15], s28 offen offset:3072 sc1
    v_fma_f32 v20, v20, v36, v36
    v_mfma_f32_16x16x32_bf16 v[240:243], a[136:139], v[192:195], v[240:243]
    v_fma_f32 v21, v21, v36, v36
    v_fma_f32 v22, v22, v36, v36
    v_fma_f32 v23, v23, v36, v36
    v_mfma_f32_16x16x32_bf16 v[244:247], a[136:139], v[196:199], v[244:247]
    s_add_u32 m0, s39, 4096
    s_nop 0
    buffer_load_dwordx4 v7, s[12:15], s38 offen offset:3072 sc1 lds
    v_mfma_f32_16x16x32_bf16 v[248:251], a[136:139], v[200:203], v[248:251]
    v_rcp_f32 v20, v20
    s_waitcnt vmcnt(41)
    v_mfma_f32_16x16x32_bf16 v[236:239], a[84:87], a[192:195], v[236:239]
    buffer_load_dwordx4 a[136:139], v18, s[12:15], s28 offen offset:0 sc1
    v_rcp_f32 v21, v21
    v_mfma_f32_16x16x32_bf16 v[240:243], a[84:87], a[196:199], v[240:243]
    v_rcp_f32 v22, v22
    v_mfma_f32_16x16x32_bf16 v[244:247], a[84:87], a[200:203], v[244:247]
    v_rcp_f32 v23, v23
    v_mul_f32 v20, v20, v228
    v_mfma_f32_16x16x32_bf16 v[248:251], a[84:87], a[204:207], v[248:251]
    v_mul_f32 v21, v21, v229
    v_mul_f32 v22, v22, v230
    v_mul_f32 v23, v23, v231
    v_mfma_f32_16x16x32_bf16 v[236:239], a[120:123], v[124:127], v[236:239]
    buffer_load_dwordx4 a[84:87], v4, s[12:15], s28 offen offset:3072 sc1
    v_cvt_pk_bf16_f32 v40, v20, v21
    v_cvt_pk_bf16_f32 v41, v22, v23
    v_mfma_f32_16x16x32_bf16 v[240:243], a[120:123], v[128:131], v[240:243]
    ds_write_b64 v12, v[40:41] offset:2048
    v_mul_f32 v24, v232, v232
    v_mfma_f32_16x16x32_bf16 v[244:247], a[120:123], v[132:135], v[244:247]
    v_mul_f32 v25, v233, v233
    v_mul_f32 v26, v234, v234
    v_mfma_f32_16x16x32_bf16 v[248:251], a[120:123], v[136:139], v[248:251]
    v_mul_f32 v27, v235, v235
    v_fma_f32 v24, v24, v38, v37
    s_waitcnt vmcnt(41)
    v_mfma_f32_16x16x32_bf16 v[236:239], a[88:91], a[208:211], v[236:239]
    buffer_load_dwordx4 a[120:123], v17, s[12:15], s28 offen offset:0 sc1
    v_fma_f32 v25, v25, v38, v37
    v_fma_f32 v26, v26, v38, v37
    v_mfma_f32_16x16x32_bf16 v[240:243], a[88:91], a[212:215], v[240:243]
    v_fma_f32 v27, v27, v38, v37
    v_mul_f32 v24, v24, v232
    v_mul_f32 v25, v25, v233
    v_mfma_f32_16x16x32_bf16 v[244:247], a[88:91], a[216:219], v[244:247]
    v_mul_f32 v26, v26, v234
    v_mul_f32 v27, v27, v235
    v_mfma_f32_16x16x32_bf16 v[248:251], a[88:91], a[220:223], v[248:251]
    v_exp_f32 v24, v24
    s_add_u32 m0, s39, 8192
    v_mfma_f32_16x16x32_bf16 v[236:239], a[104:107], v[60:63], v[236:239]
    buffer_load_dwordx4 a[88:91], v7, s[12:15], s28 offen offset:0 sc1
    buffer_load_dwordx4 v16, s[12:15], s38 offen offset:0 sc1 lds
    v_mfma_f32_16x16x32_bf16 v[240:243], a[104:107], v[64:67], v[240:243]
    v_exp_f32 v25, v25
    v_exp_f32 v26, v26
    v_mfma_f32_16x16x32_bf16 v[244:247], a[104:107], v[68:71], v[244:247]
    v_exp_f32 v27, v27
    v_mfma_f32_16x16x32_bf16 v[248:251], a[104:107], v[72:75], v[248:251]
    v_fma_f32 v24, v24, v39, v39
    v_fma_f32 v25, v25, v39, v39
    s_waitcnt vmcnt(42)
    v_mfma_f32_16x16x32_bf16 v[236:239], a[124:127], v[140:143], v[236:239]
    buffer_load_dwordx4 a[104:107], v16, s[12:15], s28 offen offset:0 sc1
    v_fma_f32 v26, v26, v39, v39
    v_fma_f32 v27, v27, v39, v39
    v_mfma_f32_16x16x32_bf16 v[240:243], a[124:127], v[144:147], v[240:243]
    v_rcp_f32 v24, v24
    v_mfma_f32_16x16x32_bf16 v[244:247], a[124:127], v[148:151], v[244:247]
    v_rcp_f32 v25, v25
    v_rcp_f32 v26, v26
    v_mfma_f32_16x16x32_bf16 v[248:251], a[124:127], v[152:155], v[248:251]
    v_rcp_f32 v27, v27
    v_mfma_f32_16x16x32_bf16 v[236:239], a[140:143], v[204:207], v[236:239]
    buffer_load_dwordx4 a[124:127], v17, s[12:15], s28 offen offset:1024 sc1
    v_mul_f32 v24, v24, v232
    v_mul_f32 v25, v25, v233
    v_mfma_f32_16x16x32_bf16 v[240:243], a[140:143], v[208:211], v[240:243]
    v_mul_f32 v26, v26, v234
    v_mul_f32 v27, v27, v235
    v_cvt_pk_bf16_f32 v42, v24, v25
    v_mfma_f32_16x16x32_bf16 v[244:247], a[140:143], v[212:215], v[244:247]
    v_cvt_pk_bf16_f32 v43, v26, v27
    ds_write_b64 v12, v[42:43] offset:3072
    v_mfma_f32_16x16x32_bf16 v[248:251], a[140:143], v[216:219], v[248:251]
    v_add_u32 v12, 4096, v12
    buffer_load_dwordx4 a[140:143], v18, s[12:15], s28 offen offset:1024 sc1
    s_add_u32 s28, s28, 18432
    s_waitcnt vmcnt(42)
    v_mfma_f32_16x16x32_bf16 v[220:223], a[0:3], a[144:147], 0
    v_mfma_f32_16x16x32_bf16 v[224:227], a[0:3], a[148:151], 0
    v_mul_f32 v20, v236, v236
    v_mul_f32 v21, v237, v237
    v_mul_f32 v22, v238, v238
    v_mul_f32 v23, v239, v239
    v_mfma_f32_16x16x32_bf16 v[228:231], a[0:3], a[152:155], 0
    v_fma_f32 v20, v20, v29, v28
    v_fma_f32 v21, v21, v29, v28
    v_fma_f32 v22, v22, v29, v28
    v_mfma_f32_16x16x32_bf16 v[232:235], a[0:3], a[156:159], 0
    v_fma_f32 v23, v23, v29, v28
    v_mul_f32 v20, v20, v236
    v_mul_f32 v21, v21, v237
    v_mfma_f32_16x16x32_bf16 v[220:223], a[4:7], a[160:163], v[220:223]
    buffer_load_dwordx4 a[0:3], v4, s[12:15], s28 offen offset:0 sc1
    s_add_u32 m0, s39, 8192
    s_nop 0
    buffer_load_dwordx4 v16, s[12:15], s38 offen offset:1024 sc1 lds
    v_mfma_f32_16x16x32_bf16 v[224:227], a[4:7], a[164:167], v[224:227]
    v_mul_f32 v22, v22, v238
    v_mul_f32 v23, v23, v239
    v_mfma_f32_16x16x32_bf16 v[228:231], a[4:7], a[168:171], v[228:231]
    v_exp_f32 v20, v20
    v_exp_f32 v21, v21
    v_mfma_f32_16x16x32_bf16 v[232:235], a[4:7], a[172:175], v[232:235]
    s_waitcnt vmcnt(42)
    v_mfma_f32_16x16x32_bf16 v[220:223], a[8:11], a[176:179], v[220:223]
    buffer_load_dwordx4 a[4:7], v4, s[12:15], s28 offen offset:1024 sc1
    v_exp_f32 v22, v22
    v_mfma_f32_16x16x32_bf16 v[224:227], a[8:11], a[180:183], v[224:227]
    v_exp_f32 v23, v23
    v_fma_f32 v20, v20, v30, v30
    v_mfma_f32_16x16x32_bf16 v[228:231], a[8:11], a[184:187], v[228:231]
    v_fma_f32 v21, v21, v30, v30
    v_fma_f32 v22, v22, v30, v30
    v_fma_f32 v23, v23, v30, v30
    v_mfma_f32_16x16x32_bf16 v[232:235], a[8:11], a[188:191], v[232:235]
    v_rcp_f32 v20, v20
    v_mfma_f32_16x16x32_bf16 v[220:223], a[20:23], a[224:227], v[220:223]
    buffer_load_dwordx4 a[8:11], v4, s[12:15], s28 offen offset:2048 sc1
    v_rcp_f32 v21, v21
    v_mfma_f32_16x16x32_bf16 v[224:227], a[20:23], a[228:231], v[224:227]
    v_rcp_f32 v22, v22
    v_rcp_f32 v23, v23
    v_mfma_f32_16x16x32_bf16 v[228:231], a[20:23], a[232:235], v[228:231]
    v_mul_f32 v20, v20, v236
    v_mul_f32 v21, v21, v237
    v_mfma_f32_16x16x32_bf16 v[232:235], a[20:23], a[236:239], v[232:235]
    v_mul_f32 v22, v22, v238
    v_mul_f32 v23, v23, v239
    s_waitcnt vmcnt(41)
    v_mfma_f32_16x16x32_bf16 v[220:223], a[24:27], a[240:243], v[220:223]
    buffer_load_dwordx4 a[20:23], v7, s[12:15], s28 offen offset:1024 sc1
    v_cvt_pk_bf16_f32 v40, v20, v21
    v_mfma_f32_16x16x32_bf16 v[224:227], a[24:27], a[244:247], v[224:227]
    v_cvt_pk_bf16_f32 v41, v22, v23
    ds_write_b64 v13, v[40:41] offset:0
    v_mfma_f32_16x16x32_bf16 v[228:231], a[24:27], a[248:251], v[228:231]
    v_mul_f32 v24, v240, v240
    v_mul_f32 v25, v241, v241
    v_mul_f32 v26, v242, v242
    v_mfma_f32_16x16x32_bf16 v[232:235], a[24:27], a[252:255], v[232:235]
    s_add_u32 m0, s39, 8192
    s_nop 0
    buffer_load_dwordx4 v16, s[12:15], s38 offen offset:2048 sc1 lds
    v_mfma_f32_16x16x32_bf16 v[220:223], a[28:31], v[44:47], v[220:223]
    buffer_load_dwordx4 a[24:27], v7, s[12:15], s28 offen offset:2048 sc1
    v_mul_f32 v27, v243, v243
    v_fma_f32 v24, v24, v32, v31
    v_mfma_f32_16x16x32_bf16 v[224:227], a[28:31], v[48:51], v[224:227]
    v_fma_f32 v25, v25, v32, v31
    v_fma_f32 v26, v26, v32, v31
    v_fma_f32 v27, v27, v32, v31
    v_mfma_f32_16x16x32_bf16 v[228:231], a[28:31], v[52:55], v[228:231]
    v_mul_f32 v24, v24, v240
    v_mul_f32 v25, v25, v241
    v_mul_f32 v26, v26, v242
    v_mfma_f32_16x16x32_bf16 v[232:235], a[28:31], v[56:59], v[232:235]
    v_mul_f32 v27, v27, v243
    s_waitcnt vmcnt(42)
    v_mfma_f32_16x16x32_bf16 v[220:223], a[36:39], v[76:79], v[220:223]
    buffer_load_dwordx4 a[28:31], v7, s[12:15], s28 offen offset:3072 sc1
    v_exp_f32 v24, v24
    v_mfma_f32_16x16x32_bf16 v[224:227], a[36:39], v[80:83], v[224:227]
    v_exp_f32 v25, v25
    v_mfma_f32_16x16x32_bf16 v[228:231], a[36:39], v[84:87], v[228:231]
    v_exp_f32 v26, v26
    v_exp_f32 v27, v27
    v_mfma_f32_16x16x32_bf16 v[232:235], a[36:39], v[88:91], v[232:235]
    v_fma_f32 v24, v24, v33, v33
    v_fma_f32 v25, v25, v33, v33
    v_mfma_f32_16x16x32_bf16 v[220:223], a[40:43], v[92:95], v[220:223]
    buffer_load_dwordx4 a[36:39], v16, s[12:15], s28 offen offset:1024 sc1
    v_fma_f32 v26, v26, v33, v33
    v_fma_f32 v27, v27, v33, v33
    v_mfma_f32_16x16x32_bf16 v[224:227], a[40:43], v[96:99], v[224:227]
    v_rcp_f32 v24, v24
    v_mfma_f32_16x16x32_bf16 v[228:231], a[40:43], v[100:103], v[228:231]
    v_rcp_f32 v25, v25
    v_rcp_f32 v26, v26
    v_mfma_f32_16x16x32_bf16 v[232:235], a[40:43], v[104:107], v[232:235]
    v_rcp_f32 v27, v27
    s_waitcnt vmcnt(41)
    v_mfma_f32_16x16x32_bf16 v[220:223], a[44:47], v[108:111], v[220:223]
    buffer_load_dwordx4 a[40:43], v16, s[12:15], s28 offen offset:2048 sc1
    v_mul_f32 v24, v24, v240
    v_mfma_f32_16x16x32_bf16 v[224:227], a[44:47], v[112:115], v[224:227]
    v_mul_f32 v25, v25, v241
    v_mul_f32 v26, v26, v242
    s_add_u32 m0, s39, 8192
    v_mfma_f32_16x16x32_bf16 v[228:231], a[44:47], v[116:119], v[228:231]
    buffer_load_dwordx4 v16, s[12:15], s38 offen offset:3072 sc1 lds
    v_mul_f32 v27, v27, v243
    v_mfma_f32_16x16x32_bf16 v[232:235], a[44:47], v[120:123], v[232:235]
    v_cvt_pk_bf16_f32 v42, v24, v25
    v_cvt_pk_bf16_f32 v43, v26, v27
    ds_write_b64 v13, v[42:43] offset:1024
    v_mfma_f32_16x16x32_bf16 v[220:223], a[56:59], v[156:159], v[220:223]
    buffer_load_dwordx4 a[44:47], v16, s[12:15], s28 offen offset:3072 sc1
    v_mul_f32 v20, v244, v244
    v_mfma_f32_16x16x32_bf16 v[224:227], a[56:59], v[160:163], v[224:227]
    v_mul_f32 v21, v245, v245
    v_mul_f32 v22, v246, v246
    v_mfma_f32_16x16x32_bf16 v[228:231], a[56:59], v[164:167], v[228:231]
    v_mul_f32 v23, v247, v247
    v_fma_f32 v20, v20, v35, v34
    v_fma_f32 v21, v21, v35, v34
    v_mfma_f32_16x16x32_bf16 v[232:235], a[56:59], v[168:171], v[232:235]
    v_fma_f32 v22, v22, v35, v34
    v_fma_f32 v23, v23, v35, v34
    s_waitcnt vmcnt(41)
    v_mfma_f32_16x16x32_bf16 v[220:223], a[60:63], v[172:175], v[220:223]
    buffer_load_dwordx4 a[56:59], v17, s[12:15], s28 offen offset:2048 sc1
    v_mul_f32 v20, v20, v244
    v_mul_f32 v21, v21, v245
    v_mfma_f32_16x16x32_bf16 v[224:227], a[60:63], v[176:179], v[224:227]
    v_mul_f32 v22, v22, v246
    v_mul_f32 v23, v23, v247
    v_mfma_f32_16x16x32_bf16 v[228:231], a[60:63], v[180:183], v[228:231]
    v_exp_f32 v20, v20
    v_exp_f32 v21, v21
    v_mfma_f32_16x16x32_bf16 v[232:235], a[60:63], v[184:187], v[232:235]
    v_exp_f32 v22, v22
    v_mfma_f32_16x16x32_bf16 v[220:223], a[64:67], v[188:191], v[220:223]
    buffer_load_dwordx4 a[60:63], v17, s[12:15], s28 offen offset:3072 sc1
    v_exp_f32 v23, v23
    v_mfma_f32_16x16x32_bf16 v[224:227], a[64:67], v[192:195], v[224:227]
    v_fma_f32 v20, v20, v36, v36
    v_fma_f32 v21, v21, v36, v36
    v_mfma_f32_16x16x32_bf16 v[228:231], a[64:67], v[196:199], v[228:231]
    v_fma_f32 v22, v22, v36, v36
    v_fma_f32 v23, v23, v36, v36
    s_add_u32 m0, s39, 12288
    v_mfma_f32_16x16x32_bf16 v[232:235], a[64:67], v[200:203], v[232:235]
    buffer_load_dwordx4 v17, s[12:15], s38 offen offset:0 sc1 lds
    s_waitcnt vmcnt(42)
    v_mfma_f32_16x16x32_bf16 v[220:223], a[12:15], a[192:195], v[220:223]
    buffer_load_dwordx4 a[64:67], v18, s[12:15], s28 offen offset:0 sc1
    v_rcp_f32 v20, v20
    v_mfma_f32_16x16x32_bf16 v[224:227], a[12:15], a[196:199], v[224:227]
    v_rcp_f32 v21, v21
    v_rcp_f32 v22, v22
    v_mfma_f32_16x16x32_bf16 v[228:231], a[12:15], a[200:203], v[228:231]
    v_rcp_f32 v23, v23
    v_mfma_f32_16x16x32_bf16 v[232:235], a[12:15], a[204:207], v[232:235]
    v_mul_f32 v20, v20, v244
    v_mul_f32 v21, v21, v245
    v_mul_f32 v22, v22, v246
    v_mfma_f32_16x16x32_bf16 v[220:223], a[48:51], v[124:127], v[220:223]
    buffer_load_dwordx4 a[12:15], v4, s[12:15], s28 offen offset:3072 sc1
    v_mul_f32 v23, v23, v247
    v_mfma_f32_16x16x32_bf16 v[224:227], a[48:51], v[128:131], v[224:227]
    v_cvt_pk_bf16_f32 v40, v20, v21
    v_cvt_pk_bf16_f32 v41, v22, v23
    ds_write_b64 v13, v[40:41] offset:2048
    v_mfma_f32_16x16x32_bf16 v[228:231], a[48:51], v[132:135], v[228:231]
    v_mul_f32 v24, v248, v248
    v_mul_f32 v25, v249, v249
    v_mfma_f32_16x16x32_bf16 v[232:235], a[48:51], v[136:139], v[232:235]
    v_mul_f32 v26, v250, v250
    s_waitcnt vmcnt(42)
    v_mfma_f32_16x16x32_bf16 v[220:223], a[16:19], a[208:211], v[220:223]
    buffer_load_dwordx4 a[48:51], v17, s[12:15], s28 offen offset:0 sc1
    v_mul_f32 v27, v251, v251
    v_fma_f32 v24, v24, v38, v37
    v_mfma_f32_16x16x32_bf16 v[224:227], a[16:19], a[212:215], v[224:227]
    v_fma_f32 v25, v25, v38, v37
    v_fma_f32 v26, v26, v38, v37
    v_fma_f32 v27, v27, v38, v37
    v_mfma_f32_16x16x32_bf16 v[228:231], a[16:19], a[216:219], v[228:231]
    v_mul_f32 v24, v24, v248
    v_mul_f32 v25, v25, v249
    v_mul_f32 v26, v26, v250
    v_mfma_f32_16x16x32_bf16 v[232:235], a[16:19], a[220:223], v[232:235]
    v_mul_f32 v27, v27, v251
    v_exp_f32 v24, v24
    v_mfma_f32_16x16x32_bf16 v[220:223], a[32:35], v[60:63], v[220:223]
    buffer_load_dwordx4 a[16:19], v7, s[12:15], s28 offen offset:0 sc1
    v_exp_f32 v25, v25
    v_mfma_f32_16x16x32_bf16 v[224:227], a[32:35], v[64:67], v[224:227]
    v_exp_f32 v26, v26
    v_mfma_f32_16x16x32_bf16 v[228:231], a[32:35], v[68:71], v[228:231]
    v_exp_f32 v27, v27
    v_fma_f32 v24, v24, v39, v39
    v_mfma_f32_16x16x32_bf16 v[232:235], a[32:35], v[72:75], v[232:235]
    v_fma_f32 v25, v25, v39, v39
    s_waitcnt vmcnt(42)
    v_mfma_f32_16x16x32_bf16 v[220:223], a[52:55], v[140:143], v[220:223]
    buffer_load_dwordx4 a[32:35], v16, s[12:15], s28 offen offset:0 sc1
    v_fma_f32 v26, v26, v39, v39
    v_fma_f32 v27, v27, v39, v39
    v_mfma_f32_16x16x32_bf16 v[224:227], a[52:55], v[144:147], v[224:227]
    v_rcp_f32 v24, v24
    v_mfma_f32_16x16x32_bf16 v[228:231], a[52:55], v[148:151], v[228:231]
    v_rcp_f32 v25, v25
    v_rcp_f32 v26, v26
    v_mfma_f32_16x16x32_bf16 v[232:235], a[52:55], v[152:155], v[232:235]
    v_rcp_f32 v27, v27
    v_mfma_f32_16x16x32_bf16 v[220:223], a[68:71], v[204:207], v[220:223]
    buffer_load_dwordx4 a[52:55], v17, s[12:15], s28 offen offset:1024 sc1
    v_mul_f32 v24, v24, v248
    v_mul_f32 v25, v25, v249
    v_mfma_f32_16x16x32_bf16 v[224:227], a[68:71], v[208:211], v[224:227]
    v_mul_f32 v26, v26, v250
    v_mul_f32 v27, v27, v251
    v_cvt_pk_bf16_f32 v42, v24, v25
    v_mfma_f32_16x16x32_bf16 v[228:231], a[68:71], v[212:215], v[228:231]
    v_cvt_pk_bf16_f32 v43, v26, v27
    ds_write_b64 v13, v[42:43] offset:3072
    v_mfma_f32_16x16x32_bf16 v[232:235], a[68:71], v[216:219], v[232:235]
    v_add_u32 v13, 4096, v13
    buffer_load_dwordx4 a[68:71], v18, s[12:15], s28 offen offset:1024 sc1
    s_add_u32 s28, s28, 18432
    s_mov_b32 s28, s29
    s_waitcnt vmcnt(42)
    v_mfma_f32_16x16x32_bf16 v[236:239], a[72:75], a[144:147], 0
    v_mfma_f32_16x16x32_bf16 v[240:243], a[72:75], a[148:151], 0
    v_mul_f32 v20, v220, v220
    v_mul_f32 v21, v221, v221
    v_mul_f32 v22, v222, v222
    v_mul_f32 v23, v223, v223
    v_fma_f32 v20, v20, v29, v28
    v_mfma_f32_16x16x32_bf16 v[244:247], a[72:75], a[152:155], 0
    v_fma_f32 v21, v21, v29, v28
    v_fma_f32 v22, v22, v29, v28
    v_mfma_f32_16x16x32_bf16 v[248:251], a[72:75], a[156:159], 0
    v_fma_f32 v23, v23, v29, v28
    v_mul_f32 v20, v20, v220
    v_mul_f32 v21, v21, v221
    v_mfma_f32_16x16x32_bf16 v[236:239], a[76:79], a[160:163], v[236:239]
    buffer_load_dwordx4 a[72:75], v4, s[12:15], s28 offen offset:0 sc1
    s_add_u32 m0, s39, 12288
    s_nop 0
    buffer_load_dwordx4 v17, s[12:15], s38 offen offset:1024 sc1 lds
    v_mfma_f32_16x16x32_bf16 v[240:243], a[76:79], a[164:167], v[240:243]
    v_mul_f32 v22, v22, v222
    v_mul_f32 v23, v23, v223
    v_mfma_f32_16x16x32_bf16 v[244:247], a[76:79], a[168:171], v[244:247]
    v_exp_f32 v20, v20
    v_exp_f32 v21, v21
    v_mfma_f32_16x16x32_bf16 v[248:251], a[76:79], a[172:175], v[248:251]
    v_exp_f32 v22, v22
    s_waitcnt vmcnt(42)
    v_mfma_f32_16x16x32_bf16 v[236:239], a[80:83], a[176:179], v[236:239]
    buffer_load_dwordx4 a[76:79], v4, s[12:15], s28 offen offset:1024 sc1
    v_mfma_f32_16x16x32_bf16 v[240:243], a[80:83], a[180:183], v[240:243]
    v_exp_f32 v23, v23
    v_fma_f32 v20, v20, v30, v30
    v_fma_f32 v21, v21, v30, v30
    v_mfma_f32_16x16x32_bf16 v[244:247], a[80:83], a[184:187], v[244:247]
    v_fma_f32 v22, v22, v30, v30
    v_fma_f32 v23, v23, v30, v30
    v_mfma_f32_16x16x32_bf16 v[248:251], a[80:83], a[188:191], v[248:251]
    v_rcp_f32 v20, v20
    v_rcp_f32 v21, v21
    v_mfma_f32_16x16x32_bf16 v[236:239], a[92:95], a[224:227], v[236:239]
    buffer_load_dwordx4 a[80:83], v4, s[12:15], s28 offen offset:2048 sc1
    v_mfma_f32_16x16x32_bf16 v[240:243], a[92:95], a[228:231], v[240:243]
    v_rcp_f32 v22, v22
    v_rcp_f32 v23, v23
    v_mfma_f32_16x16x32_bf16 v[244:247], a[92:95], a[232:235], v[244:247]
    v_mul_f32 v20, v20, v220
    v_mul_f32 v21, v21, v221
    v_mfma_f32_16x16x32_bf16 v[248:251], a[92:95], a[236:239], v[248:251]
    v_mul_f32 v22, v22, v222
    v_mul_f32 v23, v23, v223
    s_waitcnt vmcnt(41)
    v_mfma_f32_16x16x32_bf16 v[236:239], a[96:99], a[240:243], v[236:239]
    buffer_load_dwordx4 a[92:95], v7, s[12:15], s28 offen offset:1024 sc1
    v_cvt_pk_bf16_f32 v40, v20, v21
    v_cvt_pk_bf16_f32 v41, v22, v23
    v_mfma_f32_16x16x32_bf16 v[240:243], a[96:99], a[244:247], v[240:243]
    ds_write_b64 v12, v[40:41] offset:0
    v_mul_f32 v24, v224, v224
    v_mfma_f32_16x16x32_bf16 v[244:247], a[96:99], a[248:251], v[244:247]
    v_mul_f32 v25, v225, v225
    v_mul_f32 v26, v226, v226
    v_mfma_f32_16x16x32_bf16 v[248:251], a[96:99], a[252:255], v[248:251]
    s_add_u32 m0, s39, 12288
    s_nop 0
    buffer_load_dwordx4 v17, s[12:15], s38 offen offset:2048 sc1 lds
    v_mul_f32 v27, v227, v227
    v_mfma_f32_16x16x32_bf16 v[236:239], a[100:103], v[44:47], v[236:239]
    buffer_load_dwordx4 a[96:99], v7, s[12:15], s28 offen offset:2048 sc1
    v_fma_f32 v24, v24, v32, v31
    v_fma_f32 v25, v25, v32, v31
    v_mfma_f32_16x16x32_bf16 v[240:243], a[100:103], v[48:51], v[240:243]
    v_fma_f32 v26, v26, v32, v31
    v_fma_f32 v27, v27, v32, v31
    v_mul_f32 v24, v24, v224
    v_mfma_f32_16x16x32_bf16 v[244:247], a[100:103], v[52:55], v[244:247]
    v_mul_f32 v25, v25, v225
    v_mul_f32 v26, v26, v226
    v_mfma_f32_16x16x32_bf16 v[248:251], a[100:103], v[56:59], v[248:251]
    v_mul_f32 v27, v27, v227
    v_exp_f32 v24, v24
    s_waitcnt vmcnt(42)
    v_mfma_f32_16x16x32_bf16 v[236:239], a[108:111], v[76:79], v[236:239]
    buffer_load_dwordx4 a[100:103], v7, s[12:15], s28 offen offset:3072 sc1
    v_mfma_f32_16x16x32_bf16 v[240:243], a[108:111], v[80:83], v[240:243]
    v_exp_f32 v25, v25
    v_exp_f32 v26, v26
    v_mfma_f32_16x16x32_bf16 v[244:247], a[108:111], v[84:87], v[244:247]
    v_exp_f32 v27, v27
    v_mfma_f32_16x16x32_bf16 v[248:251], a[108:111], v[88:91], v[248:251]
    v_fma_f32 v24, v24, v33, v33
    v_fma_f32 v25, v25, v33, v33
    v_fma_f32 v26, v26, v33, v33
    v_mfma_f32_16x16x32_bf16 v[236:239], a[112:115], v[92:95], v[236:239]
    buffer_load_dwordx4 a[108:111], v16, s[12:15], s28 offen offset:1024 sc1
    v_fma_f32 v27, v27, v33, v33
    v_mfma_f32_16x16x32_bf16 v[240:243], a[112:115], v[96:99], v[240:243]
    v_rcp_f32 v24, v24
    v_rcp_f32 v25, v25
    v_mfma_f32_16x16x32_bf16 v[244:247], a[112:115], v[100:103], v[244:247]
    v_rcp_f32 v26, v26
    v_mfma_f32_16x16x32_bf16 v[248:251], a[112:115], v[104:107], v[248:251]
    v_rcp_f32 v27, v27
    s_waitcnt vmcnt(41)
    v_mfma_f32_16x16x32_bf16 v[236:239], a[116:119], v[108:111], v[236:239]
    buffer_load_dwordx4 a[112:115], v16, s[12:15], s28 offen offset:2048 sc1
    v_mul_f32 v24, v24, v224
    v_mul_f32 v25, v25, v225
    v_mfma_f32_16x16x32_bf16 v[240:243], a[116:119], v[112:115], v[240:243]
    v_mul_f32 v26, v26, v226
    s_add_u32 m0, s39, 12288
    s_nop 0
    buffer_load_dwordx4 v17, s[12:15], s38 offen offset:3072 sc1 lds
    v_mfma_f32_16x16x32_bf16 v[244:247], a[116:119], v[116:119], v[244:247]
    v_mul_f32 v27, v27, v227
    v_cvt_pk_bf16_f32 v42, v24, v25
    v_mfma_f32_16x16x32_bf16 v[248:251], a[116:119], v[120:123], v[248:251]
    v_cvt_pk_bf16_f32 v43, v26, v27
    ds_write_b64 v12, v[42:43] offset:1024
    v_mfma_f32_16x16x32_bf16 v[236:239], a[128:131], v[156:159], v[236:239]
    buffer_load_dwordx4 a[116:119], v16, s[12:15], s28 offen offset:3072 sc1
    v_mul_f32 v20, v228, v228
    v_mul_f32 v21, v229, v229
    v_mfma_f32_16x16x32_bf16 v[240:243], a[128:131], v[160:163], v[240:243]
    v_mul_f32 v22, v230, v230
    v_mul_f32 v23, v231, v231
    v_fma_f32 v20, v20, v35, v34
    v_mfma_f32_16x16x32_bf16 v[244:247], a[128:131], v[164:167], v[244:247]
    v_fma_f32 v21, v21, v35, v34
    v_fma_f32 v22, v22, v35, v34
    v_mfma_f32_16x16x32_bf16 v[248:251], a[128:131], v[168:171], v[248:251]
    v_fma_f32 v23, v23, v35, v34
    v_mul_f32 v20, v20, v228
    s_waitcnt vmcnt(41)
    v_mfma_f32_16x16x32_bf16 v[236:239], a[132:135], v[172:175], v[236:239]
    buffer_load_dwordx4 a[128:131], v17, s[12:15], s28 offen offset:2048 sc1
    v_mul_f32 v21, v21, v229
    v_mul_f32 v22, v22, v230
    v_mfma_f32_16x16x32_bf16 v[240:243], a[132:135], v[176:179], v[240:243]
    v_mul_f32 v23, v23, v231
    v_exp_f32 v20, v20
    v_mfma_f32_16x16x32_bf16 v[244:247], a[132:135], v[180:183], v[244:247]
    v_exp_f32 v21, v21
    v_mfma_f32_16x16x32_bf16 v[248:251], a[132:135], v[184:187], v[248:251]
    v_exp_f32 v22, v22
    v_exp_f32 v23, v23
    v_mfma_f32_16x16x32_bf16 v[236:239], a[136:139], v[188:191], v[236:239]
    buffer_load_dwordx4 a[132:135], v17, s[12:15], s28 offen offset:3072 sc1
    v_fma_f32 v20, v20, v36, v36
    v_mfma_f32_16x16x32_bf16 v[240:243], a[136:139], v[192:195], v[240:243]
    v_fma_f32 v21, v21, v36, v36
    v_fma_f32 v22, v22, v36, v36
    v_fma_f32 v23, v23, v36, v36
    v_mfma_f32_16x16x32_bf16 v[244:247], a[136:139], v[196:199], v[244:247]
    s_add_u32 m0, s39, 16384
    s_nop 0
    buffer_load_dwordx4 v18, s[12:15], s38 offen offset:0 sc1 lds
    v_mfma_f32_16x16x32_bf16 v[248:251], a[136:139], v[200:203], v[248:251]
    v_rcp_f32 v20, v20
    s_waitcnt vmcnt(42)
    v_mfma_f32_16x16x32_bf16 v[236:239], a[84:87], a[192:195], v[236:239]
    buffer_load_dwordx4 a[136:139], v18, s[12:15], s28 offen offset:0 sc1
    v_rcp_f32 v21, v21
    v_mfma_f32_16x16x32_bf16 v[240:243], a[84:87], a[196:199], v[240:243]
    v_rcp_f32 v22, v22
    v_mfma_f32_16x16x32_bf16 v[244:247], a[84:87], a[200:203], v[244:247]
    v_rcp_f32 v23, v23
    v_mul_f32 v20, v20, v228
    v_mfma_f32_16x16x32_bf16 v[248:251], a[84:87], a[204:207], v[248:251]
    v_mul_f32 v21, v21, v229
    v_mul_f32 v22, v22, v230
    v_mul_f32 v23, v23, v231
    v_mfma_f32_16x16x32_bf16 v[236:239], a[120:123], v[124:127], v[236:239]
    buffer_load_dwordx4 a[84:87], v4, s[12:15], s28 offen offset:3072 sc1
    v_cvt_pk_bf16_f32 v40, v20, v21
    v_cvt_pk_bf16_f32 v41, v22, v23
    v_mfma_f32_16x16x32_bf16 v[240:243], a[120:123], v[128:131], v[240:243]
    ds_write_b64 v12, v[40:41] offset:2048
    v_mul_f32 v24, v232, v232
    v_mfma_f32_16x16x32_bf16 v[244:247], a[120:123], v[132:135], v[244:247]
    v_mul_f32 v25, v233, v233
    v_mul_f32 v26, v234, v234
    v_mfma_f32_16x16x32_bf16 v[248:251], a[120:123], v[136:139], v[248:251]
    v_mul_f32 v27, v235, v235
    v_fma_f32 v24, v24, v38, v37
    s_waitcnt vmcnt(41)
    v_mfma_f32_16x16x32_bf16 v[236:239], a[88:91], a[208:211], v[236:239]
    buffer_load_dwordx4 a[120:123], v17, s[12:15], s28 offen offset:0 sc1
    v_fma_f32 v25, v25, v38, v37
    v_fma_f32 v26, v26, v38, v37
    v_mfma_f32_16x16x32_bf16 v[240:243], a[88:91], a[212:215], v[240:243]
    v_fma_f32 v27, v27, v38, v37
    v_mul_f32 v24, v24, v232
    v_mul_f32 v25, v25, v233
    v_mfma_f32_16x16x32_bf16 v[244:247], a[88:91], a[216:219], v[244:247]
    v_mul_f32 v26, v26, v234
    v_mul_f32 v27, v27, v235
    v_mfma_f32_16x16x32_bf16 v[248:251], a[88:91], a[220:223], v[248:251]
    v_exp_f32 v24, v24
    s_add_u32 m0, s39, 16384
    v_mfma_f32_16x16x32_bf16 v[236:239], a[104:107], v[60:63], v[236:239]
    buffer_load_dwordx4 a[88:91], v7, s[12:15], s28 offen offset:0 sc1
    buffer_load_dwordx4 v18, s[12:15], s38 offen offset:1024 sc1 lds
    v_mfma_f32_16x16x32_bf16 v[240:243], a[104:107], v[64:67], v[240:243]
    v_exp_f32 v25, v25
    v_exp_f32 v26, v26
    v_mfma_f32_16x16x32_bf16 v[244:247], a[104:107], v[68:71], v[244:247]
    v_exp_f32 v27, v27
    v_mfma_f32_16x16x32_bf16 v[248:251], a[104:107], v[72:75], v[248:251]
    v_fma_f32 v24, v24, v39, v39
    v_fma_f32 v25, v25, v39, v39
    s_waitcnt vmcnt(42)
    v_mfma_f32_16x16x32_bf16 v[236:239], a[124:127], v[140:143], v[236:239]
    buffer_load_dwordx4 a[104:107], v16, s[12:15], s28 offen offset:0 sc1
    v_fma_f32 v26, v26, v39, v39
    v_fma_f32 v27, v27, v39, v39
    v_mfma_f32_16x16x32_bf16 v[240:243], a[124:127], v[144:147], v[240:243]
    v_rcp_f32 v24, v24
    v_mfma_f32_16x16x32_bf16 v[244:247], a[124:127], v[148:151], v[244:247]
    v_rcp_f32 v25, v25
    v_rcp_f32 v26, v26
    v_mfma_f32_16x16x32_bf16 v[248:251], a[124:127], v[152:155], v[248:251]
    v_rcp_f32 v27, v27
    v_mfma_f32_16x16x32_bf16 v[236:239], a[140:143], v[204:207], v[236:239]
    buffer_load_dwordx4 a[124:127], v17, s[12:15], s28 offen offset:1024 sc1
    v_mul_f32 v24, v24, v232
    v_mul_f32 v25, v25, v233
    v_mfma_f32_16x16x32_bf16 v[240:243], a[140:143], v[208:211], v[240:243]
    v_mul_f32 v26, v26, v234
    v_mul_f32 v27, v27, v235
    v_cvt_pk_bf16_f32 v42, v24, v25
    v_mfma_f32_16x16x32_bf16 v[244:247], a[140:143], v[212:215], v[244:247]
    v_cvt_pk_bf16_f32 v43, v26, v27
    ds_write_b64 v12, v[42:43] offset:3072
    v_mfma_f32_16x16x32_bf16 v[248:251], a[140:143], v[216:219], v[248:251]
    v_add_u32 v12, 4096, v12
    buffer_load_dwordx4 a[140:143], v18, s[12:15], s28 offen offset:1024 sc1
    s_add_u32 s28, s28, 18432
    s_waitcnt lgkmcnt(0)
    s_barrier
    s_waitcnt vmcnt(42)
    v_mfma_f32_16x16x32_bf16 v[220:223], a[0:3], a[144:147], 0
    v_mfma_f32_16x16x32_bf16 v[224:227], a[0:3], a[148:151], 0
    v_mul_f32 v20, v236, v236
    v_mul_f32 v21, v237, v237
    v_mul_f32 v22, v238, v238
    v_mul_f32 v23, v239, v239
    v_fma_f32 v20, v20, v29, v28
    v_fma_f32 v21, v21, v29, v28
    v_mfma_f32_16x16x32_bf16 v[228:231], a[0:3], a[152:155], 0
    v_fma_f32 v22, v22, v29, v28
    v_fma_f32 v23, v23, v29, v28
    v_mul_f32 v20, v20, v236
    v_mfma_f32_16x16x32_bf16 v[232:235], a[0:3], a[156:159], 0
    ds_read_b128 a[144:147], v10 offset:0
    ds_read_b128 a[148:151], v10 offset:1024
    ds_read_b128 a[152:155], v10 offset:2048
    ds_read_b128 a[156:159], v10 offset:3072
    v_mfma_f32_16x16x32_bf16 v[220:223], a[4:7], a[160:163], v[220:223]
    buffer_load_dwordx4 a[0:3], v4, s[12:15], s28 offen offset:0 sc1
    v_mul_f32 v21, v21, v237
    v_mul_f32 v22, v22, v238
    v_mul_f32 v23, v23, v239
    v_mfma_f32_16x16x32_bf16 v[224:227], a[4:7], a[164:167], v[224:227]
    v_exp_f32 v20, v20
    v_exp_f32 v21, v21
    v_mfma_f32_16x16x32_bf16 v[228:231], a[4:7], a[168:171], v[228:231]
    v_exp_f32 v22, v22
    v_mfma_f32_16x16x32_bf16 v[232:235], a[4:7], a[172:175], v[232:235]
    ds_read_b128 a[160:163], v10 offset:4096
    ds_read_b128 a[164:167], v10 offset:5120
    ds_read_b128 a[168:171], v10 offset:6144
    ds_read_b128 a[172:175], v10 offset:7168
    s_waitcnt vmcnt(41)
    v_mfma_f32_16x16x32_bf16 v[220:223], a[8:11], a[176:179], v[220:223]
    buffer_load_dwordx4 a[4:7], v4, s[12:15], s28 offen offset:1024 sc1
    v_exp_f32 v23, v23
    v_mfma_f32_16x16x32_bf16 v[224:227], a[8:11], a[180:183], v[224:227]
    v_fma_f32 v20, v20, v30, v30
    v_fma_f32 v21, v21, v30, v30
    v_fma_f32 v22, v22, v30, v30
    v_mfma_f32_16x16x32_bf16 v[228:231], a[8:11], a[184:187], v[228:231]
    v_fma_f32 v23, v23, v30, v30
    v_rcp_f32 v20, v20
    v_mfma_f32_16x16x32_bf16 v[232:235], a[8:11], a[188:191], v[232:235]
    ds_read_b128 a[176:179], v10 offset:8192
    ds_read_b128 a[180:183], v10 offset:9216
    ds_read_b128 a[184:187], v10 offset:10240
    ds_read_b128 a[188:191], v10 offset:11264
    v_rcp_f32 v21, v21
    v_mfma_f32_16x16x32_bf16 v[220:223], a[20:23], a[224:227], v[220:223]
    buffer_load_dwordx4 a[8:11], v4, s[12:15], s28 offen offset:2048 sc1
    v_rcp_f32 v22, v22
    v_mfma_f32_16x16x32_bf16 v[224:227], a[20:23], a[228:231], v[224:227]
    v_rcp_f32 v23, v23
    v_mul_f32 v20, v20, v236
    v_mfma_f32_16x16x32_bf16 v[228:231], a[20:23], a[232:235], v[228:231]
    v_mul_f32 v21, v21, v237
    v_mul_f32 v22, v22, v238
    v_mul_f32 v23, v23, v239
    v_mfma_f32_16x16x32_bf16 v[232:235], a[20:23], a[236:239], v[232:235]
    ds_read_b128 a[224:227], v10 offset:20480
    ds_read_b128 a[228:231], v10 offset:21504
    ds_read_b128 a[232:235], v10 offset:22528
    ds_read_b128 a[236:239], v10 offset:23552
    s_waitcnt vmcnt(40)
    v_mfma_f32_16x16x32_bf16 v[220:223], a[24:27], a[240:243], v[220:223]
    buffer_load_dwordx4 a[20:23], v7, s[12:15], s28 offen offset:1024 sc1
    v_cvt_pk_bf16_f32 v40, v20, v21
    v_cvt_pk_bf16_f32 v41, v22, v23
    v_mfma_f32_16x16x32_bf16 v[224:227], a[24:27], a[244:247], v[224:227]
    ds_write_b64 v13, v[40:41] offset:0
    v_mul_f32 v24, v240, v240
    v_mfma_f32_16x16x32_bf16 v[228:231], a[24:27], a[248:251], v[228:231]
    v_mul_f32 v25, v241, v241
    v_mul_f32 v26, v242, v242
    v_mul_f32 v27, v243, v243
    v_fma_f32 v24, v24, v32, v31
    v_mfma_f32_16x16x32_bf16 v[232:235], a[24:27], a[252:255], v[232:235]
    ds_read_b128 a[240:243], v10 offset:24576
    ds_read_b128 a[244:247], v10 offset:25600
    ds_read_b128 a[248:251], v10 offset:26624
    ds_read_b128 a[252:255], v10 offset:27648
    v_mfma_f32_16x16x32_bf16 v[220:223], a[28:31], v[44:47], v[220:223]
    buffer_load_dwordx4 a[24:27], v7, s[12:15], s28 offen offset:2048 sc1
    v_fma_f32 v25, v25, v32, v31
    v_fma_f32 v26, v26, v32, v31
    v_fma_f32 v27, v27, v32, v31
    v_mfma_f32_16x16x32_bf16 v[224:227], a[28:31], v[48:51], v[224:227]
    v_mul_f32 v24, v24, v240
    v_mul_f32 v25, v25, v241
    v_mul_f32 v26, v26, v242
    v_mfma_f32_16x16x32_bf16 v[228:231], a[28:31], v[52:55], v[228:231]
    v_mul_f32 v27, v27, v243
    v_exp_f32 v24, v24
    v_mfma_f32_16x16x32_bf16 v[232:235], a[28:31], v[56:59], v[232:235]
    ds_read_b128 v[44:47], v10 offset:28672
    ds_read_b128 v[48:51], v10 offset:29696
    ds_read_b128 v[52:55], v10 offset:30720
    ds_read_b128 v[56:59], v10 offset:31744
    s_waitcnt vmcnt(40)
    v_mfma_f32_16x16x32_bf16 v[220:223], a[36:39], v[76:79], v[220:223]
    buffer_load_dwordx4 a[28:31], v7, s[12:15], s28 offen offset:3072 sc1
    v_exp_f32 v25, v25
    v_mfma_f32_16x16x32_bf16 v[224:227], a[36:39], v[80:83], v[224:227]
    v_exp_f32 v26, v26
    v_exp_f32 v27, v27
    v_mfma_f32_16x16x32_bf16 v[228:231], a[36:39], v[84:87], v[228:231]
    v_fma_f32 v24, v24, v33, v33
    v_fma_f32 v25, v25, v33, v33
    v_fma_f32 v26, v26, v33, v33
    v_mfma_f32_16x16x32_bf16 v[232:235], a[36:39], v[88:91], v[232:235]
    ds_read_b128 v[76:79], v11 offset:0
    ds_read_b128 v[80:83], v11 offset:1024
    ds_read_b128 v[84:87], v11 offset:2048
    ds_read_b128 v[88:91], v11 offset:3072
    v_mfma_f32_16x16x32_bf16 v[220:223], a[40:43], v[92:95], v[220:223]
    buffer_load_dwordx4 a[36:39], v16, s[12:15], s28 offen offset:1024 sc1
    v_fma_f32 v27, v27, v33, v33
    v_rcp_f32 v24, v24
    v_mfma_f32_16x16x32_bf16 v[224:227], a[40:43], v[96:99], v[224:227]
    v_rcp_f32 v25, v25
    v_mfma_f32_16x16x32_bf16 v[228:231], a[40:43], v[100:103], v[228:231]
    v_rcp_f32 v26, v26
    v_rcp_f32 v27, v27
    v_mfma_f32_16x16x32_bf16 v[232:235], a[40:43], v[104:107], v[232:235]
    ds_read_b128 v[92:95], v11 offset:4096
    ds_read_b128 v[96:99], v11 offset:5120
    ds_read_b128 v[100:103], v11 offset:6144
    ds_read_b128 v[104:107], v11 offset:7168
    s_waitcnt vmcnt(39)
    v_mfma_f32_16x16x32_bf16 v[220:223], a[44:47], v[108:111], v[220:223]
    buffer_load_dwordx4 a[40:43], v16, s[12:15], s28 offen offset:2048 sc1
    v_mul_f32 v24, v24, v240
    v_mul_f32 v25, v25, v241
    v_mfma_f32_16x16x32_bf16 v[224:227], a[44:47], v[112:115], v[224:227]
    v_mul_f32 v26, v26, v242
    v_mul_f32 v27, v27, v243
    v_cvt_pk_bf16_f32 v42, v24, v25
    v_mfma_f32_16x16x32_bf16 v[228:231], a[44:47], v[116:119], v[228:231]
    v_cvt_pk_bf16_f32 v43, v26, v27
    ds_write_b64 v13, v[42:43] offset:1024
    v_mfma_f32_16x16x32_bf16 v[232:235], a[44:47], v[120:123], v[232:235]
    ds_read_b128 v[108:111], v11 offset:8192
    ds_read_b128 v[112:115], v11 offset:9216
    ds_read_b128 v[116:119], v11 offset:10240
    ds_read_b128 v[120:123], v11 offset:11264
    v_mul_f32 v20, v244, v244
    v_mfma_f32_16x16x32_bf16 v[220:223], a[56:59], v[156:159], v[220:223]
    buffer_load_dwordx4 a[44:47], v16, s[12:15], s28 offen offset:3072 sc1
    v_mul_f32 v21, v245, v245
    v_mul_f32 v22, v246, v246
    v_mfma_f32_16x16x32_bf16 v[224:227], a[56:59], v[160:163], v[224:227]
    v_mul_f32 v23, v247, v247
    v_fma_f32 v20, v20, v35, v34
    v_fma_f32 v21, v21, v35, v34
    v_fma_f32 v22, v22, v35, v34
    v_mfma_f32_16x16x32_bf16 v[228:231], a[56:59], v[164:167], v[228:231]
    v_fma_f32 v23, v23, v35, v34
    v_mul_f32 v20, v20, v244
    v_mul_f32 v21, v21, v245
    v_mfma_f32_16x16x32_bf16 v[232:235], a[56:59], v[168:171], v[232:235]
    ds_read_b128 v[156:159], v11 offset:20480
    ds_read_b128 v[160:163], v11 offset:21504
    ds_read_b128 v[164:167], v11 offset:22528
    ds_read_b128 v[168:171], v11 offset:23552
    s_waitcnt vmcnt(38)
    v_mfma_f32_16x16x32_bf16 v[220:223], a[60:63], v[172:175], v[220:223]
    buffer_load_dwordx4 a[56:59], v17, s[12:15], s28 offen offset:2048 sc1
    v_mul_f32 v22, v22, v246
    v_mul_f32 v23, v23, v247
    v_mfma_f32_16x16x32_bf16 v[224:227], a[60:63], v[176:179], v[224:227]
    v_exp_f32 v20, v20
    v_exp_f32 v21, v21
    v_mfma_f32_16x16x32_bf16 v[228:231], a[60:63], v[180:183], v[228:231]
    v_exp_f32 v22, v22
    v_mfma_f32_16x16x32_bf16 v[232:235], a[60:63], v[184:187], v[232:235]
    ds_read_b128 v[172:175], v11 offset:24576
    ds_read_b128 v[176:179], v11 offset:25600
    ds_read_b128 v[180:183], v11 offset:26624
    ds_read_b128 v[184:187], v11 offset:27648
    v_mfma_f32_16x16x32_bf16 v[220:223], a[64:67], v[188:191], v[220:223]
    buffer_load_dwordx4 a[60:63], v17, s[12:15], s28 offen offset:3072 sc1
    v_exp_f32 v23, v23
    v_fma_f32 v20, v20, v36, v36
    v_mfma_f32_16x16x32_bf16 v[224:227], a[64:67], v[192:195], v[224:227]
    v_fma_f32 v21, v21, v36, v36
    v_fma_f32 v22, v22, v36, v36
    v_fma_f32 v23, v23, v36, v36
    v_mfma_f32_16x16x32_bf16 v[228:231], a[64:67], v[196:199], v[228:231]
    v_rcp_f32 v20, v20
    v_rcp_f32 v21, v21
    v_mfma_f32_16x16x32_bf16 v[232:235], a[64:67], v[200:203], v[232:235]
    ds_read_b128 v[188:191], v11 offset:28672
    ds_read_b128 v[192:195], v11 offset:29696
    ds_read_b128 v[196:199], v11 offset:30720
    ds_read_b128 v[200:203], v11 offset:31744
    s_waitcnt vmcnt(38)
    v_mfma_f32_16x16x32_bf16 v[220:223], a[12:15], a[192:195], v[220:223]
    buffer_load_dwordx4 a[64:67], v18, s[12:15], s28 offen offset:0 sc1
    v_rcp_f32 v22, v22
    v_mfma_f32_16x16x32_bf16 v[224:227], a[12:15], a[196:199], v[224:227]
    v_rcp_f32 v23, v23
    v_mul_f32 v20, v20, v244
    v_mfma_f32_16x16x32_bf16 v[228:231], a[12:15], a[200:203], v[228:231]
    v_mul_f32 v21, v21, v245
    v_mul_f32 v22, v22, v246
    v_mul_f32 v23, v23, v247
    v_mfma_f32_16x16x32_bf16 v[232:235], a[12:15], a[204:207], v[232:235]
    v_cvt_pk_bf16_f32 v40, v20, v21
    v_mfma_f32_16x16x32_bf16 v[220:223], a[48:51], v[124:127], v[220:223]
    buffer_load_dwordx4 a[12:15], v4, s[12:15], s28 offen offset:3072 sc1
    v_cvt_pk_bf16_f32 v41, v22, v23
    ds_write_b64 v13, v[40:41] offset:2048
    v_mfma_f32_16x16x32_bf16 v[224:227], a[48:51], v[128:131], v[224:227]
    v_mul_f32 v24, v248, v248
    v_mul_f32 v25, v249, v249
    v_mfma_f32_16x16x32_bf16 v[228:231], a[48:51], v[132:135], v[228:231]
    v_mul_f32 v26, v250, v250
    v_mul_f32 v27, v251, v251
    v_fma_f32 v24, v24, v38, v37
    v_fma_f32 v25, v25, v38, v37
    v_mfma_f32_16x16x32_bf16 v[232:235], a[48:51], v[136:139], v[232:235]
    s_waitcnt vmcnt(38)
    v_mfma_f32_16x16x32_bf16 v[220:223], a[16:19], a[208:211], v[220:223]
    buffer_load_dwordx4 a[48:51], v17, s[12:15], s28 offen offset:0 sc1
    v_fma_f32 v26, v26, v38, v37
    v_fma_f32 v27, v27, v38, v37
    v_mfma_f32_16x16x32_bf16 v[224:227], a[16:19], a[212:215], v[224:227]
    v_mul_f32 v24, v24, v248
    v_mul_f32 v25, v25, v249
    v_mul_f32 v26, v26, v250
    v_mfma_f32_16x16x32_bf16 v[228:231], a[16:19], a[216:219], v[228:231]
    v_mul_f32 v27, v27, v251
    v_exp_f32 v24, v24
    v_mfma_f32_16x16x32_bf16 v[232:235], a[16:19], a[220:223], v[232:235]
    v_mfma_f32_16x16x32_bf16 v[220:223], a[32:35], v[60:63], v[220:223]
    buffer_load_dwordx4 a[16:19], v7, s[12:15], s28 offen offset:0 sc1
    v_exp_f32 v25, v25
    v_mfma_f32_16x16x32_bf16 v[224:227], a[32:35], v[64:67], v[224:227]
    v_exp_f32 v26, v26
    v_exp_f32 v27, v27
    v_mfma_f32_16x16x32_bf16 v[228:231], a[32:35], v[68:71], v[228:231]
    v_fma_f32 v24, v24, v39, v39
    v_fma_f32 v25, v25, v39, v39
    v_fma_f32 v26, v26, v39, v39
    v_fma_f32 v27, v27, v39, v39
    v_mfma_f32_16x16x32_bf16 v[232:235], a[32:35], v[72:75], v[232:235]
    s_waitcnt vmcnt(38)
    v_mfma_f32_16x16x32_bf16 v[220:223], a[52:55], v[140:143], v[220:223]
    buffer_load_dwordx4 a[32:35], v16, s[12:15], s28 offen offset:0 sc1
    v_rcp_f32 v24, v24
    v_mfma_f32_16x16x32_bf16 v[224:227], a[52:55], v[144:147], v[224:227]
    v_rcp_f32 v25, v25
    v_mfma_f32_16x16x32_bf16 v[228:231], a[52:55], v[148:151], v[228:231]
    v_rcp_f32 v26, v26
    v_rcp_f32 v27, v27
    v_mfma_f32_16x16x32_bf16 v[232:235], a[52:55], v[152:155], v[232:235]
    v_mul_f32 v24, v24, v248
    v_mfma_f32_16x16x32_bf16 v[220:223], a[68:71], v[204:207], v[220:223]
    buffer_load_dwordx4 a[52:55], v17, s[12:15], s28 offen offset:1024 sc1
    v_mul_f32 v25, v25, v249
    v_mul_f32 v26, v26, v250
    v_mfma_f32_16x16x32_bf16 v[224:227], a[68:71], v[208:211], v[224:227]
    v_mul_f32 v27, v27, v251
    v_cvt_pk_bf16_f32 v42, v24, v25
    v_cvt_pk_bf16_f32 v43, v26, v27
    v_mfma_f32_16x16x32_bf16 v[228:231], a[68:71], v[212:215], v[228:231]
    ds_write_b64 v13, v[42:43] offset:3072
    v_add_u32 v13, 4096, v13
    v_mfma_f32_16x16x32_bf16 v[232:235], a[68:71], v[216:219], v[232:235]
    buffer_load_dwordx4 a[68:71], v18, s[12:15], s28 offen offset:1024 sc1
    s_add_u32 s28, s28, 18432
    s_waitcnt lgkmcnt(0)
    s_barrier
    ds_read_b128 a[192:195], v10 offset:12288
    ds_read_b128 a[196:199], v10 offset:13312
    ds_read_b128 a[200:203], v10 offset:14336
    ds_read_b128 a[204:207], v10 offset:15360
    ds_read_b128 v[124:127], v11 offset:12288
    ds_read_b128 v[128:131], v11 offset:13312
    ds_read_b128 v[132:135], v11 offset:14336
    ds_read_b128 v[136:139], v11 offset:15360
    s_waitcnt vmcnt(38)
    v_mfma_f32_16x16x32_bf16 v[236:239], a[72:75], a[144:147], 0
    v_mul_f32 v20, v220, v220
    v_mul_f32 v21, v221, v221
    v_mul_f32 v22, v222, v222
    v_mfma_f32_16x16x32_bf16 v[240:243], a[72:75], a[148:151], 0
    v_mul_f32 v23, v223, v223
    v_fma_f32 v20, v20, v29, v28
    v_fma_f32 v21, v21, v29, v28
    v_fma_f32 v22, v22, v29, v28
    v_fma_f32 v23, v23, v29, v28
    v_mfma_f32_16x16x32_bf16 v[244:247], a[72:75], a[152:155], 0
    v_mul_f32 v20, v20, v220
    v_mul_f32 v21, v21, v221
    v_mul_f32 v22, v22, v222
    v_mul_f32 v23, v23, v223
    v_mfma_f32_16x16x32_bf16 v[248:251], a[72:75], a[156:159], 0
    v_exp_f32 v20, v20
    v_exp_f32 v21, v21
    v_mfma_f32_16x16x32_bf16 v[236:239], a[76:79], a[160:163], v[236:239]
    buffer_load_dwordx4 a[72:75], v4, s[12:15], s28 offen offset:0 sc1
    v_exp_f32 v22, v22
    v_exp_f32 v23, v23
    v_mfma_f32_16x16x32_bf16 v[240:243], a[76:79], a[164:167], v[240:243]
    v_fma_f32 v20, v20, v30, v30
    v_fma_f32 v21, v21, v30, v30
    v_fma_f32 v22, v22, v30, v30
    v_fma_f32 v23, v23, v30, v30
    v_mfma_f32_16x16x32_bf16 v[244:247], a[76:79], a[168:171], v[244:247]
    v_rcp_f32 v20, v20
    v_rcp_f32 v21, v21
    v_mfma_f32_16x16x32_bf16 v[248:251], a[76:79], a[172:175], v[248:251]
    v_rcp_f32 v22, v22
    v_rcp_f32 v23, v23
    s_waitcnt vmcnt(37)
    v_mfma_f32_16x16x32_bf16 v[236:239], a[80:83], a[176:179], v[236:239]
    buffer_load_dwordx4 a[76:79], v4, s[12:15], s28 offen offset:1024 sc1
    v_mul_f32 v20, v20, v220
    v_mul_f32 v21, v21, v221
    v_mul_f32 v22, v22, v222
    v_mfma_f32_16x16x32_bf16 v[240:243], a[80:83], a[180:183], v[240:243]
    v_mul_f32 v23, v23, v223
    v_cvt_pk_bf16_f32 v40, v20, v21
    v_cvt_pk_bf16_f32 v41, v22, v23
    ds_write_b64 v12, v[40:41] offset:0
    v_mfma_f32_16x16x32_bf16 v[244:247], a[80:83], a[184:187], v[244:247]
    v_mul_f32 v24, v224, v224
    v_mul_f32 v25, v225, v225
    v_mul_f32 v26, v226, v226
    v_mul_f32 v27, v227, v227
    v_mfma_f32_16x16x32_bf16 v[248:251], a[80:83], a[188:191], v[248:251]
    v_fma_f32 v24, v24, v32, v31
    v_fma_f32 v25, v25, v32, v31
    v_fma_f32 v26, v26, v32, v31
    v_fma_f32 v27, v27, v32, v31
    v_mul_f32 v24, v24, v224
    v_mfma_f32_16x16x32_bf16 v[236:239], a[92:95], a[224:227], v[236:239]
    buffer_load_dwordx4 a[80:83], v4, s[12:15], s28 offen offset:2048 sc1
    v_mul_f32 v25, v25, v225
    v_mul_f32 v26, v26, v226
    v_mul_f32 v27, v27, v227
    v_mfma_f32_16x16x32_bf16 v[240:243], a[92:95], a[228:231], v[240:243]
    v_exp_f32 v24, v24
    v_exp_f32 v25, v25
    v_mfma_f32_16x16x32_bf16 v[244:247], a[92:95], a[232:235], v[244:247]
    v_exp_f32 v26, v26
    v_exp_f32 v27, v27
    v_fma_f32 v24, v24, v33, v33
    v_mfma_f32_16x16x32_bf16 v[248:251], a[92:95], a[236:239], v[248:251]
    v_fma_f32 v25, v25, v33, v33
    v_fma_f32 v26, v26, v33, v33
    v_fma_f32 v27, v27, v33, v33
    s_waitcnt vmcnt(36)
    v_mfma_f32_16x16x32_bf16 v[236:239], a[96:99], a[240:243], v[236:239]
    buffer_load_dwordx4 a[92:95], v7, s[12:15], s28 offen offset:1024 sc1
    v_rcp_f32 v24, v24
    v_rcp_f32 v25, v25
    v_mfma_f32_16x16x32_bf16 v[240:243], a[96:99], a[244:247], v[240:243]
    v_rcp_f32 v26, v26
    v_rcp_f32 v27, v27
    v_mfma_f32_16x16x32_bf16 v[244:247], a[96:99], a[248:251], v[244:247]
    v_mul_f32 v24, v24, v224
    v_mul_f32 v25, v25, v225
    v_mul_f32 v26, v26, v226
    v_mul_f32 v27, v27, v227
    v_mfma_f32_16x16x32_bf16 v[248:251], a[96:99], a[252:255], v[248:251]
    v_cvt_pk_bf16_f32 v42, v24, v25
    v_cvt_pk_bf16_f32 v43, v26, v27
    ds_write_b64 v12, v[42:43] offset:1024
    v_mul_f32 v20, v228, v228
    v_mfma_f32_16x16x32_bf16 v[236:239], a[100:103], v[44:47], v[236:239]
    buffer_load_dwordx4 a[96:99], v7, s[12:15], s28 offen offset:2048 sc1
    v_mul_f32 v21, v229, v229
    v_mul_f32 v22, v230, v230
    v_mul_f32 v23, v231, v231
    v_mfma_f32_16x16x32_bf16 v[240:243], a[100:103], v[48:51], v[240:243]
    v_fma_f32 v20, v20, v35, v34
    v_fma_f32 v21, v21, v35, v34
    v_fma_f32 v22, v22, v35, v34
    v_fma_f32 v23, v23, v35, v34
    v_mfma_f32_16x16x32_bf16 v[244:247], a[100:103], v[52:55], v[244:247]
    v_mul_f32 v20, v20, v228
    v_mul_f32 v21, v21, v229
    v_mul_f32 v22, v22, v230
    v_mul_f32 v23, v23, v231
    v_mfma_f32_16x16x32_bf16 v[248:251], a[100:103], v[56:59], v[248:251]
    v_exp_f32 v20, v20
    v_exp_f32 v21, v21
    s_waitcnt vmcnt(36)
    v_mfma_f32_16x16x32_bf16 v[236:239], a[108:111], v[76:79], v[236:239]
    buffer_load_dwordx4 a[100:103], v7, s[12:15], s28 offen offset:3072 sc1
    v_exp_f32 v22, v22
    v_exp_f32 v23, v23
    v_mfma_f32_16x16x32_bf16 v[240:243], a[108:111], v[80:83], v[240:243]
    v_fma_f32 v20, v20, v36, v36
    v_fma_f32 v21, v21, v36, v36
    v_fma_f32 v22, v22, v36, v36
    v_fma_f32 v23, v23, v36, v36
    v_mfma_f32_16x16x32_bf16 v[244:247], a[108:111], v[84:87], v[244:247]
    v_rcp_f32 v20, v20
    v_rcp_f32 v21, v21
    v_mfma_f32_16x16x32_bf16 v[248:251], a[108:111], v[88:91], v[248:251]
    v_rcp_f32 v22, v22
    v_rcp_f32 v23, v23
    v_mul_f32 v20, v20, v228
    v_mfma_f32_16x16x32_bf16 v[236:239], a[112:115], v[92:95], v[236:239]
    buffer_load_dwordx4 a[108:111], v16, s[12:15], s28 offen offset:1024 sc1
    v_mul_f32 v21, v21, v229
    v_mul_f32 v22, v22, v230
    v_mul_f32 v23, v23, v231
    v_mfma_f32_16x16x32_bf16 v[240:243], a[112:115], v[96:99], v[240:243]
    v_cvt_pk_bf16_f32 v40, v20, v21
    v_cvt_pk_bf16_f32 v41, v22, v23
    ds_write_b64 v12, v[40:41] offset:2048
    v_mfma_f32_16x16x32_bf16 v[244:247], a[112:115], v[100:103], v[244:247]
    v_mul_f32 v24, v232, v232
    v_mul_f32 v25, v233, v233
    v_mul_f32 v26, v234, v234
    v_mul_f32 v27, v235, v235
    v_fma_f32 v24, v24, v38, v37
    v_mfma_f32_16x16x32_bf16 v[248:251], a[112:115], v[104:107], v[248:251]
    v_fma_f32 v25, v25, v38, v37
    v_fma_f32 v26, v26, v38, v37
    v_fma_f32 v27, v27, v38, v37
    s_waitcnt vmcnt(35)
    v_mfma_f32_16x16x32_bf16 v[236:239], a[116:119], v[108:111], v[236:239]
    buffer_load_dwordx4 a[112:115], v16, s[12:15], s28 offen offset:2048 sc1
    v_mul_f32 v24, v24, v232
    v_mul_f32 v25, v25, v233
    v_mul_f32 v26, v26, v234
    v_mfma_f32_16x16x32_bf16 v[240:243], a[116:119], v[112:115], v[240:243]
    v_mul_f32 v27, v27, v235
    v_exp_f32 v24, v24
    v_exp_f32 v25, v25
    v_mfma_f32_16x16x32_bf16 v[244:247], a[116:119], v[116:119], v[244:247]
    v_exp_f32 v26, v26
    v_exp_f32 v27, v27
    v_mfma_f32_16x16x32_bf16 v[248:251], a[116:119], v[120:123], v[248:251]
    v_fma_f32 v24, v24, v39, v39
    v_fma_f32 v25, v25, v39, v39
    v_fma_f32 v26, v26, v39, v39
    v_fma_f32 v27, v27, v39, v39
    v_mfma_f32_16x16x32_bf16 v[236:239], a[128:131], v[156:159], v[236:239]
    buffer_load_dwordx4 a[116:119], v16, s[12:15], s28 offen offset:3072 sc1
    v_rcp_f32 v24, v24
    v_rcp_f32 v25, v25
    v_mfma_f32_16x16x32_bf16 v[240:243], a[128:131], v[160:163], v[240:243]
    v_rcp_f32 v26, v26
    v_rcp_f32 v27, v27
    v_mfma_f32_16x16x32_bf16 v[244:247], a[128:131], v[164:167], v[244:247]
    v_mul_f32 v24, v24, v232
    v_mul_f32 v25, v25, v233
    v_mul_f32 v26, v26, v234
    v_mul_f32 v27, v27, v235
    v_cvt_pk_bf16_f32 v42, v24, v25
    v_mfma_f32_16x16x32_bf16 v[248:251], a[128:131], v[168:171], v[248:251]
    v_cvt_pk_bf16_f32 v43, v26, v27
    ds_write_b64 v12, v[42:43] offset:3072
    s_waitcnt lgkmcnt(0)
    s_barrier
    ds_read_b128 a[208:211], v10 offset:16384
    ds_read_b128 a[212:215], v10 offset:17408
    ds_read_b128 a[216:219], v10 offset:18432
    ds_read_b128 a[220:223], v10 offset:19456
    ds_read_b128 v[60:63], v10 offset:32768
    ds_read_b128 v[64:67], v10 offset:33792
    ds_read_b128 v[68:71], v10 offset:34816
    ds_read_b128 v[72:75], v10 offset:35840
    ds_read_b128 v[140:143], v11 offset:16384
    ds_read_b128 v[144:147], v11 offset:17408
    ds_read_b128 v[148:151], v11 offset:18432
    ds_read_b128 v[152:155], v11 offset:19456
    ds_read_b128 v[204:207], v11 offset:32768
    ds_read_b128 v[208:211], v11 offset:33792
    ds_read_b128 v[212:215], v11 offset:34816
    ds_read_b128 v[216:219], v11 offset:35840
    s_waitcnt vmcnt(34)
    v_mfma_f32_16x16x32_bf16 v[236:239], a[132:135], v[172:175], v[236:239]
    buffer_load_dwordx4 a[128:131], v17, s[12:15], s28 offen offset:2048 sc1
    v_mfma_f32_16x16x32_bf16 v[240:243], a[132:135], v[176:179], v[240:243]
    v_mfma_f32_16x16x32_bf16 v[244:247], a[132:135], v[180:183], v[244:247]
    v_mfma_f32_16x16x32_bf16 v[248:251], a[132:135], v[184:187], v[248:251]
    v_mfma_f32_16x16x32_bf16 v[236:239], a[136:139], v[188:191], v[236:239]
    buffer_load_dwordx4 a[132:135], v17, s[12:15], s28 offen offset:3072 sc1
    v_mfma_f32_16x16x32_bf16 v[240:243], a[136:139], v[192:195], v[240:243]
    v_mfma_f32_16x16x32_bf16 v[244:247], a[136:139], v[196:199], v[244:247]
    v_mfma_f32_16x16x32_bf16 v[248:251], a[136:139], v[200:203], v[248:251]
    s_waitcnt vmcnt(34)
    v_mfma_f32_16x16x32_bf16 v[236:239], a[84:87], a[192:195], v[236:239]
    buffer_load_dwordx4 a[136:139], v18, s[12:15], s28 offen offset:0 sc1
    v_mfma_f32_16x16x32_bf16 v[240:243], a[84:87], a[196:199], v[240:243]
    v_mfma_f32_16x16x32_bf16 v[244:247], a[84:87], a[200:203], v[244:247]
    v_mfma_f32_16x16x32_bf16 v[248:251], a[84:87], a[204:207], v[248:251]
    v_mfma_f32_16x16x32_bf16 v[236:239], a[120:123], v[124:127], v[236:239]
    buffer_load_dwordx4 a[84:87], v4, s[12:15], s28 offen offset:3072 sc1
    v_mfma_f32_16x16x32_bf16 v[240:243], a[120:123], v[128:131], v[240:243]
    v_mfma_f32_16x16x32_bf16 v[244:247], a[120:123], v[132:135], v[244:247]
    v_mfma_f32_16x16x32_bf16 v[248:251], a[120:123], v[136:139], v[248:251]
    s_waitcnt lgkmcnt(12)
    s_waitcnt vmcnt(33)
    v_mfma_f32_16x16x32_bf16 v[236:239], a[88:91], a[208:211], v[236:239]
    buffer_load_dwordx4 a[120:123], v17, s[12:15], s28 offen offset:0 sc1
    v_mfma_f32_16x16x32_bf16 v[240:243], a[88:91], a[212:215], v[240:243]
    v_mfma_f32_16x16x32_bf16 v[244:247], a[88:91], a[216:219], v[244:247]
    v_mfma_f32_16x16x32_bf16 v[248:251], a[88:91], a[220:223], v[248:251]
    s_waitcnt lgkmcnt(8)
    v_mfma_f32_16x16x32_bf16 v[236:239], a[104:107], v[60:63], v[236:239]
    buffer_load_dwordx4 a[88:91], v7, s[12:15], s28 offen offset:0 sc1
    v_mfma_f32_16x16x32_bf16 v[240:243], a[104:107], v[64:67], v[240:243]
    v_mfma_f32_16x16x32_bf16 v[244:247], a[104:107], v[68:71], v[244:247]
    v_mfma_f32_16x16x32_bf16 v[248:251], a[104:107], v[72:75], v[248:251]
    s_waitcnt lgkmcnt(4)
    s_waitcnt vmcnt(33)
    v_mfma_f32_16x16x32_bf16 v[236:239], a[124:127], v[140:143], v[236:239]
    buffer_load_dwordx4 a[104:107], v16, s[12:15], s28 offen offset:0 sc1
    v_mfma_f32_16x16x32_bf16 v[240:243], a[124:127], v[144:147], v[240:243]
    v_mfma_f32_16x16x32_bf16 v[244:247], a[124:127], v[148:151], v[244:247]
    v_mfma_f32_16x16x32_bf16 v[248:251], a[124:127], v[152:155], v[248:251]
    s_waitcnt lgkmcnt(0)
    v_mfma_f32_16x16x32_bf16 v[236:239], a[140:143], v[204:207], v[236:239]
    buffer_load_dwordx4 a[124:127], v17, s[12:15], s28 offen offset:1024 sc1
    v_mfma_f32_16x16x32_bf16 v[240:243], a[140:143], v[208:211], v[240:243]
    v_mfma_f32_16x16x32_bf16 v[244:247], a[140:143], v[212:215], v[244:247]
    v_mfma_f32_16x16x32_bf16 v[248:251], a[140:143], v[216:219], v[248:251]
    buffer_load_dwordx4 a[140:143], v18, s[12:15], s28 offen offset:1024 sc1
    s_mul_i32 s44, s18, 589824
    s_lshl_b32 s20, s3, 14
    s_add_u32 s44, s44, s20
    s_lshl_b32 s20, s19, 10
    s_add_u32 s44, s44, s20
    s_add_u32 s44, s44, 33554432
    s_mov_b32 s48, s39
    v_add_u32 v31, s39, v4
    s_mov_b32 s56, s44
    s_add_u32 s28, s28, 18432
    s_waitcnt vmcnt(34)
    v_mfma_f32_16x16x32_bf16 v[220:223], a[0:3], a[144:147], 0
    v_mfma_f32_16x16x32_bf16 v[224:227], a[0:3], a[148:151], 0
    v_cvt_pk_bf16_f32 v20, v236, v237
    v_cvt_pk_bf16_f32 v21, v238, v239
    v_cvt_pk_bf16_f32 v22, v240, v241
    v_mfma_f32_16x16x32_bf16 v[228:231], a[0:3], a[152:155], 0
    v_cvt_pk_bf16_f32 v23, v242, v243
    buffer_store_dwordx4 v[20:23], v4, s[4:7], s44 offen sc1
    v_mfma_f32_16x16x32_bf16 v[232:235], a[0:3], a[156:159], 0
    s_add_u32 s44, s44, 65536
    v_mfma_f32_16x16x32_bf16 v[220:223], a[4:7], a[160:163], v[220:223]
    buffer_load_dwordx4 a[0:3], v4, s[12:15], s28 offen offset:0 sc1
    v_mfma_f32_16x16x32_bf16 v[224:227], a[4:7], a[164:167], v[224:227]
    v_mfma_f32_16x16x32_bf16 v[228:231], a[4:7], a[168:171], v[228:231]
    v_mfma_f32_16x16x32_bf16 v[232:235], a[4:7], a[172:175], v[232:235]
    s_waitcnt vmcnt(34)
    v_mfma_f32_16x16x32_bf16 v[220:223], a[8:11], a[176:179], v[220:223]
    buffer_load_dwordx4 a[4:7], v4, s[12:15], s28 offen offset:1024 sc1
    s_mov_b32 s40, s32
    v_mfma_f32_16x16x32_bf16 v[224:227], a[8:11], a[180:183], v[224:227]
    s_mov_b32 s41, s33
    s_mov_b32 s42, 2359296
    v_mfma_f32_16x16x32_bf16 v[228:231], a[8:11], a[184:187], v[228:231]
    s_mov_b32 s43, 0x20000
    s_lshl_b32 s20, s19, 13
    v_mfma_f32_16x16x32_bf16 v[232:235], a[8:11], a[188:191], v[232:235]
    s_mul_i32 s45, s18, 589824
    s_add_u32 s45, s45, s20
    v_mfma_f32_16x16x32_bf16 v[220:223], a[20:23], a[224:227], v[220:223]
    buffer_load_dwordx4 a[8:11], v4, s[12:15], s28 offen offset:2048 sc1
    s_add_u32 s45, s45, 33554432
    v_mfma_f32_16x16x32_bf16 v[224:227], a[20:23], a[228:231], v[224:227]
    s_mul_i32 s46, s18, 36
    s_lshr_b32 s47, s19, 1
    v_mfma_f32_16x16x32_bf16 v[228:231], a[20:23], a[232:235], v[228:231]
    s_add_u32 s20, s46, s47
    s_lshl_b32 s20, s20, 7
    v_mfma_f32_16x16x32_bf16 v[232:235], a[20:23], a[236:239], v[232:235]
    v_mov_b32 v14, s20
    s_waitcnt vmcnt(34)
    v_mfma_f32_16x16x32_bf16 v[220:223], a[24:27], a[240:243], v[220:223]
    buffer_load_dwordx4 a[20:23], v7, s[12:15], s28 offen offset:1024 sc1
    s_add_u32 s46, s46, s3
    v_mfma_f32_16x16x32_bf16 v[224:227], a[24:27], a[244:247], v[224:227]
    s_lshl_b32 s46, s46, 7
    s_add_u32 s46, s46, 40960
    v_mfma_f32_16x16x32_bf16 v[228:231], a[24:27], a[248:251], v[228:231]
    s_mul_i32 s47, s47, 9
    s_lshl_b32 s20, s3, 8
    v_mfma_f32_16x16x32_bf16 v[232:235], a[24:27], a[252:255], v[232:235]
    v_lshl_add_u32 v40, v3, 4, s20
    v_lshl_add_u32 v28, v2, 10, v40
    v_mfma_f32_16x16x32_bf16 v[220:223], a[28:31], v[44:47], v[220:223]
    buffer_load_dwordx4 a[24:27], v7, s[12:15], s28 offen offset:2048 sc1
    v_and_b32 v41, 1, v2
    v_mfma_f32_16x16x32_bf16 v[224:227], a[28:31], v[48:51], v[224:227]
    v_lshrrev_b32 v42, 1, v2
    v_lshl_add_u32 v40, v42, 4, v3
    v_mfma_f32_16x16x32_bf16 v[228:231], a[28:31], v[52:55], v[228:231]
    v_lshlrev_b32 v29, 3, v40
    v_lshl_add_u32 v29, v41, 2, v29
    v_mfma_f32_16x16x32_bf16 v[232:235], a[28:31], v[56:59], v[232:235]
    s_and_b32 s31, s19, 1
    s_waitcnt vmcnt(34)
    v_mfma_f32_16x16x32_bf16 v[220:223], a[36:39], v[76:79], v[220:223]
    buffer_load_dwordx4 a[28:31], v7, s[12:15], s28 offen offset:3072 sc1
    s_lshl_b32 s20, s18, 1
    v_mfma_f32_16x16x32_bf16 v[224:227], a[36:39], v[80:83], v[224:227]
    s_add_u32 s31, s31, s20
    s_lshl_b32 s31, s31, 8
    v_mfma_f32_16x16x32_bf16 v[228:231], a[36:39], v[84:87], v[228:231]
    s_lshl_b32 s20, s3, 14
    s_add_u32 s31, s31, s20
    v_mfma_f32_16x16x32_bf16 v[232:235], a[36:39], v[88:91], v[232:235]
    v_add_u32 v29, s31, v29
    s_mul_i32 s49, s3, 2304
    v_mfma_f32_16x16x32_bf16 v[220:223], a[40:43], v[92:95], v[220:223]
    buffer_load_dwordx4 a[36:39], v16, s[12:15], s28 offen offset:1024 sc1
    s_add_u32 s49, s49, 73728
    v_mfma_f32_16x16x32_bf16 v[224:227], a[40:43], v[96:99], v[224:227]
    v_lshl_add_u32 v32, v1, 2, s49
    s_mul_i32 s20, s3, 1040
    v_mfma_f32_16x16x32_bf16 v[228:231], a[40:43], v[100:103], v[228:231]
    s_add_u32 s20, s20, 82944
    v_lshl_add_u32 v33, v41, 3, s20
    v_mfma_f32_16x16x32_bf16 v[232:235], a[40:43], v[104:107], v[232:235]
    v_mul_u32_u24 v34, 304, v40
    s_waitcnt vmcnt(34)
    v_mfma_f32_16x16x32_bf16 v[220:223], a[44:47], v[108:111], v[220:223]
    buffer_load_dwordx4 a[40:43], v16, s[12:15], s28 offen offset:2048 sc1
    v_lshl_add_u32 v34, v41, 2, v34
    v_mfma_f32_16x16x32_bf16 v[224:227], a[44:47], v[112:115], v[224:227]
    s_lshl_b32 s20, s3, 3
    s_add_u32 s20, s20, 87040
    v_mfma_f32_16x16x32_bf16 v[228:231], a[44:47], v[116:119], v[228:231]
    v_add_u32 v34, s20, v34
    s_and_b32 s20, s19, 3
    v_mfma_f32_16x16x32_bf16 v[232:235], a[44:47], v[120:123], v[232:235]
    s_lshl_b32 s31, s20, 4
    s_lshl_b64 s[50:51], 0xffff, s31
    v_mfma_f32_16x16x32_bf16 v[220:223], a[56:59], v[156:159], v[220:223]
    buffer_load_dwordx4 a[44:47], v16, s[12:15], s28 offen offset:3072 sc1
    s_not_b64 s[50:51], s[50:51]
    v_mfma_f32_16x16x32_bf16 v[224:227], a[56:59], v[160:163], v[224:227]
    s_cmp_ge_u32 s19, 4
    s_cselect_b64 s[52:53], s[50:51], -1
    v_mfma_f32_16x16x32_bf16 v[228:231], a[56:59], v[164:167], v[228:231]
    s_cselect_b64 s[50:51], -1, s[50:51]
    s_lshl_b32 s20, s19, 8
    v_mfma_f32_16x16x32_bf16 v[232:235], a[56:59], v[168:171], v[232:235]
    v_mul_u32_u24 v40, 18432, v2
    s_waitcnt vmcnt(34)
    v_mfma_f32_16x16x32_bf16 v[220:223], a[60:63], v[172:175], v[220:223]
    buffer_load_dwordx4 a[56:59], v17, s[12:15], s28 offen offset:2048 sc1
    v_lshl_add_u32 v40, v3, 4, v40
    v_mfma_f32_16x16x32_bf16 v[224:227], a[60:63], v[176:179], v[224:227]
    v_add_u32 v40, s20, v40
    v_add_u32 v41, 98304, v4
    v_mfma_f32_16x16x32_bf16 v[228:231], a[60:63], v[180:183], v[228:231]
    s_lshl_b32 s20, s3, 1
    s_cmp_eq_u32 s20, s19
    v_mfma_f32_16x16x32_bf16 v[232:235], a[60:63], v[184:187], v[232:235]
    s_cselect_b64 vcc, -1, 0
    s_cselect_b32 s54, 1, 0
    v_mfma_f32_16x16x32_bf16 v[220:223], a[64:67], v[188:191], v[220:223]
    buffer_load_dwordx4 a[60:63], v17, s[12:15], s28 offen offset:3072 sc1
    v_cndmask_b32 v12, v41, v40, vcc
    v_mfma_f32_16x16x32_bf16 v[224:227], a[64:67], v[192:195], v[224:227]
    s_add_u32 s20, s20, 1
    s_cmp_eq_u32 s20, s19
    v_mfma_f32_16x16x32_bf16 v[228:231], a[64:67], v[196:199], v[228:231]
    s_cselect_b64 vcc, -1, 0
    s_cselect_b32 s55, 1, 0
    v_mfma_f32_16x16x32_bf16 v[232:235], a[64:67], v[200:203], v[232:235]
    v_cndmask_b32 v13, v41, v40, vcc
    s_waitcnt vmcnt(34)
    v_mfma_f32_16x16x32_bf16 v[220:223], a[12:15], a[192:195], v[220:223]
    buffer_load_dwordx4 a[64:67], v18, s[12:15], s28 offen offset:0 sc1
    v_cvt_pk_bf16_f32 v24, v244, v245
    v_mfma_f32_16x16x32_bf16 v[224:227], a[12:15], a[196:199], v[224:227]
    v_cvt_pk_bf16_f32 v25, v246, v247
    v_cvt_pk_bf16_f32 v26, v248, v249
    v_mfma_f32_16x16x32_bf16 v[228:231], a[12:15], a[200:203], v[228:231]
    v_cvt_pk_bf16_f32 v27, v250, v251
    buffer_store_dwordx4 v[24:27], v16, s[4:7], s56 offen sc1
    v_mfma_f32_16x16x32_bf16 v[232:235], a[12:15], a[204:207], v[232:235]
    s_add_u32 s56, s56, 65536
    v_mfma_f32_16x16x32_bf16 v[220:223], a[48:51], v[124:127], v[220:223]
    buffer_load_dwordx4 a[12:15], v4, s[12:15], s28 offen offset:3072 sc1
    v_mfma_f32_16x16x32_bf16 v[224:227], a[48:51], v[128:131], v[224:227]
    v_mfma_f32_16x16x32_bf16 v[228:231], a[48:51], v[132:135], v[228:231]
    v_mfma_f32_16x16x32_bf16 v[232:235], a[48:51], v[136:139], v[232:235]
    s_waitcnt vmcnt(35)
    v_mfma_f32_16x16x32_bf16 v[220:223], a[16:19], a[208:211], v[220:223]
    buffer_load_dwordx4 a[48:51], v17, s[12:15], s28 offen offset:0 sc1
    v_mfma_f32_16x16x32_bf16 v[224:227], a[16:19], a[212:215], v[224:227]
    v_mfma_f32_16x16x32_bf16 v[228:231], a[16:19], a[216:219], v[228:231]
    v_mfma_f32_16x16x32_bf16 v[232:235], a[16:19], a[220:223], v[232:235]
    v_mfma_f32_16x16x32_bf16 v[220:223], a[32:35], v[60:63], v[220:223]
    buffer_load_dwordx4 a[16:19], v7, s[12:15], s28 offen offset:0 sc1
    v_mfma_f32_16x16x32_bf16 v[224:227], a[32:35], v[64:67], v[224:227]
    v_mfma_f32_16x16x32_bf16 v[228:231], a[32:35], v[68:71], v[228:231]
    v_mfma_f32_16x16x32_bf16 v[232:235], a[32:35], v[72:75], v[232:235]
    s_waitcnt vmcnt(35)
    v_mfma_f32_16x16x32_bf16 v[220:223], a[52:55], v[140:143], v[220:223]
    buffer_load_dwordx4 a[32:35], v16, s[12:15], s28 offen offset:0 sc1
    v_mfma_f32_16x16x32_bf16 v[224:227], a[52:55], v[144:147], v[224:227]
    v_mfma_f32_16x16x32_bf16 v[228:231], a[52:55], v[148:151], v[228:231]
    v_mfma_f32_16x16x32_bf16 v[232:235], a[52:55], v[152:155], v[232:235]
    v_mfma_f32_16x16x32_bf16 v[220:223], a[68:71], v[204:207], v[220:223]
    buffer_load_dwordx4 a[52:55], v17, s[12:15], s28 offen offset:1024 sc1
    v_mfma_f32_16x16x32_bf16 v[224:227], a[68:71], v[208:211], v[224:227]
    v_mfma_f32_16x16x32_bf16 v[228:231], a[68:71], v[212:215], v[228:231]
    v_mfma_f32_16x16x32_bf16 v[232:235], a[68:71], v[216:219], v[232:235]
    buffer_load_dwordx4 a[68:71], v18, s[12:15], s28 offen offset:1024 sc1
    s_add_u32 s28, s28, 18432
    s_barrier
    s_waitcnt vmcnt(36)
    v_mfma_f32_16x16x32_bf16 v[236:239], a[72:75], a[144:147], 0
    v_mfma_f32_16x16x32_bf16 v[240:243], a[72:75], a[148:151], 0
    v_cvt_pk_bf16_f32 v20, v220, v221
    v_cvt_pk_bf16_f32 v21, v222, v223
    v_cvt_pk_bf16_f32 v22, v224, v225
    v_mfma_f32_16x16x32_bf16 v[244:247], a[72:75], a[152:155], 0
    v_cvt_pk_bf16_f32 v23, v226, v227
    buffer_store_dwordx4 v[20:23], v4, s[4:7], s44 offen sc1
    v_mfma_f32_16x16x32_bf16 v[248:251], a[72:75], a[156:159], 0
    s_add_u32 s44, s44, 65536
    v_mfma_f32_16x16x32_bf16 v[236:239], a[76:79], a[160:163], v[236:239]
    ds_read_b128 a[72:75], v31 offset:0
    v_mfma_f32_16x16x32_bf16 v[240:243], a[76:79], a[164:167], v[240:243]
    v_mfma_f32_16x16x32_bf16 v[244:247], a[76:79], a[168:171], v[244:247]
    v_mfma_f32_16x16x32_bf16 v[248:251], a[76:79], a[172:175], v[248:251]
    s_waitcnt vmcnt(35)
    v_mfma_f32_16x16x32_bf16 v[236:239], a[80:83], a[176:179], v[236:239]
    ds_read_b128 a[76:79], v31 offset:1024
    s_lshl_b32 s20, s47, 6
    v_mfma_f32_16x16x32_bf16 v[240:243], a[80:83], a[180:183], v[240:243]
    s_add_u32 s20, s20, 290048
    s_lshl_b32 s31, s3, 10
    v_mfma_f32_16x16x32_bf16 v[244:247], a[80:83], a[184:187], v[244:247]
    s_add_u32 m0, s31, 82944
    s_nop 0
    buffer_load_dwordx4 v4, s[4:7], s20 offen sc1 lds
    v_mfma_f32_16x16x32_bf16 v[248:251], a[80:83], a[188:191], v[248:251]
    v_mfma_f32_16x16x32_bf16 v[236:239], a[92:95], a[224:227], v[236:239]
    ds_read_b128 a[80:83], v31 offset:2048
    v_mfma_f32_16x16x32_bf16 v[240:243], a[92:95], a[228:231], v[240:243]
    v_mfma_f32_16x16x32_bf16 v[244:247], a[92:95], a[232:235], v[244:247]
    v_mfma_f32_16x16x32_bf16 v[248:251], a[92:95], a[236:239], v[248:251]
    s_waitcnt vmcnt(34)
    v_mfma_f32_16x16x32_bf16 v[236:239], a[96:99], a[240:243], v[236:239]
    ds_read_b128 a[92:95], v31 offset:5120
    s_add_u32 s20, s47, 0
    v_mfma_f32_16x16x32_bf16 v[240:243], a[96:99], a[244:247], v[240:243]
    s_lshl_b32 s20, s20, 16
    s_add_u32 s20, s20, 52428800
    v_mfma_f32_16x16x32_bf16 v[244:247], a[96:99], a[248:251], v[244:247]
    s_add_u32 m0, s49, 0
    s_nop 0
    buffer_load_dword v29, s[4:7], s20 offen sc1 lds
    v_mfma_f32_16x16x32_bf16 v[248:251], a[96:99], a[252:255], v[248:251]
    s_add_u32 s20, s47, 1
    s_lshl_b32 s20, s20, 16
    v_mfma_f32_16x16x32_bf16 v[236:239], a[100:103], v[44:47], v[236:239]
    ds_read_b128 a[96:99], v31 offset:6144
    s_add_u32 s20, s20, 52428800
    v_mfma_f32_16x16x32_bf16 v[240:243], a[100:103], v[48:51], v[240:243]
    s_add_u32 m0, s49, 256
    s_nop 0
    buffer_load_dword v29, s[4:7], s20 offen sc1 lds
    v_mfma_f32_16x16x32_bf16 v[244:247], a[100:103], v[52:55], v[244:247]
    v_mfma_f32_16x16x32_bf16 v[248:251], a[100:103], v[56:59], v[248:251]
    s_waitcnt vmcnt(34)
    v_mfma_f32_16x16x32_bf16 v[236:239], a[108:111], v[76:79], v[236:239]
    ds_read_b128 a[100:103], v31 offset:7168
    v_mfma_f32_16x16x32_bf16 v[240:243], a[108:111], v[80:83], v[240:243]
    s_waitcnt vmcnt(10)
    s_mov_b64 exec, 1
    buffer_atomic_add v5, v6, s[4:7], s46 offen offset:0 sc1
    s_mov_b64 exec, -1
    v_mfma_f32_16x16x32_bf16 v[244:247], a[108:111], v[84:87], v[244:247]
    v_mfma_f32_16x16x32_bf16 v[248:251], a[108:111], v[88:91], v[248:251]
    v_mfma_f32_16x16x32_bf16 v[236:239], a[112:115], v[92:95], v[236:239]
    ds_read_b128 a[108:111], v31 offset:9216
    v_mfma_f32_16x16x32_bf16 v[240:243], a[112:115], v[96:99], v[240:243]
    v_mfma_f32_16x16x32_bf16 v[244:247], a[112:115], v[100:103], v[244:247]
    v_mfma_f32_16x16x32_bf16 v[248:251], a[112:115], v[104:107], v[248:251]
    v_mfma_f32_16x16x32_bf16 v[236:239], a[116:119], v[108:111], v[236:239]
    ds_read_b128 a[112:115], v31 offset:10240
    v_mfma_f32_16x16x32_bf16 v[240:243], a[116:119], v[112:115], v[240:243]
    v_mfma_f32_16x16x32_bf16 v[244:247], a[116:119], v[116:119], v[244:247]
    v_mfma_f32_16x16x32_bf16 v[248:251], a[116:119], v[120:123], v[248:251]
    v_mfma_f32_16x16x32_bf16 v[236:239], a[128:131], v[156:159], v[236:239]
    ds_read_b128 a[116:119], v31 offset:11264
    v_cvt_pk_bf16_f32 v24, v228, v229
    v_cvt_pk_bf16_f32 v25, v230, v231
    v_mfma_f32_16x16x32_bf16 v[240:243], a[128:131], v[160:163], v[240:243]
    v_cvt_pk_bf16_f32 v26, v232, v233
    v_cvt_pk_bf16_f32 v27, v234, v235
    v_mfma_f32_16x16x32_bf16 v[244:247], a[128:131], v[164:167], v[244:247]
    buffer_store_dwordx4 v[24:27], v16, s[4:7], s56 offen sc1
    s_add_u32 s56, s56, 65536
    v_mfma_f32_16x16x32_bf16 v[248:251], a[128:131], v[168:171], v[248:251]
    v_mfma_f32_16x16x32_bf16 v[236:239], a[132:135], v[172:175], v[236:239]
    ds_read_b128 a[128:131], v31 offset:14336
    v_mfma_f32_16x16x32_bf16 v[240:243], a[132:135], v[176:179], v[240:243]
    v_mfma_f32_16x16x32_bf16 v[244:247], a[132:135], v[180:183], v[244:247]
    v_mfma_f32_16x16x32_bf16 v[248:251], a[132:135], v[184:187], v[248:251]
    v_mfma_f32_16x16x32_bf16 v[236:239], a[136:139], v[188:191], v[236:239]
    ds_read_b128 a[132:135], v31 offset:15360
    v_mfma_f32_16x16x32_bf16 v[240:243], a[136:139], v[192:195], v[240:243]
    v_mfma_f32_16x16x32_bf16 v[244:247], a[136:139], v[196:199], v[244:247]
    v_mfma_f32_16x16x32_bf16 v[248:251], a[136:139], v[200:203], v[248:251]
    v_mfma_f32_16x16x32_bf16 v[236:239], a[84:87], a[192:195], v[236:239]
    ds_read_b128 a[136:139], v31 offset:16384
    v_mfma_f32_16x16x32_bf16 v[240:243], a[84:87], a[196:199], v[240:243]
    v_mfma_f32_16x16x32_bf16 v[244:247], a[84:87], a[200:203], v[244:247]
    v_mfma_f32_16x16x32_bf16 v[248:251], a[84:87], a[204:207], v[248:251]
    v_mfma_f32_16x16x32_bf16 v[236:239], a[120:123], v[124:127], v[236:239]
    ds_read_b128 a[84:87], v31 offset:3072
    v_mfma_f32_16x16x32_bf16 v[240:243], a[120:123], v[128:131], v[240:243]
    v_mfma_f32_16x16x32_bf16 v[244:247], a[120:123], v[132:135], v[244:247]
    v_mfma_f32_16x16x32_bf16 v[248:251], a[120:123], v[136:139], v[248:251]
    v_mfma_f32_16x16x32_bf16 v[236:239], a[88:91], a[208:211], v[236:239]
    ds_read_b128 a[120:123], v31 offset:12288
    v_mfma_f32_16x16x32_bf16 v[240:243], a[88:91], a[212:215], v[240:243]
    v_mfma_f32_16x16x32_bf16 v[244:247], a[88:91], a[216:219], v[244:247]
    v_mfma_f32_16x16x32_bf16 v[248:251], a[88:91], a[220:223], v[248:251]
    v_mfma_f32_16x16x32_bf16 v[236:239], a[104:107], v[60:63], v[236:239]
    ds_read_b128 a[88:91], v31 offset:4096
    v_mfma_f32_16x16x32_bf16 v[240:243], a[104:107], v[64:67], v[240:243]
    v_mfma_f32_16x16x32_bf16 v[244:247], a[104:107], v[68:71], v[244:247]
    v_mfma_f32_16x16x32_bf16 v[248:251], a[104:107], v[72:75], v[248:251]
    v_mfma_f32_16x16x32_bf16 v[236:239], a[124:127], v[140:143], v[236:239]
    ds_read_b128 a[104:107], v31 offset:8192
    v_mfma_f32_16x16x32_bf16 v[240:243], a[124:127], v[144:147], v[240:243]
    v_mfma_f32_16x16x32_bf16 v[244:247], a[124:127], v[148:151], v[244:247]
    v_mfma_f32_16x16x32_bf16 v[248:251], a[124:127], v[152:155], v[248:251]
    v_mfma_f32_16x16x32_bf16 v[236:239], a[140:143], v[204:207], v[236:239]
    ds_read_b128 a[124:127], v31 offset:13312
    v_mfma_f32_16x16x32_bf16 v[240:243], a[140:143], v[208:211], v[240:243]
    v_mfma_f32_16x16x32_bf16 v[244:247], a[140:143], v[212:215], v[244:247]
    v_mfma_f32_16x16x32_bf16 v[248:251], a[140:143], v[216:219], v[248:251]
    ds_read_b128 a[140:143], v31 offset:17408
    s_waitcnt lgkmcnt(0)
    s_barrier
    s_add_u32 s28, s28, 18432
    v_mfma_f32_16x16x32_bf16 v[220:223], a[0:3], a[144:147], 0
    v_mfma_f32_16x16x32_bf16 v[224:227], a[0:3], a[148:151], 0
    v_cvt_pk_bf16_f32 v20, v236, v237
    v_cvt_pk_bf16_f32 v21, v238, v239
    v_cvt_pk_bf16_f32 v22, v240, v241
    v_cvt_pk_bf16_f32 v23, v242, v243
    v_mfma_f32_16x16x32_bf16 v[228:231], a[0:3], a[152:155], 0
    s_cmp_lg_u32 s54, 0
    s_cselect_b32 s44, 67108864, s44
    v_mfma_f32_16x16x32_bf16 v[232:235], a[0:3], a[156:159], 0
    buffer_store_dwordx4 v[20:23], v4, s[4:7], s44 offen sc1
    ds_write_b128 v12, v[20:23] offset:4096
    v_mfma_f32_16x16x32_bf16 v[220:223], a[4:7], a[160:163], v[220:223]
    buffer_load_dwordx4 a[0:3], v4, s[12:15], s28 offen offset:0 sc1
    v_mfma_f32_16x16x32_bf16 v[224:227], a[4:7], a[164:167], v[224:227]
    s_add_u32 s44, s44, 65536
    v_mfma_f32_16x16x32_bf16 v[228:231], a[4:7], a[168:171], v[228:231]
    v_mfma_f32_16x16x32_bf16 v[232:235], a[4:7], a[172:175], v[232:235]
    v_mfma_f32_16x16x32_bf16 v[220:223], a[8:11], a[176:179], v[220:223]
    buffer_load_dwordx4 a[4:7], v4, s[12:15], s28 offen offset:1024 sc1
    v_mfma_f32_16x16x32_bf16 v[224:227], a[8:11], a[180:183], v[224:227]
    v_mfma_f32_16x16x32_bf16 v[228:231], a[8:11], a[184:187], v[228:231]
    v_mfma_f32_16x16x32_bf16 v[232:235], a[8:11], a[188:191], v[232:235]
    v_mfma_f32_16x16x32_bf16 v[220:223], a[20:23], a[224:227], v[220:223]
    buffer_load_dwordx4 a[8:11], v4, s[12:15], s28 offen offset:2048 sc1
    v_mfma_f32_16x16x32_bf16 v[224:227], a[20:23], a[228:231], v[224:227]
    v_mfma_f32_16x16x32_bf16 v[228:231], a[20:23], a[232:235], v[228:231]
    v_mfma_f32_16x16x32_bf16 v[232:235], a[20:23], a[236:239], v[232:235]
    v_mfma_f32_16x16x32_bf16 v[220:223], a[24:27], a[240:243], v[220:223]
    buffer_load_dwordx4 a[20:23], v7, s[12:15], s28 offen offset:1024 sc1
    s_add_u32 s20, s47, 2
    s_lshl_b32 s20, s20, 16
    v_mfma_f32_16x16x32_bf16 v[224:227], a[24:27], a[244:247], v[224:227]
    s_add_u32 s20, s20, 52428800
    s_add_u32 m0, s49, 512
    v_mfma_f32_16x16x32_bf16 v[228:231], a[24:27], a[248:251], v[228:231]
    buffer_load_dword v29, s[4:7], s20 offen sc1 lds
    s_add_u32 s20, s47, 3
    v_mfma_f32_16x16x32_bf16 v[232:235], a[24:27], a[252:255], v[232:235]
    s_lshl_b32 s20, s20, 16
    s_add_u32 s20, s20, 52428800
    v_mfma_f32_16x16x32_bf16 v[220:223], a[28:31], v[44:47], v[220:223]
    buffer_load_dwordx4 a[24:27], v7, s[12:15], s28 offen offset:2048 sc1
    s_add_u32 m0, s49, 768
    v_mfma_f32_16x16x32_bf16 v[224:227], a[28:31], v[48:51], v[224:227]
    buffer_load_dword v29, s[4:7], s20 offen sc1 lds
    v_mfma_f32_16x16x32_bf16 v[228:231], a[28:31], v[52:55], v[228:231]
    v_mfma_f32_16x16x32_bf16 v[232:235], a[28:31], v[56:59], v[232:235]
    v_mfma_f32_16x16x32_bf16 v[220:223], a[36:39], v[76:79], v[220:223]
    buffer_load_dwordx4 a[28:31], v7, s[12:15], s28 offen offset:3072 sc1
    s_waitcnt vmcnt(9)
    s_mov_b64 exec, 1
    buffer_atomic_add v5, v6, s[4:7], s46 offen offset:512 sc1
    s_mov_b64 exec, -1
    v_mfma_f32_16x16x32_bf16 v[224:227], a[36:39], v[80:83], v[224:227]
    v_mfma_f32_16x16x32_bf16 v[228:231], a[36:39], v[84:87], v[228:231]
    v_mfma_f32_16x16x32_bf16 v[232:235], a[36:39], v[88:91], v[232:235]
    v_mfma_f32_16x16x32_bf16 v[220:223], a[40:43], v[92:95], v[220:223]
    buffer_load_dwordx4 a[36:39], v16, s[12:15], s28 offen offset:1024 sc1
    v_mfma_f32_16x16x32_bf16 v[224:227], a[40:43], v[96:99], v[224:227]
    v_mfma_f32_16x16x32_bf16 v[228:231], a[40:43], v[100:103], v[228:231]
    v_mfma_f32_16x16x32_bf16 v[232:235], a[40:43], v[104:107], v[232:235]
    v_mfma_f32_16x16x32_bf16 v[220:223], a[44:47], v[108:111], v[220:223]
    buffer_load_dwordx4 a[40:43], v16, s[12:15], s28 offen offset:2048 sc1
    v_mfma_f32_16x16x32_bf16 v[224:227], a[44:47], v[112:115], v[224:227]
    v_mfma_f32_16x16x32_bf16 v[228:231], a[44:47], v[116:119], v[228:231]
    v_mfma_f32_16x16x32_bf16 v[232:235], a[44:47], v[120:123], v[232:235]
    v_mfma_f32_16x16x32_bf16 v[220:223], a[56:59], v[156:159], v[220:223]
    buffer_load_dwordx4 a[44:47], v16, s[12:15], s28 offen offset:3072 sc1
    v_cvt_pk_bf16_f32 v24, v244, v245
    v_cvt_pk_bf16_f32 v25, v246, v247
    v_mfma_f32_16x16x32_bf16 v[224:227], a[56:59], v[160:163], v[224:227]
    v_cvt_pk_bf16_f32 v26, v248, v249
    v_cvt_pk_bf16_f32 v27, v250, v251
    v_mfma_f32_16x16x32_bf16 v[228:231], a[56:59], v[164:167], v[228:231]
    s_cmp_lg_u32 s55, 0
    s_cselect_b32 s56, 67108864, s56
    v_mfma_f32_16x16x32_bf16 v[232:235], a[56:59], v[168:171], v[232:235]
    buffer_store_dwordx4 v[24:27], v16, s[4:7], s56 offen sc1
    v_mfma_f32_16x16x32_bf16 v[220:223], a[60:63], v[172:175], v[220:223]
    buffer_load_dwordx4 a[56:59], v17, s[12:15], s28 offen offset:2048 sc1
    ds_write_b128 v13, v[24:27] offset:4096
    v_mfma_f32_16x16x32_bf16 v[224:227], a[60:63], v[176:179], v[224:227]
    s_add_u32 s56, s56, 65536
    v_mfma_f32_16x16x32_bf16 v[228:231], a[60:63], v[180:183], v[228:231]
    v_mfma_f32_16x16x32_bf16 v[232:235], a[60:63], v[184:187], v[232:235]
    v_mfma_f32_16x16x32_bf16 v[220:223], a[64:67], v[188:191], v[220:223]
    buffer_load_dwordx4 a[60:63], v17, s[12:15], s28 offen offset:3072 sc1
    v_mfma_f32_16x16x32_bf16 v[224:227], a[64:67], v[192:195], v[224:227]
    v_mfma_f32_16x16x32_bf16 v[228:231], a[64:67], v[196:199], v[228:231]
    v_mfma_f32_16x16x32_bf16 v[232:235], a[64:67], v[200:203], v[232:235]
    v_mfma_f32_16x16x32_bf16 v[220:223], a[12:15], a[192:195], v[220:223]
    buffer_load_dwordx4 a[64:67], v18, s[12:15], s28 offen offset:0 sc1
    v_mfma_f32_16x16x32_bf16 v[224:227], a[12:15], a[196:199], v[224:227]
    v_mfma_f32_16x16x32_bf16 v[228:231], a[12:15], a[200:203], v[228:231]
    v_mfma_f32_16x16x32_bf16 v[232:235], a[12:15], a[204:207], v[232:235]
    v_mfma_f32_16x16x32_bf16 v[220:223], a[48:51], v[124:127], v[220:223]
    buffer_load_dwordx4 a[12:15], v4, s[12:15], s28 offen offset:3072 sc1
    v_mfma_f32_16x16x32_bf16 v[224:227], a[48:51], v[128:131], v[224:227]
    v_mfma_f32_16x16x32_bf16 v[228:231], a[48:51], v[132:135], v[228:231]
    v_mfma_f32_16x16x32_bf16 v[232:235], a[48:51], v[136:139], v[232:235]
    v_mfma_f32_16x16x32_bf16 v[220:223], a[16:19], a[208:211], v[220:223]
    buffer_load_dwordx4 a[48:51], v17, s[12:15], s28 offen offset:0 sc1
    v_mfma_f32_16x16x32_bf16 v[224:227], a[16:19], a[212:215], v[224:227]
    v_mfma_f32_16x16x32_bf16 v[228:231], a[16:19], a[216:219], v[228:231]
    v_mfma_f32_16x16x32_bf16 v[232:235], a[16:19], a[220:223], v[232:235]
    v_mfma_f32_16x16x32_bf16 v[220:223], a[32:35], v[60:63], v[220:223]
    buffer_load_dwordx4 a[16:19], v7, s[12:15], s28 offen offset:0 sc1
    s_mov_b32 s21, 40960
    buffer_load_dword v8, v14, s[4:7], s21 offen sc1
    v_mfma_f32_16x16x32_bf16 v[224:227], a[32:35], v[64:67], v[224:227]
    v_mfma_f32_16x16x32_bf16 v[228:231], a[32:35], v[68:71], v[228:231]
    v_mfma_f32_16x16x32_bf16 v[232:235], a[32:35], v[72:75], v[232:235]
    v_mfma_f32_16x16x32_bf16 v[220:223], a[52:55], v[140:143], v[220:223]
    buffer_load_dwordx4 a[32:35], v16, s[12:15], s28 offen offset:0 sc1
    v_mfma_f32_16x16x32_bf16 v[224:227], a[52:55], v[144:147], v[224:227]
    v_mfma_f32_16x16x32_bf16 v[228:231], a[52:55], v[148:151], v[228:231]
    v_mfma_f32_16x16x32_bf16 v[232:235], a[52:55], v[152:155], v[232:235]
    v_mfma_f32_16x16x32_bf16 v[220:223], a[68:71], v[204:207], v[220:223]
    buffer_load_dwordx4 a[52:55], v17, s[12:15], s28 offen offset:1024 sc1
    v_mfma_f32_16x16x32_bf16 v[224:227], a[68:71], v[208:211], v[224:227]
    v_mfma_f32_16x16x32_bf16 v[228:231], a[68:71], v[212:215], v[228:231]
    v_mfma_f32_16x16x32_bf16 v[232:235], a[68:71], v[216:219], v[232:235]
    buffer_load_dwordx4 a[68:71], v18, s[12:15], s28 offen offset:1024 sc1
    s_add_u32 s28, s28, 18432
    v_mfma_f32_16x16x32_bf16 v[236:239], a[72:75], a[144:147], 0
    v_mfma_f32_16x16x32_bf16 v[240:243], a[72:75], a[148:151], 0
    v_cvt_pk_bf16_f32 v20, v220, v221
    v_cvt_pk_bf16_f32 v21, v222, v223
    v_cvt_pk_bf16_f32 v22, v224, v225
    v_cvt_pk_bf16_f32 v23, v226, v227
    v_mfma_f32_16x16x32_bf16 v[244:247], a[72:75], a[152:155], 0
    buffer_store_dwordx4 v[20:23], v4, s[4:7], s44 offen sc1
    ds_write_b128 v12, v[20:23] offset:6144
    v_mfma_f32_16x16x32_bf16 v[248:251], a[72:75], a[156:159], 0
    s_add_u32 s44, s44, 65536
    v_mfma_f32_16x16x32_bf16 v[236:239], a[76:79], a[160:163], v[236:239]
    buffer_load_dwordx4 a[72:75], v4, s[12:15], s28 offen offset:0 sc1
    v_mfma_f32_16x16x32_bf16 v[240:243], a[76:79], a[164:167], v[240:243]
    v_mfma_f32_16x16x32_bf16 v[244:247], a[76:79], a[168:171], v[244:247]
    v_mfma_f32_16x16x32_bf16 v[248:251], a[76:79], a[172:175], v[248:251]
    v_mfma_f32_16x16x32_bf16 v[236:239], a[80:83], a[176:179], v[236:239]
    buffer_load_dwordx4 a[76:79], v4, s[12:15], s28 offen offset:1024 sc1
    v_mfma_f32_16x16x32_bf16 v[240:243], a[80:83], a[180:183], v[240:243]
    v_mfma_f32_16x16x32_bf16 v[244:247], a[80:83], a[184:187], v[244:247]
    v_mfma_f32_16x16x32_bf16 v[248:251], a[80:83], a[188:191], v[248:251]
    v_mfma_f32_16x16x32_bf16 v[236:239], a[92:95], a[224:227], v[236:239]
    buffer_load_dwordx4 a[80:83], v4, s[12:15], s28 offen offset:2048 sc1
    v_mfma_f32_16x16x32_bf16 v[240:243], a[92:95], a[228:231], v[240:243]
    v_mfma_f32_16x16x32_bf16 v[244:247], a[92:95], a[232:235], v[244:247]
    v_mfma_f32_16x16x32_bf16 v[248:251], a[92:95], a[236:239], v[248:251]
    v_mfma_f32_16x16x32_bf16 v[236:239], a[96:99], a[240:243], v[236:239]
    buffer_load_dwordx4 a[92:95], v7, s[12:15], s28 offen offset:1024 sc1
    s_add_u32 s20, s47, 4
    s_lshl_b32 s20, s20, 16
    v_mfma_f32_16x16x32_bf16 v[240:243], a[96:99], a[244:247], v[240:243]
    s_add_u32 s20, s20, 52428800
    s_add_u32 m0, s49, 1024
    v_mfma_f32_16x16x32_bf16 v[244:247], a[96:99], a[248:251], v[244:247]
    buffer_load_dword v29, s[4:7], s20 offen sc1 lds
    s_add_u32 s20, s47, 5
    v_mfma_f32_16x16x32_bf16 v[248:251], a[96:99], a[252:255], v[248:251]
    s_lshl_b32 s20, s20, 16
    s_add_u32 s20, s20, 52428800
    v_mfma_f32_16x16x32_bf16 v[236:239], a[100:103], v[44:47], v[236:239]
    buffer_load_dwordx4 a[96:99], v7, s[12:15], s28 offen offset:2048 sc1
    s_add_u32 m0, s49, 1280
    v_mfma_f32_16x16x32_bf16 v[240:243], a[100:103], v[48:51], v[240:243]
    buffer_load_dword v29, s[4:7], s20 offen sc1 lds
    v_mfma_f32_16x16x32_bf16 v[244:247], a[100:103], v[52:55], v[244:247]
    v_mfma_f32_16x16x32_bf16 v[248:251], a[100:103], v[56:59], v[248:251]
    v_mfma_f32_16x16x32_bf16 v[236:239], a[108:111], v[76:79], v[236:239]
    buffer_load_dwordx4 a[100:103], v7, s[12:15], s28 offen offset:3072 sc1
    s_waitcnt vmcnt(19)
    s_waitcnt lgkmcnt(0)
    s_mov_b64 exec, 1
    buffer_atomic_add v5, v6, s[4:7], s46 offen offset:1024 sc1
    s_mov_b64 exec, -1
    v_mfma_f32_16x16x32_bf16 v[240:243], a[108:111], v[80:83], v[240:243]
    v_mfma_f32_16x16x32_bf16 v[244:247], a[108:111], v[84:87], v[244:247]
    v_mfma_f32_16x16x32_bf16 v[248:251], a[108:111], v[88:91], v[248:251]
    v_mfma_f32_16x16x32_bf16 v[236:239], a[112:115], v[92:95], v[236:239]
    buffer_load_dwordx4 a[108:111], v16, s[12:15], s28 offen offset:1024 sc1
    v_mfma_f32_16x16x32_bf16 v[240:243], a[112:115], v[96:99], v[240:243]
    v_mfma_f32_16x16x32_bf16 v[244:247], a[112:115], v[100:103], v[244:247]
    v_mfma_f32_16x16x32_bf16 v[248:251], a[112:115], v[104:107], v[248:251]
    v_mfma_f32_16x16x32_bf16 v[236:239], a[116:119], v[108:111], v[236:239]
    buffer_load_dwordx4 a[112:115], v16, s[12:15], s28 offen offset:2048 sc1
    v_mfma_f32_16x16x32_bf16 v[240:243], a[116:119], v[112:115], v[240:243]
    v_mfma_f32_16x16x32_bf16 v[244:247], a[116:119], v[116:119], v[244:247]
    v_mfma_f32_16x16x32_bf16 v[248:251], a[116:119], v[120:123], v[248:251]
    v_mfma_f32_16x16x32_bf16 v[236:239], a[128:131], v[156:159], v[236:239]
    buffer_load_dwordx4 a[116:119], v16, s[12:15], s28 offen offset:3072 sc1
    v_cvt_pk_bf16_f32 v24, v228, v229
    v_cvt_pk_bf16_f32 v25, v230, v231
    v_mfma_f32_16x16x32_bf16 v[240:243], a[128:131], v[160:163], v[240:243]
    v_cvt_pk_bf16_f32 v26, v232, v233
    v_cvt_pk_bf16_f32 v27, v234, v235
    v_mfma_f32_16x16x32_bf16 v[244:247], a[128:131], v[164:167], v[244:247]
    buffer_store_dwordx4 v[24:27], v16, s[4:7], s56 offen sc1
    ds_write_b128 v13, v[24:27] offset:6144
    v_mfma_f32_16x16x32_bf16 v[248:251], a[128:131], v[168:171], v[248:251]
    v_mfma_f32_16x16x32_bf16 v[236:239], a[132:135], v[172:175], v[236:239]
    buffer_load_dwordx4 a[128:131], v17, s[12:15], s28 offen offset:2048 sc1
    s_add_u32 s56, s56, 65536
    v_mfma_f32_16x16x32_bf16 v[240:243], a[132:135], v[176:179], v[240:243]
    v_mfma_f32_16x16x32_bf16 v[244:247], a[132:135], v[180:183], v[244:247]
    v_mfma_f32_16x16x32_bf16 v[248:251], a[132:135], v[184:187], v[248:251]
    v_mfma_f32_16x16x32_bf16 v[236:239], a[136:139], v[188:191], v[236:239]
    buffer_load_dwordx4 a[132:135], v17, s[12:15], s28 offen offset:3072 sc1
    v_mfma_f32_16x16x32_bf16 v[240:243], a[136:139], v[192:195], v[240:243]
    v_mfma_f32_16x16x32_bf16 v[244:247], a[136:139], v[196:199], v[244:247]
    v_mfma_f32_16x16x32_bf16 v[248:251], a[136:139], v[200:203], v[248:251]
    v_mfma_f32_16x16x32_bf16 v[236:239], a[84:87], a[192:195], v[236:239]
    buffer_load_dwordx4 a[136:139], v18, s[12:15], s28 offen offset:0 sc1
    s_waitcnt vmcnt(20)
chk_adaLN_cond__ssm_conv_s4d__mixer_s_mlp__prompt_68:
    v_cmp_gt_u32 vcc, 8, v8
    s_nop 0
    s_cmp_eq_u64 vcc, 0
    s_cbranch_scc0 slow_adaLN_cond__ssm_conv_s4d__mixer_s_mlp__prompt_69
    v_mfma_f32_16x16x32_bf16 v[240:243], a[84:87], a[196:199], v[240:243]
    v_mfma_f32_16x16x32_bf16 v[244:247], a[84:87], a[200:203], v[244:247]
    s_add_u32 m0, s48, 0
    s_nop 0
    buffer_load_dwordx4 v28, s[4:7], s45 offen sc1 lds
    v_mfma_f32_16x16x32_bf16 v[248:251], a[84:87], a[204:207], v[248:251]
    s_add_u32 s20, s45, 4096
    s_add_u32 m0, s48, 1024
    v_mfma_f32_16x16x32_bf16 v[236:239], a[120:123], v[124:127], v[236:239]
    buffer_load_dwordx4 a[84:87], v4, s[12:15], s28 offen offset:3072 sc1
    buffer_load_dwordx4 v28, s[4:7], s20 offen sc1 lds
    v_mfma_f32_16x16x32_bf16 v[240:243], a[120:123], v[128:131], v[240:243]
    s_add_u32 s45, s45, 65536
    v_mfma_f32_16x16x32_bf16 v[244:247], a[120:123], v[132:135], v[244:247]
    v_mfma_f32_16x16x32_bf16 v[248:251], a[120:123], v[136:139], v[248:251]
    v_mfma_f32_16x16x32_bf16 v[236:239], a[88:91], a[208:211], v[236:239]
    buffer_load_dwordx4 a[120:123], v17, s[12:15], s28 offen offset:0 sc1
    v_mfma_f32_16x16x32_bf16 v[240:243], a[88:91], a[212:215], v[240:243]
    v_mfma_f32_16x16x32_bf16 v[244:247], a[88:91], a[216:219], v[244:247]
    v_mfma_f32_16x16x32_bf16 v[248:251], a[88:91], a[220:223], v[248:251]
    v_mfma_f32_16x16x32_bf16 v[236:239], a[104:107], v[60:63], v[236:239]
    buffer_load_dwordx4 a[88:91], v7, s[12:15], s28 offen offset:0 sc1
    s_mov_b32 s21, 41472
    buffer_load_dword v8, v14, s[4:7], s21 offen sc1
    v_mfma_f32_16x16x32_bf16 v[240:243], a[104:107], v[64:67], v[240:243]
    v_mfma_f32_16x16x32_bf16 v[244:247], a[104:107], v[68:71], v[244:247]
    v_mfma_f32_16x16x32_bf16 v[248:251], a[104:107], v[72:75], v[248:251]
    v_mfma_f32_16x16x32_bf16 v[236:239], a[124:127], v[140:143], v[236:239]
    buffer_load_dwordx4 a[104:107], v16, s[12:15], s28 offen offset:0 sc1
    v_mfma_f32_16x16x32_bf16 v[240:243], a[124:127], v[144:147], v[240:243]
    v_mfma_f32_16x16x32_bf16 v[244:247], a[124:127], v[148:151], v[244:247]
    v_mfma_f32_16x16x32_bf16 v[248:251], a[124:127], v[152:155], v[248:251]
    v_mfma_f32_16x16x32_bf16 v[236:239], a[140:143], v[204:207], v[236:239]
    buffer_load_dwordx4 a[124:127], v17, s[12:15], s28 offen offset:1024 sc1
    v_mfma_f32_16x16x32_bf16 v[240:243], a[140:143], v[208:211], v[240:243]
    v_mfma_f32_16x16x32_bf16 v[244:247], a[140:143], v[212:215], v[244:247]
    v_mfma_f32_16x16x32_bf16 v[248:251], a[140:143], v[216:219], v[248:251]
    buffer_load_dwordx4 a[140:143], v18, s[12:15], s28 offen offset:1024 sc1
    s_add_u32 s28, s28, 18432
    v_mfma_f32_16x16x32_bf16 v[220:223], a[0:3], a[144:147], 0
    v_mfma_f32_16x16x32_bf16 v[224:227], a[0:3], a[148:151], 0
    v_cvt_pk_bf16_f32 v20, v236, v237
    v_cvt_pk_bf16_f32 v21, v238, v239
    v_cvt_pk_bf16_f32 v22, v240, v241
    v_cvt_pk_bf16_f32 v23, v242, v243
    v_mfma_f32_16x16x32_bf16 v[228:231], a[0:3], a[152:155], 0
    buffer_store_dwordx4 v[20:23], v4, s[4:7], s44 offen sc1
    ds_write_b128 v12, v[20:23] offset:8192
    v_mfma_f32_16x16x32_bf16 v[232:235], a[0:3], a[156:159], 0
    s_add_u32 s44, s44, 65536
    v_mfma_f32_16x16x32_bf16 v[220:223], a[4:7], a[160:163], v[220:223]
    buffer_load_dwordx4 a[0:3], v4, s[12:15], s28 offen offset:0 sc1
    v_mfma_f32_16x16x32_bf16 v[224:227], a[4:7], a[164:167], v[224:227]
    v_mfma_f32_16x16x32_bf16 v[228:231], a[4:7], a[168:171], v[228:231]
    v_mfma_f32_16x16x32_bf16 v[232:235], a[4:7], a[172:175], v[232:235]
    v_mfma_f32_16x16x32_bf16 v[220:223], a[8:11], a[176:179], v[220:223]
    buffer_load_dwordx4 a[4:7], v4, s[12:15], s28 offen offset:1024 sc1
    v_mfma_f32_16x16x32_bf16 v[224:227], a[8:11], a[180:183], v[224:227]
    v_mfma_f32_16x16x32_bf16 v[228:231], a[8:11], a[184:187], v[228:231]
    v_mfma_f32_16x16x32_bf16 v[232:235], a[8:11], a[188:191], v[232:235]
    v_mfma_f32_16x16x32_bf16 v[220:223], a[20:23], a[224:227], v[220:223]
    buffer_load_dwordx4 a[8:11], v4, s[12:15], s28 offen offset:2048 sc1
    v_mfma_f32_16x16x32_bf16 v[224:227], a[20:23], a[228:231], v[224:227]
    v_mfma_f32_16x16x32_bf16 v[228:231], a[20:23], a[232:235], v[228:231]
    v_mfma_f32_16x16x32_bf16 v[232:235], a[20:23], a[236:239], v[232:235]
    v_mfma_f32_16x16x32_bf16 v[220:223], a[24:27], a[240:243], v[220:223]
    buffer_load_dwordx4 a[20:23], v7, s[12:15], s28 offen offset:1024 sc1
    s_add_u32 s20, s47, 6
    s_lshl_b32 s20, s20, 16
    v_mfma_f32_16x16x32_bf16 v[224:227], a[24:27], a[244:247], v[224:227]
    s_add_u32 s20, s20, 52428800
    s_add_u32 m0, s49, 1536
    v_mfma_f32_16x16x32_bf16 v[228:231], a[24:27], a[248:251], v[228:231]
    buffer_load_dword v29, s[4:7], s20 offen sc1 lds
    s_add_u32 s20, s47, 7
    v_mfma_f32_16x16x32_bf16 v[232:235], a[24:27], a[252:255], v[232:235]
    s_lshl_b32 s20, s20, 16
    s_add_u32 s20, s20, 52428800
    v_mfma_f32_16x16x32_bf16 v[220:223], a[28:31], v[44:47], v[220:223]
    buffer_load_dwordx4 a[24:27], v7, s[12:15], s28 offen offset:2048 sc1
    s_add_u32 m0, s49, 1792
    v_mfma_f32_16x16x32_bf16 v[224:227], a[28:31], v[48:51], v[224:227]
    buffer_load_dword v29, s[4:7], s20 offen sc1 lds
    v_mfma_f32_16x16x32_bf16 v[228:231], a[28:31], v[52:55], v[228:231]
    v_mfma_f32_16x16x32_bf16 v[232:235], a[28:31], v[56:59], v[232:235]
    v_mfma_f32_16x16x32_bf16 v[220:223], a[36:39], v[76:79], v[220:223]
    buffer_load_dwordx4 a[28:31], v7, s[12:15], s28 offen offset:3072 sc1
    s_waitcnt vmcnt(21)
    s_waitcnt lgkmcnt(0)
    s_mov_b64 exec, 1
    buffer_atomic_add v5, v6, s[4:7], s46 offen offset:1536 sc1
    s_mov_b64 exec, -1
    v_mfma_f32_16x16x32_bf16 v[224:227], a[36:39], v[80:83], v[224:227]
    v_mfma_f32_16x16x32_bf16 v[228:231], a[36:39], v[84:87], v[228:231]
    v_mfma_f32_16x16x32_bf16 v[232:235], a[36:39], v[88:91], v[232:235]
    v_mfma_f32_16x16x32_bf16 v[220:223], a[40:43], v[92:95], v[220:223]
    buffer_load_dwordx4 a[36:39], v16, s[12:15], s28 offen offset:1024 sc1
    v_mfma_f32_16x16x32_bf16 v[224:227], a[40:43], v[96:99], v[224:227]
    v_mfma_f32_16x16x32_bf16 v[228:231], a[40:43], v[100:103], v[228:231]
    v_mfma_f32_16x16x32_bf16 v[232:235], a[40:43], v[104:107], v[232:235]
    v_mfma_f32_16x16x32_bf16 v[220:223], a[44:47], v[108:111], v[220:223]
    buffer_load_dwordx4 a[40:43], v16, s[12:15], s28 offen offset:2048 sc1
    v_mfma_f32_16x16x32_bf16 v[224:227], a[44:47], v[112:115], v[224:227]
    v_mfma_f32_16x16x32_bf16 v[228:231], a[44:47], v[116:119], v[228:231]
    v_mfma_f32_16x16x32_bf16 v[232:235], a[44:47], v[120:123], v[232:235]
    v_mfma_f32_16x16x32_bf16 v[220:223], a[56:59], v[156:159], v[220:223]
    buffer_load_dwordx4 a[44:47], v16, s[12:15], s28 offen offset:3072 sc1
    v_cvt_pk_bf16_f32 v24, v244, v245
    v_cvt_pk_bf16_f32 v25, v246, v247
    v_mfma_f32_16x16x32_bf16 v[224:227], a[56:59], v[160:163], v[224:227]
    v_cvt_pk_bf16_f32 v26, v248, v249
    v_cvt_pk_bf16_f32 v27, v250, v251
    v_mfma_f32_16x16x32_bf16 v[228:231], a[56:59], v[164:167], v[228:231]
    buffer_store_dwordx4 v[24:27], v16, s[4:7], s56 offen sc1
    ds_write_b128 v13, v[24:27] offset:8192
    v_mfma_f32_16x16x32_bf16 v[232:235], a[56:59], v[168:171], v[232:235]
    v_mfma_f32_16x16x32_bf16 v[220:223], a[60:63], v[172:175], v[220:223]
    buffer_load_dwordx4 a[56:59], v17, s[12:15], s28 offen offset:2048 sc1
    s_add_u32 s56, s56, 65536
    v_mfma_f32_16x16x32_bf16 v[224:227], a[60:63], v[176:179], v[224:227]
    v_mfma_f32_16x16x32_bf16 v[228:231], a[60:63], v[180:183], v[228:231]
    v_mfma_f32_16x16x32_bf16 v[232:235], a[60:63], v[184:187], v[232:235]
    v_mfma_f32_16x16x32_bf16 v[220:223], a[64:67], v[188:191], v[220:223]
    buffer_load_dwordx4 a[60:63], v17, s[12:15], s28 offen offset:3072 sc1
    v_mfma_f32_16x16x32_bf16 v[224:227], a[64:67], v[192:195], v[224:227]
    v_mfma_f32_16x16x32_bf16 v[228:231], a[64:67], v[196:199], v[228:231]
    v_mfma_f32_16x16x32_bf16 v[232:235], a[64:67], v[200:203], v[232:235]
    v_mfma_f32_16x16x32_bf16 v[220:223], a[12:15], a[192:195], v[220:223]
    buffer_load_dwordx4 a[64:67], v18, s[12:15], s28 offen offset:0 sc1
    s_waitcnt vmcnt(20)
chk_adaLN_cond__ssm_conv_s4d__mixer_s_mlp__prompt_70:
    v_cmp_gt_u32 vcc, 8, v8
    s_nop 0
    s_cmp_eq_u64 vcc, 0
    s_cbranch_scc0 slow_adaLN_cond__ssm_conv_s4d__mixer_s_mlp__prompt_71
    v_mfma_f32_16x16x32_bf16 v[224:227], a[12:15], a[196:199], v[224:227]
    v_mfma_f32_16x16x32_bf16 v[228:231], a[12:15], a[200:203], v[228:231]
    s_add_u32 m0, s48, 2048
    s_nop 0
    buffer_load_dwordx4 v28, s[4:7], s45 offen sc1 lds
    v_mfma_f32_16x16x32_bf16 v[232:235], a[12:15], a[204:207], v[232:235]
    s_add_u32 s20, s45, 4096
    s_add_u32 m0, s48, 3072
    v_mfma_f32_16x16x32_bf16 v[220:223], a[48:51], v[124:127], v[220:223]
    buffer_load_dwordx4 a[12:15], v4, s[12:15], s28 offen offset:3072 sc1
    buffer_load_dwordx4 v28, s[4:7], s20 offen sc1 lds
    v_mfma_f32_16x16x32_bf16 v[224:227], a[48:51], v[128:131], v[224:227]
    s_add_u32 s45, s45, 65536
    v_mfma_f32_16x16x32_bf16 v[228:231], a[48:51], v[132:135], v[228:231]
    v_mfma_f32_16x16x32_bf16 v[232:235], a[48:51], v[136:139], v[232:235]
    v_mfma_f32_16x16x32_bf16 v[220:223], a[16:19], a[208:211], v[220:223]
    buffer_load_dwordx4 a[48:51], v17, s[12:15], s28 offen offset:0 sc1
    v_mfma_f32_16x16x32_bf16 v[224:227], a[16:19], a[212:215], v[224:227]
    v_mfma_f32_16x16x32_bf16 v[228:231], a[16:19], a[216:219], v[228:231]
    v_mfma_f32_16x16x32_bf16 v[232:235], a[16:19], a[220:223], v[232:235]
    v_mfma_f32_16x16x32_bf16 v[220:223], a[32:35], v[60:63], v[220:223]
    buffer_load_dwordx4 a[16:19], v7, s[12:15], s28 offen offset:0 sc1
    s_mov_b32 s21, 41984
    buffer_load_dword v8, v14, s[4:7], s21 offen sc1
    v_mfma_f32_16x16x32_bf16 v[224:227], a[32:35], v[64:67], v[224:227]
    v_mfma_f32_16x16x32_bf16 v[228:231], a[32:35], v[68:71], v[228:231]
    v_mfma_f32_16x16x32_bf16 v[232:235], a[32:35], v[72:75], v[232:235]
    v_mfma_f32_16x16x32_bf16 v[220:223], a[52:55], v[140:143], v[220:223]
    buffer_load_dwordx4 a[32:35], v16, s[12:15], s28 offen offset:0 sc1
    v_mfma_f32_16x16x32_bf16 v[224:227], a[52:55], v[144:147], v[224:227]
    v_mfma_f32_16x16x32_bf16 v[228:231], a[52:55], v[148:151], v[228:231]
    v_mfma_f32_16x16x32_bf16 v[232:235], a[52:55], v[152:155], v[232:235]
    v_mfma_f32_16x16x32_bf16 v[220:223], a[68:71], v[204:207], v[220:223]
    buffer_load_dwordx4 a[52:55], v17, s[12:15], s28 offen offset:1024 sc1
    v_mfma_f32_16x16x32_bf16 v[224:227], a[68:71], v[208:211], v[224:227]
    v_mfma_f32_16x16x32_bf16 v[228:231], a[68:71], v[212:215], v[228:231]
    v_mfma_f32_16x16x32_bf16 v[232:235], a[68:71], v[216:219], v[232:235]
    buffer_load_dwordx4 a[68:71], v18, s[12:15], s28 offen offset:1024 sc1
    s_add_u32 s28, s28, 18432
    v_mfma_f32_16x16x32_bf16 v[236:239], a[72:75], a[144:147], 0
    v_mfma_f32_16x16x32_bf16 v[240:243], a[72:75], a[148:151], 0
    v_cvt_pk_bf16_f32 v20, v220, v221
    v_cvt_pk_bf16_f32 v21, v222, v223
    v_cvt_pk_bf16_f32 v22, v224, v225
    v_cvt_pk_bf16_f32 v23, v226, v227
    v_mfma_f32_16x16x32_bf16 v[244:247], a[72:75], a[152:155], 0
    buffer_store_dwordx4 v[20:23], v4, s[4:7], s44 offen sc1
    ds_write_b128 v12, v[20:23] offset:10240
    v_mfma_f32_16x16x32_bf16 v[248:251], a[72:75], a[156:159], 0
    s_add_u32 s44, s44, 65536
    v_mfma_f32_16x16x32_bf16 v[236:239], a[76:79], a[160:163], v[236:239]
    buffer_load_dwordx4 a[72:75], v4, s[12:15], s28 offen offset:0 sc1
    v_mfma_f32_16x16x32_bf16 v[240:243], a[76:79], a[164:167], v[240:243]
    v_mfma_f32_16x16x32_bf16 v[244:247], a[76:79], a[168:171], v[244:247]
    v_mfma_f32_16x16x32_bf16 v[248:251], a[76:79], a[172:175], v[248:251]
    v_mfma_f32_16x16x32_bf16 v[236:239], a[80:83], a[176:179], v[236:239]
    buffer_load_dwordx4 a[76:79], v4, s[12:15], s28 offen offset:1024 sc1
    v_mfma_f32_16x16x32_bf16 v[240:243], a[80:83], a[180:183], v[240:243]
    v_mfma_f32_16x16x32_bf16 v[244:247], a[80:83], a[184:187], v[244:247]
    v_mfma_f32_16x16x32_bf16 v[248:251], a[80:83], a[188:191], v[248:251]
    v_mfma_f32_16x16x32_bf16 v[236:239], a[92:95], a[224:227], v[236:239]
    buffer_load_dwordx4 a[80:83], v4, s[12:15], s28 offen offset:2048 sc1
    v_mfma_f32_16x16x32_bf16 v[240:243], a[92:95], a[228:231], v[240:243]
    v_mfma_f32_16x16x32_bf16 v[244:247], a[92:95], a[232:235], v[244:247]
    v_mfma_f32_16x16x32_bf16 v[248:251], a[92:95], a[236:239], v[248:251]
    v_mfma_f32_16x16x32_bf16 v[236:239], a[96:99], a[240:243], v[236:239]
    buffer_load_dwordx4 a[92:95], v7, s[12:15], s28 offen offset:1024 sc1
    s_add_u32 s20, s47, 8
    s_lshl_b32 s20, s20, 16
    v_mfma_f32_16x16x32_bf16 v[240:243], a[96:99], a[244:247], v[240:243]
    s_add_u32 s20, s20, 52428800
    s_add_u32 m0, s49, 2048
    v_mfma_f32_16x16x32_bf16 v[244:247], a[96:99], a[248:251], v[244:247]
    buffer_load_dword v29, s[4:7], s20 offen sc1 lds
    v_mfma_f32_16x16x32_bf16 v[248:251], a[96:99], a[252:255], v[248:251]
    v_mfma_f32_16x16x32_bf16 v[236:239], a[100:103], v[44:47], v[236:239]
    buffer_load_dwordx4 a[96:99], v7, s[12:15], s28 offen offset:2048 sc1
    v_mfma_f32_16x16x32_bf16 v[240:243], a[100:103], v[48:51], v[240:243]
    v_mfma_f32_16x16x32_bf16 v[244:247], a[100:103], v[52:55], v[244:247]
    v_mfma_f32_16x16x32_bf16 v[248:251], a[100:103], v[56:59], v[248:251]
    v_mfma_f32_16x16x32_bf16 v[236:239], a[108:111], v[76:79], v[236:239]
    buffer_load_dwordx4 a[100:103], v7, s[12:15], s28 offen offset:3072 sc1
    s_waitcnt vmcnt(20)
    s_waitcnt lgkmcnt(0)
    s_mov_b64 exec, 1
    buffer_atomic_add v5, v6, s[4:7], s46 offen offset:2048 sc1
    s_mov_b64 exec, -1
    v_mfma_f32_16x16x32_bf16 v[240:243], a[108:111], v[80:83], v[240:243]
    v_mfma_f32_16x16x32_bf16 v[244:247], a[108:111], v[84:87], v[244:247]
    v_mfma_f32_16x16x32_bf16 v[248:251], a[108:111], v[88:91], v[248:251]
    v_mfma_f32_16x16x32_bf16 v[236:239], a[112:115], v[92:95], v[236:239]
    buffer_load_dwordx4 a[108:111], v16, s[12:15], s28 offen offset:1024 sc1
    v_mfma_f32_16x16x32_bf16 v[240:243], a[112:115], v[96:99], v[240:243]
    v_mfma_f32_16x16x32_bf16 v[244:247], a[112:115], v[100:103], v[244:247]
    v_mfma_f32_16x16x32_bf16 v[248:251], a[112:115], v[104:107], v[248:251]
    v_mfma_f32_16x16x32_bf16 v[236:239], a[116:119], v[108:111], v[236:239]
    buffer_load_dwordx4 a[112:115], v16, s[12:15], s28 offen offset:2048 sc1
    v_mfma_f32_16x16x32_bf16 v[240:243], a[116:119], v[112:115], v[240:243]
    v_mfma_f32_16x16x32_bf16 v[244:247], a[116:119], v[116:119], v[244:247]
    v_mfma_f32_16x16x32_bf16 v[248:251], a[116:119], v[120:123], v[248:251]
    v_mfma_f32_16x16x32_bf16 v[236:239], a[128:131], v[156:159], v[236:239]
    buffer_load_dwordx4 a[116:119], v16, s[12:15], s28 offen offset:3072 sc1
    v_cvt_pk_bf16_f32 v24, v228, v229
    v_cvt_pk_bf16_f32 v25, v230, v231
    v_mfma_f32_16x16x32_bf16 v[240:243], a[128:131], v[160:163], v[240:243]
    v_cvt_pk_bf16_f32 v26, v232, v233
    v_cvt_pk_bf16_f32 v27, v234, v235
    v_mfma_f32_16x16x32_bf16 v[244:247], a[128:131], v[164:167], v[244:247]
    buffer_store_dwordx4 v[24:27], v16, s[4:7], s56 offen sc1
    ds_write_b128 v13, v[24:27] offset:10240
    v_mfma_f32_16x16x32_bf16 v[248:251], a[128:131], v[168:171], v[248:251]
    v_mfma_f32_16x16x32_bf16 v[236:239], a[132:135], v[172:175], v[236:239]
    buffer_load_dwordx4 a[128:131], v17, s[12:15], s28 offen offset:2048 sc1
    s_add_u32 s56, s56, 65536
    v_mfma_f32_16x16x32_bf16 v[240:243], a[132:135], v[176:179], v[240:243]
    v_mfma_f32_16x16x32_bf16 v[244:247], a[132:135], v[180:183], v[244:247]
    v_mfma_f32_16x16x32_bf16 v[248:251], a[132:135], v[184:187], v[248:251]
    v_mfma_f32_16x16x32_bf16 v[236:239], a[136:139], v[188:191], v[236:239]
    buffer_load_dwordx4 a[132:135], v17, s[12:15], s28 offen offset:3072 sc1
    v_mfma_f32_16x16x32_bf16 v[240:243], a[136:139], v[192:195], v[240:243]
    v_mfma_f32_16x16x32_bf16 v[244:247], a[136:139], v[196:199], v[244:247]
    v_mfma_f32_16x16x32_bf16 v[248:251], a[136:139], v[200:203], v[248:251]
    v_mfma_f32_16x16x32_bf16 v[236:239], a[84:87], a[192:195], v[236:239]
    buffer_load_dwordx4 a[136:139], v18, s[12:15], s28 offen offset:0 sc1
    s_waitcnt vmcnt(19)
chk_adaLN_cond__ssm_conv_s4d__mixer_s_mlp__prompt_72:
    v_cmp_gt_u32 vcc, 8, v8
    s_nop 0
    s_cmp_eq_u64 vcc, 0
    s_cbranch_scc0 slow_adaLN_cond__ssm_conv_s4d__mixer_s_mlp__prompt_73
    v_mfma_f32_16x16x32_bf16 v[240:243], a[84:87], a[196:199], v[240:243]
    v_mfma_f32_16x16x32_bf16 v[244:247], a[84:87], a[200:203], v[244:247]
    s_add_u32 m0, s48, 4096
    v_mfma_f32_16x16x32_bf16 v[248:251], a[84:87], a[204:207], v[248:251]
    s_mov_b64 exec, s[50:51]
    buffer_load_dwordx4 v28, s[4:7], s45 offen sc1 lds
    s_mov_b64 exec, -1
    v_mfma_f32_16x16x32_bf16 v[236:239], a[120:123], v[124:127], v[236:239]
    buffer_load_dwordx4 a[84:87], v4, s[12:15], s28 offen offset:3072 sc1
    s_add_u32 s20, s45, 4096
    v_mfma_f32_16x16x32_bf16 v[240:243], a[120:123], v[128:131], v[240:243]
    s_add_u32 m0, s48, 5120
    v_mfma_f32_16x16x32_bf16 v[244:247], a[120:123], v[132:135], v[244:247]
    s_mov_b64 exec, s[52:53]
    buffer_load_dwordx4 v28, s[4:7], s20 offen sc1 lds
    s_mov_b64 exec, -1
    v_mfma_f32_16x16x32_bf16 v[248:251], a[120:123], v[136:139], v[248:251]
    s_add_u32 s45, s45, 65536
    v_mfma_f32_16x16x32_bf16 v[236:239], a[88:91], a[208:211], v[236:239]
    buffer_load_dwordx4 a[120:123], v17, s[12:15], s28 offen offset:0 sc1
    v_mfma_f32_16x16x32_bf16 v[240:243], a[88:91], a[212:215], v[240:243]
    v_mfma_f32_16x16x32_bf16 v[244:247], a[88:91], a[216:219], v[244:247]
    v_mfma_f32_16x16x32_bf16 v[248:251], a[88:91], a[220:223], v[248:251]
    v_mfma_f32_16x16x32_bf16 v[236:239], a[104:107], v[60:63], v[236:239]
    buffer_load_dwordx4 a[88:91], v7, s[12:15], s28 offen offset:0 sc1
    s_mov_b32 s21, 42496
    buffer_load_dword v8, v14, s[4:7], s21 offen sc1
    v_mfma_f32_16x16x32_bf16 v[240:243], a[104:107], v[64:67], v[240:243]
    v_mfma_f32_16x16x32_bf16 v[244:247], a[104:107], v[68:71], v[244:247]
    v_mfma_f32_16x16x32_bf16 v[248:251], a[104:107], v[72:75], v[248:251]
    v_mfma_f32_16x16x32_bf16 v[236:239], a[124:127], v[140:143], v[236:239]
    buffer_load_dwordx4 a[104:107], v16, s[12:15], s28 offen offset:0 sc1
    v_mfma_f32_16x16x32_bf16 v[240:243], a[124:127], v[144:147], v[240:243]
    v_mfma_f32_16x16x32_bf16 v[244:247], a[124:127], v[148:151], v[244:247]
    v_mfma_f32_16x16x32_bf16 v[248:251], a[124:127], v[152:155], v[248:251]
    v_mfma_f32_16x16x32_bf16 v[236:239], a[140:143], v[204:207], v[236:239]
    buffer_load_dwordx4 a[124:127], v17, s[12:15], s28 offen offset:1024 sc1
    v_mfma_f32_16x16x32_bf16 v[240:243], a[140:143], v[208:211], v[240:243]
    v_mfma_f32_16x16x32_bf16 v[244:247], a[140:143], v[212:215], v[244:247]
    v_mfma_f32_16x16x32_bf16 v[248:251], a[140:143], v[216:219], v[248:251]
    buffer_load_dwordx4 a[140:143], v18, s[12:15], s28 offen offset:1024 sc1
    s_add_u32 s28, s28, 18432
    v_mfma_f32_16x16x32_bf16 v[220:223], a[0:3], a[144:147], 0
    v_mfma_f32_16x16x32_bf16 v[224:227], a[0:3], a[148:151], 0
    v_cvt_pk_bf16_f32 v20, v236, v237
    v_cvt_pk_bf16_f32 v21, v238, v239
    v_cvt_pk_bf16_f32 v22, v240, v241
    v_cvt_pk_bf16_f32 v23, v242, v243
    v_mfma_f32_16x16x32_bf16 v[228:231], a[0:3], a[152:155], 0
    buffer_store_dwordx4 v[20:23], v4, s[4:7], s44 offen sc1
    ds_write_b128 v12, v[20:23] offset:12288
    v_mfma_f32_16x16x32_bf16 v[232:235], a[0:3], a[156:159], 0
    s_add_u32 s44, s44, 65536
    v_mfma_f32_16x16x32_bf16 v[220:223], a[4:7], a[160:163], v[220:223]
    v_mfma_f32_16x16x32_bf16 v[224:227], a[4:7], a[164:167], v[224:227]
    v_mfma_f32_16x16x32_bf16 v[228:231], a[4:7], a[168:171], v[228:231]
    v_mfma_f32_16x16x32_bf16 v[232:235], a[4:7], a[172:175], v[232:235]
    v_mfma_f32_16x16x32_bf16 v[220:223], a[8:11], a[176:179], v[220:223]
    v_mfma_f32_16x16x32_bf16 v[224:227], a[8:11], a[180:183], v[224:227]
    v_mfma_f32_16x16x32_bf16 v[228:231], a[8:11], a[184:187], v[228:231]
    v_mfma_f32_16x16x32_bf16 v[232:235], a[8:11], a[188:191], v[232:235]
    v_mfma_f32_16x16x32_bf16 v[220:223], a[20:23], a[224:227], v[220:223]
    v_mfma_f32_16x16x32_bf16 v[224:227], a[20:23], a[228:231], v[224:227]
    v_mfma_f32_16x16x32_bf16 v[228:231], a[20:23], a[232:235], v[228:231]
    v_mfma_f32_16x16x32_bf16 v[232:235], a[20:23], a[236:239], v[232:235]
    v_mfma_f32_16x16x32_bf16 v[220:223], a[24:27], a[240:243], v[220:223]
    v_mfma_f32_16x16x32_bf16 v[224:227], a[24:27], a[244:247], v[224:227]
    v_mfma_f32_16x16x32_bf16 v[228:231], a[24:27], a[248:251], v[228:231]
    v_mfma_f32_16x16x32_bf16 v[232:235], a[24:27], a[252:255], v[232:235]
    v_mfma_f32_16x16x32_bf16 v[220:223], a[28:31], v[44:47], v[220:223]
    v_mfma_f32_16x16x32_bf16 v[224:227], a[28:31], v[48:51], v[224:227]
    v_mfma_f32_16x16x32_bf16 v[228:231], a[28:31], v[52:55], v[228:231]
    v_mfma_f32_16x16x32_bf16 v[232:235], a[28:31], v[56:59], v[232:235]
    v_mfma_f32_16x16x32_bf16 v[220:223], a[36:39], v[76:79], v[220:223]
    s_waitcnt vmcnt(13)
    s_waitcnt lgkmcnt(0)
    s_mov_b64 exec, 1
    buffer_atomic_add v5, v6, s[4:7], s46 offen offset:2560 sc1
    s_mov_b64 exec, -1
    v_mfma_f32_16x16x32_bf16 v[224:227], a[36:39], v[80:83], v[224:227]
    v_mfma_f32_16x16x32_bf16 v[228:231], a[36:39], v[84:87], v[228:231]
    v_mfma_f32_16x16x32_bf16 v[232:235], a[36:39], v[88:91], v[232:235]
    v_mfma_f32_16x16x32_bf16 v[220:223], a[40:43], v[92:95], v[220:223]
    v_mfma_f32_16x16x32_bf16 v[224:227], a[40:43], v[96:99], v[224:227]
    v_mfma_f32_16x16x32_bf16 v[228:231], a[40:43], v[100:103], v[228:231]
    v_mfma_f32_16x16x32_bf16 v[232:235], a[40:43], v[104:107], v[232:235]
    v_mfma_f32_16x16x32_bf16 v[220:223], a[44:47], v[108:111], v[220:223]
    v_mfma_f32_16x16x32_bf16 v[224:227], a[44:47], v[112:115], v[224:227]
    v_mfma_f32_16x16x32_bf16 v[228:231], a[44:47], v[116:119], v[228:231]
    v_mfma_f32_16x16x32_bf16 v[232:235], a[44:47], v[120:123], v[232:235]
    v_mfma_f32_16x16x32_bf16 v[220:223], a[56:59], v[156:159], v[220:223]
    v_cvt_pk_bf16_f32 v24, v244, v245
    v_cvt_pk_bf16_f32 v25, v246, v247
    v_cvt_pk_bf16_f32 v26, v248, v249
    v_mfma_f32_16x16x32_bf16 v[224:227], a[56:59], v[160:163], v[224:227]
    v_cvt_pk_bf16_f32 v27, v250, v251
    buffer_store_dwordx4 v[24:27], v16, s[4:7], s56 offen sc1
    v_mfma_f32_16x16x32_bf16 v[228:231], a[56:59], v[164:167], v[228:231]
    ds_write_b128 v13, v[24:27] offset:12288
    v_mfma_f32_16x16x32_bf16 v[232:235], a[56:59], v[168:171], v[232:235]
    s_add_u32 s56, s56, 65536
    v_mfma_f32_16x16x32_bf16 v[220:223], a[60:63], v[172:175], v[220:223]
    v_mfma_f32_16x16x32_bf16 v[224:227], a[60:63], v[176:179], v[224:227]
    v_mfma_f32_16x16x32_bf16 v[228:231], a[60:63], v[180:183], v[228:231]
    v_mfma_f32_16x16x32_bf16 v[232:235], a[60:63], v[184:187], v[232:235]
    v_mfma_f32_16x16x32_bf16 v[220:223], a[64:67], v[188:191], v[220:223]
    v_mfma_f32_16x16x32_bf16 v[224:227], a[64:67], v[192:195], v[224:227]
    v_mfma_f32_16x16x32_bf16 v[228:231], a[64:67], v[196:199], v[228:231]
    v_mfma_f32_16x16x32_bf16 v[232:235], a[64:67], v[200:203], v[232:235]
    v_mfma_f32_16x16x32_bf16 v[220:223], a[12:15], a[192:195], v[220:223]
    s_waitcnt vmcnt(6)
chk_adaLN_cond__ssm_conv_s4d__mixer_s_mlp__prompt_74:
    v_cmp_gt_u32 vcc, 8, v8
    s_nop 0
    s_cmp_eq_u64 vcc, 0
    s_cbranch_scc0 slow_adaLN_cond__ssm_conv_s4d__mixer_s_mlp__prompt_75
    v_mfma_f32_16x16x32_bf16 v[224:227], a[12:15], a[196:199], v[224:227]
    s_add_u32 m0, s48, 6144
    v_mfma_f32_16x16x32_bf16 v[228:231], a[12:15], a[200:203], v[228:231]
    s_mov_b64 exec, s[50:51]
    buffer_load_dwordx4 v28, s[4:7], s45 offen sc1 lds
    s_mov_b64 exec, -1
    v_mfma_f32_16x16x32_bf16 v[232:235], a[12:15], a[204:207], v[232:235]
    s_add_u32 s20, s45, 4096
    v_mfma_f32_16x16x32_bf16 v[220:223], a[48:51], v[124:127], v[220:223]
    s_add_u32 m0, s48, 7168
    v_mfma_f32_16x16x32_bf16 v[224:227], a[48:51], v[128:131], v[224:227]
    s_mov_b64 exec, s[52:53]
    buffer_load_dwordx4 v28, s[4:7], s20 offen sc1 lds
    s_mov_b64 exec, -1
    v_mfma_f32_16x16x32_bf16 v[228:231], a[48:51], v[132:135], v[228:231]
    s_add_u32 s45, s45, 65536
    v_mfma_f32_16x16x32_bf16 v[232:235], a[48:51], v[136:139], v[232:235]
    v_mfma_f32_16x16x32_bf16 v[220:223], a[16:19], a[208:211], v[220:223]
    v_mfma_f32_16x16x32_bf16 v[224:227], a[16:19], a[212:215], v[224:227]
    v_mfma_f32_16x16x32_bf16 v[228:231], a[16:19], a[216:219], v[228:231]
    v_mfma_f32_16x16x32_bf16 v[232:235], a[16:19], a[220:223], v[232:235]
    v_mfma_f32_16x16x32_bf16 v[220:223], a[32:35], v[60:63], v[220:223]
    s_mov_b32 s21, 43008
    buffer_load_dword v8, v14, s[4:7], s21 offen sc1
    v_mfma_f32_16x16x32_bf16 v[224:227], a[32:35], v[64:67], v[224:227]
    v_mfma_f32_16x16x32_bf16 v[228:231], a[32:35], v[68:71], v[228:231]
    v_mfma_f32_16x16x32_bf16 v[232:235], a[32:35], v[72:75], v[232:235]
    v_mfma_f32_16x16x32_bf16 v[220:223], a[52:55], v[140:143], v[220:223]
    v_mfma_f32_16x16x32_bf16 v[224:227], a[52:55], v[144:147], v[224:227]
    v_mfma_f32_16x16x32_bf16 v[228:231], a[52:55], v[148:151], v[228:231]
    v_mfma_f32_16x16x32_bf16 v[232:235], a[52:55], v[152:155], v[232:235]
    v_mfma_f32_16x16x32_bf16 v[220:223], a[68:71], v[204:207], v[220:223]
    v_mfma_f32_16x16x32_bf16 v[224:227], a[68:71], v[208:211], v[224:227]
    v_mfma_f32_16x16x32_bf16 v[228:231], a[68:71], v[212:215], v[228:231]
    v_mfma_f32_16x16x32_bf16 v[232:235], a[68:71], v[216:219], v[232:235]
    s_add_u32 s28, s28, 18432
    v_mfma_f32_16x16x32_bf16 v[236:239], a[72:75], a[144:147], 0
    v_mfma_f32_16x16x32_bf16 v[240:243], a[72:75], a[148:151], 0
    s_nop 1
    v_cvt_pk_bf16_f32 v20, v220, v221
    v_cvt_pk_bf16_f32 v21, v222, v223
    v_cvt_pk_bf16_f32 v22, v224, v225
    v_cvt_pk_bf16_f32 v23, v226, v227
    v_mfma_f32_16x16x32_bf16 v[244:247], a[72:75], a[152:155], 0
    buffer_store_dwordx4 v[20:23], v4, s[4:7], s44 offen sc1
    ds_write_b128 v12, v[20:23] offset:14336
    v_mfma_f32_16x16x32_bf16 v[248:251], a[72:75], a[156:159], 0
    s_add_u32 s44, s44, 65536
    v_mfma_f32_16x16x32_bf16 v[236:239], a[76:79], a[160:163], v[236:239]
    v_mfma_f32_16x16x32_bf16 v[240:243], a[76:79], a[164:167], v[240:243]
    v_mfma_f32_16x16x32_bf16 v[244:247], a[76:79], a[168:171], v[244:247]
    v_mfma_f32_16x16x32_bf16 v[248:251], a[76:79], a[172:175], v[248:251]
    v_mfma_f32_16x16x32_bf16 v[236:239], a[80:83], a[176:179], v[236:239]
    v_mfma_f32_16x16x32_bf16 v[240:243], a[80:83], a[180:183], v[240:243]
    v_mfma_f32_16x16x32_bf16 v[244:247], a[80:83], a[184:187], v[244:247]
    v_mfma_f32_16x16x32_bf16 v[248:251], a[80:83], a[188:191], v[248:251]
    v_mfma_f32_16x16x32_bf16 v[236:239], a[92:95], a[224:227], v[236:239]
    v_mfma_f32_16x16x32_bf16 v[240:243], a[92:95], a[228:231], v[240:243]
    v_mfma_f32_16x16x32_bf16 v[244:247], a[92:95], a[232:235], v[244:247]
    v_mfma_f32_16x16x32_bf16 v[248:251], a[92:95], a[236:239], v[248:251]
    v_mfma_f32_16x16x32_bf16 v[236:239], a[96:99], a[240:243], v[236:239]
    v_mfma_f32_16x16x32_bf16 v[240:243], a[96:99], a[244:247], v[240:243]
    v_mfma_f32_16x16x32_bf16 v[244:247], a[96:99], a[248:251], v[244:247]
    v_mfma_f32_16x16x32_bf16 v[248:251], a[96:99], a[252:255], v[248:251]
    v_mfma_f32_16x16x32_bf16 v[236:239], a[100:103], v[44:47], v[236:239]
    v_mfma_f32_16x16x32_bf16 v[240:243], a[100:103], v[48:51], v[240:243]
    v_mfma_f32_16x16x32_bf16 v[244:247], a[100:103], v[52:55], v[244:247]
    v_mfma_f32_16x16x32_bf16 v[248:251], a[100:103], v[56:59], v[248:251]
    v_mfma_f32_16x16x32_bf16 v[236:239], a[108:111], v[76:79], v[236:239]
    s_waitcnt vmcnt(4)
    s_waitcnt lgkmcnt(0)
    s_mov_b64 exec, 1
    buffer_atomic_add v5, v6, s[4:7], s46 offen offset:3072 sc1
    s_mov_b64 exec, -1
    v_mfma_f32_16x16x32_bf16 v[240:243], a[108:111], v[80:83], v[240:243]
    v_mfma_f32_16x16x32_bf16 v[244:247], a[108:111], v[84:87], v[244:247]
    v_mfma_f32_16x16x32_bf16 v[248:251], a[108:111], v[88:91], v[248:251]
    v_mfma_f32_16x16x32_bf16 v[236:239], a[112:115], v[92:95], v[236:239]
    v_mfma_f32_16x16x32_bf16 v[240:243], a[112:115], v[96:99], v[240:243]
    v_mfma_f32_16x16x32_bf16 v[244:247], a[112:115], v[100:103], v[244:247]
    v_mfma_f32_16x16x32_bf16 v[248:251], a[112:115], v[104:107], v[248:251]
    v_mfma_f32_16x16x32_bf16 v[236:239], a[116:119], v[108:111], v[236:239]
    v_mfma_f32_16x16x32_bf16 v[240:243], a[116:119], v[112:115], v[240:243]
    v_mfma_f32_16x16x32_bf16 v[244:247], a[116:119], v[116:119], v[244:247]
    v_mfma_f32_16x16x32_bf16 v[248:251], a[116:119], v[120:123], v[248:251]
    v_mfma_f32_16x16x32_bf16 v[236:239], a[128:131], v[156:159], v[236:239]
    v_cvt_pk_bf16_f32 v24, v228, v229
    v_cvt_pk_bf16_f32 v25, v230, v231
    v_cvt_pk_bf16_f32 v26, v232, v233
    v_mfma_f32_16x16x32_bf16 v[240:243], a[128:131], v[160:163], v[240:243]
    v_cvt_pk_bf16_f32 v27, v234, v235
    buffer_store_dwordx4 v[24:27], v16, s[4:7], s56 offen sc1
    v_mfma_f32_16x16x32_bf16 v[244:247], a[128:131], v[164:167], v[244:247]
    ds_write_b128 v13, v[24:27] offset:14336
    v_mfma_f32_16x16x32_bf16 v[248:251], a[128:131], v[168:171], v[248:251]
    s_add_u32 s56, s56, 65536
    v_mfma_f32_16x16x32_bf16 v[236:239], a[132:135], v[172:175], v[236:239]
    v_mfma_f32_16x16x32_bf16 v[240:243], a[132:135], v[176:179], v[240:243]
    v_mfma_f32_16x16x32_bf16 v[244:247], a[132:135], v[180:183], v[244:247]
    v_mfma_f32_16x16x32_bf16 v[248:251], a[132:135], v[184:187], v[248:251]
    v_mfma_f32_16x16x32_bf16 v[236:239], a[136:139], v[188:191], v[236:239]
    v_mfma_f32_16x16x32_bf16 v[240:243], a[136:139], v[192:195], v[240:243]
    v_mfma_f32_16x16x32_bf16 v[244:247], a[136:139], v[196:199], v[244:247]
    v_mfma_f32_16x16x32_bf16 v[248:251], a[136:139], v[200:203], v[248:251]
    v_mfma_f32_16x16x32_bf16 v[236:239], a[84:87], a[192:195], v[236:239]
    s_waitcnt vmcnt(3)
chk_adaLN_cond__ssm_conv_s4d__mixer_s_mlp__prompt_76:
    v_cmp_gt_u32 vcc, 8, v8
    s_nop 0
    s_cmp_eq_u64 vcc, 0
    s_cbranch_scc0 slow_adaLN_cond__ssm_conv_s4d__mixer_s_mlp__prompt_77
    v_mfma_f32_16x16x32_bf16 v[240:243], a[84:87], a[196:199], v[240:243]
    s_add_u32 m0, s48, 8192
    v_mfma_f32_16x16x32_bf16 v[244:247], a[84:87], a[200:203], v[244:247]
    s_mov_b64 exec, s[50:51]
    buffer_load_dwordx4 v28, s[4:7], s45 offen sc1 lds
    s_mov_b64 exec, -1
    v_mfma_f32_16x16x32_bf16 v[248:251], a[84:87], a[204:207], v[248:251]
    s_add_u32 s20, s45, 4096
    v_mfma_f32_16x16x32_bf16 v[236:239], a[120:123], v[124:127], v[236:239]
    s_add_u32 m0, s48, 9216
    v_mfma_f32_16x16x32_bf16 v[240:243], a[120:123], v[128:131], v[240:243]
    s_mov_b64 exec, s[52:53]
    buffer_load_dwordx4 v28, s[4:7], s20 offen sc1 lds
    s_mov_b64 exec, -1
    v_mfma_f32_16x16x32_bf16 v[244:247], a[120:123], v[132:135], v[244:247]
    s_add_u32 s45, s45, 65536
    v_mfma_f32_16x16x32_bf16 v[248:251], a[120:123], v[136:139], v[248:251]
    v_mfma_f32_16x16x32_bf16 v[236:239], a[88:91], a[208:211], v[236:239]
    v_mfma_f32_16x16x32_bf16 v[240:243], a[88:91], a[212:215], v[240:243]
    v_mfma_f32_16x16x32_bf16 v[244:247], a[88:91], a[216:219], v[244:247]
    v_mfma_f32_16x16x32_bf16 v[248:251], a[88:91], a[220:223], v[248:251]
    v_mfma_f32_16x16x32_bf16 v[236:239], a[104:107], v[60:63], v[236:239]
    s_mov_b32 s21, 43520
    buffer_load_dword v8, v14, s[4:7], s21 offen sc1
    v_mfma_f32_16x16x32_bf16 v[240:243], a[104:107], v[64:67], v[240:243]
    v_mfma_f32_16x16x32_bf16 v[244:247], a[104:107], v[68:71], v[244:247]
    v_mfma_f32_16x16x32_bf16 v[248:251], a[104:107], v[72:75], v[248:251]
    v_mfma_f32_16x16x32_bf16 v[236:239], a[124:127], v[140:143], v[236:239]
    v_mfma_f32_16x16x32_bf16 v[240:243], a[124:127], v[144:147], v[240:243]
    v_mfma_f32_16x16x32_bf16 v[244:247], a[124:127], v[148:151], v[244:247]
    v_mfma_f32_16x16x32_bf16 v[248:251], a[124:127], v[152:155], v[248:251]
    v_mfma_f32_16x16x32_bf16 v[236:239], a[140:143], v[204:207], v[236:239]
    v_mfma_f32_16x16x32_bf16 v[240:243], a[140:143], v[208:211], v[240:243]
    v_mfma_f32_16x16x32_bf16 v[244:247], a[140:143], v[212:215], v[244:247]
    v_mfma_f32_16x16x32_bf16 v[248:251], a[140:143], v[216:219], v[248:251]
    s_nop 4
    v_cvt_pk_bf16_f32 v20, v236, v237
    v_cvt_pk_bf16_f32 v21, v238, v239
    v_cvt_pk_bf16_f32 v22, v240, v241
    v_cvt_pk_bf16_f32 v23, v242, v243
    buffer_store_dwordx4 v[20:23], v4, s[4:7], s44 offen sc1
    ds_write_b128 v12, v[20:23] offset:16384
    s_add_u32 s44, s44, 65536
    v_cvt_pk_bf16_f32 v24, v244, v245
    v_cvt_pk_bf16_f32 v25, v246, v247
    v_cvt_pk_bf16_f32 v26, v248, v249
    v_cvt_pk_bf16_f32 v27, v250, v251
    buffer_store_dwordx4 v[24:27], v16, s[4:7], s56 offen sc1
    ds_write_b128 v13, v[24:27] offset:16384
    s_add_u32 s56, s56, 65536
    s_waitcnt vmcnt(5)
    s_waitcnt lgkmcnt(0)
    s_mov_b64 exec, 1
    buffer_atomic_add v5, v6, s[4:7], s46 offen offset:3584 sc1
    s_mov_b64 exec, -1
    s_waitcnt vmcnt(3)
chk_adaLN_cond__ssm_conv_s4d__mixer_s_mlp__prompt_78:
    v_cmp_gt_u32 vcc, 8, v8
    s_nop 0
    s_cmp_eq_u64 vcc, 0
    s_cbranch_scc0 slow_adaLN_cond__ssm_conv_s4d__mixer_s_mlp__prompt_79
    s_add_u32 m0, s48, 10240
    s_mov_b64 exec, s[50:51]
    buffer_load_dwordx4 v28, s[4:7], s45 offen sc1 lds
    s_mov_b64 exec, -1
    s_add_u32 s20, s45, 4096
    s_add_u32 m0, s48, 11264
    s_mov_b64 exec, s[52:53]
    buffer_load_dwordx4 v28, s[4:7], s20 offen sc1 lds
    s_mov_b64 exec, -1
    s_add_u32 s45, s45, 65536
    s_mov_b32 s21, 44032
    buffer_load_dword v8, v14, s[4:7], s21 offen sc1
    ds_read_b128 v[44:47], v31 offset:0
    ds_read_b128 v[48:51], v31 offset:1024
    ds_read_b32 v10, v32 offset:0
    ds_read_b32 v11, v254 offset:0
    ds_read_b64 v[52:53], v33 offset:0
    ds_read_b128 v[54:57], v31 offset:2048
    ds_read_b128 v[58:61], v31 offset:3072
    ds_read_b32 v62, v32 offset:256
    ds_read_b32 v63, v254 offset:256
    ds_read_b64 v[64:65], v33 offset:64
    ds_read_b128 v[66:69], v31 offset:4096
    ds_read_b128 v[70:73], v31 offset:5120
    ds_read_b32 v74, v32 offset:512
    ds_read_b32 v75, v254 offset:512
    ds_read_b64 v[76:77], v33 offset:128
    s_waitcnt lgkmcnt(10)
    v_lshlrev_b32 v150, 16, v44
    v_lshlrev_b32 v151, 16, v48
    v_lshlrev_b32 v152, 16, v45
    v_lshlrev_b32 v153, 16, v49
    v_lshlrev_b32 v154, 16, v46
    v_lshlrev_b32 v155, 16, v50
    v_lshlrev_b32 v156, 16, v47
    v_lshlrev_b32 v157, 16, v51
    v_and_b32 v44, 0xffff0000, v44
    v_add_f32 v150, v150, v151
    v_and_b32 v48, 0xffff0000, v48
    v_and_b32 v45, 0xffff0000, v45
    v_add_f32 v152, v152, v153
    v_and_b32 v49, 0xffff0000, v49
    v_and_b32 v46, 0xffff0000, v46
    v_add_f32 v154, v154, v155
    v_and_b32 v50, 0xffff0000, v50
    v_and_b32 v47, 0xffff0000, v47
    v_add_f32 v156, v156, v157
    v_and_b32 v51, 0xffff0000, v51
    v_add_f32 v151, v44, v48
    v_add_f32 v153, v45, v49
    v_add_f32 v155, v46, v50
    v_add_f32 v157, v47, v51
    v_permlane32_swap_b32 v150, v154
    v_permlane32_swap_b32 v152, v156
    v_permlane32_swap_b32 v151, v155
    v_permlane32_swap_b32 v153, v157
    v_add_f32 v150, v150, v154
    v_add_f32 v152, v152, v156
    v_add_f32 v151, v151, v155
    v_add_f32 v153, v153, v157
    v_lshlrev_b32 v156, 16, v11
    v_and_b32 v157, 0xffff0000, v11
    v_permlane16_swap_b32 v150, v152
    v_permlane16_swap_b32 v151, v153
    v_lshlrev_b32 v154, 16, v10
    v_and_b32 v155, 0xffff0000, v10
    v_add_f32 v150, v150, v152
    v_add_f32 v151, v151, v153
    v_add_f32 v150, v150, v156
    v_add_f32 v151, v151, v157
    v_fma_f32 v150, v150, v52, v154
    v_fma_f32 v151, v151, v53, v155
    v_cvt_pk_bf16_f32 v154, v150, v151
    ds_write_b32 v34, v154 offset:0
    s_add_u32 s46, s46, 4096
    s_waitcnt vmcnt(4)
    s_waitcnt lgkmcnt(0)
    s_mov_b64 exec, 1
    buffer_atomic_add v5, v6, s[4:7], s46 offen offset:0 sc1
    s_mov_b64 exec, -1
    v_lshlrev_b32 v150, 16, v54
    v_lshlrev_b32 v151, 16, v58
    v_lshlrev_b32 v152, 16, v55
    v_lshlrev_b32 v153, 16, v59
    v_lshlrev_b32 v154, 16, v56
    v_lshlrev_b32 v155, 16, v60
    v_lshlrev_b32 v156, 16, v57
    v_lshlrev_b32 v157, 16, v61
    v_and_b32 v54, 0xffff0000, v54
    v_add_f32 v150, v150, v151
    v_and_b32 v58, 0xffff0000, v58
    v_and_b32 v55, 0xffff0000, v55
    v_add_f32 v152, v152, v153
    v_and_b32 v59, 0xffff0000, v59
    v_and_b32 v56, 0xffff0000, v56
    v_add_f32 v154, v154, v155
    v_and_b32 v60, 0xffff0000, v60
    v_and_b32 v57, 0xffff0000, v57
    v_add_f32 v156, v156, v157
    v_and_b32 v61, 0xffff0000, v61
    v_add_f32 v151, v54, v58
    v_add_f32 v153, v55, v59
    v_add_f32 v155, v56, v60
    v_add_f32 v157, v57, v61
    v_permlane32_swap_b32 v150, v154
    v_permlane32_swap_b32 v152, v156
    v_permlane32_swap_b32 v151, v155
    v_permlane32_swap_b32 v153, v157
    v_add_f32 v150, v150, v154
    v_add_f32 v152, v152, v156
    v_add_f32 v151, v151, v155
    v_add_f32 v153, v153, v157
    v_lshlrev_b32 v156, 16, v63
    v_and_b32 v157, 0xffff0000, v63
    v_permlane16_swap_b32 v150, v152
    v_permlane16_swap_b32 v151, v153
    v_lshlrev_b32 v154, 16, v62
    v_and_b32 v155, 0xffff0000, v62
    v_add_f32 v150, v150, v152
    v_add_f32 v151, v151, v153
    v_add_f32 v150, v150, v156
    v_add_f32 v151, v151, v157
    v_fma_f32 v150, v150, v64, v154
    v_fma_f32 v151, v151, v65, v155
    v_cvt_pk_bf16_f32 v154, v150, v151
    ds_write_b32 v34, v154 offset:32
    s_waitcnt vmcnt(1)
chk_adaLN_cond__ssm_conv_s4d__mixer_s_mlp__prompt_80:
    v_cmp_gt_u32 vcc, 8, v8
    s_nop 0
    s_cmp_eq_u64 vcc, 0
    s_cbranch_scc0 slow_adaLN_cond__ssm_conv_s4d__mixer_s_mlp__prompt_81
    s_add_u32 m0, s48, 12288
    s_mov_b64 exec, s[50:51]
    buffer_load_dwordx4 v28, s[4:7], s45 offen sc1 lds
    s_mov_b64 exec, -1
    s_add_u32 s20, s45, 4096
    s_add_u32 m0, s48, 13312
    s_mov_b64 exec, s[52:53]
    buffer_load_dwordx4 v28, s[4:7], s20 offen sc1 lds
    s_mov_b64 exec, -1
    s_add_u32 s45, s45, 65536
    s_mov_b32 s21, 44544
    buffer_load_dword v8, v14, s[4:7], s21 offen sc1
    ds_read_b128 v[78:81], v31 offset:6144
    ds_read_b128 v[82:85], v31 offset:7168
    ds_read_b32 v86, v32 offset:768
    ds_read_b32 v87, v254 offset:768
    ds_read_b64 v[88:89], v33 offset:192
    ds_read_b128 v[90:93], v31 offset:8192
    ds_read_b128 v[94:97], v31 offset:9216
    ds_read_b32 v98, v32 offset:1024
    ds_read_b32 v99, v254 offset:1024
    ds_read_b64 v[100:101], v33 offset:256
    v_lshlrev_b32 v150, 16, v66
    v_lshlrev_b32 v151, 16, v70
    v_lshlrev_b32 v152, 16, v67
    v_lshlrev_b32 v153, 16, v71
    v_lshlrev_b32 v154, 16, v68
    v_lshlrev_b32 v155, 16, v72
    v_lshlrev_b32 v156, 16, v69
    v_lshlrev_b32 v157, 16, v73
    v_and_b32 v66, 0xffff0000, v66
    v_add_f32 v150, v150, v151
    v_and_b32 v70, 0xffff0000, v70
    v_and_b32 v67, 0xffff0000, v67
    v_add_f32 v152, v152, v153
    v_and_b32 v71, 0xffff0000, v71
    v_and_b32 v68, 0xffff0000, v68
    v_add_f32 v154, v154, v155
    v_and_b32 v72, 0xffff0000, v72
    v_and_b32 v69, 0xffff0000, v69
    v_add_f32 v156, v156, v157
    v_and_b32 v73, 0xffff0000, v73
    v_add_f32 v151, v66, v70
    v_add_f32 v153, v67, v71
    v_add_f32 v155, v68, v72
    v_add_f32 v157, v69, v73
    v_permlane32_swap_b32 v150, v154
    v_permlane32_swap_b32 v152, v156
    v_permlane32_swap_b32 v151, v155
    v_permlane32_swap_b32 v153, v157
    v_add_f32 v150, v150, v154
    v_add_f32 v152, v152, v156
    v_add_f32 v151, v151, v155
    v_add_f32 v153, v153, v157
    v_lshlrev_b32 v156, 16, v75
    v_and_b32 v157, 0xffff0000, v75
    v_permlane16_swap_b32 v150, v152
    v_permlane16_swap_b32 v151, v153
    v_lshlrev_b32 v154, 16, v74
    v_and_b32 v155, 0xffff0000, v74
    v_add_f32 v150, v150, v152
    v_add_f32 v151, v151, v153
    v_add_f32 v150, v150, v156
    v_add_f32 v151, v151, v157
    v_fma_f32 v150, v150, v76, v154
    v_fma_f32 v151, v151, v77, v155
    v_cvt_pk_bf16_f32 v154, v150, v151
    ds_write_b32 v34, v154 offset:64
    s_waitcnt lgkmcnt(6)
    v_lshlrev_b32 v150, 16, v78
    v_lshlrev_b32 v151, 16, v82
    v_lshlrev_b32 v152, 16, v79
    v_lshlrev_b32 v153, 16, v83
    v_lshlrev_b32 v154, 16, v80
    v_lshlrev_b32 v155, 16, v84
    v_lshlrev_b32 v156, 16, v81
    v_lshlrev_b32 v157, 16, v85
    v_and_b32 v78, 0xffff0000, v78
    v_add_f32 v150, v150, v151
    v_and_b32 v82, 0xffff0000, v82
    v_and_b32 v79, 0xffff0000, v79
    v_add_f32 v152, v152, v153
    v_and_b32 v83, 0xffff0000, v83
    v_and_b32 v80, 0xffff0000, v80
    v_add_f32 v154, v154, v155
    v_and_b32 v84, 0xffff0000, v84
    v_and_b32 v81, 0xffff0000, v81
    v_add_f32 v156, v156, v157
    v_and_b32 v85, 0xffff0000, v85
    v_add_f32 v151, v78, v82
    v_add_f32 v153, v79, v83
    v_add_f32 v155, v80, v84
    v_add_f32 v157, v81, v85
    v_permlane32_swap_b32 v150, v154
    v_permlane32_swap_b32 v152, v156
    v_permlane32_swap_b32 v151, v155
    v_permlane32_swap_b32 v153, v157
    v_add_f32 v150, v150, v154
    v_add_f32 v152, v152, v156
    v_add_f32 v151, v151, v155
    v_add_f32 v153, v153, v157
    v_lshlrev_b32 v156, 16, v87
    v_and_b32 v157, 0xffff0000, v87
    v_permlane16_swap_b32 v150, v152
    v_permlane16_swap_b32 v151, v153
    v_lshlrev_b32 v154, 16, v86
    v_and_b32 v155, 0xffff0000, v86
    v_add_f32 v150, v150, v152
    v_add_f32 v151, v151, v153
    v_add_f32 v150, v150, v156
    v_add_f32 v151, v151, v157
    v_fma_f32 v150, v150, v88, v154
    v_fma_f32 v151, v151, v89, v155
    v_cvt_pk_bf16_f32 v154, v150, v151
    ds_write_b32 v34, v154 offset:96
    s_waitcnt vmcnt(0)
chk_adaLN_cond__ssm_conv_s4d__mixer_s_mlp__prompt_82:
    v_cmp_gt_u32 vcc, 8, v8
    s_nop 0
    s_cmp_eq_u64 vcc, 0
    s_cbranch_scc0 slow_adaLN_cond__ssm_conv_s4d__mixer_s_mlp__prompt_83
    s_add_u32 m0, s48, 14336
    s_mov_b64 exec, s[50:51]
    buffer_load_dwordx4 v28, s[4:7], s45 offen sc1 lds
    s_mov_b64 exec, -1
    s_add_u32 s20, s45, 4096
    s_add_u32 m0, s48, 15360
    s_mov_b64 exec, s[52:53]
    buffer_load_dwordx4 v28, s[4:7], s20 offen sc1 lds
    s_mov_b64 exec, -1
    s_add_u32 s45, s45, 65536
    s_mov_b32 s21, 45056
    buffer_load_dword v8, v14, s[4:7], s21 offen sc1
    ds_read_b128 v[102:105], v31 offset:10240
    ds_read_b128 v[106:109], v31 offset:11264
    ds_read_b32 v110, v32 offset:1280
    ds_read_b32 v111, v254 offset:1280
    ds_read_b64 v[112:113], v33 offset:320
    s_waitcnt lgkmcnt(7)
    v_lshlrev_b32 v150, 16, v90
    v_lshlrev_b32 v151, 16, v94
    v_lshlrev_b32 v152, 16, v91
    v_lshlrev_b32 v153, 16, v95
    v_lshlrev_b32 v154, 16, v92
    v_lshlrev_b32 v155, 16, v96
    v_lshlrev_b32 v156, 16, v93
    v_lshlrev_b32 v157, 16, v97
    v_and_b32 v90, 0xffff0000, v90
    v_add_f32 v150, v150, v151
    v_and_b32 v94, 0xffff0000, v94
    v_and_b32 v91, 0xffff0000, v91
    v_add_f32 v152, v152, v153
    v_and_b32 v95, 0xffff0000, v95
    v_and_b32 v92, 0xffff0000, v92
    v_add_f32 v154, v154, v155
    v_and_b32 v96, 0xffff0000, v96
    v_and_b32 v93, 0xffff0000, v93
    v_add_f32 v156, v156, v157
    v_and_b32 v97, 0xffff0000, v97
    v_add_f32 v151, v90, v94
    v_add_f32 v153, v91, v95
    v_add_f32 v155, v92, v96
    v_add_f32 v157, v93, v97
    v_permlane32_swap_b32 v150, v154
    v_permlane32_swap_b32 v152, v156
    v_permlane32_swap_b32 v151, v155
    v_permlane32_swap_b32 v153, v157
    v_add_f32 v150, v150, v154
    v_add_f32 v152, v152, v156
    v_add_f32 v151, v151, v155
    v_add_f32 v153, v153, v157
    v_lshlrev_b32 v156, 16, v99
    v_and_b32 v157, 0xffff0000, v99
    v_permlane16_swap_b32 v150, v152
    v_permlane16_swap_b32 v151, v153
    v_lshlrev_b32 v154, 16, v98
    v_and_b32 v155, 0xffff0000, v98
    v_add_f32 v150, v150, v152
    v_add_f32 v151, v151, v153
    v_add_f32 v150, v150, v156
    v_add_f32 v151, v151, v157
    v_fma_f32 v150, v150, v100, v154
    v_fma_f32 v151, v151, v101, v155
    v_cvt_pk_bf16_f32 v154, v150, v151
    ds_write_b32 v34, v154 offset:128
    s_waitcnt lgkmcnt(1)
    v_lshlrev_b32 v150, 16, v102
    v_lshlrev_b32 v151, 16, v106
    v_lshlrev_b32 v152, 16, v103
    v_lshlrev_b32 v153, 16, v107
    v_lshlrev_b32 v154, 16, v104
    v_lshlrev_b32 v155, 16, v108
    v_lshlrev_b32 v156, 16, v105
    v_lshlrev_b32 v157, 16, v109
    v_and_b32 v102, 0xffff0000, v102
    v_add_f32 v150, v150, v151
    v_and_b32 v106, 0xffff0000, v106
    v_and_b32 v103, 0xffff0000, v103
    v_add_f32 v152, v152, v153
    v_and_b32 v107, 0xffff0000, v107
    v_and_b32 v104, 0xffff0000, v104
    v_add_f32 v154, v154, v155
    v_and_b32 v108, 0xffff0000, v108
    v_and_b32 v105, 0xffff0000, v105
    v_add_f32 v156, v156, v157
    v_and_b32 v109, 0xffff0000, v109
    v_add_f32 v151, v102, v106
    v_add_f32 v153, v103, v107
    v_add_f32 v155, v104, v108
    v_add_f32 v157, v105, v109
    v_permlane32_swap_b32 v150, v154
    v_permlane32_swap_b32 v152, v156
    v_permlane32_swap_b32 v151, v155
    v_permlane32_swap_b32 v153, v157
    v_add_f32 v150, v150, v154
    v_add_f32 v152, v152, v156
    v_add_f32 v151, v151, v155
    v_add_f32 v153, v153, v157
    v_lshlrev_b32 v156, 16, v111
    v_and_b32 v157, 0xffff0000, v111
    v_permlane16_swap_b32 v150, v152
    v_permlane16_swap_b32 v151, v153
    v_lshlrev_b32 v154, 16, v110
    v_and_b32 v155, 0xffff0000, v110
    v_add_f32 v150, v150, v152
    v_add_f32 v151, v151, v153
    v_add_f32 v150, v150, v156
    v_add_f32 v151, v151, v157
    v_fma_f32 v150, v150, v112, v154
    v_fma_f32 v151, v151, v113, v155
    v_cvt_pk_bf16_f32 v154, v150, v151
    ds_write_b32 v34, v154 offset:160
    v_mul_u32_u24 v158, 3641, v0
    v_lshrrev_b32 v158, 16, v158
    v_mul_u32_u24 v159, 18, v158
    v_sub_u32 v159, v0, v159
    v_lshlrev_b32 v159, 4, v159
    v_mul_u32_u24 v35, 304, v158
    v_add_u32 v35, v35, v159
    v_add_u32 v35, 87040, v35
    v_mul_u32_u24 v30, 1152, v158
    v_add_u32 v30, v30, v159
    s_lshl_b32 s20, s18, 1
    s_and_b32 s31, s19, 1
    s_add_u32 s31, s31, s20
    s_mul_i32 s31, s31, 36864
    s_lshl_b32 s20, s47, 5
    s_add_u32 s31, s31, s20
    s_waitcnt vmcnt(0)
chk_adaLN_cond__ssm_conv_s4d__mixer_s_mlp__prompt_84:
    v_cmp_gt_u32 vcc, 8, v8
    s_nop 0
    s_cmp_eq_u64 vcc, 0
    s_cbranch_scc1 slow_adaLN_cond__ssm_conv_s4d__mixer_s_mlp__prompt_85
    s_mov_b32 s21, 45056
    buffer_load_dword v8, v14, s[4:7], s21 offen sc1
    s_waitcnt vmcnt(0)
    s_add_u32 s24, s24, 1
    s_cmp_lt_u32 s24, 40000
    s_cbranch_scc1 chk_adaLN_cond__ssm_conv_s4d__mixer_s_mlp__prompt_84
    s_branch all_done
slow_adaLN_cond__ssm_conv_s4d__mixer_s_mlp__prompt_85:
    s_add_u32 m0, s48, 16384
    s_mov_b64 exec, s[50:51]
    buffer_load_dwordx4 v28, s[4:7], s45 offen sc1 lds
    s_mov_b64 exec, -1
    s_add_u32 s20, s45, 4096
    s_add_u32 m0, s48, 17408
    s_mov_b64 exec, s[52:53]
    buffer_load_dwordx4 v28, s[4:7], s20 offen sc1 lds
    s_mov_b64 exec, -1
    s_add_u32 s45, s45, 65536
    ds_read_b128 v[114:117], v31 offset:12288
    ds_read_b128 v[118:121], v31 offset:13312
    ds_read_b32 v122, v32 offset:1536
    ds_read_b32 v123, v254 offset:1536
    ds_read_b64 v[124:125], v33 offset:384
    ds_read_b128 v[126:129], v31 offset:14336
    ds_read_b128 v[130:133], v31 offset:15360
    ds_read_b32 v134, v32 offset:1792
    ds_read_b32 v135, v254 offset:1792
    ds_read_b64 v[136:137], v33 offset:448
    s_waitcnt lgkmcnt(5)
    v_lshlrev_b32 v150, 16, v114
    v_lshlrev_b32 v151, 16, v118
    v_lshlrev_b32 v152, 16, v115
    v_lshlrev_b32 v153, 16, v119
    v_lshlrev_b32 v154, 16, v116
    v_lshlrev_b32 v155, 16, v120
    v_lshlrev_b32 v156, 16, v117
    v_lshlrev_b32 v157, 16, v121
    v_and_b32 v114, 0xffff0000, v114
    v_add_f32 v150, v150, v151
    v_and_b32 v118, 0xffff0000, v118
    v_and_b32 v115, 0xffff0000, v115
    v_add_f32 v152, v152, v153
    v_and_b32 v119, 0xffff0000, v119
    v_and_b32 v116, 0xffff0000, v116
    v_add_f32 v154, v154, v155
    v_and_b32 v120, 0xffff0000, v120
    v_and_b32 v117, 0xffff0000, v117
    v_add_f32 v156, v156, v157
    v_and_b32 v121, 0xffff0000, v121
    v_add_f32 v151, v114, v118
    v_add_f32 v153, v115, v119
    v_add_f32 v155, v116, v120
    v_add_f32 v157, v117, v121
    v_permlane32_swap_b32 v150, v154
    v_permlane32_swap_b32 v152, v156
    v_permlane32_swap_b32 v151, v155
    v_permlane32_swap_b32 v153, v157
    v_add_f32 v150, v150, v154
    v_add_f32 v152, v152, v156
    v_add_f32 v151, v151, v155
    v_add_f32 v153, v153, v157
    v_lshlrev_b32 v156, 16, v123
    v_and_b32 v157, 0xffff0000, v123
    v_permlane16_swap_b32 v150, v152
    v_permlane16_swap_b32 v151, v153
    v_lshlrev_b32 v154, 16, v122
    v_and_b32 v155, 0xffff0000, v122
    v_add_f32 v150, v150, v152
    v_add_f32 v151, v151, v153
    v_add_f32 v150, v150, v156
    v_add_f32 v151, v151, v157
    v_fma_f32 v150, v150, v124, v154
    v_fma_f32 v151, v151, v125, v155
    v_cvt_pk_bf16_f32 v154, v150, v151
    ds_write_b32 v34, v154 offset:192
    s_waitcnt lgkmcnt(1)
    v_lshlrev_b32 v150, 16, v126
    v_lshlrev_b32 v151, 16, v130
    v_lshlrev_b32 v152, 16, v127
    v_lshlrev_b32 v153, 16, v131
    v_lshlrev_b32 v154, 16, v128
    v_lshlrev_b32 v155, 16, v132
    v_lshlrev_b32 v156, 16, v129
    v_lshlrev_b32 v157, 16, v133
    v_and_b32 v126, 0xffff0000, v126
    v_add_f32 v150, v150, v151
    v_and_b32 v130, 0xffff0000, v130
    v_and_b32 v127, 0xffff0000, v127
    v_add_f32 v152, v152, v153
    v_and_b32 v131, 0xffff0000, v131
    v_and_b32 v128, 0xffff0000, v128
    v_add_f32 v154, v154, v155
    v_and_b32 v132, 0xffff0000, v132
    v_and_b32 v129, 0xffff0000, v129
    v_add_f32 v156, v156, v157
    v_and_b32 v133, 0xffff0000, v133
    v_add_f32 v151, v126, v130
    v_add_f32 v153, v127, v131
    v_add_f32 v155, v128, v132
    v_add_f32 v157, v129, v133
    v_permlane32_swap_b32 v150, v154
    v_permlane32_swap_b32 v152, v156
    v_permlane32_swap_b32 v151, v155
    v_permlane32_swap_b32 v153, v157
    v_add_f32 v150, v150, v154
    v_add_f32 v152, v152, v156
    v_add_f32 v151, v151, v155
    v_add_f32 v153, v153, v157
    v_lshlrev_b32 v156, 16, v135
    v_and_b32 v157, 0xffff0000, v135
    v_permlane16_swap_b32 v150, v152
    v_permlane16_swap_b32 v151, v153
    v_lshlrev_b32 v154, 16, v134
    v_and_b32 v155, 0xffff0000, v134
    v_add_f32 v150, v150, v152
    v_add_f32 v151, v151, v153
    v_add_f32 v150, v150, v156
    v_add_f32 v151, v151, v157
    v_fma_f32 v150, v150, v136, v154
    v_fma_f32 v151, v151, v137, v155
    v_cvt_pk_bf16_f32 v154, v150, v151
    ds_write_b32 v34, v154 offset:224
    s_waitcnt vmcnt(0)
    ds_read_b128 v[138:141], v31 offset:16384
    ds_read_b128 v[142:145], v31 offset:17408
    ds_read_b32 v146, v32 offset:2048
    ds_read_b32 v147, v254 offset:2048
    ds_read_b64 v[148:149], v33 offset:512
    s_waitcnt lgkmcnt(0)
    v_lshlrev_b32 v150, 16, v138
    v_lshlrev_b32 v151, 16, v142
    v_lshlrev_b32 v152, 16, v139
    v_lshlrev_b32 v153, 16, v143
    v_lshlrev_b32 v154, 16, v140
    v_lshlrev_b32 v155, 16, v144
    v_lshlrev_b32 v156, 16, v141
    v_lshlrev_b32 v157, 16, v145
    v_and_b32 v138, 0xffff0000, v138
    v_add_f32 v150, v150, v151
    v_and_b32 v142, 0xffff0000, v142
    v_and_b32 v139, 0xffff0000, v139
    v_add_f32 v152, v152, v153
    v_and_b32 v143, 0xffff0000, v143
    v_and_b32 v140, 0xffff0000, v140
    v_add_f32 v154, v154, v155
    v_and_b32 v144, 0xffff0000, v144
    v_and_b32 v141, 0xffff0000, v141
    v_add_f32 v156, v156, v157
    v_and_b32 v145, 0xffff0000, v145
    v_add_f32 v151, v138, v142
    v_add_f32 v153, v139, v143
    v_add_f32 v155, v140, v144
    v_add_f32 v157, v141, v145
    v_permlane32_swap_b32 v150, v154
    v_permlane32_swap_b32 v152, v156
    v_permlane32_swap_b32 v151, v155
    v_permlane32_swap_b32 v153, v157
    v_add_f32 v150, v150, v154
    v_add_f32 v152, v152, v156
    v_add_f32 v151, v151, v155
    v_add_f32 v153, v153, v157
    v_lshlrev_b32 v156, 16, v147
    v_and_b32 v157, 0xffff0000, v147
    v_permlane16_swap_b32 v150, v152
    v_permlane16_swap_b32 v151, v153
    v_lshlrev_b32 v154, 16, v146
    v_and_b32 v155, 0xffff0000, v146
    v_add_f32 v150, v150, v152
    v_add_f32 v151, v151, v153
    v_add_f32 v150, v150, v156
    v_add_f32 v151, v151, v157
    v_fma_f32 v150, v150, v148, v154
    v_fma_f32 v151, v151, v149, v155
    v_cvt_pk_bf16_f32 v154, v150, v151
    ds_write_b32 v34, v154 offset:256
    s_waitcnt lgkmcnt(0)
    s_barrier
    v_cmp_gt_u32 vcc, 252, v0
    s_nop 0
    s_and_b64 exec, exec, vcc
    ds_read_b128 v[44:47], v35 offset:0
    ds_read_b128 v[48:51], v35 offset:4256
    ds_read_b128 v[54:57], v35 offset:8512
    s_waitcnt lgkmcnt(2)
    buffer_store_dwordx4 v[44:47], v30, s[40:43], s31 offen
    s_add_u32 s31, s31, 16128
    s_waitcnt lgkmcnt(1)
    buffer_store_dwordx4 v[48:51], v30, s[40:43], s31 offen
    s_add_u32 s31, s31, 16128
    s_cmp_ge_u32 s3, 2
    s_cbranch_scc1 all_done
    v_cmp_gt_u32 vcc, 72, v0
    s_nop 0
    s_and_b64 exec, exec, vcc
    s_waitcnt lgkmcnt(0)
    buffer_store_dwordx4 v[54:57], v30, s[40:43], s31 offen
all_done:
exit:
    s_endpgm
k1_service:
    s_mov_b32 s40, s36
    s_mov_b32 s41, s37
    s_mov_b32 s42, 67108864
    s_mov_b32 s43, 0x20000
    s_mov_b32 s44, s34
    s_mov_b32 s45, s35
    s_mov_b32 s46, 256
    s_mov_b32 s47, 0x20000
    v_lshrrev_b32 v10, 4, v1
    v_and_b32 v11, 15, v1
    v_lshlrev_b32 v9, 4, v1
    v_lshrrev_b32 v160, 3, v1
    v_bfe_u32 v162, v1, 5, 1
    s_and_b32 vcc_lo, s3, 1
    v_xor_b32 v162, vcc_lo, v162
    v_bfe_u32 v163, v1, 4, 1
    v_lshl_or_b32 v162, v162, 1, v163
    v_lshlrev_b32 v162, 1, v162
    v_and_b32 v163, 7, v1
    v_xor_b32 v162, v162, v163
    v_lshlrev_b32 v161, 4, v162
    s_cmp_ge_u32 s2, 103
    s_cbranch_scc1 w1_adaLN_cond__ssm_conv_s4d__mixer_s_mlp__prompt_4
    s_cmp_ge_u32 s2, 64
    s_cbranch_scc1 mod_adaLN_cond__ssm_conv_s4d__mixer_s_mlp__prompt_1
    s_mov_b32 s48, s4
    s_mov_b32 s49, s5
    s_mov_b32 s50, 2359296
    s_mov_b32 s51, 0x20000
    s_and_b32 s58, s3, 1
    s_lshl_b32 s65, s2, 1
    s_add_u32 s58, s58, s65
    s_lshl_b32 s58, s58, 4
    v_and_b32 v166, 7, v11
    v_lshrrev_b32 v168, 3, v11
    v_lshl_add_u32 v171, v166, 1, v168
    v_add_u32 v163, s58, v171
    s_lshr_b32 s65, s3, 1
    s_mul_i32 s58, s65, 576
    v_mul_u32_u24 v162, 1152, v163
    v_lshl_add_u32 v162, v10, 4, v162
    v_mov_b32 v4, 0
    v_mov_b32 v5, 0
    v_mov_b32 v6, 0
    v_mov_b32 v7, 0
    s_lshl_b32 s56, s2, 8
    s_add_u32 s56, s56, 262144
    s_cmp_eq_u32 s3, 0
    s_cselect_b32 s56, s56, 67108864
    s_mov_b64 exec, 0xffff
    buffer_store_dwordx4 v[4:7], v9, s[40:43], s56 offen sc1
    s_mov_b64 exec, -1
    s_or_b32 s56, s2, s3
    s_cmp_eq_u32 s56, 0
    s_mov_b32 s56, 36864
    s_cselect_b32 s56, s56, 67108864
    buffer_store_dwordx4 v[4:7], v9, s[40:43], s56 offen sc1
    buffer_store_dwordx4 v[4:7], v9, s[40:43], s56 offen offset:1024 sc1
    buffer_store_dwordx4 v[4:7], v9, s[40:43], s56 offen offset:2048 sc1
    buffer_load_dwordx4 v[12:15], v162, s[48:51], s58 offen offset:0
    buffer_load_dwordx4 v[16:19], v162, s[48:51], s58 offen offset:64
    buffer_load_dwordx4 v[20:23], v162, s[48:51], s58 offen offset:128
    buffer_load_dwordx4 v[24:27], v162, s[48:51], s58 offen offset:192
    buffer_load_dwordx4 v[28:31], v162, s[48:51], s58 offen offset:256
    buffer_load_dwordx4 v[32:35], v162, s[48:51], s58 offen offset:320
    buffer_load_dwordx4 v[36:39], v162, s[48:51], s58 offen offset:384
    buffer_load_dwordx4 v[40:43], v162, s[48:51], s58 offen offset:448
    buffer_load_dwordx4 v[44:47], v162, s[48:51], s58 offen offset:512
    v_mov_b32 v4, 0
    v_mov_b32 v5, 0
    v_mov_b32 v6, 0
    v_mov_b32 v7, 0
    v_mov_b32 v8, 1
    s_mov_b32 s59, 0
    s_add_u32 s60, s2, 32
    s_sub_u32 s62, s2, 64
    s_cmp_ge_u32 s2, 64
    s_cselect_b32 s60, s62, s60
    s_sub_u32 s62, s2, 58
    s_cmp_ge_u32 s2, 73
    s_cselect_b32 s60, s62, s60
    s_cmp_ge_u32 s2, 90
    s_cselect_b32 s60, 200, s60
    s_sub_u32 s62, s2, 82
    s_cmp_ge_u32 s2, 91
    s_cselect_b32 s60, s62, s60
    s_cmp_ge_u32 s2, 97
    s_cselect_b32 s60, 200, s60
    s_sub_u32 s62, s2, 7
    s_cmp_ge_u32 s2, 103
    s_cselect_b32 s60, s62, s60
    s_mov_b32 s52, s30
    s_mov_b32 s53, s31
    s_mov_b32 s54, 3981312
    s_mov_b32 s55, 0x20000
    s_mov_b32 s61, 0
    s_cmp_ge_u32 s60, 9
    s_cselect_b32 s62, 30, 45
    s_add_u32 s62, s62, s60
    s_mov_b32 s64, 6912
    s_sub_u32 s63, s60, 15
    s_cmp_ge_u32 s60, 15
    s_cselect_b32 s62, s63, s62
    s_cselect_b32 s61, 2, s61
    s_cselect_b32 s64, 1152, s64
    s_cselect_b32 s52, s22, s52
    s_cselect_b32 s53, s23, s53
    s_cselect_b32 s54, 663552, s54
    s_sub_u32 s63, s60, 24
    s_cmp_ge_u32 s60, 24
    s_cselect_b32 s62, s63, s62
    s_cselect_b32 s61, 3, s61
    s_cselect_b32 s64, 9216, s64
    s_cselect_b32 s52, s24, s52
    s_cselect_b32 s53, s25, s53
    s_cselect_b32 s54, 5308416, s54
    s_sub_u32 s63, s60, 96
    s_cmp_ge_u32 s60, 96
    s_cselect_b32 s62, s63, s62
    s_cselect_b32 s61, 1, s61
    s_cselect_b32 s64, 1152, s64
    s_cselect_b32 s52, s20, s52
    s_cselect_b32 s53, s21, s53
    s_cselect_b32 s54, 663552, s54
    s_lshl_b32 s63, s62, 7
    s_cmp_lg_u32 s3, 0
    s_cbranch_scc1 noarr_adaLN_cond__ssm_conv_s4d__mixer_s_mlp__prompt_5
    s_mov_b64 exec, 1
    v_mov_b32 v128, 1
    s_waitcnt vmcnt(9)
    buffer_atomic_add v128, v4, s[44:47], 0 offen offset:64 sc0 sc1
    s_mov_b64 exec, -1
noarr_adaLN_cond__ssm_conv_s4d__mixer_s_mlp__prompt_5:
    v_mov_b32 v124, 0x3f803f80
    v_mov_b32 v125, 0x3f803f80
    v_mov_b32 v126, 0x3f803f80
    v_mov_b32 v127, 0x3f803f80
    v_and_b32 v166, 3, v11
    v_cmp_eq_u32 s[68:69], 1, v166
    v_cmp_eq_u32 s[70:71], 2, v166
    v_cmp_eq_u32 s[72:73], 3, v166
    s_lshl_b32 s58, s3, 8
    s_add_u32 s58, s58, 147456
    v_lshl_add_u32 v169, v171, 2, s58
    v_lshrrev_b32 v166, 2, v11
    v_cmp_eq_u32 vcc, v166, v10
    v_add_u32 v170, 128, v169
    v_add_u32 v171, 192, v169
    v_cndmask_b32 v170, v171, v170, vcc
    v_lshrrev_b32 v166, 3, v11
    v_lshl_add_u32 v167, v10, 1, v166
    v_lshlrev_b32 v164, 14, v167
    v_sub_u32 v167, v163, v166
    v_lshl_add_u32 v164, v167, 3, v164
    s_mul_i32 s65, s65, 1179648
    s_add_u32 s65, s65, 1048576
    v_cmp_eq_u32 vcc, 0, v166
    s_waitcnt vmcnt(8)
    v_mfma_f32_16x16x32_bf16 v[156:159], v[124:127], v[12:15], 0
    v_cndmask_b32_dpp v84, v14, v12, vcc row_ror:8 row_mask:0xf bank_mask:0xf
    v_cndmask_b32_dpp v85, v15, v13, vcc row_ror:8 row_mask:0xf bank_mask:0xf
    s_not_b64 vcc, vcc
    v_mfma_f32_16x16x32_bf16 v[120:123], v[12:15], v[12:15], 0
    v_cndmask_b32_dpp v86, v12, v14, vcc row_ror:8 row_mask:0xf bank_mask:0xf
    v_cndmask_b32_dpp v87, v13, v15, vcc row_ror:8 row_mask:0xf bank_mask:0xf
    s_not_b64 vcc, vcc
    buffer_store_dwordx4 v[84:87], v164, s[40:43], s65 offen sc1
    s_add_u32 s65, s65, 131072
    s_waitcnt vmcnt(8)
    v_mfma_f32_16x16x32_bf16 v[156:159], v[124:127], v[16:19], v[156:159]
    v_cndmask_b32_dpp v88, v18, v16, vcc row_ror:8 row_mask:0xf bank_mask:0xf
    v_cndmask_b32_dpp v89, v19, v17, vcc row_ror:8 row_mask:0xf bank_mask:0xf
    s_not_b64 vcc, vcc
    v_mfma_f32_16x16x32_bf16 v[120:123], v[16:19], v[16:19], v[120:123]
    v_cndmask_b32_dpp v90, v16, v18, vcc row_ror:8 row_mask:0xf bank_mask:0xf
    v_cndmask_b32_dpp v91, v17, v19, vcc row_ror:8 row_mask:0xf bank_mask:0xf
    s_not_b64 vcc, vcc
    buffer_store_dwordx4 v[88:91], v164, s[40:43], s65 offen sc1
    s_add_u32 s65, s65, 131072
    s_waitcnt vmcnt(8)
    v_mfma_f32_16x16x32_bf16 v[156:159], v[124:127], v[20:23], v[156:159]
    v_cndmask_b32_dpp v92, v22, v20, vcc row_ror:8 row_mask:0xf bank_mask:0xf
    v_cndmask_b32_dpp v93, v23, v21, vcc row_ror:8 row_mask:0xf bank_mask:0xf
    s_not_b64 vcc, vcc
    v_mfma_f32_16x16x32_bf16 v[120:123], v[20:23], v[20:23], v[120:123]
    v_cndmask_b32_dpp v94, v20, v22, vcc row_ror:8 row_mask:0xf bank_mask:0xf
    v_cndmask_b32_dpp v95, v21, v23, vcc row_ror:8 row_mask:0xf bank_mask:0xf
    s_not_b64 vcc, vcc
    buffer_store_dwordx4 v[92:95], v164, s[40:43], s65 offen sc1
    s_add_u32 s65, s65, 131072
    s_waitcnt vmcnt(8)
    v_mfma_f32_16x16x32_bf16 v[156:159], v[124:127], v[24:27], v[156:159]
    v_cndmask_b32_dpp v96, v26, v24, vcc row_ror:8 row_mask:0xf bank_mask:0xf
    v_cndmask_b32_dpp v97, v27, v25, vcc row_ror:8 row_mask:0xf bank_mask:0xf
    s_not_b64 vcc, vcc
    v_mfma_f32_16x16x32_bf16 v[120:123], v[24:27], v[24:27], v[120:123]
    v_cndmask_b32_dpp v98, v24, v26, vcc row_ror:8 row_mask:0xf bank_mask:0xf
    v_cndmask_b32_dpp v99, v25, v27, vcc row_ror:8 row_mask:0xf bank_mask:0xf
    s_not_b64 vcc, vcc
    buffer_store_dwordx4 v[96:99], v164, s[40:43], s65 offen sc1
    s_add_u32 s65, s65, 131072
    s_waitcnt vmcnt(8)
    v_mfma_f32_16x16x32_bf16 v[156:159], v[124:127], v[28:31], v[156:159]
    v_cndmask_b32_dpp v100, v30, v28, vcc row_ror:8 row_mask:0xf bank_mask:0xf
    v_cndmask_b32_dpp v101, v31, v29, vcc row_ror:8 row_mask:0xf bank_mask:0xf
    s_not_b64 vcc, vcc
    v_mfma_f32_16x16x32_bf16 v[120:123], v[28:31], v[28:31], v[120:123]
    v_cndmask_b32_dpp v102, v28, v30, vcc row_ror:8 row_mask:0xf bank_mask:0xf
    v_cndmask_b32_dpp v103, v29, v31, vcc row_ror:8 row_mask:0xf bank_mask:0xf
    s_not_b64 vcc, vcc
    buffer_store_dwordx4 v[100:103], v164, s[40:43], s65 offen sc1
    s_add_u32 s65, s65, 131072
    s_waitcnt vmcnt(8)
    v_mfma_f32_16x16x32_bf16 v[156:159], v[124:127], v[32:35], v[156:159]
    v_cndmask_b32_dpp v104, v34, v32, vcc row_ror:8 row_mask:0xf bank_mask:0xf
    v_cndmask_b32_dpp v105, v35, v33, vcc row_ror:8 row_mask:0xf bank_mask:0xf
    s_not_b64 vcc, vcc
    v_mfma_f32_16x16x32_bf16 v[120:123], v[32:35], v[32:35], v[120:123]
    v_cndmask_b32_dpp v106, v32, v34, vcc row_ror:8 row_mask:0xf bank_mask:0xf
    v_cndmask_b32_dpp v107, v33, v35, vcc row_ror:8 row_mask:0xf bank_mask:0xf
    s_not_b64 vcc, vcc
    buffer_store_dwordx4 v[104:107], v164, s[40:43], s65 offen sc1
    s_add_u32 s65, s65, 131072
    s_waitcnt vmcnt(8)
    v_mfma_f32_16x16x32_bf16 v[156:159], v[124:127], v[36:39], v[156:159]
    v_cndmask_b32_dpp v108, v38, v36, vcc row_ror:8 row_mask:0xf bank_mask:0xf
    v_cndmask_b32_dpp v109, v39, v37, vcc row_ror:8 row_mask:0xf bank_mask:0xf
    s_not_b64 vcc, vcc
    v_mfma_f32_16x16x32_bf16 v[120:123], v[36:39], v[36:39], v[120:123]
    v_cndmask_b32_dpp v110, v36, v38, vcc row_ror:8 row_mask:0xf bank_mask:0xf
    v_cndmask_b32_dpp v111, v37, v39, vcc row_ror:8 row_mask:0xf bank_mask:0xf
    s_not_b64 vcc, vcc
    buffer_store_dwordx4 v[108:111], v164, s[40:43], s65 offen sc1
    s_add_u32 s65, s65, 131072
    s_waitcnt vmcnt(8)
    v_mfma_f32_16x16x32_bf16 v[156:159], v[124:127], v[40:43], v[156:159]
    v_cndmask_b32_dpp v112, v42, v40, vcc row_ror:8 row_mask:0xf bank_mask:0xf
    v_cndmask_b32_dpp v113, v43, v41, vcc row_ror:8 row_mask:0xf bank_mask:0xf
    s_not_b64 vcc, vcc
    v_mfma_f32_16x16x32_bf16 v[120:123], v[40:43], v[40:43], v[120:123]
    v_cndmask_b32_dpp v114, v40, v42, vcc row_ror:8 row_mask:0xf bank_mask:0xf
    v_cndmask_b32_dpp v115, v41, v43, vcc row_ror:8 row_mask:0xf bank_mask:0xf
    s_not_b64 vcc, vcc
    buffer_store_dwordx4 v[112:115], v164, s[40:43], s65 offen sc1
    s_add_u32 s65, s65, 131072
    s_waitcnt vmcnt(8)
    v_mfma_f32_16x16x32_bf16 v[156:159], v[124:127], v[44:47], v[156:159]
    v_cndmask_b32_dpp v116, v46, v44, vcc row_ror:8 row_mask:0xf bank_mask:0xf
    v_cndmask_b32_dpp v117, v47, v45, vcc row_ror:8 row_mask:0xf bank_mask:0xf
    s_not_b64 vcc, vcc
    v_mfma_f32_16x16x32_bf16 v[120:123], v[44:47], v[44:47], v[120:123]
    v_cndmask_b32_dpp v118, v44, v46, vcc row_ror:8 row_mask:0xf bank_mask:0xf
    v_cndmask_b32_dpp v119, v45, v47, vcc row_ror:8 row_mask:0xf bank_mask:0xf
    s_not_b64 vcc, vcc
    buffer_store_dwordx4 v[116:119], v164, s[40:43], s65 offen sc1
    s_nop 3
    v_cndmask_b32 v166, v120, v121, s[68:69]
    v_cndmask_b32 v166, v166, v122, s[70:71]
    v_cndmask_b32 v166, v166, v123, s[72:73]
    ds_write_b32 v169, v156
    ds_write_b32 v170, v166
    s_waitcnt lgkmcnt(0)
    s_barrier
    s_cmp_lg_u32 s3, 0
    s_cbranch_scc1 notw0_adaLN_cond__ssm_conv_s4d__mixer_s_mlp__prompt_6
    v_and_b32 v167, 1, v10
    v_lshlrev_b32 v167, 8, v167
    v_lshl_add_u32 v167, v11, 2, v167
    v_add_u32 v167, 147456, v167
    ds_read2_b32 v[168:169], v167 offset0:0 offset1:32
    ds_read2_b32 v[170:171], v167 offset0:128 offset1:160
    s_waitcnt vmcnt(9)
    v_readfirstlane_b32 s58, v128
    s_nop 0
    s_cmp_lg_u32 s58, 102
    s_cbranch_scc1 notlast_adaLN_cond__ssm_conv_s4d__mixer_s_mlp__prompt_8
    s_mov_b64 exec, 1
    buffer_store_dword v8, v4, s[44:47], 0 offen offset:192 sc1
    s_mov_b64 exec, -1
notlast_adaLN_cond__ssm_conv_s4d__mixer_s_mlp__prompt_8:
    s_waitcnt lgkmcnt(0)
    v_add_f32 v166, v168, v170
    v_add_f32 v168, v169, v171
    v_mul_f32 v166, 0x3ae38e39, v166
    v_mul_f32 v168, 0x3ae38e39, v168
    v_fma_f32 v168, -v166, v166, v168
    v_max_f32 v168, 0, v168
    v_cvt_pk_bf16_f32 v168, v168, v168
    v_and_b32 v168, 0xffff0000, v168
    v_add_f32 v168, 0x3727c5ac, v168
    v_cvt_pk_bf16_f32 v168, v168, v168
    v_and_b32 v168, 0xffff0000, v168
    v_sqrt_f32 v168, v168
    s_nop 0
    v_cvt_pk_bf16_f32 v168, v166, v168
    v_mov_b32 v169, 1
    v_lshlrev_b32 v167, 3, v1
    s_lshl_b32 s58, s2, 8
    s_add_u32 s58, s58, 262144
notw0_adaLN_cond__ssm_conv_s4d__mixer_s_mlp__prompt_6:
    s_waitcnt vmcnt(0)
    s_barrier
    s_cmp_lg_u32 s3, 0
    s_cbranch_scc1 sigd_adaLN_cond__ssm_conv_s4d__mixer_s_mlp__prompt_7
    s_mov_b32 exec_hi, 0
    buffer_store_dwordx2 v[168:169], v167, s[40:43], s58 offen sc1
    s_mov_b64 exec, -1
sigd_adaLN_cond__ssm_conv_s4d__mixer_s_mlp__prompt_7:
    s_getpc_b64 s[66:67]
pc_adaLN_cond__ssm_conv_s4d__mixer_s_mlp__prompt_9:
    s_sub_u32 s66, s66, pc_adaLN_cond__ssm_conv_s4d__mixer_s_mlp__prompt_9-phase2
    s_subb_u32 s67, s67, 0
    v_lshlrev_b32 v172, 7, v0
    v_min_u32 v172, code_end-phase2-4, v172
    global_load_dword v173, v172, s[66:67]
    v_add_u32 v172, 0x8000, v172
    v_min_u32 v172, code_end-phase2-4, v172
    global_load_dword v173, v172, s[66:67]
    v_mad_u32_u24 v174, v160, s64, v161
    s_lshl_b32 s69, s64, 3
    s_mul_i32 s68, s69, s3
    s_add_u32 s68, s68, s63
    s_lshl_b32 s69, s69, 2
    s_lshl_b32 s70, s3, 10
    s_add_u32 m0, s70, 73728
    s_nop 0
    buffer_load_dwordx4 v174, s[52:55], s68 offen nt lds
    s_add_u32 s68, s68, s69
    s_add_u32 m0, s70, 77824
    s_nop 0
    buffer_load_dwordx4 v174, s[52:55], s68 offen nt lds
    s_add_u32 s68, s68, s69
    s_add_u32 m0, s70, 81920
    s_nop 0
    buffer_load_dwordx4 v174, s[52:55], s68 offen nt lds
    s_add_u32 s68, s68, s69
    s_add_u32 m0, s70, 86016
    s_nop 0
    buffer_load_dwordx4 v174, s[52:55], s68 offen nt lds
    s_add_u32 s68, s68, s69
    s_add_u32 m0, s70, 90112
    s_nop 0
    buffer_load_dwordx4 v174, s[52:55], s68 offen nt lds
    s_add_u32 s68, s68, s69
    s_add_u32 m0, s70, 94208
    s_nop 0
    buffer_load_dwordx4 v174, s[52:55], s68 offen nt lds
    s_add_u32 s68, s68, s69
    s_add_u32 m0, s70, 98304
    s_nop 0
    buffer_load_dwordx4 v174, s[52:55], s68 offen nt lds
    s_add_u32 s68, s68, s69
    s_add_u32 m0, s70, 102400
    s_nop 0
    buffer_load_dwordx4 v174, s[52:55], s68 offen nt lds
    s_add_u32 s68, s68, s69
    s_add_u32 m0, s70, 106496
    s_nop 0
    buffer_load_dwordx4 v174, s[52:55], s68 offen nt lds
    s_add_u32 s68, s68, s69
    s_add_u32 m0, s70, 110592
    s_nop 0
    buffer_load_dwordx4 v174, s[52:55], s68 offen nt lds
    s_add_u32 s68, s68, s69
    s_add_u32 m0, s70, 114688
    s_nop 0
    buffer_load_dwordx4 v174, s[52:55], s68 offen nt lds
    s_add_u32 s68, s68, s69
    s_add_u32 m0, s70, 118784
    s_nop 0
    buffer_load_dwordx4 v174, s[52:55], s68 offen nt lds
    s_add_u32 s68, s68, s69
    s_add_u32 m0, s70, 122880
    s_nop 0
    buffer_load_dwordx4 v174, s[52:55], s68 offen nt lds
    s_add_u32 s68, s68, s69
    s_add_u32 m0, s70, 126976
    s_nop 0
    buffer_load_dwordx4 v174, s[52:55], s68 offen nt lds
    s_add_u32 s68, s68, s69
    s_add_u32 m0, s70, 131072
    s_nop 0
    buffer_load_dwordx4 v174, s[52:55], s68 offen nt lds
    s_add_u32 s68, s68, s69
    s_add_u32 m0, s70, 135168
    s_nop 0
    buffer_load_dwordx4 v174, s[52:55], s68 offen nt lds
    s_add_u32 s68, s68, s69
    s_add_u32 m0, s70, 139264
    s_nop 0
    buffer_load_dwordx4 v174, s[52:55], s68 offen nt lds
    s_add_u32 s68, s68, s69
    s_add_u32 m0, s70, 143360
    s_nop 0
    buffer_load_dwordx4 v174, s[52:55], s68 offen nt lds
    s_lshl_b32 s58, s2, 2
    s_add_u32 s58, s58, s3
    s_lshl_b32 s58, s58, 10
    s_cmp_eq_u32 s2, 9
    s_cselect_b32 s58, 67108864, s58
    buffer_store_dwordx4 v[4:7], v9, s[40:43], s58 offen sc1
    s_cmp_lg_u32 s3, 2
    s_cbranch_scc1 nopad_adaLN_cond__ssm_conv_s4d__mixer_s_mlp__prompt_10
    s_cmp_ge_u32 s2, 36
    s_cbranch_scc1 nopad_adaLN_cond__ssm_conv_s4d__mixer_s_mlp__prompt_10
    s_lshr_b32 s58, s2, 1
    s_mul_i32 s58, s58, 133120
    s_bitcmp1_b32 s2, 0
    s_cselect_b32 s56, 132096, 0
    s_add_u32 s58, s58, s56
    s_add_u32 s58, s58, 4194304
    buffer_store_dwordx4 v[4:7], v9, s[40:43], s58 offen sc1
nopad_adaLN_cond__ssm_conv_s4d__mixer_s_mlp__prompt_10:
    s_branch jobB_adaLN_cond__ssm_conv_s4d__mixer_s_mlp__prompt_2
mod_adaLN_cond__ssm_conv_s4d__mixer_s_mlp__prompt_1:
    s_mov_b32 s48, s30
    s_mov_b32 s49, s31
    s_mov_b32 s50, 3981312
    s_mov_b32 s51, 0x20000
    s_mov_b32 s72, s28
    s_mov_b32 s73, s29
    s_mov_b32 s74, 1152
    s_mov_b32 s75, 0x20000
    s_sub_u32 s65, s2, 64
    s_lshl_b32 s68, s65, 7
    s_mov_b32 s69, 6912
    v_lshlrev_b32 v170, 3, v0
    v_mov_b32 v4, 0
    v_mov_b32 v5, 0
    v_mov_b32 v6, 0
    v_mov_b32 v7, 0
    s_lshl_b32 s58, s65, 9
    s_add_u32 s58, s58, 303104
    s_cmp_eq_u32 s3, 0
    s_cselect_b32 s58, s58, 67108864
    s_mov_b32 exec_hi, 0
    buffer_store_dwordx4 v[4:7], v9, s[40:43], s58 offen sc1
    s_mov_b64 exec, -1
    buffer_load_dwordx2 v[162:163], v170, s[72:75], 0 offen
    v_mad_u32_u24 v171, v160, s69, v161
    s_lshl_b32 s71, s69, 3
    s_mul_i32 s70, s71, s3
    s_add_u32 s70, s70, s68
    s_lshl_b32 s71, s71, 2
    s_lshl_b32 s76, s3, 10
    s_add_u32 m0, s76, 0
    s_nop 0
    buffer_load_dwordx4 v171, s[48:51], s70 offen lds
    s_add_u32 s70, s70, s71
    s_add_u32 m0, s76, 4096
    s_nop 0
    buffer_load_dwordx4 v171, s[48:51], s70 offen lds
    s_add_u32 s70, s70, s71
    s_add_u32 m0, s76, 8192
    s_nop 0
    buffer_load_dwordx4 v171, s[48:51], s70 offen lds
    s_add_u32 s70, s70, s71
    s_add_u32 m0, s76, 12288
    s_nop 0
    buffer_load_dwordx4 v171, s[48:51], s70 offen lds
    s_add_u32 s70, s70, s71
    s_add_u32 m0, s76, 16384
    s_nop 0
    buffer_load_dwordx4 v171, s[48:51], s70 offen lds
    s_add_u32 s70, s70, s71
    s_add_u32 m0, s76, 20480
    s_nop 0
    buffer_load_dwordx4 v171, s[48:51], s70 offen lds
    s_add_u32 s70, s70, s71
    s_add_u32 m0, s76, 24576
    s_nop 0
    buffer_load_dwordx4 v171, s[48:51], s70 offen lds
    s_add_u32 s70, s70, s71
    s_add_u32 m0, s76, 28672
    s_nop 0
    buffer_load_dwordx4 v171, s[48:51], s70 offen lds
    s_add_u32 s70, s70, s71
    s_add_u32 m0, s76, 32768
    s_nop 0
    buffer_load_dwordx4 v171, s[48:51], s70 offen lds
    s_add_u32 s70, s70, s71
    s_add_u32 m0, s76, 36864
    s_nop 0
    buffer_load_dwordx4 v171, s[48:51], s70 offen lds
    s_add_u32 s70, s70, s71
    s_add_u32 m0, s76, 40960
    s_nop 0
    buffer_load_dwordx4 v171, s[48:51], s70 offen lds
    s_add_u32 s70, s70, s71
    s_add_u32 m0, s76, 45056
    s_nop 0
    buffer_load_dwordx4 v171, s[48:51], s70 offen lds
    s_add_u32 s70, s70, s71
    s_add_u32 m0, s76, 49152
    s_nop 0
    buffer_load_dwordx4 v171, s[48:51], s70 offen lds
    s_add_u32 s70, s70, s71
    s_add_u32 m0, s76, 53248
    s_nop 0
    buffer_load_dwordx4 v171, s[48:51], s70 offen lds
    s_add_u32 s70, s70, s71
    s_add_u32 m0, s76, 57344
    s_nop 0
    buffer_load_dwordx4 v171, s[48:51], s70 offen lds
    s_add_u32 s70, s70, s71
    s_add_u32 m0, s76, 61440
    s_nop 0
    buffer_load_dwordx4 v171, s[48:51], s70 offen lds
    s_add_u32 s70, s70, s71
    s_add_u32 m0, s76, 65536
    s_nop 0
    buffer_load_dwordx4 v171, s[48:51], s70 offen lds
    s_add_u32 s70, s70, s71
    s_add_u32 m0, s76, 69632
    s_nop 0
    buffer_load_dwordx4 v171, s[48:51], s70 offen lds
    v_mov_b32 v4, 0
    v_mov_b32 v5, 0
    v_mov_b32 v6, 0
    v_mov_b32 v7, 0
    v_mov_b32 v8, 1
    s_mov_b32 s59, 0
    s_add_u32 s60, s2, 32
    s_sub_u32 s62, s2, 64
    s_cmp_ge_u32 s2, 64
    s_cselect_b32 s60, s62, s60
    s_sub_u32 s62, s2, 58
    s_cmp_ge_u32 s2, 73
    s_cselect_b32 s60, s62, s60
    s_cmp_ge_u32 s2, 90
    s_cselect_b32 s60, 200, s60
    s_sub_u32 s62, s2, 82
    s_cmp_ge_u32 s2, 91
    s_cselect_b32 s60, s62, s60
    s_cmp_ge_u32 s2, 97
    s_cselect_b32 s60, 200, s60
    s_sub_u32 s62, s2, 7
    s_cmp_ge_u32 s2, 103
    s_cselect_b32 s60, s62, s60
    s_mov_b32 s52, s30
    s_mov_b32 s53, s31
    s_mov_b32 s54, 3981312
    s_mov_b32 s55, 0x20000
    s_mov_b32 s61, 0
    s_cmp_ge_u32 s60, 9
    s_cselect_b32 s62, 30, 45
    s_add_u32 s62, s62, s60
    s_mov_b32 s64, 6912
    s_sub_u32 s63, s60, 15
    s_cmp_ge_u32 s60, 15
    s_cselect_b32 s62, s63, s62
    s_cselect_b32 s61, 2, s61
    s_cselect_b32 s64, 1152, s64
    s_cselect_b32 s52, s22, s52
    s_cselect_b32 s53, s23, s53
    s_cselect_b32 s54, 663552, s54
    s_sub_u32 s63, s60, 24
    s_cmp_ge_u32 s60, 24
    s_cselect_b32 s62, s63, s62
    s_cselect_b32 s61, 3, s61
    s_cselect_b32 s64, 9216, s64
    s_cselect_b32 s52, s24, s52
    s_cselect_b32 s53, s25, s53
    s_cselect_b32 s54, 5308416, s54
    s_sub_u32 s63, s60, 96
    s_cmp_ge_u32 s60, 96
    s_cselect_b32 s62, s63, s62
    s_cselect_b32 s61, 1, s61
    s_cselect_b32 s64, 1152, s64
    s_cselect_b32 s52, s20, s52
    s_cselect_b32 s53, s21, s53
    s_cselect_b32 s54, 663552, s54
    s_lshl_b32 s63, s62, 7
    s_waitcnt vmcnt(18)
    s_cmp_lg_u32 s3, 0
    s_cbranch_scc1 noarr_adaLN_cond__ssm_conv_s4d__mixer_s_mlp__prompt_11
    s_mov_b64 exec, 1
    v_mov_b32 v157, 1
    buffer_atomic_add v157, v4, s[44:47], 0 offen offset:64 sc0 sc1
    s_mov_b64 exec, -1
noarr_adaLN_cond__ssm_conv_s4d__mixer_s_mlp__prompt_11:
    v_lshlrev_b32 v164, 16, v162
    v_and_b32 v165, 0xffff0000, v162
    v_lshlrev_b32 v166, 16, v163
    v_and_b32 v167, 0xffff0000, v163
    v_mul_f32 v174, 0xbfb8aa3b, v164
    v_mul_f32 v175, 0xbfb8aa3b, v165
    v_mul_f32 v176, 0xbfb8aa3b, v166
    v_mul_f32 v177, 0xbfb8aa3b, v167
    v_exp_f32 v174, v174
    v_exp_f32 v175, v175
    v_exp_f32 v176, v176
    v_exp_f32 v177, v177
    v_add_f32 v174, 1.0, v174
    v_add_f32 v175, 1.0, v175
    v_add_f32 v176, 1.0, v176
    v_add_f32 v177, 1.0, v177
    v_rcp_f32 v174, v174
    v_rcp_f32 v175, v175
    v_rcp_f32 v176, v176
    v_rcp_f32 v177, v177
    v_mul_f32 v174, v174, v164
    v_mul_f32 v175, v175, v165
    v_mul_f32 v176, v176, v166
    v_mul_f32 v177, v177, v167
    v_cvt_pk_bf16_f32 v162, v174, v175
    v_cvt_pk_bf16_f32 v163, v176, v177
    v_add_u32 v170, 147456, v170
    ds_write_b64 v170, v[162:163]
    v_lshlrev_b32 v170, 4, v10
    v_add_u32 v170, 147456, v170
    s_waitcnt lgkmcnt(0)
    s_barrier
    ds_read_b128 v[84:87], v170 offset:0
    ds_read_b128 v[88:91], v170 offset:64
    ds_read_b128 v[92:95], v170 offset:128
    ds_read_b128 v[96:99], v170 offset:192
    ds_read_b128 v[100:103], v170 offset:256
    ds_read_b128 v[104:107], v170 offset:320
    ds_read_b128 v[108:111], v170 offset:384
    ds_read_b128 v[112:115], v170 offset:448
    ds_read_b128 v[116:119], v170 offset:512
    ds_read_b128 v[120:123], v170 offset:576
    ds_read_b128 v[124:127], v170 offset:640
    ds_read_b128 v[128:131], v170 offset:704
    ds_read_b128 v[132:135], v170 offset:768
    ds_read_b128 v[136:139], v170 offset:832
    ds_read_b128 v[140:143], v170 offset:896
    ds_read_b128 v[144:147], v170 offset:960
    ds_read_b128 v[148:151], v170 offset:1024
    ds_read_b128 v[152:155], v170 offset:1088
    v_lshrrev_b32 v171, 4, v1
    v_bfe_u32 v182, v1, 2, 2
    v_and_b32 v183, 3, v1
    v_mov_b32 v184, s3
    v_lshlrev_b32 v185, 3, v183
    v_lshl_add_u32 v178, v171, 3, v182
    v_add_u32 v178, 0, v178
    v_lshrrev_b32 v186, 1, v178
    v_xor_b32 v186, v186, v178
    v_bfe_u32 v186, v186, 2, 1
    v_bfe_u32 v187, v178, 1, 1
    v_lshl_or_b32 v186, v186, 1, v187
    v_xor_b32 v186, v186, v184
    v_lshl_add_u32 v186, v186, 5, v185
    v_lshl_add_u32 v178, v178, 7, v186
    v_add_u32 v178, 0, v178
    v_add_u32 v180, 0x9000, v178
    v_lshl_add_u32 v179, v171, 3, v182
    v_add_u32 v179, 4, v179
    v_lshrrev_b32 v186, 1, v179
    v_xor_b32 v186, v186, v179
    v_bfe_u32 v186, v186, 2, 1
    v_bfe_u32 v187, v179, 1, 1
    v_lshl_or_b32 v186, v186, 1, v187
    v_xor_b32 v186, v186, v184
    v_lshl_add_u32 v186, v186, 5, v185
    v_lshl_add_u32 v179, v179, 7, v186
    v_add_u32 v179, 0, v179
    v_add_u32 v181, 0x9000, v179
    s_waitcnt vmcnt(0) lgkmcnt(0)
    s_cmp_lg_u32 s3, 0
    s_cbranch_scc1 notlast_adaLN_cond__ssm_conv_s4d__mixer_s_mlp__prompt_12
    v_readfirstlane_b32 s58, v157
    s_nop 0
    s_cmp_lg_u32 s58, 102
    s_cbranch_scc1 notlast_adaLN_cond__ssm_conv_s4d__mixer_s_mlp__prompt_12
    s_mov_b64 exec, 1
    buffer_store_dword v8, v4, s[44:47], 0 offen offset:192 sc1
    s_mov_b64 exec, -1
notlast_adaLN_cond__ssm_conv_s4d__mixer_s_mlp__prompt_12:
    s_barrier
    ds_read_b64_tr_b16 v[12:13], v178 offset:0
    ds_read_b64_tr_b16 v[14:15], v179 offset:0
    ds_read_b64_tr_b16 v[16:17], v178 offset:4096
    ds_read_b64_tr_b16 v[18:19], v179 offset:4096
    ds_read_b64_tr_b16 v[20:21], v178 offset:8192
    ds_read_b64_tr_b16 v[22:23], v179 offset:8192
    ds_read_b64_tr_b16 v[24:25], v178 offset:12288
    ds_read_b64_tr_b16 v[26:27], v179 offset:12288
    ds_read_b64_tr_b16 v[28:29], v178 offset:16384
    ds_read_b64_tr_b16 v[30:31], v179 offset:16384
    ds_read_b64_tr_b16 v[32:33], v178 offset:20480
    ds_read_b64_tr_b16 v[34:35], v179 offset:20480
    ds_read_b64_tr_b16 v[36:37], v178 offset:24576
    ds_read_b64_tr_b16 v[38:39], v179 offset:24576
    ds_read_b64_tr_b16 v[40:41], v178 offset:28672
    ds_read_b64_tr_b16 v[42:43], v179 offset:28672
    ds_read_b64_tr_b16 v[44:45], v178 offset:32768
    ds_read_b64_tr_b16 v[46:47], v179 offset:32768
    ds_read_b64_tr_b16 v[48:49], v180 offset:0
    ds_read_b64_tr_b16 v[50:51], v181 offset:0
    ds_read_b64_tr_b16 v[52:53], v180 offset:4096
    ds_read_b64_tr_b16 v[54:55], v181 offset:4096
    ds_read_b64_tr_b16 v[56:57], v180 offset:8192
    ds_read_b64_tr_b16 v[58:59], v181 offset:8192
    ds_read_b64_tr_b16 v[60:61], v180 offset:12288
    ds_read_b64_tr_b16 v[62:63], v181 offset:12288
    ds_read_b64_tr_b16 v[64:65], v180 offset:16384
    ds_read_b64_tr_b16 v[66:67], v181 offset:16384
    ds_read_b64_tr_b16 v[68:69], v180 offset:20480
    ds_read_b64_tr_b16 v[70:71], v181 offset:20480
    ds_read_b64_tr_b16 v[72:73], v180 offset:24576
    ds_read_b64_tr_b16 v[74:75], v181 offset:24576
    ds_read_b64_tr_b16 v[76:77], v180 offset:28672
    ds_read_b64_tr_b16 v[78:79], v181 offset:28672
    ds_read_b64_tr_b16 v[80:81], v180 offset:32768
    ds_read_b64_tr_b16 v[82:83], v181 offset:32768
    s_cmp_lt_u32 s65, 27
    s_cbranch_scc1 lateB_adaLN_cond__ssm_conv_s4d__mixer_s_mlp__prompt_13
    s_cmp_ge_u32 s60, 200
    s_cbranch_scc1 lateB_adaLN_cond__ssm_conv_s4d__mixer_s_mlp__prompt_13
    v_mad_u32_u24 v171, v160, s64, v161
    s_lshl_b32 s71, s64, 3
    s_mul_i32 s70, s71, s3
    s_add_u32 s70, s70, s63
    s_lshl_b32 s71, s71, 2
    s_lshl_b32 s76, s3, 10
    s_add_u32 m0, s76, 73728
    s_nop 0
    buffer_load_dwordx4 v171, s[52:55], s70 offen lds
    s_add_u32 s70, s70, s71
    s_add_u32 m0, s76, 77824
    s_nop 0
    buffer_load_dwordx4 v171, s[52:55], s70 offen lds
    s_add_u32 s70, s70, s71
    s_add_u32 m0, s76, 81920
    s_nop 0
    buffer_load_dwordx4 v171, s[52:55], s70 offen lds
    s_add_u32 s70, s70, s71
    s_add_u32 m0, s76, 86016
    s_nop 0
    buffer_load_dwordx4 v171, s[52:55], s70 offen lds
    s_add_u32 s70, s70, s71
    s_add_u32 m0, s76, 90112
    s_nop 0
    buffer_load_dwordx4 v171, s[52:55], s70 offen lds
    s_add_u32 s70, s70, s71
    s_add_u32 m0, s76, 94208
    s_nop 0
    buffer_load_dwordx4 v171, s[52:55], s70 offen lds
    s_add_u32 s70, s70, s71
    s_add_u32 m0, s76, 98304
    s_nop 0
    buffer_load_dwordx4 v171, s[52:55], s70 offen lds
    s_add_u32 s70, s70, s71
    s_add_u32 m0, s76, 102400
    s_nop 0
    buffer_load_dwordx4 v171, s[52:55], s70 offen lds
    s_add_u32 s70, s70, s71
    s_add_u32 m0, s76, 106496
    s_nop 0
    buffer_load_dwordx4 v171, s[52:55], s70 offen lds
    s_add_u32 s70, s70, s71
    s_add_u32 m0, s76, 110592
    s_nop 0
    buffer_load_dwordx4 v171, s[52:55], s70 offen lds
    s_add_u32 s70, s70, s71
    s_add_u32 m0, s76, 114688
    s_nop 0
    buffer_load_dwordx4 v171, s[52:55], s70 offen lds
    s_add_u32 s70, s70, s71
    s_add_u32 m0, s76, 118784
    s_nop 0
    buffer_load_dwordx4 v171, s[52:55], s70 offen lds
    s_add_u32 s70, s70, s71
    s_add_u32 m0, s76, 122880
    s_nop 0
    buffer_load_dwordx4 v171, s[52:55], s70 offen lds
    s_add_u32 s70, s70, s71
    s_add_u32 m0, s76, 126976
    s_nop 0
    buffer_load_dwordx4 v171, s[52:55], s70 offen lds
    s_add_u32 s70, s70, s71
    s_add_u32 m0, s76, 131072
    s_nop 0
    buffer_load_dwordx4 v171, s[52:55], s70 offen lds
    s_add_u32 s70, s70, s71
    s_add_u32 m0, s76, 135168
    s_nop 0
    buffer_load_dwordx4 v171, s[52:55], s70 offen lds
    s_add_u32 s70, s70, s71
    s_add_u32 m0, s76, 139264
    s_nop 0
    buffer_load_dwordx4 v171, s[52:55], s70 offen lds
    s_add_u32 s70, s70, s71
    s_add_u32 m0, s76, 143360
    s_nop 0
    buffer_load_dwordx4 v171, s[52:55], s70 offen lds
lateB_adaLN_cond__ssm_conv_s4d__mixer_s_mlp__prompt_13:
    s_waitcnt lgkmcnt(15)
    v_mfma_f32_16x16x32_bf16 v[156:159], v[84:87], v[12:15], 0
    v_mfma_f32_16x16x32_bf16 v[156:159], v[88:91], v[16:19], v[156:159]
    v_mfma_f32_16x16x32_bf16 v[156:159], v[92:95], v[20:23], v[156:159]
    v_mfma_f32_16x16x32_bf16 v[156:159], v[96:99], v[24:27], v[156:159]
    v_mfma_f32_16x16x32_bf16 v[156:159], v[100:103], v[28:31], v[156:159]
    v_mfma_f32_16x16x32_bf16 v[156:159], v[104:107], v[32:35], v[156:159]
    v_mfma_f32_16x16x32_bf16 v[156:159], v[108:111], v[36:39], v[156:159]
    v_mfma_f32_16x16x32_bf16 v[156:159], v[112:115], v[40:43], v[156:159]
    v_mfma_f32_16x16x32_bf16 v[156:159], v[116:119], v[44:47], v[156:159]
    v_mfma_f32_16x16x32_bf16 v[156:159], v[120:123], v[48:51], v[156:159]
    s_waitcnt lgkmcnt(12)
    v_mfma_f32_16x16x32_bf16 v[156:159], v[124:127], v[52:55], v[156:159]
    v_mfma_f32_16x16x32_bf16 v[156:159], v[128:131], v[56:59], v[156:159]
    s_waitcnt lgkmcnt(8)
    v_mfma_f32_16x16x32_bf16 v[156:159], v[132:135], v[60:63], v[156:159]
    v_mfma_f32_16x16x32_bf16 v[156:159], v[136:139], v[64:67], v[156:159]
    s_waitcnt lgkmcnt(4)
    v_mfma_f32_16x16x32_bf16 v[156:159], v[140:143], v[68:71], v[156:159]
    v_mfma_f32_16x16x32_bf16 v[156:159], v[144:147], v[72:75], v[156:159]
    s_waitcnt lgkmcnt(0)
    v_mfma_f32_16x16x32_bf16 v[156:159], v[148:151], v[76:79], v[156:159]
    v_mfma_f32_16x16x32_bf16 v[156:159], v[152:155], v[80:83], v[156:159]
    s_lshl_b32 s70, s3, 6
    s_add_u32 s70, s70, 149504
    v_lshl_add_u32 v171, v11, 2, s70
    s_nop 4
    v_cvt_pk_bf16_f32 v178, v156, v156
    v_and_b32 v178, 0xffff0000, v178
    v_add_f32 v179, 1.0, v178
    v_cvt_pk_bf16_f32 v179, v179, v179
    v_and_b32 v179, 0xffff0000, v179
    s_mov_b64 vcc, 0
    s_sub_u32 s70, s65, 9
    s_cmp_lt_u32 s70, 9
    s_cselect_b64 vcc, -1, vcc
    s_sub_u32 s70, s65, 36
    s_cmp_lt_u32 s70, 9
    s_cselect_b64 vcc, -1, vcc
    v_cndmask_b32 v178, v178, v179, vcc
    ds_write_b32 v171, v178
    s_waitcnt lgkmcnt(0)
    s_barrier
    s_cmp_lg_u32 s3, 0
    s_cbranch_scc1 notw0_adaLN_cond__ssm_conv_s4d__mixer_s_mlp__prompt_14
    v_lshlrev_b32 v171, 3, v1
    v_add_u32 v178, 149504, v171
    ds_read_b64 v[178:179], v178
    s_lshl_b32 s70, s65, 8
    s_add_u32 s70, s70, 278528
    s_mov_b32 exec_hi, 0
    s_lshl_b32 s56, s65, 9
    s_add_u32 s56, s56, 303104
    v_mov_b32 v157, 1
    v_mov_b32 v159, 1
    s_waitcnt lgkmcnt(0)
    v_mov_b32 v156, v178
    v_mov_b32 v158, v179
    buffer_store_dwordx4 v[156:159], v9, s[40:43], s56 offen sc1
    s_waitcnt lgkmcnt(0)
    buffer_store_dwordx2 v[178:179], v171, s[40:43], s70 offen sc1
    s_sub_u32 s70, s65, 27
    s_cmp_ge_u32 s70, 18
    s_cbranch_scc1 notw0_adaLN_cond__ssm_conv_s4d__mixer_s_mlp__prompt_14
    v_cvt_pk_bf16_f32 v156, v178, v179
    v_lshrrev_b32 v171, 1, v171
    s_lshl_b32 s70, s70, 7
    s_add_u32 s70, s70, 299008
    buffer_store_dword v156, v171, s[40:43], s70 offen sc1
    s_waitcnt vmcnt(0)
    s_mov_b64 exec, 1
    v_mov_b32 v156, 1
    buffer_atomic_add v156, v4, s[44:47], 12 offen offset:64 sc0 sc1
    s_waitcnt vmcnt(0)
    v_readfirstlane_b32 s58, v156
    s_nop 0
    s_cmp_lg_u32 s58, 17
    s_cbranch_scc1 notlast_adaLN_cond__ssm_conv_s4d__mixer_s_mlp__prompt_16
    buffer_store_dword v8, v4, s[44:47], 12 offen offset:192 sc1
notlast_adaLN_cond__ssm_conv_s4d__mixer_s_mlp__prompt_16:
    s_mov_b64 exec, -1
notw0_adaLN_cond__ssm_conv_s4d__mixer_s_mlp__prompt_14:
    s_mov_b64 exec, -1
    s_cmp_ge_u32 s60, 200
    s_cbranch_scc1 jobC_adaLN_cond__ssm_conv_s4d__mixer_s_mlp__prompt_3
    s_cmp_ge_u32 s65, 27
    s_cbranch_scc1 lateB_adaLN_cond__ssm_conv_s4d__mixer_s_mlp__prompt_13_w
    v_mad_u32_u24 v171, v160, s64, v161
    s_lshl_b32 s71, s64, 3
    s_mul_i32 s70, s71, s3
    s_add_u32 s70, s70, s63
    s_lshl_b32 s71, s71, 2
    s_lshl_b32 s76, s3, 10
    s_add_u32 m0, s76, 73728
    s_nop 0
    buffer_load_dwordx4 v171, s[52:55], s70 offen nt lds
    s_add_u32 s70, s70, s71
    s_add_u32 m0, s76, 77824
    s_nop 0
    buffer_load_dwordx4 v171, s[52:55], s70 offen nt lds
    s_add_u32 s70, s70, s71
    s_add_u32 m0, s76, 81920
    s_nop 0
    buffer_load_dwordx4 v171, s[52:55], s70 offen nt lds
    s_add_u32 s70, s70, s71
    s_add_u32 m0, s76, 86016
    s_nop 0
    buffer_load_dwordx4 v171, s[52:55], s70 offen nt lds
    s_add_u32 s70, s70, s71
    s_add_u32 m0, s76, 90112
    s_nop 0
    buffer_load_dwordx4 v171, s[52:55], s70 offen nt lds
    s_add_u32 s70, s70, s71
    s_add_u32 m0, s76, 94208
    s_nop 0
    buffer_load_dwordx4 v171, s[52:55], s70 offen nt lds
    s_add_u32 s70, s70, s71
    s_add_u32 m0, s76, 98304
    s_nop 0
    buffer_load_dwordx4 v171, s[52:55], s70 offen nt lds
    s_add_u32 s70, s70, s71
    s_add_u32 m0, s76, 102400
    s_nop 0
    buffer_load_dwordx4 v171, s[52:55], s70 offen nt lds
    s_add_u32 s70, s70, s71
    s_add_u32 m0, s76, 106496
    s_nop 0
    buffer_load_dwordx4 v171, s[52:55], s70 offen nt lds
    s_add_u32 s70, s70, s71
    s_add_u32 m0, s76, 110592
    s_nop 0
    buffer_load_dwordx4 v171, s[52:55], s70 offen nt lds
    s_add_u32 s70, s70, s71
    s_add_u32 m0, s76, 114688
    s_nop 0
    buffer_load_dwordx4 v171, s[52:55], s70 offen nt lds
    s_add_u32 s70, s70, s71
    s_add_u32 m0, s76, 118784
    s_nop 0
    buffer_load_dwordx4 v171, s[52:55], s70 offen nt lds
    s_add_u32 s70, s70, s71
    s_add_u32 m0, s76, 122880
    s_nop 0
    buffer_load_dwordx4 v171, s[52:55], s70 offen nt lds
    s_add_u32 s70, s70, s71
    s_add_u32 m0, s76, 126976
    s_nop 0
    buffer_load_dwordx4 v171, s[52:55], s70 offen nt lds
    s_add_u32 s70, s70, s71
    s_add_u32 m0, s76, 131072
    s_nop 0
    buffer_load_dwordx4 v171, s[52:55], s70 offen nt lds
    s_add_u32 s70, s70, s71
    s_add_u32 m0, s76, 135168
    s_nop 0
    buffer_load_dwordx4 v171, s[52:55], s70 offen nt lds
    s_add_u32 s70, s70, s71
    s_add_u32 m0, s76, 139264
    s_nop 0
    buffer_load_dwordx4 v171, s[52:55], s70 offen nt lds
    s_add_u32 s70, s70, s71
    s_add_u32 m0, s76, 143360
    s_nop 0
    buffer_load_dwordx4 v171, s[52:55], s70 offen nt lds
lateB_adaLN_cond__ssm_conv_s4d__mixer_s_mlp__prompt_13_w:
    s_waitcnt vmcnt(0)
    s_branch jobB_adaLN_cond__ssm_conv_s4d__mixer_s_mlp__prompt_2
w1_adaLN_cond__ssm_conv_s4d__mixer_s_mlp__prompt_4:
    v_mov_b32 v4, 0
    v_mov_b32 v5, 0
    v_mov_b32 v6, 0
    v_mov_b32 v7, 0
    v_mov_b32 v8, 1
    s_mov_b32 s59, 0
    s_add_u32 s60, s2, 32
    s_sub_u32 s62, s2, 64
    s_cmp_ge_u32 s2, 64
    s_cselect_b32 s60, s62, s60
    s_sub_u32 s62, s2, 58
    s_cmp_ge_u32 s2, 73
    s_cselect_b32 s60, s62, s60
    s_cmp_ge_u32 s2, 90
    s_cselect_b32 s60, 200, s60
    s_sub_u32 s62, s2, 82
    s_cmp_ge_u32 s2, 91
    s_cselect_b32 s60, s62, s60
    s_cmp_ge_u32 s2, 97
    s_cselect_b32 s60, 200, s60
    s_sub_u32 s62, s2, 7
    s_cmp_ge_u32 s2, 103
    s_cselect_b32 s60, s62, s60
    s_mov_b32 s52, s30
    s_mov_b32 s53, s31
    s_mov_b32 s54, 3981312
    s_mov_b32 s55, 0x20000
    s_mov_b32 s61, 0
    s_cmp_ge_u32 s60, 9
    s_cselect_b32 s62, 30, 45
    s_add_u32 s62, s62, s60
    s_mov_b32 s64, 6912
    s_sub_u32 s63, s60, 15
    s_cmp_ge_u32 s60, 15
    s_cselect_b32 s62, s63, s62
    s_cselect_b32 s61, 2, s61
    s_cselect_b32 s64, 1152, s64
    s_cselect_b32 s52, s22, s52
    s_cselect_b32 s53, s23, s53
    s_cselect_b32 s54, 663552, s54
    s_sub_u32 s63, s60, 24
    s_cmp_ge_u32 s60, 24
    s_cselect_b32 s62, s63, s62
    s_cselect_b32 s61, 3, s61
    s_cselect_b32 s64, 9216, s64
    s_cselect_b32 s52, s24, s52
    s_cselect_b32 s53, s25, s53
    s_cselect_b32 s54, 5308416, s54
    s_sub_u32 s63, s60, 96
    s_cmp_ge_u32 s60, 96
    s_cselect_b32 s62, s63, s62
    s_cselect_b32 s61, 1, s61
    s_cselect_b32 s64, 1152, s64
    s_cselect_b32 s52, s20, s52
    s_cselect_b32 s53, s21, s53
    s_cselect_b32 s54, 663552, s54
    s_lshl_b32 s63, s62, 7
    v_mad_u32_u24 v162, v160, s64, v161
    s_lshl_b32 s71, s64, 3
    s_mul_i32 s70, s71, s3
    s_add_u32 s70, s70, s63
    s_lshl_b32 s71, s71, 2
    s_lshl_b32 s76, s3, 10
    s_add_u32 m0, s76, 73728
    s_nop 0
    buffer_load_dwordx4 v162, s[52:55], s70 offen lds
    s_add_u32 s70, s70, s71
    s_add_u32 m0, s76, 77824
    s_nop 0
    buffer_load_dwordx4 v162, s[52:55], s70 offen lds
    s_add_u32 s70, s70, s71
    s_add_u32 m0, s76, 81920
    s_nop 0
    buffer_load_dwordx4 v162, s[52:55], s70 offen lds
    s_add_u32 s70, s70, s71
    s_add_u32 m0, s76, 86016
    s_nop 0
    buffer_load_dwordx4 v162, s[52:55], s70 offen lds
    s_add_u32 s70, s70, s71
    s_add_u32 m0, s76, 90112
    s_nop 0
    buffer_load_dwordx4 v162, s[52:55], s70 offen lds
    s_add_u32 s70, s70, s71
    s_add_u32 m0, s76, 94208
    s_nop 0
    buffer_load_dwordx4 v162, s[52:55], s70 offen lds
    s_add_u32 s70, s70, s71
    s_add_u32 m0, s76, 98304
    s_nop 0
    buffer_load_dwordx4 v162, s[52:55], s70 offen lds
    s_add_u32 s70, s70, s71
    s_add_u32 m0, s76, 102400
    s_nop 0
    buffer_load_dwordx4 v162, s[52:55], s70 offen lds
    s_add_u32 s70, s70, s71
    s_add_u32 m0, s76, 106496
    s_nop 0
    buffer_load_dwordx4 v162, s[52:55], s70 offen lds
    s_add_u32 s70, s70, s71
    s_add_u32 m0, s76, 110592
    s_nop 0
    buffer_load_dwordx4 v162, s[52:55], s70 offen lds
    s_add_u32 s70, s70, s71
    s_add_u32 m0, s76, 114688
    s_nop 0
    buffer_load_dwordx4 v162, s[52:55], s70 offen lds
    s_add_u32 s70, s70, s71
    s_add_u32 m0, s76, 118784
    s_nop 0
    buffer_load_dwordx4 v162, s[52:55], s70 offen lds
    s_add_u32 s70, s70, s71
    s_add_u32 m0, s76, 122880
    s_nop 0
    buffer_load_dwordx4 v162, s[52:55], s70 offen lds
    s_add_u32 s70, s70, s71
    s_add_u32 m0, s76, 126976
    s_nop 0
    buffer_load_dwordx4 v162, s[52:55], s70 offen lds
    s_add_u32 s70, s70, s71
    s_add_u32 m0, s76, 131072
    s_nop 0
    buffer_load_dwordx4 v162, s[52:55], s70 offen lds
    s_add_u32 s70, s70, s71
    s_add_u32 m0, s76, 135168
    s_nop 0
    buffer_load_dwordx4 v162, s[52:55], s70 offen lds
    s_add_u32 s70, s70, s71
    s_add_u32 m0, s76, 139264
    s_nop 0
    buffer_load_dwordx4 v162, s[52:55], s70 offen lds
    s_add_u32 s70, s70, s71
    s_add_u32 m0, s76, 143360
    s_nop 0
    buffer_load_dwordx4 v162, s[52:55], s70 offen lds
    s_waitcnt vmcnt(0)
jobB_adaLN_cond__ssm_conv_s4d__mixer_s_mlp__prompt_2:
    s_waitcnt vmcnt(1) lgkmcnt(0)
    s_barrier
    s_sub_u32 s70, s61, 1
    s_cmp_lt_u32 s70, 2
    s_cselect_b32 s70, 1, 0
    v_lshrrev_b32 v166, 4, v1
    v_bfe_u32 v167, v1, 2, 2
    v_and_b32 v168, 3, v1
    v_mov_b32 v169, s3
    v_lshlrev_b32 v170, 3, v168
    s_and_b32 s71, s3, 2
    v_lshrrev_b32 v174, 1, v168
    v_add_u32 v174, s71, v174
    s_and_b32 s71, s3, 1
    s_lshl_b32 s71, s71, 3
    v_and_b32 v175, 1, v168
    v_lshl_add_u32 v175, v175, 4, s71
    s_cmp_lg_u32 s70, 0
    s_cselect_b64 vcc, -1, 0
    v_cndmask_b32 v169, v169, v174, vcc
    v_cndmask_b32 v170, v170, v175, vcc
    v_lshl_add_u32 v162, v166, 3, v167
    v_add_u32 v162, 0, v162
    v_lshrrev_b32 v174, 1, v162
    v_xor_b32 v174, v174, v162
    v_bfe_u32 v174, v174, 2, 1
    v_bfe_u32 v175, v162, 1, 1
    v_lshl_or_b32 v174, v174, 1, v175
    v_xor_b32 v174, v174, v169
    v_lshl_add_u32 v174, v174, 5, v170
    v_lshl_add_u32 v162, v162, 7, v174
    v_add_u32 v162, 73728, v162
    v_add_u32 v164, 0x9000, v162
    v_lshl_add_u32 v163, v166, 3, v167
    v_add_u32 v163, 4, v163
    v_lshrrev_b32 v174, 1, v163
    v_xor_b32 v174, v174, v163
    v_bfe_u32 v174, v174, 2, 1
    v_bfe_u32 v175, v163, 1, 1
    v_lshl_or_b32 v174, v174, 1, v175
    v_xor_b32 v174, v174, v169
    v_lshl_add_u32 v174, v174, 5, v170
    v_lshl_add_u32 v163, v163, 7, v174
    v_add_u32 v163, 73728, v163
    v_add_u32 v165, 0x9000, v163
    ds_read_b64_tr_b16 v[12:13], v162 offset:0
    ds_read_b64_tr_b16 v[14:15], v163 offset:0
    ds_read_b64_tr_b16 v[16:17], v162 offset:4096
    ds_read_b64_tr_b16 v[18:19], v163 offset:4096
    ds_read_b64_tr_b16 v[20:21], v162 offset:8192
    ds_read_b64_tr_b16 v[22:23], v163 offset:8192
    ds_read_b64_tr_b16 v[24:25], v162 offset:12288
    ds_read_b64_tr_b16 v[26:27], v163 offset:12288
    ds_read_b64_tr_b16 v[28:29], v162 offset:16384
    ds_read_b64_tr_b16 v[30:31], v163 offset:16384
    ds_read_b64_tr_b16 v[32:33], v162 offset:20480
    ds_read_b64_tr_b16 v[34:35], v163 offset:20480
    ds_read_b64_tr_b16 v[36:37], v162 offset:24576
    ds_read_b64_tr_b16 v[38:39], v163 offset:24576
    ds_read_b64_tr_b16 v[40:41], v162 offset:28672
    ds_read_b64_tr_b16 v[42:43], v163 offset:28672
    ds_read_b64_tr_b16 v[44:45], v162 offset:32768
    ds_read_b64_tr_b16 v[46:47], v163 offset:32768
    ds_read_b64_tr_b16 v[48:49], v164 offset:0
    ds_read_b64_tr_b16 v[50:51], v165 offset:0
    ds_read_b64_tr_b16 v[52:53], v164 offset:4096
    ds_read_b64_tr_b16 v[54:55], v165 offset:4096
    ds_read_b64_tr_b16 v[56:57], v164 offset:8192
    ds_read_b64_tr_b16 v[58:59], v165 offset:8192
    ds_read_b64_tr_b16 v[60:61], v164 offset:12288
    ds_read_b64_tr_b16 v[62:63], v165 offset:12288
    ds_read_b64_tr_b16 v[64:65], v164 offset:16384
    ds_read_b64_tr_b16 v[66:67], v165 offset:16384
    ds_read_b64_tr_b16 v[68:69], v164 offset:20480
    ds_read_b64_tr_b16 v[70:71], v165 offset:20480
    ds_read_b64_tr_b16 v[72:73], v164 offset:24576
    ds_read_b64_tr_b16 v[74:75], v165 offset:24576
    ds_read_b64_tr_b16 v[76:77], v164 offset:28672
    ds_read_b64_tr_b16 v[78:79], v165 offset:28672
    ds_read_b64_tr_b16 v[80:81], v164 offset:32768
    ds_read_b64_tr_b16 v[82:83], v165 offset:32768
    s_cmp_lg_u32 s61, 0
    s_cbranch_scc1 notmod_adaLN_cond__ssm_conv_s4d__mixer_s_mlp__prompt_17
    s_waitcnt lgkmcnt(15)
    v_mfma_f32_16x16x32_bf16 v[156:159], v[84:87], v[12:15], 0
    v_mfma_f32_16x16x32_bf16 v[156:159], v[88:91], v[16:19], v[156:159]
    v_mfma_f32_16x16x32_bf16 v[156:159], v[92:95], v[20:23], v[156:159]
    v_mfma_f32_16x16x32_bf16 v[156:159], v[96:99], v[24:27], v[156:159]
    v_mfma_f32_16x16x32_bf16 v[156:159], v[100:103], v[28:31], v[156:159]
    v_mfma_f32_16x16x32_bf16 v[156:159], v[104:107], v[32:35], v[156:159]
    v_mfma_f32_16x16x32_bf16 v[156:159], v[108:111], v[36:39], v[156:159]
    v_mfma_f32_16x16x32_bf16 v[156:159], v[112:115], v[40:43], v[156:159]
    v_mfma_f32_16x16x32_bf16 v[156:159], v[116:119], v[44:47], v[156:159]
    v_mfma_f32_16x16x32_bf16 v[156:159], v[120:123], v[48:51], v[156:159]
    s_waitcnt lgkmcnt(12)
    v_mfma_f32_16x16x32_bf16 v[156:159], v[124:127], v[52:55], v[156:159]
    v_mfma_f32_16x16x32_bf16 v[156:159], v[128:131], v[56:59], v[156:159]
    s_waitcnt lgkmcnt(8)
    v_mfma_f32_16x16x32_bf16 v[156:159], v[132:135], v[60:63], v[156:159]
    v_mfma_f32_16x16x32_bf16 v[156:159], v[136:139], v[64:67], v[156:159]
    s_waitcnt lgkmcnt(4)
    v_mfma_f32_16x16x32_bf16 v[156:159], v[140:143], v[68:71], v[156:159]
    v_mfma_f32_16x16x32_bf16 v[156:159], v[144:147], v[72:75], v[156:159]
    s_waitcnt lgkmcnt(0)
    v_mfma_f32_16x16x32_bf16 v[156:159], v[148:151], v[76:79], v[156:159]
    v_mfma_f32_16x16x32_bf16 v[156:159], v[152:155], v[80:83], v[156:159]
    s_lshl_b32 s71, s3, 6
    s_add_u32 s71, s71, 149504
    v_lshl_add_u32 v164, v11, 2, s71
    s_nop 4
    v_cvt_pk_bf16_f32 v162, v156, v156
    v_and_b32 v162, 0xffff0000, v162
    v_add_f32 v163, 1.0, v162
    v_cvt_pk_bf16_f32 v163, v163, v163
    v_and_b32 v163, 0xffff0000, v163
    s_mov_b64 vcc, 0
    s_sub_u32 s71, s62, 9
    s_cmp_lt_u32 s71, 9
    s_cselect_b64 vcc, -1, vcc
    s_sub_u32 s71, s62, 36
    s_cmp_lt_u32 s71, 9
    s_cselect_b64 vcc, -1, vcc
    v_cndmask_b32 v162, v162, v163, vcc
    ds_write_b32 v164, v162
    s_waitcnt lgkmcnt(0)
    s_barrier
    s_cmp_lg_u32 s3, 0
    s_cbranch_scc1 notw0_adaLN_cond__ssm_conv_s4d__mixer_s_mlp__prompt_19
    v_lshlrev_b32 v164, 3, v1
    v_add_u32 v162, 149504, v164
    ds_read_b64 v[162:163], v162
    s_lshl_b32 s71, s62, 8
    s_add_u32 s71, s71, 278528
    s_mov_b32 exec_hi, 0
    s_waitcnt lgkmcnt(0)
    buffer_store_dwordx2 v[162:163], v164, s[40:43], s71 offen sc1
    s_sub_u32 s71, s62, 27
    s_cmp_ge_u32 s71, 18
    s_cbranch_scc1 notw0_adaLN_cond__ssm_conv_s4d__mixer_s_mlp__prompt_19
    v_cvt_pk_bf16_f32 v156, v162, v163
    v_lshrrev_b32 v164, 1, v164
    s_lshl_b32 s71, s71, 7
    s_add_u32 s71, s71, 299008
    buffer_store_dword v156, v164, s[40:43], s71 offen sc1
    s_waitcnt vmcnt(0)
    s_mov_b64 exec, 1
    v_mov_b32 v156, 1
    buffer_atomic_add v156, v4, s[44:47], 12 offen offset:64 sc0 sc1
    s_waitcnt vmcnt(0)
    v_readfirstlane_b32 s58, v156
    s_nop 0
    s_cmp_lg_u32 s58, 17
    s_cbranch_scc1 notlast_adaLN_cond__ssm_conv_s4d__mixer_s_mlp__prompt_21
    buffer_store_dword v8, v4, s[44:47], 12 offen offset:192 sc1
notlast_adaLN_cond__ssm_conv_s4d__mixer_s_mlp__prompt_21:
    s_mov_b64 exec, -1
notw0_adaLN_cond__ssm_conv_s4d__mixer_s_mlp__prompt_19:
    s_mov_b64 exec, -1
    s_branch jobC_adaLN_cond__ssm_conv_s4d__mixer_s_mlp__prompt_3
notmod_adaLN_cond__ssm_conv_s4d__mixer_s_mlp__prompt_17:
    s_waitcnt lgkmcnt(0)
    s_lshl_b32 s71, s62, 2
    s_add_u32 s71, s71, s3
    s_mul_hi_u32 s76, s71, 715827883
    s_mul_i32 s77, s76, 6
    s_sub_u32 s77, s71, s77
    s_lshl_b32 s77, s77, 10
    s_mul_i32 s78, s76, 110592
    s_add_u32 s77, s77, s78
    s_mul_i32 s79, s76, 3
    s_sub_u32 s79, 18, s79
    s_cmp_eq_u32 s79, 18
    s_cselect_b32 s79, 0, s79
    s_cmp_eq_u32 s61, 1
    s_cselect_b32 s79, s79, 0
    s_cselect_b32 s78, 0, 1048576
    s_add_u32 s77, s77, s78
    s_add_u32 s77, s77, 15728640
    s_mul_i32 s76, s71, 18432
    s_add_u32 s76, s76, 17825792
    s_cmp_ge_u32 s61, 3
    s_cselect_b32 s77, s76, s77
    s_cselect_b32 s78, 1, 6
    s_lshl_b32 s78, s78, 10
    s_bitcmp0_b32 s61, 0
    s_cbranch_scc1 nocenter_adaLN_cond__ssm_conv_s4d__mixer_s_mlp__prompt_18
    buffer_load_dwordx4 v[168:171], v4, s[44:47], 0 offen offset:192 sc1
    v_mov_b32 v84, 0x3f803f80
    v_mov_b32 v85, 0x3f803f80
    v_mov_b32 v86, 0x3f803f80
    v_mov_b32 v87, 0x3f803f80
    s_nop 1
    v_mfma_f32_16x16x32_bf16 v[156:159], v[84:87], v[12:15], 0
    v_mfma_f32_16x16x32_bf16 v[156:159], v[84:87], v[16:19], v[156:159]
    v_mfma_f32_16x16x32_bf16 v[156:159], v[84:87], v[20:23], v[156:159]
    v_mfma_f32_16x16x32_bf16 v[156:159], v[84:87], v[24:27], v[156:159]
    v_mfma_f32_16x16x32_bf16 v[156:159], v[84:87], v[28:31], v[156:159]
    v_mfma_f32_16x16x32_bf16 v[156:159], v[84:87], v[32:35], v[156:159]
    v_mfma_f32_16x16x32_bf16 v[156:159], v[84:87], v[36:39], v[156:159]
    v_mfma_f32_16x16x32_bf16 v[156:159], v[84:87], v[40:43], v[156:159]
    v_mfma_f32_16x16x32_bf16 v[156:159], v[84:87], v[44:47], v[156:159]
    v_mfma_f32_16x16x32_bf16 v[156:159], v[84:87], v[48:51], v[156:159]
    v_mfma_f32_16x16x32_bf16 v[156:159], v[84:87], v[52:55], v[156:159]
    v_mfma_f32_16x16x32_bf16 v[156:159], v[84:87], v[56:59], v[156:159]
    v_mfma_f32_16x16x32_bf16 v[156:159], v[84:87], v[60:63], v[156:159]
    v_mfma_f32_16x16x32_bf16 v[156:159], v[84:87], v[64:67], v[156:159]
    v_mfma_f32_16x16x32_bf16 v[156:159], v[84:87], v[68:71], v[156:159]
    v_mfma_f32_16x16x32_bf16 v[156:159], v[84:87], v[72:75], v[156:159]
    v_mfma_f32_16x16x32_bf16 v[156:159], v[84:87], v[76:79], v[156:159]
    v_mfma_f32_16x16x32_bf16 v[156:159], v[84:87], v[80:83], v[156:159]
    s_nop 7
    v_mul_f32 v88, 0xbae38e39, v156
    s_mov_b32 s58, 0x3f80
    s_mov_b32 s56, 0x3f800000
    v_dot2_f32_bf16 v92, v12, s58, v88
    v_dot2_f32_bf16 v93, v12, s56, v88
    v_dot2_f32_bf16 v94, v13, s58, v88
    v_dot2_f32_bf16 v95, v13, s56, v88
    v_dot2_f32_bf16 v96, v14, s58, v88
    v_dot2_f32_bf16 v97, v14, s56, v88
    v_dot2_f32_bf16 v98, v15, s58, v88
    v_dot2_f32_bf16 v99, v15, s56, v88
    v_dot2_f32_bf16 v100, v16, s58, v88
    v_dot2_f32_bf16 v101, v16, s56, v88
    v_dot2_f32_bf16 v102, v17, s58, v88
    v_dot2_f32_bf16 v103, v17, s56, v88
    v_dot2_f32_bf16 v104, v18, s58, v88
    v_dot2_f32_bf16 v105, v18, s56, v88
    v_dot2_f32_bf16 v106, v19, s58, v88
    v_dot2_f32_bf16 v107, v19, s56, v88
    v_cvt_pk_bf16_f32 v12, v92, v93
    v_cvt_pk_bf16_f32 v13, v94, v95
    v_cvt_pk_bf16_f32 v14, v96, v97
    v_cvt_pk_bf16_f32 v15, v98, v99
    s_mul_i32 s76, s79, s78
    s_add_u32 s76, s76, s77
    s_add_u32 s79, s79, 1
    s_cmp_eq_u32 s79, 18
    s_cselect_b32 s79, 0, s79
    buffer_store_dwordx4 v[12:15], v9, s[40:43], s76 offen sc1
    v_dot2_f32_bf16 v92, v20, s58, v88
    v_dot2_f32_bf16 v93, v20, s56, v88
    v_dot2_f32_bf16 v94, v21, s58, v88
    v_dot2_f32_bf16 v95, v21, s56, v88
    v_dot2_f32_bf16 v96, v22, s58, v88
    v_dot2_f32_bf16 v97, v22, s56, v88
    v_dot2_f32_bf16 v98, v23, s58, v88
    v_dot2_f32_bf16 v99, v23, s56, v88
    v_cvt_pk_bf16_f32 v16, v100, v101
    v_cvt_pk_bf16_f32 v17, v102, v103
    v_cvt_pk_bf16_f32 v18, v104, v105
    v_cvt_pk_bf16_f32 v19, v106, v107
    s_mul_i32 s76, s79, s78
    s_add_u32 s76, s76, s77
    s_add_u32 s79, s79, 1
    s_cmp_eq_u32 s79, 18
    s_cselect_b32 s79, 0, s79
    buffer_store_dwordx4 v[16:19], v9, s[40:43], s76 offen sc1
    v_dot2_f32_bf16 v100, v24, s58, v88
    v_dot2_f32_bf16 v101, v24, s56, v88
    v_dot2_f32_bf16 v102, v25, s58, v88
    v_dot2_f32_bf16 v103, v25, s56, v88
    v_dot2_f32_bf16 v104, v26, s58, v88
    v_dot2_f32_bf16 v105, v26, s56, v88
    v_dot2_f32_bf16 v106, v27, s58, v88
    v_dot2_f32_bf16 v107, v27, s56, v88
    v_cvt_pk_bf16_f32 v20, v92, v93
    v_cvt_pk_bf16_f32 v21, v94, v95
    v_cvt_pk_bf16_f32 v22, v96, v97
    v_cvt_pk_bf16_f32 v23, v98, v99
    s_mul_i32 s76, s79, s78
    s_add_u32 s76, s76, s77
    s_add_u32 s79, s79, 1
    s_cmp_eq_u32 s79, 18
    s_cselect_b32 s79, 0, s79
    buffer_store_dwordx4 v[20:23], v9, s[40:43], s76 offen sc1
    v_dot2_f32_bf16 v92, v28, s58, v88
    v_dot2_f32_bf16 v93, v28, s56, v88
    v_dot2_f32_bf16 v94, v29, s58, v88
    v_dot2_f32_bf16 v95, v29, s56, v88
    v_dot2_f32_bf16 v96, v30, s58, v88
    v_dot2_f32_bf16 v97, v30, s56, v88
    v_dot2_f32_bf16 v98, v31, s58, v88
    v_dot2_f32_bf16 v99, v31, s56, v88
    v_cvt_pk_bf16_f32 v24, v100, v101
    v_cvt_pk_bf16_f32 v25, v102, v103
    v_cvt_pk_bf16_f32 v26, v104, v105
    v_cvt_pk_bf16_f32 v27, v106, v107
    s_mul_i32 s76, s79, s78
    s_add_u32 s76, s76, s77
    s_add_u32 s79, s79, 1
    s_cmp_eq_u32 s79, 18
    s_cselect_b32 s79, 0, s79
    buffer_store_dwordx4 v[24:27], v9, s[40:43], s76 offen sc1
    v_dot2_f32_bf16 v100, v32, s58, v88
    v_dot2_f32_bf16 v101, v32, s56, v88
    v_dot2_f32_bf16 v102, v33, s58, v88
    v_dot2_f32_bf16 v103, v33, s56, v88
    v_dot2_f32_bf16 v104, v34, s58, v88
    v_dot2_f32_bf16 v105, v34, s56, v88
    v_dot2_f32_bf16 v106, v35, s58, v88
    v_dot2_f32_bf16 v107, v35, s56, v88
    v_cvt_pk_bf16_f32 v28, v92, v93
    v_cvt_pk_bf16_f32 v29, v94, v95
    v_cvt_pk_bf16_f32 v30, v96, v97
    v_cvt_pk_bf16_f32 v31, v98, v99
    s_mul_i32 s76, s79, s78
    s_add_u32 s76, s76, s77
    s_add_u32 s79, s79, 1
    s_cmp_eq_u32 s79, 18
    s_cselect_b32 s79, 0, s79
    buffer_store_dwordx4 v[28:31], v9, s[40:43], s76 offen sc1
    v_dot2_f32_bf16 v92, v36, s58, v88
    v_dot2_f32_bf16 v93, v36, s56, v88
    v_dot2_f32_bf16 v94, v37, s58, v88
    v_dot2_f32_bf16 v95, v37, s56, v88
    v_dot2_f32_bf16 v96, v38, s58, v88
    v_dot2_f32_bf16 v97, v38, s56, v88
    v_dot2_f32_bf16 v98, v39, s58, v88
    v_dot2_f32_bf16 v99, v39, s56, v88
    v_cvt_pk_bf16_f32 v32, v100, v101
    v_cvt_pk_bf16_f32 v33, v102, v103
    v_cvt_pk_bf16_f32 v34, v104, v105
    v_cvt_pk_bf16_f32 v35, v106, v107
    s_mul_i32 s76, s79, s78
    s_add_u32 s76, s76, s77
    s_add_u32 s79, s79, 1
    s_cmp_eq_u32 s79, 18
    s_cselect_b32 s79, 0, s79
    buffer_store_dwordx4 v[32:35], v9, s[40:43], s76 offen sc1
    v_dot2_f32_bf16 v100, v40, s58, v88
    v_dot2_f32_bf16 v101, v40, s56, v88
    v_dot2_f32_bf16 v102, v41, s58, v88
    v_dot2_f32_bf16 v103, v41, s56, v88
    v_dot2_f32_bf16 v104, v42, s58, v88
    v_dot2_f32_bf16 v105, v42, s56, v88
    v_dot2_f32_bf16 v106, v43, s58, v88
    v_dot2_f32_bf16 v107, v43, s56, v88
    v_cvt_pk_bf16_f32 v36, v92, v93
    v_cvt_pk_bf16_f32 v37, v94, v95
    v_cvt_pk_bf16_f32 v38, v96, v97
    v_cvt_pk_bf16_f32 v39, v98, v99
    s_mul_i32 s76, s79, s78
    s_add_u32 s76, s76, s77
    s_add_u32 s79, s79, 1
    s_cmp_eq_u32 s79, 18
    s_cselect_b32 s79, 0, s79
    buffer_store_dwordx4 v[36:39], v9, s[40:43], s76 offen sc1
    v_dot2_f32_bf16 v92, v44, s58, v88
    v_dot2_f32_bf16 v93, v44, s56, v88
    v_dot2_f32_bf16 v94, v45, s58, v88
    v_dot2_f32_bf16 v95, v45, s56, v88
    v_dot2_f32_bf16 v96, v46, s58, v88
    v_dot2_f32_bf16 v97, v46, s56, v88
    v_dot2_f32_bf16 v98, v47, s58, v88
    v_dot2_f32_bf16 v99, v47, s56, v88
    v_cvt_pk_bf16_f32 v40, v100, v101
    v_cvt_pk_bf16_f32 v41, v102, v103
    v_cvt_pk_bf16_f32 v42, v104, v105
    v_cvt_pk_bf16_f32 v43, v106, v107
    s_mul_i32 s76, s79, s78
    s_add_u32 s76, s76, s77
    s_add_u32 s79, s79, 1
    s_cmp_eq_u32 s79, 18
    s_cselect_b32 s79, 0, s79
    buffer_store_dwordx4 v[40:43], v9, s[40:43], s76 offen sc1
    v_dot2_f32_bf16 v100, v48, s58, v88
    v_dot2_f32_bf16 v101, v48, s56, v88
    v_dot2_f32_bf16 v102, v49, s58, v88
    v_dot2_f32_bf16 v103, v49, s56, v88
    v_dot2_f32_bf16 v104, v50, s58, v88
    v_dot2_f32_bf16 v105, v50, s56, v88
    v_dot2_f32_bf16 v106, v51, s58, v88
    v_dot2_f32_bf16 v107, v51, s56, v88
    v_cvt_pk_bf16_f32 v44, v92, v93
    v_cvt_pk_bf16_f32 v45, v94, v95
    v_cvt_pk_bf16_f32 v46, v96, v97
    v_cvt_pk_bf16_f32 v47, v98, v99
    s_mul_i32 s76, s79, s78
    s_add_u32 s76, s76, s77
    s_add_u32 s79, s79, 1
    s_cmp_eq_u32 s79, 18
    s_cselect_b32 s79, 0, s79
    buffer_store_dwordx4 v[44:47], v9, s[40:43], s76 offen sc1
    v_dot2_f32_bf16 v92, v52, s58, v88
    v_dot2_f32_bf16 v93, v52, s56, v88
    v_dot2_f32_bf16 v94, v53, s58, v88
    v_dot2_f32_bf16 v95, v53, s56, v88
    v_dot2_f32_bf16 v96, v54, s58, v88
    v_dot2_f32_bf16 v97, v54, s56, v88
    v_dot2_f32_bf16 v98, v55, s58, v88
    v_dot2_f32_bf16 v99, v55, s56, v88
    v_cvt_pk_bf16_f32 v48, v100, v101
    v_cvt_pk_bf16_f32 v49, v102, v103
    v_cvt_pk_bf16_f32 v50, v104, v105
    v_cvt_pk_bf16_f32 v51, v106, v107
    s_mul_i32 s76, s79, s78
    s_add_u32 s76, s76, s77
    s_add_u32 s79, s79, 1
    s_cmp_eq_u32 s79, 18
    s_cselect_b32 s79, 0, s79
    buffer_store_dwordx4 v[48:51], v9, s[40:43], s76 offen sc1
    v_dot2_f32_bf16 v100, v56, s58, v88
    v_dot2_f32_bf16 v101, v56, s56, v88
    v_dot2_f32_bf16 v102, v57, s58, v88
    v_dot2_f32_bf16 v103, v57, s56, v88
    v_dot2_f32_bf16 v104, v58, s58, v88
    v_dot2_f32_bf16 v105, v58, s56, v88
    v_dot2_f32_bf16 v106, v59, s58, v88
    v_dot2_f32_bf16 v107, v59, s56, v88
    v_cvt_pk_bf16_f32 v52, v92, v93
    v_cvt_pk_bf16_f32 v53, v94, v95
    v_cvt_pk_bf16_f32 v54, v96, v97
    v_cvt_pk_bf16_f32 v55, v98, v99
    s_mul_i32 s76, s79, s78
    s_add_u32 s76, s76, s77
    s_add_u32 s79, s79, 1
    s_cmp_eq_u32 s79, 18
    s_cselect_b32 s79, 0, s79
    buffer_store_dwordx4 v[52:55], v9, s[40:43], s76 offen sc1
    v_dot2_f32_bf16 v92, v60, s58, v88
    v_dot2_f32_bf16 v93, v60, s56, v88
    v_dot2_f32_bf16 v94, v61, s58, v88
    v_dot2_f32_bf16 v95, v61, s56, v88
    v_dot2_f32_bf16 v96, v62, s58, v88
    v_dot2_f32_bf16 v97, v62, s56, v88
    v_dot2_f32_bf16 v98, v63, s58, v88
    v_dot2_f32_bf16 v99, v63, s56, v88
    v_cvt_pk_bf16_f32 v56, v100, v101
    v_cvt_pk_bf16_f32 v57, v102, v103
    v_cvt_pk_bf16_f32 v58, v104, v105
    v_cvt_pk_bf16_f32 v59, v106, v107
    s_mul_i32 s76, s79, s78
    s_add_u32 s76, s76, s77
    s_add_u32 s79, s79, 1
    s_cmp_eq_u32 s79, 18
    s_cselect_b32 s79, 0, s79
    buffer_store_dwordx4 v[56:59], v9, s[40:43], s76 offen sc1
    v_dot2_f32_bf16 v100, v64, s58, v88
    v_dot2_f32_bf16 v101, v64, s56, v88
    v_dot2_f32_bf16 v102, v65, s58, v88
    v_dot2_f32_bf16 v103, v65, s56, v88
    v_dot2_f32_bf16 v104, v66, s58, v88
    v_dot2_f32_bf16 v105, v66, s56, v88
    v_dot2_f32_bf16 v106, v67, s58, v88
    v_dot2_f32_bf16 v107, v67, s56, v88
    v_cvt_pk_bf16_f32 v60, v92, v93
    v_cvt_pk_bf16_f32 v61, v94, v95
    v_cvt_pk_bf16_f32 v62, v96, v97
    v_cvt_pk_bf16_f32 v63, v98, v99
    s_mul_i32 s76, s79, s78
    s_add_u32 s76, s76, s77
    s_add_u32 s79, s79, 1
    s_cmp_eq_u32 s79, 18
    s_cselect_b32 s79, 0, s79
    buffer_store_dwordx4 v[60:63], v9, s[40:43], s76 offen sc1
    v_dot2_f32_bf16 v92, v68, s58, v88
    v_dot2_f32_bf16 v93, v68, s56, v88
    v_dot2_f32_bf16 v94, v69, s58, v88
    v_dot2_f32_bf16 v95, v69, s56, v88
    v_dot2_f32_bf16 v96, v70, s58, v88
    v_dot2_f32_bf16 v97, v70, s56, v88
    v_dot2_f32_bf16 v98, v71, s58, v88
    v_dot2_f32_bf16 v99, v71, s56, v88
    v_cvt_pk_bf16_f32 v64, v100, v101
    v_cvt_pk_bf16_f32 v65, v102, v103
    v_cvt_pk_bf16_f32 v66, v104, v105
    v_cvt_pk_bf16_f32 v67, v106, v107
    s_mul_i32 s76, s79, s78
    s_add_u32 s76, s76, s77
    s_add_u32 s79, s79, 1
    s_cmp_eq_u32 s79, 18
    s_cselect_b32 s79, 0, s79
    buffer_store_dwordx4 v[64:67], v9, s[40:43], s76 offen sc1
    v_dot2_f32_bf16 v100, v72, s58, v88
    v_dot2_f32_bf16 v101, v72, s56, v88
    v_dot2_f32_bf16 v102, v73, s58, v88
    v_dot2_f32_bf16 v103, v73, s56, v88
    v_dot2_f32_bf16 v104, v74, s58, v88
    v_dot2_f32_bf16 v105, v74, s56, v88
    v_dot2_f32_bf16 v106, v75, s58, v88
    v_dot2_f32_bf16 v107, v75, s56, v88
    v_cvt_pk_bf16_f32 v68, v92, v93
    v_cvt_pk_bf16_f32 v69, v94, v95
    v_cvt_pk_bf16_f32 v70, v96, v97
    v_cvt_pk_bf16_f32 v71, v98, v99
    s_mul_i32 s76, s79, s78
    s_add_u32 s76, s76, s77
    s_add_u32 s79, s79, 1
    s_cmp_eq_u32 s79, 18
    s_cselect_b32 s79, 0, s79
    buffer_store_dwordx4 v[68:71], v9, s[40:43], s76 offen sc1
    v_dot2_f32_bf16 v92, v76, s58, v88
    v_dot2_f32_bf16 v93, v76, s56, v88
    v_dot2_f32_bf16 v94, v77, s58, v88
    v_dot2_f32_bf16 v95, v77, s56, v88
    v_dot2_f32_bf16 v96, v78, s58, v88
    v_dot2_f32_bf16 v97, v78, s56, v88
    v_dot2_f32_bf16 v98, v79, s58, v88
    v_dot2_f32_bf16 v99, v79, s56, v88
    v_cvt_pk_bf16_f32 v72, v100, v101
    v_cvt_pk_bf16_f32 v73, v102, v103
    v_cvt_pk_bf16_f32 v74, v104, v105
    v_cvt_pk_bf16_f32 v75, v106, v107
    s_mul_i32 s76, s79, s78
    s_add_u32 s76, s76, s77
    s_add_u32 s79, s79, 1
    s_cmp_eq_u32 s79, 18
    s_cselect_b32 s79, 0, s79
    buffer_store_dwordx4 v[72:75], v9, s[40:43], s76 offen sc1
    v_dot2_f32_bf16 v100, v80, s58, v88
    v_dot2_f32_bf16 v101, v80, s56, v88
    v_dot2_f32_bf16 v102, v81, s58, v88
    v_dot2_f32_bf16 v103, v81, s56, v88
    v_dot2_f32_bf16 v104, v82, s58, v88
    v_dot2_f32_bf16 v105, v82, s56, v88
    v_dot2_f32_bf16 v106, v83, s58, v88
    v_dot2_f32_bf16 v107, v83, s56, v88
    v_cvt_pk_bf16_f32 v76, v92, v93
    v_cvt_pk_bf16_f32 v77, v94, v95
    v_cvt_pk_bf16_f32 v78, v96, v97
    v_cvt_pk_bf16_f32 v79, v98, v99
    s_mul_i32 s76, s79, s78
    s_add_u32 s76, s76, s77
    s_add_u32 s79, s79, 1
    s_cmp_eq_u32 s79, 18
    s_cselect_b32 s79, 0, s79
    buffer_store_dwordx4 v[76:79], v9, s[40:43], s76 offen sc1
    v_cvt_pk_bf16_f32 v80, v100, v101
    v_cvt_pk_bf16_f32 v81, v102, v103
    v_cvt_pk_bf16_f32 v82, v104, v105
    v_cvt_pk_bf16_f32 v83, v106, v107
    s_mul_i32 s76, s79, s78
    s_add_u32 s76, s76, s77
    s_add_u32 s79, s79, 1
    s_cmp_eq_u32 s79, 18
    s_cselect_b32 s79, 0, s79
    buffer_store_dwordx4 v[80:83], v9, s[40:43], s76 offen sc1
    s_cmp_lg_u32 s61, 1
    s_cbranch_scc1 jobC_adaLN_cond__ssm_conv_s4d__mixer_s_mlp__prompt_3
    s_waitcnt vmcnt(0)
    s_barrier
    s_cmp_lg_u32 s3, 0
    s_cbranch_scc1 nosig_adaLN_cond__ssm_conv_s4d__mixer_s_mlp__prompt_23
    s_mov_b64 exec, 1
    v_mov_b32 v156, 1
    buffer_atomic_add v156, v4, s[44:47], 8 offen offset:64 sc0 sc1
    s_waitcnt vmcnt(0)
    v_readfirstlane_b32 s58, v156
    s_nop 0
    s_cmp_lg_u32 s58, 8
    s_cbranch_scc1 notlast_adaLN_cond__ssm_conv_s4d__mixer_s_mlp__prompt_24
    buffer_store_dword v8, v4, s[44:47], 8 offen offset:192 sc1
notlast_adaLN_cond__ssm_conv_s4d__mixer_s_mlp__prompt_24:
    s_mov_b64 exec, -1
nosig_adaLN_cond__ssm_conv_s4d__mixer_s_mlp__prompt_23:
pollm_adaLN_cond__ssm_conv_s4d__mixer_s_mlp__prompt_25:
    s_waitcnt vmcnt(0)
    v_and_b32 v171, v171, v168
    s_nop 0
    v_readfirstlane_b32 s58, v171
    s_nop 0
    s_cmp_ge_u32 s58, 1
    s_cbranch_scc1 gotm_adaLN_cond__ssm_conv_s4d__mixer_s_mlp__prompt_26
    s_sleep 2
    buffer_load_dwordx4 v[168:171], v4, s[44:47], 0 offen offset:192 sc1
    s_add_u32 s59, s59, 1
    s_cmp_lt_u32 s59, 40000
    s_cbranch_scc1 pollm_adaLN_cond__ssm_conv_s4d__mixer_s_mlp__prompt_25
    s_branch all_done
gotm_adaLN_cond__ssm_conv_s4d__mixer_s_mlp__prompt_26:
    v_and_b32 v162, 1, v11
    v_xor_b32 v162, 1, v162
    v_mul_u32_u24 v162, 1152, v162
    v_lshl_add_u32 v162, v10, 4, v162
    s_mov_b32 s58, 299008
    buffer_load_dwordx4 v[84:87], v162, s[40:43], s58 offen offset:0 sc1
    buffer_load_dwordx4 v[88:91], v162, s[40:43], s58 offen offset:64 sc1
    buffer_load_dwordx4 v[92:95], v162, s[40:43], s58 offen offset:128 sc1
    buffer_load_dwordx4 v[96:99], v162, s[40:43], s58 offen offset:192 sc1
    buffer_load_dwordx4 v[100:103], v162, s[40:43], s58 offen offset:256 sc1
    buffer_load_dwordx4 v[104:107], v162, s[40:43], s58 offen offset:320 sc1
    buffer_load_dwordx4 v[108:111], v162, s[40:43], s58 offen offset:384 sc1
    buffer_load_dwordx4 v[112:115], v162, s[40:43], s58 offen offset:448 sc1
    buffer_load_dwordx4 v[116:119], v162, s[40:43], s58 offen offset:512 sc1
    buffer_load_dwordx4 v[120:123], v162, s[40:43], s58 offen offset:576 sc1
    buffer_load_dwordx4 v[124:127], v162, s[40:43], s58 offen offset:640 sc1
    buffer_load_dwordx4 v[128:131], v162, s[40:43], s58 offen offset:704 sc1
    buffer_load_dwordx4 v[132:135], v162, s[40:43], s58 offen offset:768 sc1
    buffer_load_dwordx4 v[136:139], v162, s[40:43], s58 offen offset:832 sc1
    buffer_load_dwordx4 v[140:143], v162, s[40:43], s58 offen offset:896 sc1
    buffer_load_dwordx4 v[144:147], v162, s[40:43], s58 offen offset:960 sc1
    buffer_load_dwordx4 v[148:151], v162, s[40:43], s58 offen offset:1024 sc1
    buffer_load_dwordx4 v[152:155], v162, s[40:43], s58 offen offset:1088 sc1
    s_lshr_b32 s76, s3, 1
    s_lshl_b32 s76, s76, 7
    s_and_b32 s58, s3, 1
    s_lshl_b32 s58, s58, 4
    s_add_u32 s76, s76, s58
    s_add_u32 s76, s76, 147456
    v_lshrrev_b32 v163, 2, v11
    v_and_b32 v164, 3, v11
    v_lshlrev_b32 v164, 2, v164
    v_lshl_add_u32 v163, v163, 5, v164
    v_add_u32 v163, s76, v163
    s_waitcnt vmcnt(17)
    v_mfma_f32_16x16x32_bf16 v[156:159], v[84:87], v[12:15], 0
    s_waitcnt vmcnt(16)
    v_mfma_f32_16x16x32_bf16 v[156:159], v[88:91], v[16:19], v[156:159]
    s_waitcnt vmcnt(15)
    v_mfma_f32_16x16x32_bf16 v[156:159], v[92:95], v[20:23], v[156:159]
    s_waitcnt vmcnt(14)
    v_mfma_f32_16x16x32_bf16 v[156:159], v[96:99], v[24:27], v[156:159]
    s_waitcnt vmcnt(13)
    v_mfma_f32_16x16x32_bf16 v[156:159], v[100:103], v[28:31], v[156:159]
    s_waitcnt vmcnt(12)
    v_mfma_f32_16x16x32_bf16 v[156:159], v[104:107], v[32:35], v[156:159]
    s_waitcnt vmcnt(11)
    v_mfma_f32_16x16x32_bf16 v[156:159], v[108:111], v[36:39], v[156:159]
    s_waitcnt vmcnt(10)
    v_mfma_f32_16x16x32_bf16 v[156:159], v[112:115], v[40:43], v[156:159]
    s_waitcnt vmcnt(9)
    v_mfma_f32_16x16x32_bf16 v[156:159], v[116:119], v[44:47], v[156:159]
    s_waitcnt vmcnt(8)
    v_mfma_f32_16x16x32_bf16 v[156:159], v[120:123], v[48:51], v[156:159]
    s_waitcnt vmcnt(7)
    v_mfma_f32_16x16x32_bf16 v[156:159], v[124:127], v[52:55], v[156:159]
    s_waitcnt vmcnt(6)
    v_mfma_f32_16x16x32_bf16 v[156:159], v[128:131], v[56:59], v[156:159]
    s_waitcnt vmcnt(5)
    v_mfma_f32_16x16x32_bf16 v[156:159], v[132:135], v[60:63], v[156:159]
    s_waitcnt vmcnt(4)
    v_mfma_f32_16x16x32_bf16 v[156:159], v[136:139], v[64:67], v[156:159]
    s_waitcnt vmcnt(3)
    v_mfma_f32_16x16x32_bf16 v[156:159], v[140:143], v[68:71], v[156:159]
    s_waitcnt vmcnt(2)
    v_mfma_f32_16x16x32_bf16 v[156:159], v[144:147], v[72:75], v[156:159]
    s_waitcnt vmcnt(1)
    v_mfma_f32_16x16x32_bf16 v[156:159], v[148:151], v[76:79], v[156:159]
    s_waitcnt vmcnt(0)
    v_mfma_f32_16x16x32_bf16 v[156:159], v[152:155], v[80:83], v[156:159]
    s_nop 7
    ds_write2st64_b32 v163, v156, v157 offset0:0 offset1:1
    s_waitcnt lgkmcnt(0)
    s_barrier
    s_cmp_lg_u32 s3, 0
    s_cbranch_scc1 stored_adaLN_cond__ssm_conv_s4d__mixer_s_mlp__prompt_22
    v_add_u32 v162, 147456, v9
    ds_read_b128 v[156:159], v162
    v_mul_u32_u24 v163, 2304, v10
    v_lshl_add_u32 v163, v11, 4, v163
    s_lshl_b32 s76, s62, 8
    s_add_u32 s76, s76, 292352
    s_mov_b32 exec_hi, 0
    s_waitcnt lgkmcnt(0)
    buffer_store_dwordx4 v[156:159], v163, s[40:43], s76 offen sc1
    s_mov_b32 s76, 39424
    s_mov_b64 exec, 1
    s_waitcnt vmcnt(0)
    buffer_atomic_add v8, v4, s[40:43], s76 offen sc1
    s_mov_b64 exec, -1
stored_adaLN_cond__ssm_conv_s4d__mixer_s_mlp__prompt_22:
    s_branch jobC_adaLN_cond__ssm_conv_s4d__mixer_s_mlp__prompt_3
nocenter_adaLN_cond__ssm_conv_s4d__mixer_s_mlp__prompt_18:
    v_lshlrev_b32 v166, 4, v1
    s_mov_b32 s81, s79
    s_mul_i32 s80, s81, s78
    s_add_u32 s80, s80, s77
    s_add_u32 s81, s81, 1
    s_cmp_eq_u32 s81, 18
    s_cselect_b32 s81, 0, s81
    buffer_store_dwordx4 v[12:15], v166, s[40:43], s80 offen sc1
    s_mul_i32 s80, s81, s78
    s_add_u32 s80, s80, s77
    s_add_u32 s81, s81, 1
    s_cmp_eq_u32 s81, 18
    s_cselect_b32 s81, 0, s81
    buffer_store_dwordx4 v[16:19], v166, s[40:43], s80 offen sc1
    s_mul_i32 s80, s81, s78
    s_add_u32 s80, s80, s77
    s_add_u32 s81, s81, 1
    s_cmp_eq_u32 s81, 18
    s_cselect_b32 s81, 0, s81
    buffer_store_dwordx4 v[20:23], v166, s[40:43], s80 offen sc1
    s_mul_i32 s80, s81, s78
    s_add_u32 s80, s80, s77
    s_add_u32 s81, s81, 1
    s_cmp_eq_u32 s81, 18
    s_cselect_b32 s81, 0, s81
    buffer_store_dwordx4 v[24:27], v166, s[40:43], s80 offen sc1
    s_mul_i32 s80, s81, s78
    s_add_u32 s80, s80, s77
    s_add_u32 s81, s81, 1
    s_cmp_eq_u32 s81, 18
    s_cselect_b32 s81, 0, s81
    buffer_store_dwordx4 v[28:31], v166, s[40:43], s80 offen sc1
    s_mul_i32 s80, s81, s78
    s_add_u32 s80, s80, s77
    s_add_u32 s81, s81, 1
    s_cmp_eq_u32 s81, 18
    s_cselect_b32 s81, 0, s81
    buffer_store_dwordx4 v[32:35], v166, s[40:43], s80 offen sc1
    s_mul_i32 s80, s81, s78
    s_add_u32 s80, s80, s77
    s_add_u32 s81, s81, 1
    s_cmp_eq_u32 s81, 18
    s_cselect_b32 s81, 0, s81
    buffer_store_dwordx4 v[36:39], v166, s[40:43], s80 offen sc1
    s_mul_i32 s80, s81, s78
    s_add_u32 s80, s80, s77
    s_add_u32 s81, s81, 1
    s_cmp_eq_u32 s81, 18
    s_cselect_b32 s81, 0, s81
    buffer_store_dwordx4 v[40:43], v166, s[40:43], s80 offen sc1
    s_mul_i32 s80, s81, s78
    s_add_u32 s80, s80, s77
    s_add_u32 s81, s81, 1
    s_cmp_eq_u32 s81, 18
    s_cselect_b32 s81, 0, s81
    buffer_store_dwordx4 v[44:47], v166, s[40:43], s80 offen sc1
    s_mul_i32 s80, s81, s78
    s_add_u32 s80, s80, s77
    s_add_u32 s81, s81, 1
    s_cmp_eq_u32 s81, 18
    s_cselect_b32 s81, 0, s81
    buffer_store_dwordx4 v[48:51], v166, s[40:43], s80 offen sc1
    s_mul_i32 s80, s81, s78
    s_add_u32 s80, s80, s77
    s_add_u32 s81, s81, 1
    s_cmp_eq_u32 s81, 18
    s_cselect_b32 s81, 0, s81
    buffer_store_dwordx4 v[52:55], v166, s[40:43], s80 offen sc1
    s_mul_i32 s80, s81, s78
    s_add_u32 s80, s80, s77
    s_add_u32 s81, s81, 1
    s_cmp_eq_u32 s81, 18
    s_cselect_b32 s81, 0, s81
    buffer_store_dwordx4 v[56:59], v166, s[40:43], s80 offen sc1
    s_mul_i32 s80, s81, s78
    s_add_u32 s80, s80, s77
    s_add_u32 s81, s81, 1
    s_cmp_eq_u32 s81, 18
    s_cselect_b32 s81, 0, s81
    buffer_store_dwordx4 v[60:63], v166, s[40:43], s80 offen sc1
    s_mul_i32 s80, s81, s78
    s_add_u32 s80, s80, s77
    s_add_u32 s81, s81, 1
    s_cmp_eq_u32 s81, 18
    s_cselect_b32 s81, 0, s81
    buffer_store_dwordx4 v[64:67], v166, s[40:43], s80 offen sc1
    s_mul_i32 s80, s81, s78
    s_add_u32 s80, s80, s77
    s_add_u32 s81, s81, 1
    s_cmp_eq_u32 s81, 18
    s_cselect_b32 s81, 0, s81
    buffer_store_dwordx4 v[68:71], v166, s[40:43], s80 offen sc1
    s_mul_i32 s80, s81, s78
    s_add_u32 s80, s80, s77
    s_add_u32 s81, s81, 1
    s_cmp_eq_u32 s81, 18
    s_cselect_b32 s81, 0, s81
    buffer_store_dwordx4 v[72:75], v166, s[40:43], s80 offen sc1
    s_mul_i32 s80, s81, s78
    s_add_u32 s80, s80, s77
    s_add_u32 s81, s81, 1
    s_cmp_eq_u32 s81, 18
    s_cselect_b32 s81, 0, s81
    buffer_store_dwordx4 v[76:79], v166, s[40:43], s80 offen sc1
    s_mul_i32 s80, s81, s78
    s_add_u32 s80, s80, s77
    s_add_u32 s81, s81, 1
    s_cmp_eq_u32 s81, 18
    s_cselect_b32 s81, 0, s81
    buffer_store_dwordx4 v[80:83], v166, s[40:43], s80 offen sc1
jobC_adaLN_cond__ssm_conv_s4d__mixer_s_mlp__prompt_3:
    s_branch phase2
slow_adaLN_cond__ssm_conv_s4d__mixer_s_mlp__prompt_28:
    s_sleep 4
    buffer_load_dwordx2 v[38:39], v78, s[60:63], 0 offen offset:192 sc1
    s_waitcnt vmcnt(0)
    s_add_u32 s51, s51, 1
    s_cmp_lt_u32 s51, 40000
    s_cbranch_scc1 poll_adaLN_cond__ssm_conv_s4d__mixer_s_mlp__prompt_27
    s_branch all_done
again_adaLN_cond__ssm_conv_s4d__mixer_s_mlp__prompt_31:
    s_mov_b32 s42, 262144
    buffer_load_dwordx4 v[84:87], v34, s[56:59], s42 offen sc1
    s_mov_b32 s42, 266240
    buffer_load_dwordx4 v[88:91], v34, s[56:59], s42 offen sc1
    s_mov_b32 s42, 270336
    buffer_load_dwordx4 v[92:95], v34, s[56:59], s42 offen sc1
    s_mov_b32 s42, 274432
    buffer_load_dwordx4 v[96:99], v34, s[56:59], s42 offen sc1
    s_lshl_b32 s42, s40, 5
    s_add_u32 s42, s42, 303104
    buffer_load_dwordx2 v[4:5], v6, s[56:59], s42 offen sc1
    s_waitcnt vmcnt(0)
    v_and_b32 v35, v85, v87
    v_bitop3_b32 v35, v35, v89, v91 bitop3:0x80
    v_bitop3_b32 v35, v35, v93, v95 bitop3:0x80
    v_bitop3_b32 v35, v35, v97, v99 bitop3:0x80
    v_cmp_ne_u32 vcc, 1, v35
    s_nop 0
    s_cmp_eq_u64 vcc, 0
    s_cbranch_scc1 rows_adaLN_cond__ssm_conv_s4d__mixer_s_mlp__prompt_32
    s_sleep 2
    s_add_u32 s51, s51, 1
    s_cmp_lt_u32 s51, 40000
    s_cbranch_scc1 again_adaLN_cond__ssm_conv_s4d__mixer_s_mlp__prompt_31
    s_branch all_done
rows_adaLN_cond__ssm_conv_s4d__mixer_s_mlp__prompt_32:
    s_lshl_b32 s42, s40, 14
    s_add_u32 s42, s42, 1048576
    buffer_load_dwordx4 v[16:19], v34, s[56:59], s42 offen sc1
    s_add_u32 s42, s42, 4096
    buffer_load_dwordx4 v[20:23], v34, s[56:59], s42 offen sc1
    s_add_u32 s42, s42, 4096
    buffer_load_dwordx4 v[24:27], v34, s[56:59], s42 offen sc1
    s_add_u32 s42, s42, 4096
    buffer_load_dwordx4 v[28:31], v34, s[56:59], s42 offen sc1
    s_branch have_adaLN_cond__ssm_conv_s4d__mixer_s_mlp__prompt_30
slow_adaLN_cond__ssm_conv_s4d__mixer_s_mlp__prompt_35:
    s_sleep 2
    s_lshl_b32 s42, s40, 5
    s_add_u32 s42, s42, 303104
    buffer_load_dwordx2 v[4:5], v6, s[56:59], s42 offen sc1
    s_waitcnt vmcnt(0)
    s_add_u32 s51, s51, 1
    s_cmp_lt_u32 s51, 40000
    s_cbranch_scc1 gran_adaLN_cond__ssm_conv_s4d__mixer_s_mlp__prompt_33
    s_branch all_done
slow_adaLN_cond__ssm_conv_s4d__mixer_s_mlp__prompt_37:
    s_sleep 4
    buffer_load_dwordx2 v[38:39], v78, s[60:63], 0 offen offset:200 sc1
    s_waitcnt vmcnt(0)
    s_add_u32 s51, s51, 1
    s_cmp_lt_u32 s51, 40000
    s_cbranch_scc1 poll_adaLN_cond__ssm_conv_s4d__mixer_s_mlp__prompt_36
    s_branch all_done
slow_adaLN_cond__ssm_conv_s4d__mixer_s_mlp__prompt_40:
    s_sleep 16
    buffer_load_dwordx4 v[8:11], v6, s[8:11], 0 offen offset:192 sc1
    s_add_u32 s24, s24, 1
    s_cmp_lt_u32 s24, 40000
    s_cbranch_scc1 spin_adaLN_cond__ssm_conv_s4d__mixer_s_mlp__prompt_38
    s_branch all_done
slow_adaLN_cond__ssm_conv_s4d__mixer_s_mlp__prompt_48:
    s_sleep 16
    buffer_load_dwordx4 v[8:11], v6, s[8:11], 0 offen offset:192 sc1
    s_add_u32 s24, s24, 1
    s_cmp_lt_u32 s24, 40000
    s_cbranch_scc1 spin_adaLN_cond__ssm_conv_s4d__mixer_s_mlp__prompt_46
    s_branch all_done
havew1_adaLN_cond__ssm_conv_s4d__mixer_s_mlp__prompt_43_x:
    s_add_u32 m0, s40, 94720
    s_nop 0
    buffer_load_dwordx4 v4, s[4:7], s38 offen offset:0 sc1 lds
    buffer_load_dwordx4 v4, s[4:7], s38 offen offset:1024 sc1 lds
    buffer_load_dwordx4 v4, s[4:7], s38 offen offset:2048 sc1 lds
    s_add_u32 s38, s38, 12288
    s_add_u32 m0, s40, 107008
    s_nop 0
    buffer_load_dwordx4 v4, s[4:7], s38 offen offset:0 sc1 lds
    buffer_load_dwordx4 v4, s[4:7], s38 offen offset:1024 sc1 lds
    buffer_load_dwordx4 v4, s[4:7], s38 offen offset:2048 sc1 lds
    s_add_u32 s38, s38, 12288
    s_add_u32 m0, s40, 119296
    s_nop 0
    buffer_load_dwordx4 v4, s[4:7], s38 offen offset:0 sc1 lds
    buffer_load_dwordx4 v4, s[4:7], s38 offen offset:1024 sc1 lds
    buffer_load_dwordx4 v4, s[4:7], s38 offen offset:2048 sc1 lds
    s_add_u32 s38, s38, 12288
    s_add_u32 m0, s40, 131584
    s_nop 0
    buffer_load_dwordx4 v4, s[4:7], s38 offen offset:0 sc1 lds
    buffer_load_dwordx4 v4, s[4:7], s38 offen offset:1024 sc1 lds
    buffer_load_dwordx4 v4, s[4:7], s38 offen offset:2048 sc1 lds
    s_add_u32 s38, s38, 12288
    s_add_u32 m0, s40, 143872
    s_nop 0
    buffer_load_dwordx4 v4, s[4:7], s38 offen offset:0 sc1 lds
    buffer_load_dwordx4 v4, s[4:7], s38 offen offset:1024 sc1 lds
    buffer_load_dwordx4 v4, s[4:7], s38 offen offset:2048 sc1 lds
    s_add_u32 s38, s38, 12288
    s_waitcnt vmcnt(0)
    s_branch havew1_adaLN_cond__ssm_conv_s4d__mixer_s_mlp__prompt_43
slow_adaLN_cond__ssm_conv_s4d__mixer_s_mlp__prompt_54:
    s_mov_b32 s20, 39424
    buffer_load_dword v8, v6, s[4:7], s20 offen sc1
    s_waitcnt vmcnt(0)
    s_add_u32 s24, s24, 1
    s_cmp_lt_u32 s24, 40000
    s_cbranch_scc1 upoll_adaLN_cond__ssm_conv_s4d__mixer_s_mlp__prompt_53
    s_branch all_done
slow_adaLN_cond__ssm_conv_s4d__mixer_s_mlp__prompt_62:
    s_sleep 16
    buffer_load_dword v8, v13, s[4:7], 0 offen sc1
    s_add_u32 s24, s24, 1
    s_cmp_lt_u32 s24, 40000
    s_cbranch_scc1 spin_adaLN_cond__ssm_conv_s4d__mixer_s_mlp__prompt_60
    s_branch all_done
k2_idle:
    v_lshrrev_b32 v19, 3, v1
    v_bfe_u32 v46, v1, 5, 1
    s_and_b32 vcc_lo, s3, 1
    v_xor_b32 v46, vcc_lo, v46
    v_bfe_u32 v47, v1, 4, 1
    v_lshl_or_b32 v46, v46, 1, v47
    v_lshlrev_b32 v46, 1, v46
    v_and_b32 v47, 7, v1
    v_xor_b32 v46, v46, v47
    v_lshlrev_b32 v44, 4, v46
    s_mov_b32 s44, s26
    s_mov_b32 s45, s27
    s_mov_b32 s46, 5308416
    s_mov_b32 s47, 0x20000
    s_mul_hi_u32 s38, s2, 477218589
    s_mul_i32 s39, s38, 9
    s_sub_u32 s39, s2, s39
    s_lshl_b32 s39, s39, 7
    s_mul_i32 s20, s38, 663552
    s_add_u32 s39, s39, s20
    s_mov_b32 s20, 1152
    v_mad_u32_u24 v45, v19, s20, v44
    s_lshl_b32 s43, s20, 3
    s_mul_i32 s42, s43, s3
    s_add_u32 s42, s42, s39
    s_lshl_b32 s43, s43, 2
    s_lshl_b32 s48, s3, 10
    s_add_u32 m0, s48, 0
    s_nop 0
    buffer_load_dwordx4 v45, s[44:47], s42 offen nt lds
    s_add_u32 s42, s42, s43
    s_add_u32 m0, s48, 4096
    s_nop 0
    buffer_load_dwordx4 v45, s[44:47], s42 offen nt lds
    s_add_u32 s42, s42, s43
    s_add_u32 m0, s48, 8192
    s_nop 0
    buffer_load_dwordx4 v45, s[44:47], s42 offen nt lds
    s_add_u32 s42, s42, s43
    s_add_u32 m0, s48, 12288
    s_nop 0
    buffer_load_dwordx4 v45, s[44:47], s42 offen nt lds
    s_add_u32 s42, s42, s43
    s_add_u32 m0, s48, 16384
    s_nop 0
    buffer_load_dwordx4 v45, s[44:47], s42 offen nt lds
    s_add_u32 s42, s42, s43
    s_add_u32 m0, s48, 20480
    s_nop 0
    buffer_load_dwordx4 v45, s[44:47], s42 offen nt lds
    s_add_u32 s42, s42, s43
    s_add_u32 m0, s48, 24576
    s_nop 0
    buffer_load_dwordx4 v45, s[44:47], s42 offen nt lds
    s_add_u32 s42, s42, s43
    s_add_u32 m0, s48, 28672
    s_nop 0
    buffer_load_dwordx4 v45, s[44:47], s42 offen nt lds
    s_add_u32 s42, s42, s43
    s_add_u32 m0, s48, 32768
    s_nop 0
    buffer_load_dwordx4 v45, s[44:47], s42 offen nt lds
    s_add_u32 s42, s42, s43
    s_add_u32 m0, s48, 36864
    s_nop 0
    buffer_load_dwordx4 v45, s[44:47], s42 offen nt lds
    s_add_u32 s42, s42, s43
    s_add_u32 m0, s48, 40960
    s_nop 0
    buffer_load_dwordx4 v45, s[44:47], s42 offen nt lds
    s_add_u32 s42, s42, s43
    s_add_u32 m0, s48, 45056
    s_nop 0
    buffer_load_dwordx4 v45, s[44:47], s42 offen nt lds
    s_add_u32 s42, s42, s43
    s_add_u32 m0, s48, 49152
    s_nop 0
    buffer_load_dwordx4 v45, s[44:47], s42 offen nt lds
    s_add_u32 s42, s42, s43
    s_add_u32 m0, s48, 53248
    s_nop 0
    buffer_load_dwordx4 v45, s[44:47], s42 offen nt lds
    s_add_u32 s42, s42, s43
    s_add_u32 m0, s48, 57344
    s_nop 0
    buffer_load_dwordx4 v45, s[44:47], s42 offen nt lds
    s_add_u32 s42, s42, s43
    s_add_u32 m0, s48, 61440
    s_nop 0
    buffer_load_dwordx4 v45, s[44:47], s42 offen nt lds
    s_add_u32 s42, s42, s43
    s_add_u32 m0, s48, 65536
    s_nop 0
    buffer_load_dwordx4 v45, s[44:47], s42 offen nt lds
    s_add_u32 s42, s42, s43
    s_add_u32 m0, s48, 69632
    s_nop 0
    buffer_load_dwordx4 v45, s[44:47], s42 offen nt lds
    s_mul_hi_u32 s40, s2, 715827883
    s_mul_i32 s41, s40, 6
    s_sub_u32 s41, s2, s41
    s_cmp_ge_u32 s2, 48
    s_cbranch_scc1 nopart_adaLN_cond__ssm_conv_s4d__mixer_s_mlp__prompt_58
    s_mul_i32 s39, s41, 110592
    s_lshl_b32 s20, s40, 7
    s_add_u32 s39, s39, s20
    s_add_u32 s39, s39, 4644992
    s_mov_b32 s20, 1152
    v_mad_u32_u24 v45, v19, s20, v44
    s_lshl_b32 s43, s20, 3
    s_mul_i32 s42, s43, s3
    s_add_u32 s42, s42, s39
    s_lshl_b32 s43, s43, 2
    s_lshl_b32 s48, s3, 10
    s_add_u32 m0, s48, 73728
    s_nop 0
    buffer_load_dwordx4 v45, s[44:47], s42 offen nt lds
    s_add_u32 s42, s42, s43
    s_add_u32 m0, s48, 77824
    s_nop 0
    buffer_load_dwordx4 v45, s[44:47], s42 offen nt lds
    s_add_u32 s42, s42, s43
    s_add_u32 m0, s48, 81920
    s_nop 0
    buffer_load_dwordx4 v45, s[44:47], s42 offen nt lds
nopart_adaLN_cond__ssm_conv_s4d__mixer_s_mlp__prompt_58:
    v_lshrrev_b32 v45, 4, v1
    v_bfe_u32 v46, v1, 2, 2
    v_and_b32 v47, 3, v1
    v_mov_b32 v136, s3
    v_lshlrev_b32 v137, 3, v47
    v_lshl_add_u32 v132, v45, 2, v46
    v_add_u32 v132, 0, v132
    v_lshrrev_b32 v138, 1, v132
    v_xor_b32 v138, v138, v132
    v_bfe_u32 v138, v138, 2, 1
    v_bfe_u32 v139, v132, 1, 1
    v_lshl_or_b32 v138, v138, 1, v139
    v_xor_b32 v138, v138, v136
    v_lshl_add_u32 v138, v138, 5, v137
    v_lshl_add_u32 v132, v132, 7, v138
    v_add_u32 v132, 0, v132
    v_add_u32 v134, 0x9000, v132
    v_lshl_add_u32 v133, v45, 2, v46
    v_add_u32 v133, 16, v133
    v_lshrrev_b32 v138, 1, v133
    v_xor_b32 v138, v138, v133
    v_bfe_u32 v138, v138, 2, 1
    v_bfe_u32 v139, v133, 1, 1
    v_lshl_or_b32 v138, v138, 1, v139
    v_xor_b32 v138, v138, v136
    v_lshl_add_u32 v138, v138, 5, v137
    v_lshl_add_u32 v133, v133, 7, v138
    v_add_u32 v133, 0, v133
    v_add_u32 v135, 0x9000, v133
    v_lshrrev_b32 v45, 4, v1
    v_bfe_u32 v46, v1, 2, 2
    v_and_b32 v47, 3, v1
    v_mov_b32 v140, s3
    v_lshlrev_b32 v141, 3, v47
    v_lshl_add_u32 v136, v45, 2, v46
    v_add_u32 v136, 0, v136
    v_lshrrev_b32 v142, 1, v136
    v_xor_b32 v142, v142, v136
    v_bfe_u32 v142, v142, 2, 1
    v_bfe_u32 v143, v136, 1, 1
    v_lshl_or_b32 v142, v142, 1, v143
    v_xor_b32 v142, v142, v140
    v_lshl_add_u32 v142, v142, 5, v141
    v_lshl_add_u32 v136, v136, 7, v142
    v_add_u32 v136, 73728, v136
    v_add_u32 v138, 0x9000, v136
    v_lshl_add_u32 v137, v45, 2, v46
    v_add_u32 v137, 16, v137
    v_lshrrev_b32 v142, 1, v137
    v_xor_b32 v142, v142, v137
    v_bfe_u32 v142, v142, 2, 1
    v_bfe_u32 v143, v137, 1, 1
    v_lshl_or_b32 v142, v142, 1, v143
    v_xor_b32 v142, v142, v140
    v_lshl_add_u32 v142, v142, 5, v141
    v_lshl_add_u32 v137, v137, 7, v142
    v_add_u32 v137, 73728, v137
    v_add_u32 v139, 0x9000, v137
    s_waitcnt vmcnt(0)
    s_barrier
    ds_read_b64_tr_b16 v[48:49], v132 offset:0
    ds_read_b64_tr_b16 v[50:51], v133 offset:0
    ds_read_b64_tr_b16 v[52:53], v132 offset:4096
    ds_read_b64_tr_b16 v[54:55], v133 offset:4096
    ds_read_b64_tr_b16 v[56:57], v132 offset:8192
    ds_read_b64_tr_b16 v[58:59], v133 offset:8192
    ds_read_b64_tr_b16 v[60:61], v132 offset:12288
    ds_read_b64_tr_b16 v[62:63], v133 offset:12288
    ds_read_b64_tr_b16 v[64:65], v132 offset:16384
    ds_read_b64_tr_b16 v[66:67], v133 offset:16384
    ds_read_b64_tr_b16 v[68:69], v132 offset:20480
    ds_read_b64_tr_b16 v[70:71], v133 offset:20480
    ds_read_b64_tr_b16 v[72:73], v132 offset:24576
    ds_read_b64_tr_b16 v[74:75], v133 offset:24576
    ds_read_b64_tr_b16 v[76:77], v132 offset:28672
    ds_read_b64_tr_b16 v[78:79], v133 offset:28672
    ds_read_b64_tr_b16 v[80:81], v132 offset:32768
    ds_read_b64_tr_b16 v[82:83], v133 offset:32768
    ds_read_b64_tr_b16 v[84:85], v134 offset:0
    ds_read_b64_tr_b16 v[86:87], v135 offset:0
    ds_read_b64_tr_b16 v[88:89], v134 offset:4096
    ds_read_b64_tr_b16 v[90:91], v135 offset:4096
    ds_read_b64_tr_b16 v[92:93], v134 offset:8192
    ds_read_b64_tr_b16 v[94:95], v135 offset:8192
    ds_read_b64_tr_b16 v[96:97], v134 offset:12288
    ds_read_b64_tr_b16 v[98:99], v135 offset:12288
    ds_read_b64_tr_b16 v[100:101], v134 offset:16384
    ds_read_b64_tr_b16 v[102:103], v135 offset:16384
    ds_read_b64_tr_b16 v[104:105], v134 offset:20480
    ds_read_b64_tr_b16 v[106:107], v135 offset:20480
    ds_read_b64_tr_b16 v[108:109], v134 offset:24576
    ds_read_b64_tr_b16 v[110:111], v135 offset:24576
    ds_read_b64_tr_b16 v[112:113], v134 offset:28672
    ds_read_b64_tr_b16 v[114:115], v135 offset:28672
    ds_read_b64_tr_b16 v[116:117], v134 offset:32768
    ds_read_b64_tr_b16 v[118:119], v135 offset:32768
    ds_read_b64_tr_b16 v[120:121], v136 offset:0
    ds_read_b64_tr_b16 v[122:123], v137 offset:0
    ds_read_b64_tr_b16 v[124:125], v136 offset:4096
    ds_read_b64_tr_b16 v[126:127], v137 offset:4096
    ds_read_b64_tr_b16 v[128:129], v136 offset:8192
    ds_read_b64_tr_b16 v[130:131], v137 offset:8192
    s_lshl_b32 s39, s2, 2
    s_add_u32 s39, s39, s3
    s_mul_i32 s39, s39, 18432
    s_add_u32 s39, s39, 24117248
    v_lshlrev_b32 v45, 4, v1
    s_mov_b32 s42, s39
    s_waitcnt lgkmcnt(15)
    buffer_store_dwordx4 v[48:51], v45, s[4:7], s42 offen sc1
    s_add_u32 s42, s42, 1024
    buffer_store_dwordx4 v[52:55], v45, s[4:7], s42 offen sc1
    s_add_u32 s42, s42, 1024
    buffer_store_dwordx4 v[56:59], v45, s[4:7], s42 offen sc1
    s_add_u32 s42, s42, 1024
    buffer_store_dwordx4 v[60:63], v45, s[4:7], s42 offen sc1
    s_add_u32 s42, s42, 1024
    buffer_store_dwordx4 v[64:67], v45, s[4:7], s42 offen sc1
    s_add_u32 s42, s42, 1024
    buffer_store_dwordx4 v[68:71], v45, s[4:7], s42 offen sc1
    s_add_u32 s42, s42, 1024
    buffer_store_dwordx4 v[72:75], v45, s[4:7], s42 offen sc1
    s_add_u32 s42, s42, 1024
    buffer_store_dwordx4 v[76:79], v45, s[4:7], s42 offen sc1
    s_add_u32 s42, s42, 1024
    buffer_store_dwordx4 v[80:83], v45, s[4:7], s42 offen sc1
    s_add_u32 s42, s42, 1024
    buffer_store_dwordx4 v[84:87], v45, s[4:7], s42 offen sc1
    s_add_u32 s42, s42, 1024
    buffer_store_dwordx4 v[88:91], v45, s[4:7], s42 offen sc1
    s_add_u32 s42, s42, 1024
    buffer_store_dwordx4 v[92:95], v45, s[4:7], s42 offen sc1
    s_add_u32 s42, s42, 1024
    buffer_store_dwordx4 v[96:99], v45, s[4:7], s42 offen sc1
    s_add_u32 s42, s42, 1024
    s_waitcnt lgkmcnt(14)
    buffer_store_dwordx4 v[100:103], v45, s[4:7], s42 offen sc1
    s_add_u32 s42, s42, 1024
    s_waitcnt lgkmcnt(12)
    buffer_store_dwordx4 v[104:107], v45, s[4:7], s42 offen sc1
    s_add_u32 s42, s42, 1024
    s_waitcnt lgkmcnt(10)
    buffer_store_dwordx4 v[108:111], v45, s[4:7], s42 offen sc1
    s_add_u32 s42, s42, 1024
    s_waitcnt lgkmcnt(8)
    buffer_store_dwordx4 v[112:115], v45, s[4:7], s42 offen sc1
    s_add_u32 s42, s42, 1024
    s_waitcnt lgkmcnt(6)
    buffer_store_dwordx4 v[116:119], v45, s[4:7], s42 offen sc1
    s_lshl_b32 s39, s40, 2
    s_add_u32 s39, s39, s3
    s_mul_i32 s39, s39, 18432
    s_mul_i32 s20, s41, 3072
    s_add_u32 s39, s39, s20
    s_add_u32 s39, s39, 28835840
    s_cmp_ge_u32 s2, 48
    s_cselect_b32 s39, 67108864, s39
    v_lshlrev_b32 v45, 4, v1
    s_mov_b32 s42, s39
    s_waitcnt lgkmcnt(4)
    buffer_store_dwordx4 v[120:123], v45, s[4:7], s42 offen sc1
    s_add_u32 s42, s42, 1024
    s_waitcnt lgkmcnt(2)
    buffer_store_dwordx4 v[124:127], v45, s[4:7], s42 offen sc1
    s_add_u32 s42, s42, 1024
    s_waitcnt lgkmcnt(0)
    buffer_store_dwordx4 v[128:131], v45, s[4:7], s42 offen sc1
    s_waitcnt vmcnt(0)
    s_lshl_b32 s20, s38, 7
    s_add_u32 s20, s20, 36864
    s_mov_b64 exec, 1
    buffer_atomic_add v5, v6, s[4:7], s20 offen sc1
    s_mov_b64 exec, -1
    s_cmp_ge_u32 s2, 48
    s_cbranch_scc1 w4done_adaLN_cond__ssm_conv_s4d__mixer_s_mlp__prompt_59
    s_mov_b32 s38, 7
    s_lshl_b32 s20, s38, 7
    s_add_u32 s20, s20, 36864
    s_mov_b64 exec, 1
    buffer_atomic_add v5, v6, s[4:7], s20 offen sc1
    s_mov_b64 exec, -1
w4done_adaLN_cond__ssm_conv_s4d__mixer_s_mlp__prompt_59:
    buffer_load_dword v8, v13, s[4:7], 0 offen sc1
spin_adaLN_cond__ssm_conv_s4d__mixer_s_mlp__prompt_60:
    s_waitcnt vmcnt(0)
    v_cmp_eq_u32 vcc, 0, v8
    s_nop 0
    s_cmp_eq_u64 vcc, 0
    s_cbranch_scc0 slow_adaLN_cond__ssm_conv_s4d__mixer_s_mlp__prompt_62
    buffer_load_dwordx4 a[0:3], v4, s[12:15], s28 offen offset:0 sc1
    buffer_load_dwordx4 a[4:7], v4, s[12:15], s28 offen offset:1024 sc1
    buffer_load_dwordx4 a[8:11], v4, s[12:15], s28 offen offset:2048 sc1
    buffer_load_dwordx4 a[20:23], v7, s[12:15], s28 offen offset:1024 sc1
    buffer_load_dwordx4 a[24:27], v7, s[12:15], s28 offen offset:2048 sc1
    buffer_load_dwordx4 a[28:31], v7, s[12:15], s28 offen offset:3072 sc1
    buffer_load_dwordx4 a[36:39], v16, s[12:15], s28 offen offset:1024 sc1
    buffer_load_dwordx4 a[40:43], v16, s[12:15], s28 offen offset:2048 sc1
    buffer_load_dwordx4 a[44:47], v16, s[12:15], s28 offen offset:3072 sc1
    buffer_load_dwordx4 a[56:59], v17, s[12:15], s28 offen offset:2048 sc1
    buffer_load_dwordx4 a[60:63], v17, s[12:15], s28 offen offset:3072 sc1
    buffer_load_dwordx4 a[64:67], v18, s[12:15], s28 offen offset:0 sc1
    buffer_load_dwordx4 a[12:15], v4, s[12:15], s28 offen offset:3072 sc1
    buffer_load_dwordx4 a[48:51], v17, s[12:15], s28 offen offset:0 sc1
    buffer_load_dwordx4 a[16:19], v7, s[12:15], s28 offen offset:0 sc1
    buffer_load_dwordx4 a[32:35], v16, s[12:15], s28 offen offset:0 sc1
    buffer_load_dwordx4 a[52:55], v17, s[12:15], s28 offen offset:1024 sc1
    buffer_load_dwordx4 a[68:71], v18, s[12:15], s28 offen offset:1024 sc1
    s_add_u32 s28, s28, 18432
    buffer_load_dwordx4 a[72:75], v4, s[12:15], s28 offen offset:0 sc1
    buffer_load_dwordx4 a[76:79], v4, s[12:15], s28 offen offset:1024 sc1
    buffer_load_dwordx4 a[80:83], v4, s[12:15], s28 offen offset:2048 sc1
    buffer_load_dwordx4 a[92:95], v7, s[12:15], s28 offen offset:1024 sc1
    buffer_load_dwordx4 a[96:99], v7, s[12:15], s28 offen offset:2048 sc1
    buffer_load_dwordx4 a[100:103], v7, s[12:15], s28 offen offset:3072 sc1
    buffer_load_dwordx4 a[108:111], v16, s[12:15], s28 offen offset:1024 sc1
    buffer_load_dwordx4 a[112:115], v16, s[12:15], s28 offen offset:2048 sc1
    buffer_load_dwordx4 a[116:119], v16, s[12:15], s28 offen offset:3072 sc1
    buffer_load_dwordx4 a[128:131], v17, s[12:15], s28 offen offset:2048 sc1
    buffer_load_dwordx4 a[132:135], v17, s[12:15], s28 offen offset:3072 sc1
    buffer_load_dwordx4 a[136:139], v18, s[12:15], s28 offen offset:0 sc1
    buffer_load_dwordx4 a[84:87], v4, s[12:15], s28 offen offset:3072 sc1
    buffer_load_dwordx4 a[120:123], v17, s[12:15], s28 offen offset:0 sc1
    buffer_load_dwordx4 a[88:91], v7, s[12:15], s28 offen offset:0 sc1
    buffer_load_dwordx4 a[104:107], v16, s[12:15], s28 offen offset:0 sc1
    buffer_load_dwordx4 a[124:127], v17, s[12:15], s28 offen offset:1024 sc1
    buffer_load_dwordx4 a[140:143], v18, s[12:15], s28 offen offset:1024 sc1
    s_branch k2_phase_e
slow_adaLN_cond__ssm_conv_s4d__mixer_s_mlp__prompt_69:
    s_mov_b32 s21, 40960
    buffer_load_dword v8, v14, s[4:7], s21 offen sc1
    s_waitcnt vmcnt(0)
    s_add_u32 s24, s24, 1
    s_cmp_lt_u32 s24, 40000
    s_cbranch_scc1 chk_adaLN_cond__ssm_conv_s4d__mixer_s_mlp__prompt_68
    s_branch all_done
slow_adaLN_cond__ssm_conv_s4d__mixer_s_mlp__prompt_71:
    s_mov_b32 s21, 41472
    buffer_load_dword v8, v14, s[4:7], s21 offen sc1
    s_waitcnt vmcnt(0)
    s_add_u32 s24, s24, 1
    s_cmp_lt_u32 s24, 40000
    s_cbranch_scc1 chk_adaLN_cond__ssm_conv_s4d__mixer_s_mlp__prompt_70
    s_branch all_done
slow_adaLN_cond__ssm_conv_s4d__mixer_s_mlp__prompt_73:
    s_mov_b32 s21, 41984
    buffer_load_dword v8, v14, s[4:7], s21 offen sc1
    s_waitcnt vmcnt(0)
    s_add_u32 s24, s24, 1
    s_cmp_lt_u32 s24, 40000
    s_cbranch_scc1 chk_adaLN_cond__ssm_conv_s4d__mixer_s_mlp__prompt_72
    s_branch all_done
slow_adaLN_cond__ssm_conv_s4d__mixer_s_mlp__prompt_75:
    s_mov_b32 s21, 42496
    buffer_load_dword v8, v14, s[4:7], s21 offen sc1
    s_waitcnt vmcnt(0)
    s_add_u32 s24, s24, 1
    s_cmp_lt_u32 s24, 40000
    s_cbranch_scc1 chk_adaLN_cond__ssm_conv_s4d__mixer_s_mlp__prompt_74
    s_branch all_done
slow_adaLN_cond__ssm_conv_s4d__mixer_s_mlp__prompt_77:
    s_mov_b32 s21, 43008
    buffer_load_dword v8, v14, s[4:7], s21 offen sc1
    s_waitcnt vmcnt(0)
    s_add_u32 s24, s24, 1
    s_cmp_lt_u32 s24, 40000
    s_cbranch_scc1 chk_adaLN_cond__ssm_conv_s4d__mixer_s_mlp__prompt_76
    s_branch all_done
slow_adaLN_cond__ssm_conv_s4d__mixer_s_mlp__prompt_79:
    s_mov_b32 s21, 43520
    buffer_load_dword v8, v14, s[4:7], s21 offen sc1
    s_waitcnt vmcnt(0)
    s_add_u32 s24, s24, 1
    s_cmp_lt_u32 s24, 40000
    s_cbranch_scc1 chk_adaLN_cond__ssm_conv_s4d__mixer_s_mlp__prompt_78
    s_branch all_done
slow_adaLN_cond__ssm_conv_s4d__mixer_s_mlp__prompt_81:
    s_mov_b32 s21, 44032
    buffer_load_dword v8, v14, s[4:7], s21 offen sc1
    s_waitcnt vmcnt(0)
    s_add_u32 s24, s24, 1
    s_cmp_lt_u32 s24, 40000
    s_cbranch_scc1 chk_adaLN_cond__ssm_conv_s4d__mixer_s_mlp__prompt_80
    s_branch all_done
slow_adaLN_cond__ssm_conv_s4d__mixer_s_mlp__prompt_83:
    s_mov_b32 s21, 44544
    buffer_load_dword v8, v14, s[4:7], s21 offen sc1
    s_waitcnt vmcnt(0)
    s_add_u32 s24, s24, 1
    s_cmp_lt_u32 s24, 40000
    s_cbranch_scc1 chk_adaLN_cond__ssm_conv_s4d__mixer_s_mlp__prompt_82
    s_branch all_done
code_end:
    s_endpgm
.section .rodata,"a"
.p2align 6
.amdhsa_kernel adaLN_cond__ssm_conv_s4d__mixer_s_mlp__prompt_kernel
  .amdhsa_next_free_vgpr 512
  .amdhsa_next_free_sgpr 102
  .amdhsa_accum_offset 256
  .amdhsa_group_segment_fixed_size 0
  .amdhsa_kernarg_size 136
  .amdhsa_user_sgpr_count 2
  .amdhsa_user_sgpr_kernarg_segment_ptr 1
  .amdhsa_system_sgpr_workgroup_id_x 1
  .amdhsa_float_denorm_mode_32 3
.end_amdhsa_kernel
```
